```python
import torch

def _softmax(x, axis=-1):
    return torch.softmax(x, dim=axis)
def _gelu(x):
    return torch.nn.functional.gelu(x, approximate="tanh")
def _silu(x):
    return torch.nn.functional.silu(x)
def _sigmoid(x):
    return torch.sigmoid(x)
def _layernorm(x, axis=-1, eps=1e-5):
    m = x.mean(dim=axis, keepdim=True)
    v = x.var(dim=axis, keepdim=True, unbiased=False)
    return (x - m) / torch.sqrt(v + eps)
def _scatter_add(tgt, idx, src, axis=0):
    return tgt.clone().index_add_(axis, idx, src)
def _segment_sum(src, seg, n):
    out = torch.zeros((n,) + src.shape[1:], dtype=src.dtype)
    return out.index_add_(0, seg, src)
def _pad(x, pw):
    flat = tuple(v for pair in reversed(pw) for v in pair)
    return torch.nn.functional.pad(x, flat)

kernel_name = 'parallel_sum__compressed_kv_cla__dense_activation_mish__prompt'

def setup_inputs():

    _w = (lambda a: (lambda t: t.to(torch.bfloat16) if t.is_floating_point() else t)(torch.as_tensor(a)))
    def _A_setup():
        B, H, Sq, Sk, D, M = 1, 32, 2048, 2048, 128, 512
        Dc = 4 * D
        return {
            "x": _w((lambda *s: torch.randn(*s, dtype=torch.bfloat16) * 0.05)(B, Sq, M)),
            "c_kv": _w((lambda *s: torch.randn(*s, dtype=torch.bfloat16) * 0.4)(B, Sk, Dc)),
            "w_q": _w((lambda *s: torch.randn(*s, dtype=torch.bfloat16) * 3.2)(M, H, D) * (M ** -0.5)),
            "w_uk": _w((lambda *s: torch.randn(*s, dtype=torch.bfloat16) * 3.2)(Dc, H, D) * (Dc ** -0.5)),
            "w_uv": _w((lambda *s: torch.randn(*s, dtype=torch.bfloat16) * 0.4)(Dc, H, D) * (Dc ** -0.5)),
            "w_o": _w((lambda *s: torch.randn(*s, dtype=torch.bfloat16) * 0.4)(H, D, M) * ((H * D) ** -0.5)),
        }
    _A_in = _A_setup()

    def _B_setup():
        B, S, D, F = 1, 2048, 512, 1376
        return {
            "x": _w((lambda *s: torch.randn(*s, dtype=torch.bfloat16) * 0.05)(B, S, D)),
            "w1": _w((lambda *s: torch.randn(*s, dtype=torch.bfloat16) * 0.8)(D, F) * (D ** -0.5)),
            "b1": _w((lambda *s: torch.randn(*s, dtype=torch.bfloat16) * 0.2)(F)),
            "w2": _w((lambda *s: torch.randn(*s, dtype=torch.bfloat16) * 0.1)(F, D) * (F ** -0.5)),
        }
    _B_in = _B_setup()

    return {
        "A_x": _A_in["x"],
        "A_c_kv": _A_in["c_kv"],
        "A_w_q": _A_in["w_q"],
        "A_w_uk": _A_in["w_uk"],
        "A_w_uv": _A_in["w_uv"],
        "A_w_o": _A_in["w_o"],
        "B_x": _B_in["x"],
        "B_w1": _B_in["w1"],
        "B_b1": _B_in["b1"],
        "B_w2": _B_in["w2"],
    }

def reference(A_x, A_c_kv, A_w_q, A_w_uk, A_w_uv, A_w_o, B_x, B_w1, B_b1, B_w2):
    def _A_ref(x, c_kv, w_q, w_uk, w_uv, w_o):
        B, Sq, M = x.shape[0], x.shape[1], x.shape[2]
        Sk = c_kv.shape[1]
        H, D = w_q.shape[1], w_q.shape[2]
        q = torch.einsum("bqm,mhd->bhqd", x, w_q)
        k = torch.einsum("bkc,chd->bhkd", c_kv, w_uk)
        v = torch.einsum("bkc,chd->bhkd", c_kv, w_uv)
        scores = torch.einsum("bhqd,bhkd->bhqk", q, k) * (D ** -0.5)
        off = Sk - Sq
        qi = torch.arange(Sq)[:, None]
        kj = torch.arange(Sk)[None, :]
        cmask = kj <= (qi + off)
        scores = torch.where(cmask[None, None], scores, -1e9)
        p = _softmax(scores, axis=-1)
        ctx = torch.einsum("bhqk,bhkd->bhqd", p, v)
        return torch.einsum("bhqd,hdm->bqm", ctx, w_o)

    def _B_ref(x, w1, b1, w2):
        h = torch.einsum("bsd,df->bsf", x, w1) + b1
        sp = torch.log1p(torch.exp(-torch.abs(h))) + torch.where(h > 0, h, torch.zeros_like(h))
        act = h * torch.tanh(sp)
        return torch.einsum("bsf,fd->bsd", act, w2)

    x = A_x
    xn = _layernorm(x, axis=-1)
    return x + _A_ref(xn, A_c_kv, A_w_q, A_w_uk, A_w_uv, A_w_o) + _B_ref(xn, B_w1, B_b1, B_w2)
```

```asm
; @launch grid=(256,1,1) block=(256,1,1) lds=163840
.amdgcn_target "amdgcn-amd-amdhsa--gfx950"
.text
.globl parallel_sum__compressed_kv_cla__dense_activation_mish__prompt_kernel
.p2align 8
.type parallel_sum__compressed_kv_cla__dense_activation_mish__prompt_kernel,@function
parallel_sum__compressed_kv_cla__dense_activation_mish__prompt_kernel:
    s_load_dwordx4 s[28:31], s[0:1], 0
    s_load_dwordx4 s[32:35], s[0:1], 24
    s_load_dwordx2 s[36:37], s[0:1], 96
    s_load_dwordx2 s[54:55], s[0:1], 16
    s_load_dwordx4 s[64:67], s[0:1], 56
    s_load_dwordx2 s[68:69], s[0:1], 88
    s_cmp_ge_u32 s2, 256
    s_cbranch_scc1 K3_END
    s_getpc_b64 s[38:39]
K1_PC:
    s_bfe_u32 s27, s2, 0x50003
    s_lshl_b32 s27, s27, 10
    v_lshlrev_b32 v24, 2, v0
    v_add_u32 v24, s27, v24
    global_load_dword v21, v24, s[38:39]
    v_lshrrev_b32 v1, 6, v0
    v_and_b32 v2, 63, v0
    v_readfirstlane_b32 s24, v1
    v_lshlrev_b32 v3, 4, v2
    s_and_b32 s58, s2, 7
    s_lshl_b32 s58, s58, 2
    s_bfe_u32 s59, s2, 0x20003
    s_add_u32 s25, s58, s59
    s_lshr_b32 s26, s2, 5
    v_lshrrev_b32 v24, 5, v2
    v_and_b32 v25, 31, v2
    v_lshlrev_b32 v26, 10, v24
    v_lshl_add_u32 v26, v25, 5, v26
    v_lshlrev_b32 v27, 9, v25
    v_lshl_add_u32 v27, v24, 4, v27
    v_lshrrev_b32 v24, 4, v2
    v_and_b32 v25, 7, v2
    v_xor_b32 v24, v24, v25
    v_lshlrev_b32 v24, 4, v24
    v_lshrrev_b32 v25, 3, v2
    v_lshl_add_u32 v4, v25, 10, v24
    v_xor_b32 v5, 64, v4
    v_add_u32 v5, 7168, v5
    v_bfe_u32 v24, v2, 4, 1
    v_lshlrev_b32 v24, 1, v24
    v_and_b32 v25, 7, v2
    v_xor_b32 v24, v24, v25
    v_lshlrev_b32 v24, 4, v24
    v_lshrrev_b32 v25, 3, v2
    v_mul_u32_u24 v25, 8192, v25
    v_add_u32 v10, v24, v25
    v_xor_b32 v24, 64, v24
    v_add_u32 v11, v24, v25
    v_add_u32 v11, 64512, v11
    s_lshl_b32 s58, s26, 18
    s_lshl_b32 s59, s24, 16
    s_add_u32 s58, s58, s59
    s_lshl_b32 s59, s24, 14
    s_add_u32 s59, s59, 98304
    s_add_u32 s27, s25, 0
    s_and_b32 s27, s27, 3
    s_lshl_b32 s40, s27, 14
    s_add_u32 s40, s40, s58
    s_lshl_b32 s44, s27, 11
    s_add_u32 s44, s44, s59
    s_add_u32 s27, s25, 1
    s_and_b32 s27, s27, 3
    s_lshl_b32 s41, s27, 14
    s_add_u32 s41, s41, s58
    s_lshl_b32 s45, s27, 11
    s_add_u32 s45, s45, s59
    s_add_u32 s27, s25, 2
    s_and_b32 s27, s27, 3
    s_lshl_b32 s42, s27, 14
    s_add_u32 s42, s42, s58
    s_lshl_b32 s46, s27, 11
    s_add_u32 s46, s46, s59
    s_add_u32 s27, s25, 3
    s_and_b32 s27, s27, 3
    s_lshl_b32 s43, s27, 14
    s_add_u32 s43, s43, s58
    s_lshl_b32 s47, s27, 11
    s_add_u32 s47, s47, s59
    s_lshl_b32 s48, s24, 17
    s_lshr_b32 s27, s2, 3
    s_lshl_b32 s27, s27, 2
    s_add_u32 s27, s27, s24
    s_and_b32 s49, s27, 63
    s_lshl_b32 s49, s49, 13
    s_lshr_b32 s27, s27, 6
    s_mul_i32 s27, s27, 1048576
    s_add_u32 s49, s49, s27
    s_and_b32 s27, s25, 3
    s_lshl_b32 s27, s27, 8
    s_sub_u32 s49, s49, s27
    s_lshl_b32 s56, s24, 14
    s_add_u32 s56, s56, 98304
    s_lshl_b32 s57, s24, 11
    s_lshl_b32 s63, s25, 8
    s_and_b32 s60, s26, 1
    s_lshl_b32 s60, s60, 7
    s_lshl_b32 s58, s2, 3
    s_lshl_b32 s59, s24, 1
    s_add_u32 s58, s58, s59
    s_lshl_b32 s62, s58, 10
    s_waitcnt lgkmcnt(0)
    s_mov_b32 s4, s30
    s_mov_b32 s5, s31
    s_mov_b32 s6, 2097152
    s_mov_b32 s7, 0x00020000
    buffer_load_dwordx4 v[20:23], v3, s[4:7], s62 offen
    buffer_load_dwordx4 v[20:23], v3, s[4:7], s62 offen offset:1024
    s_add_u32 m0, s44, 0
    s_add_u32 s58, s40, 0
    buffer_load_dwordx4 v4, s[4:7], s58 offen lds
    buffer_load_dwordx4 v5, s[4:7], s58 offen offset:1024 lds
    s_add_u32 m0, s44, 8192
    s_add_u32 s58, s40, 256
    buffer_load_dwordx4 v4, s[4:7], s58 offen lds
    buffer_load_dwordx4 v5, s[4:7], s58 offen offset:1024 lds
    s_add_u32 s12, s34, s63
    s_addc_u32 s13, s35, 0
    s_sub_u32 s14, 4194304, s63
    s_mov_b32 s15, 0x00020000
    s_add_u32 s59, s49, 0
    buffer_load_dwordx4 v[20:23], v3, s[12:15], s59 offen
    s_mov_b32 s20, s28
    s_mov_b32 s21, s29
    s_mov_b32 s22, 2097152
    s_mov_b32 s23, 0x00020000
    s_add_u32 s8, s32, s63
    s_addc_u32 s9, s33, 0
    s_sub_u32 s10, 4194304, s63
    s_mov_b32 s11, 0x00020000
    s_add_u32 m0, s45, 0
    s_add_u32 s58, s41, 0
    buffer_load_dwordx4 v4, s[4:7], s58 offen lds
    buffer_load_dwordx4 v5, s[4:7], s58 offen offset:1024 lds
    s_add_u32 m0, s46, 0
    s_add_u32 s58, s42, 0
    buffer_load_dwordx4 v4, s[4:7], s58 offen lds
    buffer_load_dwordx4 v5, s[4:7], s58 offen offset:1024 lds
    s_add_u32 m0, s47, 0
    s_add_u32 s58, s43, 0
    buffer_load_dwordx4 v4, s[4:7], s58 offen lds
    buffer_load_dwordx4 v5, s[4:7], s58 offen offset:1024 lds
    s_add_u32 m0, s57, 0
    s_add_u32 s59, s48, 0
    buffer_load_dwordx4 v10, s[12:15], s59 offen lds
    buffer_load_dwordx4 v11, s[12:15], s59 offen offset:1024 lds
    s_add_u32 m0, s57, 8192
    s_add_u32 s59, s48, 1048576
    buffer_load_dwordx4 v10, s[12:15], s59 offen lds
    buffer_load_dwordx4 v11, s[12:15], s59 offen offset:1024 lds
    s_add_u32 m0, s45, 8192
    s_add_u32 s58, s41, 256
    buffer_load_dwordx4 v4, s[4:7], s58 offen lds
    buffer_load_dwordx4 v5, s[4:7], s58 offen offset:1024 lds
    s_add_u32 m0, s46, 8192
    s_add_u32 s58, s42, 256
    buffer_load_dwordx4 v4, s[4:7], s58 offen lds
    buffer_load_dwordx4 v5, s[4:7], s58 offen offset:1024 lds
    s_add_u32 m0, s47, 8192
    s_add_u32 s58, s43, 256
    buffer_load_dwordx4 v4, s[4:7], s58 offen lds
    buffer_load_dwordx4 v5, s[4:7], s58 offen offset:1024 lds
    s_add_u32 s59, s49, 0
    buffer_load_dwordx4 v[20:23], v3, s[8:11], s59 offen
    s_add_u32 m0, s57, 16384
    s_add_u32 s59, s48, 128
    buffer_load_dwordx4 v10, s[12:15], s59 offen lds
    buffer_load_dwordx4 v11, s[12:15], s59 offen offset:1024 lds
    s_add_u32 m0, s57, 24576
    s_add_u32 s59, s48, 1048704
    buffer_load_dwordx4 v10, s[12:15], s59 offen lds
    buffer_load_dwordx4 v11, s[12:15], s59 offen offset:1024 lds
    buffer_load_dwordx4 v[192:195], v26, s[20:23], s62 offen
    buffer_load_dwordx4 v[196:199], v26, s[20:23], s62 offen offset:16
    s_mov_b32 s16, s36
    s_mov_b32 s17, s37
    s_mov_b32 s18, 268435456
    s_mov_b32 s19, 0x00020000
    v_lshrrev_b32 v24, 4, v2
    v_lshlrev_b32 v24, 10, v24
    v_bfe_u32 v25, v2, 2, 2
    v_lshl_add_u32 v24, v25, 7, v24
    v_and_b32 v25, 3, v2
    v_lshl_add_u32 v24, v25, 3, v24
    v_bfe_u32 v25, v2, 3, 2
    v_lshl_add_u32 v12, v25, 5, v24
    v_xor_b32 v13, 32, v12
    v_xor_b32 v14, 64, v12
    v_xor_b32 v15, 96, v12
    v_add_u32 v16, 0x10000, v12
    v_add_u32 v17, 0x10000, v13
    v_add_u32 v18, 0x10000, v14
    v_add_u32 v19, 0x10000, v15
    v_and_b32 v24, 15, v2
    v_bfe_u32 v25, v2, 1, 3
    v_lshrrev_b32 v1, 4, v2
    v_xor_b32 v25, v25, v1
    v_lshlrev_b32 v25, 4, v25
    v_lshl_add_u32 v24, v24, 7, v25
    v_add_u32 v8, s56, v24
    v_xor_b32 v9, 64, v8
    s_mov_b32 s61, 0x3e0293ee
    s_waitcnt vmcnt(17)
    ds_read_b128 a[128:131], v8 offset:0
    ds_read_b128 a[132:135], v9 offset:0
    ds_read_b128 a[144:147], v8 offset:2048
    ds_read_b128 a[148:151], v9 offset:2048
    ds_read_b128 a[160:163], v8 offset:4096
    ds_read_b128 a[164:167], v9 offset:4096
    ds_read_b128 a[176:179], v8 offset:6144
    ds_read_b128 a[180:183], v9 offset:6144
    s_waitcnt vmcnt(7)
    ds_read_b128 a[136:139], v8 offset:8192
    ds_read_b128 a[140:143], v9 offset:8192
    ds_read_b128 a[152:155], v8 offset:10240
    ds_read_b128 a[156:159], v9 offset:10240
    ds_read_b128 a[168:171], v8 offset:12288
    ds_read_b128 a[172:175], v9 offset:12288
    ds_read_b128 a[184:187], v8 offset:14336
    ds_read_b128 a[188:191], v9 offset:14336
    s_waitcnt vmcnt(13)
    s_barrier
    ds_read_b64_tr_b16 v[32:33], v12 offset:0
    ds_read_b64_tr_b16 v[34:35], v12 offset:512
    ds_read_b64_tr_b16 v[36:37], v12 offset:4096
    ds_read_b64_tr_b16 v[38:39], v12 offset:4608
    ds_read_b64_tr_b16 v[40:41], v12 offset:8192
    ds_read_b64_tr_b16 v[42:43], v12 offset:8704
    ds_read_b64_tr_b16 v[44:45], v12 offset:12288
    ds_read_b64_tr_b16 v[46:47], v12 offset:12800
    s_waitcnt lgkmcnt(4)
    v_mfma_f32_16x16x32_bf16 a[0:3], a[128:131], v[32:35], 0
    s_add_u32 m0, s57, 32768
    v_mfma_f32_16x16x32_bf16 a[0:3], a[132:135], v[36:39], a[0:3]
    ds_read_b64_tr_b16 v[48:49], v13 offset:0
    s_add_u32 s59, s48, 0
    s_waitcnt lgkmcnt(1)
    v_mfma_f32_16x16x32_bf16 a[0:3], a[136:139], v[40:43], a[0:3]
    ds_read_b64_tr_b16 v[50:51], v13 offset:512
    buffer_load_dwordx4 v10, s[8:11], s59 offen lds
    s_waitcnt vmcnt(1)
    v_mfma_f32_16x16x32_bf16 a[0:3], a[140:143], v[44:47], a[0:3]
    ds_read_b64_tr_b16 v[52:53], v13 offset:4096
    v_lshlrev_b32 v208, 16, v192
    v_and_b32 v209, 0xffff0000, v192
    v_mfma_f32_16x16x32_bf16 a[4:7], a[144:147], v[32:35], 0
    v_lshlrev_b32 v210, 16, v193
    v_and_b32 v211, 0xffff0000, v193
    v_mfma_f32_16x16x32_bf16 a[4:7], a[148:151], v[36:39], a[4:7]
    ds_read_b64_tr_b16 v[54:55], v13 offset:4608
    v_lshlrev_b32 v212, 16, v194
    v_and_b32 v213, 0xffff0000, v194
    v_mfma_f32_16x16x32_bf16 a[4:7], a[152:155], v[40:43], a[4:7]
    ds_read_b64_tr_b16 v[56:57], v13 offset:8192
    buffer_load_dwordx4 v11, s[8:11], s59 offen offset:1024 lds
    v_lshlrev_b32 v214, 16, v195
    v_mfma_f32_16x16x32_bf16 a[4:7], a[156:159], v[44:47], a[4:7]
    ds_read_b64_tr_b16 v[58:59], v13 offset:8704
    v_and_b32 v215, 0xffff0000, v195
    v_lshlrev_b32 v216, 16, v196
    v_mfma_f32_16x16x32_bf16 a[8:11], a[160:163], v[32:35], 0
    s_add_u32 m0, s57, 40960
    v_and_b32 v217, 0xffff0000, v196
    v_lshlrev_b32 v218, 16, v197
    v_mfma_f32_16x16x32_bf16 a[8:11], a[164:167], v[36:39], a[8:11]
    ds_read_b64_tr_b16 v[60:61], v13 offset:12288
    s_add_u32 s59, s48, 1048576
    v_and_b32 v219, 0xffff0000, v197
    v_lshlrev_b32 v220, 16, v198
    v_mfma_f32_16x16x32_bf16 a[8:11], a[168:171], v[40:43], a[8:11]
    ds_read_b64_tr_b16 v[62:63], v13 offset:12800
    buffer_load_dwordx4 v10, s[8:11], s59 offen lds
    v_and_b32 v221, 0xffff0000, v198
    v_mfma_f32_16x16x32_bf16 a[8:11], a[172:175], v[44:47], a[8:11]
    v_lshlrev_b32 v222, 16, v199
    v_and_b32 v223, 0xffff0000, v199
    v_mfma_f32_16x16x32_bf16 a[12:15], a[176:179], v[32:35], 0
    v_add_f32 v200, v208, v209
    v_add_f32 v200, v200, v210
    v_mfma_f32_16x16x32_bf16 a[12:15], a[180:183], v[36:39], a[12:15]
    v_add_f32 v200, v200, v211
    v_mfma_f32_16x16x32_bf16 a[12:15], a[184:187], v[40:43], a[12:15]
    buffer_load_dwordx4 v11, s[8:11], s59 offen offset:1024 lds
    v_add_f32 v200, v200, v212
    v_add_f32 v200, v200, v213
    v_mfma_f32_16x16x32_bf16 a[12:15], a[188:191], v[44:47], a[12:15]
    v_add_f32 v200, v200, v214
    v_add_f32 v200, v200, v215
    s_waitcnt lgkmcnt(4)
    v_mfma_f32_16x16x32_bf16 a[16:19], a[128:131], v[48:51], 0
    s_add_u32 m0, s44, 0
    v_add_f32 v200, v200, v216
    v_add_f32 v200, v200, v217
    v_mfma_f32_16x16x32_bf16 a[16:19], a[132:135], v[52:55], a[16:19]
    ds_read_b64_tr_b16 v[32:33], v14 offset:0
    s_add_u32 s58, s40, 512
    v_add_f32 v200, v200, v218
    s_waitcnt lgkmcnt(1)
    v_mfma_f32_16x16x32_bf16 a[16:19], a[136:139], v[56:59], a[16:19]
    ds_read_b64_tr_b16 v[34:35], v14 offset:512
    buffer_load_dwordx4 v4, s[4:7], s58 offen lds
    v_add_f32 v200, v200, v219
    v_add_f32 v200, v200, v220
    v_mfma_f32_16x16x32_bf16 a[16:19], a[140:143], v[60:63], a[16:19]
    ds_read_b64_tr_b16 v[36:37], v14 offset:4096
    v_add_f32 v200, v200, v221
    v_add_f32 v200, v200, v222
    v_mfma_f32_16x16x32_bf16 a[20:23], a[144:147], v[48:51], 0
    v_add_f32 v200, v200, v223
    v_mfma_f32_16x16x32_bf16 a[20:23], a[148:151], v[52:55], a[20:23]
    ds_read_b64_tr_b16 v[38:39], v14 offset:4608
    v_add_f32_dpp v200, v200, v200 quad_perm:[1,0,3,2] row_mask:0xf bank_mask:0xf
    s_nop 1
    v_add_f32_dpp v200, v200, v200 quad_perm:[2,3,0,1] row_mask:0xf bank_mask:0xf
    v_mfma_f32_16x16x32_bf16 a[20:23], a[152:155], v[56:59], a[20:23]
    ds_read_b64_tr_b16 v[40:41], v14 offset:8192
    buffer_load_dwordx4 v5, s[4:7], s58 offen offset:1024 lds
    v_add_f32_dpp v200, v200, v200 row_half_mirror row_mask:0xf bank_mask:0xf
    s_nop 1
    v_add_f32_dpp v200, v200, v200 row_mirror row_mask:0xf bank_mask:0xf
    v_mfma_f32_16x16x32_bf16 a[20:23], a[156:159], v[60:63], a[20:23]
    ds_read_b64_tr_b16 v[42:43], v14 offset:8704
    v_mov_b32 v201, v200
    s_nop 1
    v_permlane16_swap_b32 v201, v200
    v_mfma_f32_16x16x32_bf16 a[24:27], a[160:163], v[48:51], 0
    s_add_u32 m0, s44, 8192
    v_add_f32 v200, v200, v201
    v_mfma_f32_16x16x32_bf16 a[24:27], a[164:167], v[52:55], a[24:27]
    ds_read_b64_tr_b16 v[44:45], v14 offset:12288
    s_add_u32 s58, s40, 768
    v_mul_f32 v200, 0x3b000000, v200
    v_sub_f32 v202, v208, v200
    v_mfma_f32_16x16x32_bf16 a[24:27], a[168:171], v[56:59], a[24:27]
    ds_read_b64_tr_b16 v[46:47], v14 offset:12800
    buffer_load_dwordx4 v4, s[4:7], s58 offen lds
    v_mul_f32 v203, v202, v202
    v_sub_f32 v202, v209, v200
    v_mfma_f32_16x16x32_bf16 a[24:27], a[172:175], v[60:63], a[24:27]
    v_fmac_f32 v203, v202, v202
    v_mfma_f32_16x16x32_bf16 a[28:31], a[176:179], v[48:51], 0
    v_sub_f32 v202, v210, v200
    v_fmac_f32 v203, v202, v202
    v_mfma_f32_16x16x32_bf16 a[28:31], a[180:183], v[52:55], a[28:31]
    v_sub_f32 v202, v211, v200
    v_fmac_f32 v203, v202, v202
    v_mfma_f32_16x16x32_bf16 a[28:31], a[184:187], v[56:59], a[28:31]
    buffer_load_dwordx4 v5, s[4:7], s58 offen offset:1024 lds
    v_sub_f32 v202, v212, v200
    v_fmac_f32 v203, v202, v202
    v_mfma_f32_16x16x32_bf16 a[28:31], a[188:191], v[60:63], a[28:31]
    v_sub_f32 v202, v213, v200
    s_waitcnt lgkmcnt(4)
    v_mfma_f32_16x16x32_bf16 a[32:35], a[128:131], v[32:35], 0
    s_add_u32 m0, s57, 49152
    v_fmac_f32 v203, v202, v202
    v_sub_f32 v202, v214, v200
    v_mfma_f32_16x16x32_bf16 a[32:35], a[132:135], v[36:39], a[32:35]
    ds_read_b64_tr_b16 v[48:49], v15 offset:0
    s_add_u32 s59, s48, 128
    v_fmac_f32 v203, v202, v202
    v_sub_f32 v202, v215, v200
    s_waitcnt lgkmcnt(1)
    v_mfma_f32_16x16x32_bf16 a[32:35], a[136:139], v[40:43], a[32:35]
    ds_read_b64_tr_b16 v[50:51], v15 offset:512
    buffer_load_dwordx4 v10, s[8:11], s59 offen lds
    v_fmac_f32 v203, v202, v202
    v_sub_f32 v202, v216, v200
    v_mfma_f32_16x16x32_bf16 a[32:35], a[140:143], v[44:47], a[32:35]
    ds_read_b64_tr_b16 v[52:53], v15 offset:4096
    v_fmac_f32 v203, v202, v202
    v_mfma_f32_16x16x32_bf16 a[36:39], a[144:147], v[32:35], 0
    v_sub_f32 v202, v217, v200
    v_fmac_f32 v203, v202, v202
    v_mfma_f32_16x16x32_bf16 a[36:39], a[148:151], v[36:39], a[36:39]
    ds_read_b64_tr_b16 v[54:55], v15 offset:4608
    v_sub_f32 v202, v218, v200
    v_fmac_f32 v203, v202, v202
    v_mfma_f32_16x16x32_bf16 a[36:39], a[152:155], v[40:43], a[36:39]
    ds_read_b64_tr_b16 v[56:57], v15 offset:8192
    buffer_load_dwordx4 v11, s[8:11], s59 offen offset:1024 lds
    v_sub_f32 v202, v219, v200
    v_mfma_f32_16x16x32_bf16 a[36:39], a[156:159], v[44:47], a[36:39]
    ds_read_b64_tr_b16 v[58:59], v15 offset:8704
    v_fmac_f32 v203, v202, v202
    v_sub_f32 v202, v220, v200
    v_mfma_f32_16x16x32_bf16 a[40:43], a[160:163], v[32:35], 0
    s_add_u32 m0, s57, 57344
    v_fmac_f32 v203, v202, v202
    v_sub_f32 v202, v221, v200
    v_mfma_f32_16x16x32_bf16 a[40:43], a[164:167], v[36:39], a[40:43]
    ds_read_b64_tr_b16 v[60:61], v15 offset:12288
    s_add_u32 s59, s48, 1048704
    v_fmac_f32 v203, v202, v202
    v_sub_f32 v202, v222, v200
    v_mfma_f32_16x16x32_bf16 a[40:43], a[168:171], v[40:43], a[40:43]
    ds_read_b64_tr_b16 v[62:63], v15 offset:12800
    buffer_load_dwordx4 v10, s[8:11], s59 offen lds
    v_fmac_f32 v203, v202, v202
    v_mfma_f32_16x16x32_bf16 a[40:43], a[172:175], v[44:47], a[40:43]
    v_sub_f32 v202, v223, v200
    v_fmac_f32 v203, v202, v202
    v_mfma_f32_16x16x32_bf16 a[44:47], a[176:179], v[32:35], 0
    s_nop 0
    v_add_f32_dpp v203, v203, v203 quad_perm:[1,0,3,2] row_mask:0xf bank_mask:0xf
    s_nop 1
    v_add_f32_dpp v203, v203, v203 quad_perm:[2,3,0,1] row_mask:0xf bank_mask:0xf
    v_mfma_f32_16x16x32_bf16 a[44:47], a[180:183], v[36:39], a[44:47]
    s_nop 0
    v_add_f32_dpp v203, v203, v203 row_half_mirror row_mask:0xf bank_mask:0xf
    v_mfma_f32_16x16x32_bf16 a[44:47], a[184:187], v[40:43], a[44:47]
    buffer_load_dwordx4 v11, s[8:11], s59 offen offset:1024 lds
    v_add_f32_dpp v203, v203, v203 row_mirror row_mask:0xf bank_mask:0xf
    v_mov_b32 v201, v203
    v_mfma_f32_16x16x32_bf16 a[44:47], a[188:191], v[44:47], a[44:47]
    s_nop 0
    v_permlane16_swap_b32 v201, v203
    v_add_f32 v203, v203, v201
    s_waitcnt lgkmcnt(4)
    v_mfma_f32_16x16x32_bf16 a[48:51], a[128:131], v[48:51], 0
    v_mul_f32 v203, 0x3b000000, v203
    v_cvt_pk_bf16_f32 v200, v200, v203
    s_waitcnt vmcnt(14)
    s_barrier
    v_mfma_f32_16x16x32_bf16 a[48:51], a[132:135], v[52:55], a[48:51]
    ds_read_b64_tr_b16 v[32:33], v12 offset:16384
    s_add_u32 s59, s49, 2097152
    v_and_b32 v203, 0xffff0000, v200
    s_waitcnt lgkmcnt(1)
    v_mfma_f32_16x16x32_bf16 a[48:51], a[136:139], v[56:59], a[48:51]
    ds_read_b64_tr_b16 v[34:35], v12 offset:16896
    buffer_load_dwordx4 v[20:23], v3, s[12:15], s59 offen
    v_lshlrev_b32 v200, 16, v200
    v_add_f32 v203, 0x3727c5ac, v203
    v_mfma_f32_16x16x32_bf16 a[48:51], a[140:143], v[60:63], a[48:51]
    ds_read_b64_tr_b16 v[36:37], v12 offset:20480
    v_cvt_pk_bf16_f32 v203, v203, v203
    v_lshlrev_b32 v203, 16, v203
    v_mfma_f32_16x16x32_bf16 a[52:55], a[144:147], v[48:51], 0
    v_sqrt_f32 v203, v203
    v_mfma_f32_16x16x32_bf16 a[52:55], a[148:151], v[52:55], a[52:55]
    ds_read_b64_tr_b16 v[38:39], v12 offset:20992
    s_add_u32 s59, s49, 2097152
    v_cvt_pk_bf16_f32 v203, v203, v203
    v_lshlrev_b32 v203, 16, v203
    v_mfma_f32_16x16x32_bf16 a[52:55], a[152:155], v[56:59], a[52:55]
    ds_read_b64_tr_b16 v[40:41], v12 offset:24576
    buffer_load_dwordx4 v[20:23], v3, s[8:11], s59 offen
    v_rcp_f32 v203, v203
    v_sub_f32 v208, v208, v200
    v_mfma_f32_16x16x32_bf16 a[52:55], a[156:159], v[60:63], a[52:55]
    ds_read_b64_tr_b16 v[42:43], v12 offset:25088
    v_sub_f32 v209, v209, v200
    v_cvt_pk_bf16_f32 v208, v208, v209
    v_mfma_f32_16x16x32_bf16 a[56:59], a[160:163], v[48:51], 0
    s_add_u32 m0, s57, 65536
    v_and_b32 v209, 0xffff0000, v208
    v_mfma_f32_16x16x32_bf16 a[56:59], a[164:167], v[52:55], a[56:59]
    ds_read_b64_tr_b16 v[44:45], v12 offset:28672
    s_add_u32 s59, s48, 2097152
    v_lshlrev_b32 v208, 16, v208
    v_mul_f32 v208, v208, v203
    v_mfma_f32_16x16x32_bf16 a[56:59], a[168:171], v[56:59], a[56:59]
    ds_read_b64_tr_b16 v[46:47], v12 offset:29184
    buffer_load_dwordx4 v10, s[12:15], s59 offen lds
    v_mul_f32 v209, v209, v203
    v_cvt_pk_bf16_f32 v192, v208, v209
    v_mfma_f32_16x16x32_bf16 a[56:59], a[172:175], v[60:63], a[56:59]
    v_sub_f32 v210, v210, v200
    v_mfma_f32_16x16x32_bf16 a[60:63], a[176:179], v[48:51], 0
    v_sub_f32 v211, v211, v200
    v_cvt_pk_bf16_f32 v210, v210, v211
    v_mfma_f32_16x16x32_bf16 a[60:63], a[180:183], v[52:55], a[60:63]
    v_and_b32 v211, 0xffff0000, v210
    v_lshlrev_b32 v210, 16, v210
    v_mfma_f32_16x16x32_bf16 a[60:63], a[184:187], v[56:59], a[60:63]
    buffer_load_dwordx4 v11, s[12:15], s59 offen offset:1024 lds
    v_mul_f32 v210, v210, v203
    v_mul_f32 v211, v211, v203
    v_mfma_f32_16x16x32_bf16 a[60:63], a[188:191], v[60:63], a[60:63]
    v_cvt_pk_bf16_f32 v193, v210, v211
    s_waitcnt lgkmcnt(4)
    v_mfma_f32_16x16x32_bf16 a[64:67], a[128:131], v[32:35], 0
    s_add_u32 m0, s57, 73728
    v_sub_f32 v212, v212, v200
    v_sub_f32 v213, v213, v200
    v_mfma_f32_16x16x32_bf16 a[64:67], a[132:135], v[36:39], a[64:67]
    ds_read_b64_tr_b16 v[48:49], v13 offset:16384
    s_add_u32 s59, s48, 3145728
    v_cvt_pk_bf16_f32 v212, v212, v213
    v_and_b32 v213, 0xffff0000, v212
    s_waitcnt lgkmcnt(1)
    v_mfma_f32_16x16x32_bf16 a[64:67], a[136:139], v[40:43], a[64:67]
    ds_read_b64_tr_b16 v[50:51], v13 offset:16896
    buffer_load_dwordx4 v10, s[12:15], s59 offen lds
    v_lshlrev_b32 v212, 16, v212
    v_mul_f32 v212, v212, v203
    v_mfma_f32_16x16x32_bf16 a[64:67], a[140:143], v[44:47], a[64:67]
    ds_read_b64_tr_b16 v[52:53], v13 offset:20480
    v_mul_f32 v213, v213, v203
    v_mfma_f32_16x16x32_bf16 a[68:71], a[144:147], v[32:35], 0
    v_cvt_pk_bf16_f32 v194, v212, v213
    v_sub_f32 v214, v214, v200
    v_mfma_f32_16x16x32_bf16 a[68:71], a[148:151], v[36:39], a[68:71]
    ds_read_b64_tr_b16 v[54:55], v13 offset:20992
    v_sub_f32 v215, v215, v200
    v_cvt_pk_bf16_f32 v214, v214, v215
    v_mfma_f32_16x16x32_bf16 a[68:71], a[152:155], v[40:43], a[68:71]
    ds_read_b64_tr_b16 v[56:57], v13 offset:24576
    buffer_load_dwordx4 v11, s[12:15], s59 offen offset:1024 lds
    v_and_b32 v215, 0xffff0000, v214
    v_mfma_f32_16x16x32_bf16 a[68:71], a[156:159], v[44:47], a[68:71]
    ds_read_b64_tr_b16 v[58:59], v13 offset:25088
    v_lshlrev_b32 v214, 16, v214
    v_mul_f32 v214, v214, v203
    v_mfma_f32_16x16x32_bf16 a[72:75], a[160:163], v[32:35], 0
    s_add_u32 m0, s45, 0
    v_mul_f32 v215, v215, v203
    v_cvt_pk_bf16_f32 v195, v214, v215
    v_mfma_f32_16x16x32_bf16 a[72:75], a[164:167], v[36:39], a[72:75]
    ds_read_b64_tr_b16 v[60:61], v13 offset:28672
    s_add_u32 s58, s41, 512
    v_sub_f32 v216, v216, v200
    v_sub_f32 v217, v217, v200
    v_mfma_f32_16x16x32_bf16 a[72:75], a[168:171], v[40:43], a[72:75]
    ds_read_b64_tr_b16 v[62:63], v13 offset:29184
    buffer_load_dwordx4 v4, s[4:7], s58 offen lds
    v_cvt_pk_bf16_f32 v216, v216, v217
    v_mfma_f32_16x16x32_bf16 a[72:75], a[172:175], v[44:47], a[72:75]
    v_and_b32 v217, 0xffff0000, v216
    v_lshlrev_b32 v216, 16, v216
    v_mfma_f32_16x16x32_bf16 a[76:79], a[176:179], v[32:35], 0
    v_mul_f32 v216, v216, v203
    v_mul_f32 v217, v217, v203
    v_mfma_f32_16x16x32_bf16 a[76:79], a[180:183], v[36:39], a[76:79]
    v_cvt_pk_bf16_f32 v196, v216, v217
    v_mfma_f32_16x16x32_bf16 a[76:79], a[184:187], v[40:43], a[76:79]
    buffer_load_dwordx4 v5, s[4:7], s58 offen offset:1024 lds
    v_sub_f32 v218, v218, v200
    v_sub_f32 v219, v219, v200
    v_mfma_f32_16x16x32_bf16 a[76:79], a[188:191], v[44:47], a[76:79]
    v_cvt_pk_bf16_f32 v218, v218, v219
    v_and_b32 v219, 0xffff0000, v218
    s_waitcnt lgkmcnt(4)
    v_mfma_f32_16x16x32_bf16 a[80:83], a[128:131], v[48:51], 0
    s_add_u32 m0, s46, 0
    v_lshlrev_b32 v218, 16, v218
    v_mul_f32 v218, v218, v203
    v_mfma_f32_16x16x32_bf16 a[80:83], a[132:135], v[52:55], a[80:83]
    ds_read_b64_tr_b16 v[32:33], v14 offset:16384
    s_add_u32 s58, s42, 512
    v_mul_f32 v219, v219, v203
    s_waitcnt lgkmcnt(1)
    v_mfma_f32_16x16x32_bf16 a[80:83], a[136:139], v[56:59], a[80:83]
    ds_read_b64_tr_b16 v[34:35], v14 offset:16896
    buffer_load_dwordx4 v4, s[4:7], s58 offen lds
    v_cvt_pk_bf16_f32 v197, v218, v219
    v_sub_f32 v220, v220, v200
    v_mfma_f32_16x16x32_bf16 a[80:83], a[140:143], v[60:63], a[80:83]
    ds_read_b64_tr_b16 v[36:37], v14 offset:20480
    v_sub_f32 v221, v221, v200
    v_cvt_pk_bf16_f32 v220, v220, v221
    v_mfma_f32_16x16x32_bf16 a[84:87], a[144:147], v[48:51], 0
    v_and_b32 v221, 0xffff0000, v220
    v_mfma_f32_16x16x32_bf16 a[84:87], a[148:151], v[52:55], a[84:87]
    ds_read_b64_tr_b16 v[38:39], v14 offset:20992
    v_lshlrev_b32 v220, 16, v220
    v_mul_f32 v220, v220, v203
    v_mfma_f32_16x16x32_bf16 a[84:87], a[152:155], v[56:59], a[84:87]
    ds_read_b64_tr_b16 v[40:41], v14 offset:24576
    buffer_load_dwordx4 v5, s[4:7], s58 offen offset:1024 lds
    v_mul_f32 v221, v221, v203
    v_cvt_pk_bf16_f32 v198, v220, v221
    v_mfma_f32_16x16x32_bf16 a[84:87], a[156:159], v[60:63], a[84:87]
    ds_read_b64_tr_b16 v[42:43], v14 offset:25088
    v_sub_f32 v222, v222, v200
    v_sub_f32 v223, v223, v200
    v_mfma_f32_16x16x32_bf16 a[88:91], a[160:163], v[48:51], 0
    s_add_u32 m0, s47, 0
    v_cvt_pk_bf16_f32 v222, v222, v223
    v_mfma_f32_16x16x32_bf16 a[88:91], a[164:167], v[52:55], a[88:91]
    ds_read_b64_tr_b16 v[44:45], v14 offset:28672
    s_add_u32 s58, s43, 512
    v_and_b32 v223, 0xffff0000, v222
    v_lshlrev_b32 v222, 16, v222
    v_mfma_f32_16x16x32_bf16 a[88:91], a[168:171], v[56:59], a[88:91]
    ds_read_b64_tr_b16 v[46:47], v14 offset:29184
    buffer_load_dwordx4 v4, s[4:7], s58 offen lds
    v_mul_f32 v222, v222, v203
    v_mul_f32 v223, v223, v203
    v_mfma_f32_16x16x32_bf16 a[88:91], a[172:175], v[60:63], a[88:91]
    v_cvt_pk_bf16_f32 v199, v222, v223
    v_mfma_f32_16x16x32_bf16 a[92:95], a[176:179], v[48:51], 0
    s_lshl_b32 s50, s24, 11
    v_mfma_f32_16x16x32_bf16 a[92:95], a[180:183], v[52:55], a[92:95]
    s_add_u32 s50, s50, 81920
    v_mfma_f32_16x16x32_bf16 a[92:95], a[184:187], v[56:59], a[92:95]
    buffer_load_dwordx4 v5, s[4:7], s58 offen offset:1024 lds
    v_add_u32 v26, s50, v26
    v_mfma_f32_16x16x32_bf16 a[92:95], a[188:191], v[60:63], a[92:95]
    ds_write_b128 v26, v[192:195]
    s_waitcnt lgkmcnt(5)
    v_mfma_f32_16x16x32_bf16 a[96:99], a[128:131], v[32:35], 0
    ds_write_b128 v26, v[196:199] offset:16
    v_mfma_f32_16x16x32_bf16 a[96:99], a[132:135], v[36:39], a[96:99]
    ds_read_b64_tr_b16 v[48:49], v15 offset:16384
    v_and_b32 v24, 7, v2
    s_waitcnt lgkmcnt(3)
    v_mfma_f32_16x16x32_bf16 a[96:99], a[136:139], v[40:43], a[96:99]
    ds_read_b64_tr_b16 v[50:51], v15 offset:16896
    v_lshrrev_b32 v25, 3, v2
    v_mfma_f32_16x16x32_bf16 a[96:99], a[140:143], v[44:47], a[96:99]
    ds_read_b64_tr_b16 v[52:53], v15 offset:20480
    v_lshlrev_b32 v26, 10, v24
    v_mfma_f32_16x16x32_bf16 a[100:103], a[144:147], v[32:35], 0
    v_lshl_add_u32 v26, v25, 4, v26
    v_mfma_f32_16x16x32_bf16 a[100:103], a[148:151], v[36:39], a[100:103]
    ds_read_b64_tr_b16 v[54:55], v15 offset:20992
    s_lshl_b32 s50, s24, 8
    v_mfma_f32_16x16x32_bf16 a[100:103], a[152:155], v[40:43], a[100:103]
    ds_read_b64_tr_b16 v[56:57], v15 offset:24576
    s_add_u32 s50, s50, 81920
    v_mfma_f32_16x16x32_bf16 a[100:103], a[156:159], v[44:47], a[100:103]
    ds_read_b64_tr_b16 v[58:59], v15 offset:25088
    v_add_u32 v26, s50, v26
    v_mfma_f32_16x16x32_bf16 a[104:107], a[160:163], v[32:35], 0
    v_lshlrev_b32 v27, 8, v25
    v_mfma_f32_16x16x32_bf16 a[104:107], a[164:167], v[36:39], a[104:107]
    ds_read_b64_tr_b16 v[60:61], v15 offset:28672
    v_lshl_add_u32 v27, v24, 4, v27
    v_mfma_f32_16x16x32_bf16 a[104:107], a[168:171], v[40:43], a[104:107]
    ds_read_b64_tr_b16 v[62:63], v15 offset:29184
    v_mfma_f32_16x16x32_bf16 a[104:107], a[172:175], v[44:47], a[104:107]
    v_mfma_f32_16x16x32_bf16 a[108:111], a[176:179], v[32:35], 0
    v_mfma_f32_16x16x32_bf16 a[108:111], a[180:183], v[36:39], a[108:111]
    v_mfma_f32_16x16x32_bf16 a[108:111], a[184:187], v[40:43], a[108:111]
    v_mfma_f32_16x16x32_bf16 a[108:111], a[188:191], v[44:47], a[108:111]
    s_waitcnt lgkmcnt(4)
    v_mfma_f32_16x16x32_bf16 a[112:115], a[128:131], v[48:51], 0
    s_waitcnt lgkmcnt(8)
    s_waitcnt vmcnt(20)
    s_barrier
    v_mfma_f32_16x16x32_bf16 a[112:115], a[132:135], v[52:55], a[112:115]
    ds_read_b64_tr_b16 v[32:33], v12 offset:32768
    ds_read_b128 v[192:195], v26
    s_waitcnt lgkmcnt(2)
    v_mfma_f32_16x16x32_bf16 a[112:115], a[136:139], v[56:59], a[112:115]
    ds_read_b64_tr_b16 v[34:35], v12 offset:33280
    ds_read_b128 v[196:199], v26 offset:128
    v_mfma_f32_16x16x32_bf16 a[112:115], a[140:143], v[60:63], a[112:115]
    ds_read_b64_tr_b16 v[36:37], v12 offset:36864
    s_lshr_b32 s50, s2, 1
    v_mfma_f32_16x16x32_bf16 a[116:119], a[144:147], v[48:51], 0
    s_lshl_b32 s50, s50, 14
    v_mfma_f32_16x16x32_bf16 a[116:119], a[148:151], v[52:55], a[116:119]
    ds_read_b64_tr_b16 v[38:39], v12 offset:37376
    s_and_b32 s51, s2, 1
    v_mfma_f32_16x16x32_bf16 a[116:119], a[152:155], v[56:59], a[116:119]
    ds_read_b64_tr_b16 v[40:41], v12 offset:40960
    s_lshl_b32 s51, s51, 7
    v_mfma_f32_16x16x32_bf16 a[116:119], a[156:159], v[60:63], a[116:119]
    ds_read_b64_tr_b16 v[42:43], v12 offset:41472
    s_add_u32 s50, s50, s51
    v_mfma_f32_16x16x32_bf16 a[120:123], a[160:163], v[48:51], 0
    s_lshl_b32 s51, s24, 12
    v_mfma_f32_16x16x32_bf16 a[120:123], a[164:167], v[52:55], a[120:123]
    ds_read_b64_tr_b16 v[44:45], v12 offset:45056
    s_add_u32 s50, s50, s51
    v_mfma_f32_16x16x32_bf16 a[120:123], a[168:171], v[56:59], a[120:123]
    ds_read_b64_tr_b16 v[46:47], v12 offset:45568
    s_waitcnt lgkmcnt(6)
    v_mfma_f32_16x16x32_bf16 a[120:123], a[172:175], v[60:63], a[120:123]
    buffer_store_dwordx4 v[192:195], v27, s[16:19], s50 offen offset:0 sc1
    v_mfma_f32_16x16x32_bf16 a[124:127], a[176:179], v[48:51], 0
    buffer_store_dwordx4 v[196:199], v27, s[16:19], s50 offen offset:2048 sc1
    v_mfma_f32_16x16x32_bf16 a[124:127], a[180:183], v[52:55], a[124:127]
    s_add_u32 m0, s45, 8192
    s_lshl_b32 s50, s25, 7
    v_mfma_f32_16x16x32_bf16 a[124:127], a[184:187], v[56:59], a[124:127]
    s_add_u32 s58, s41, 768
    s_lshl_b32 s51, s26, 2
    v_mfma_f32_16x16x32_bf16 a[124:127], a[188:191], v[60:63], a[124:127]
    buffer_load_dwordx4 v4, s[4:7], s58 offen lds
    s_add_u32 s50, s50, s51
    s_waitcnt lgkmcnt(4)
    v_mfma_f32_16x16x32_bf16 v[96:99], v[32:35], a[128:131], 0
    s_add_u32 s50, s50, 83886080
    v_mfma_f32_16x16x32_bf16 v[96:99], v[36:39], a[132:135], v[96:99]
    ds_read_b64_tr_b16 v[48:49], v13 offset:32768
    v_mov_b32 v24, s50
    s_waitcnt lgkmcnt(1)
    v_mfma_f32_16x16x32_bf16 v[96:99], v[40:43], a[136:139], v[96:99]
    ds_read_b64_tr_b16 v[50:51], v13 offset:33280
    s_lshl_b32 s50, s26, 7
    v_mfma_f32_16x16x32_bf16 v[96:99], v[44:47], a[140:143], v[96:99]
    ds_read_b64_tr_b16 v[52:53], v13 offset:36864
    buffer_load_dwordx4 v5, s[4:7], s58 offen offset:1024 lds
    s_lshl_b32 s51, s25, 2
    v_mfma_f32_16x16x32_bf16 v[100:103], v[32:35], a[144:147], 0
    s_add_u32 s27, s50, s51
    v_mfma_f32_16x16x32_bf16 v[100:103], v[36:39], a[148:151], v[100:103]
    ds_read_b64_tr_b16 v[54:55], v13 offset:37376
    s_add_u32 m0, s46, 8192
    s_add_u32 s27, s27, 83890176
    v_mfma_f32_16x16x32_bf16 v[100:103], v[40:43], a[152:155], v[100:103]
    ds_read_b64_tr_b16 v[56:57], v13 offset:40960
    s_add_u32 s58, s42, 768
    v_writelane_b32 v24, s27, 1
    v_mfma_f32_16x16x32_bf16 v[100:103], v[44:47], a[156:159], v[100:103]
    ds_read_b64_tr_b16 v[58:59], v13 offset:41472
    buffer_load_dwordx4 v4, s[4:7], s58 offen lds
    s_sub_u32 s27, s51, s50
    v_mfma_f32_16x16x32_bf16 v[104:107], v[32:35], a[160:163], 0
    s_add_u32 s27, s27, 83892096
    v_mfma_f32_16x16x32_bf16 v[104:107], v[36:39], a[164:167], v[104:107]
    ds_read_b64_tr_b16 v[60:61], v13 offset:45056
    v_writelane_b32 v24, s27, 2
    v_mfma_f32_16x16x32_bf16 v[104:107], v[40:43], a[168:171], v[104:107]
    ds_read_b64_tr_b16 v[62:63], v13 offset:45568
    s_lshl_b32 s27, s24, 7
    v_mfma_f32_16x16x32_bf16 v[104:107], v[44:47], a[172:175], v[104:107]
    buffer_load_dwordx4 v5, s[4:7], s58 offen offset:1024 lds
    s_add_u32 s51, s51, s27
    v_mfma_f32_16x16x32_bf16 v[108:111], v[32:35], a[176:179], 0
    s_lshl_b32 s51, s51, 5
    v_mfma_f32_16x16x32_bf16 v[108:111], v[36:39], a[180:183], v[108:111]
    s_add_u32 m0, s47, 8192
    s_lshl_b32 s50, s50, 7
    v_mfma_f32_16x16x32_bf16 v[108:111], v[40:43], a[184:187], v[108:111]
    s_add_u32 s58, s43, 768
    s_add_u32 s27, s50, s51
    v_mfma_f32_16x16x32_bf16 v[108:111], v[44:47], a[188:191], v[108:111]
    buffer_load_dwordx4 v4, s[4:7], s58 offen lds
    s_add_u32 s27, s27, 84148224
    s_waitcnt lgkmcnt(4)
    v_mfma_f32_16x16x32_bf16 v[64:67], v[48:51], a[128:131], 0
    v_writelane_b32 v24, s27, 3
    v_mfma_f32_16x16x32_bf16 v[64:67], v[52:55], a[132:135], v[64:67]
    ds_read_b64_tr_b16 v[32:33], v14 offset:32768
    s_sub_u32 s27, s51, s50
    s_waitcnt lgkmcnt(1)
    v_mfma_f32_16x16x32_bf16 v[64:67], v[56:59], a[136:139], v[64:67]
    ds_read_b64_tr_b16 v[34:35], v14 offset:33280
    s_add_u32 s27, s27, 84393984
    v_mfma_f32_16x16x32_bf16 v[64:67], v[60:63], a[140:143], v[64:67]
    ds_read_b64_tr_b16 v[36:37], v14 offset:36864
    buffer_load_dwordx4 v5, s[4:7], s58 offen offset:1024 lds
    v_writelane_b32 v24, s27, 4
    v_mfma_f32_16x16x32_bf16 v[68:71], v[48:51], a[144:147], 0
    v_mov_b32 v25, 0
    v_mfma_f32_16x16x32_bf16 v[68:71], v[52:55], a[148:151], v[68:71]
    ds_read_b64_tr_b16 v[38:39], v14 offset:37376
    buffer_store_dword v25, v24, s[16:19], 0 offen sc1
    v_mfma_f32_16x16x32_bf16 v[68:71], v[56:59], a[152:155], v[68:71]
    ds_read_b64_tr_b16 v[40:41], v14 offset:40960
    s_mov_b32 s70, 256
    v_mfma_f32_16x16x32_bf16 v[68:71], v[60:63], a[156:159], v[68:71]
    ds_read_b64_tr_b16 v[42:43], v14 offset:41472
    s_add_u32 s59, s49, 524288
    s_mov_b32 s71, 0x00020000
    v_mfma_f32_16x16x32_bf16 v[72:75], v[48:51], a[160:163], 0
    buffer_load_dwordx4 v[20:23], v3, s[12:15], s59 offen
    v_mov_b32 v26, 1
    v_mfma_f32_16x16x32_bf16 v[72:75], v[52:55], a[164:167], v[72:75]
    ds_read_b64_tr_b16 v[44:45], v14 offset:45056
    v_mfma_f32_16x16x32_bf16 v[72:75], v[56:59], a[168:171], v[72:75]
    ds_read_b64_tr_b16 v[46:47], v14 offset:45568
    v_mfma_f32_16x16x32_bf16 v[72:75], v[60:63], a[172:175], v[72:75]
    s_add_u32 s59, s49, 524288
    v_mfma_f32_16x16x32_bf16 v[76:79], v[48:51], a[176:179], 0
    buffer_load_dwordx4 v[20:23], v3, s[8:11], s59 offen
    v_mfma_f32_16x16x32_bf16 v[76:79], v[52:55], a[180:183], v[76:79]
    v_mfma_f32_16x16x32_bf16 v[76:79], v[56:59], a[184:187], v[76:79]
    v_mfma_f32_16x16x32_bf16 v[76:79], v[60:63], a[188:191], v[76:79]
    s_waitcnt lgkmcnt(4)
    v_mfma_f32_16x16x32_bf16 v[112:115], v[32:35], a[128:131], 0
    v_mfma_f32_16x16x32_bf16 v[112:115], v[36:39], a[132:135], v[112:115]
    ds_read_b64_tr_b16 v[48:49], v15 offset:32768
    s_waitcnt lgkmcnt(1)
    v_mfma_f32_16x16x32_bf16 v[112:115], v[40:43], a[136:139], v[112:115]
    ds_read_b64_tr_b16 v[50:51], v15 offset:33280
    v_mfma_f32_16x16x32_bf16 v[112:115], v[44:47], a[140:143], v[112:115]
    ds_read_b64_tr_b16 v[52:53], v15 offset:36864
    v_mfma_f32_16x16x32_bf16 v[116:119], v[32:35], a[144:147], 0
    v_mfma_f32_16x16x32_bf16 v[116:119], v[36:39], a[148:151], v[116:119]
    ds_read_b64_tr_b16 v[54:55], v15 offset:37376
    v_mfma_f32_16x16x32_bf16 v[116:119], v[40:43], a[152:155], v[116:119]
    ds_read_b64_tr_b16 v[56:57], v15 offset:40960
    v_mfma_f32_16x16x32_bf16 v[116:119], v[44:47], a[156:159], v[116:119]
    ds_read_b64_tr_b16 v[58:59], v15 offset:41472
    v_mfma_f32_16x16x32_bf16 v[120:123], v[32:35], a[160:163], 0
    v_mfma_f32_16x16x32_bf16 v[120:123], v[36:39], a[164:167], v[120:123]
    ds_read_b64_tr_b16 v[60:61], v15 offset:45056
    v_mfma_f32_16x16x32_bf16 v[120:123], v[40:43], a[168:171], v[120:123]
    ds_read_b64_tr_b16 v[62:63], v15 offset:45568
    v_mfma_f32_16x16x32_bf16 v[120:123], v[44:47], a[172:175], v[120:123]
    v_mfma_f32_16x16x32_bf16 v[124:127], v[32:35], a[176:179], 0
    v_mfma_f32_16x16x32_bf16 v[124:127], v[36:39], a[180:183], v[124:127]
    v_mfma_f32_16x16x32_bf16 v[124:127], v[40:43], a[184:187], v[124:127]
    v_mfma_f32_16x16x32_bf16 v[124:127], v[44:47], a[188:191], v[124:127]
    s_waitcnt lgkmcnt(4)
    v_mfma_f32_16x16x32_bf16 v[80:83], v[48:51], a[128:131], 0
    s_waitcnt vmcnt(23)
    s_barrier
    v_mfma_f32_16x16x32_bf16 v[80:83], v[52:55], a[132:135], v[80:83]
    ds_read_b64_tr_b16 v[32:33], v12 offset:49152
    s_add_u32 m0, s57, 81920
    s_waitcnt lgkmcnt(1)
    v_mfma_f32_16x16x32_bf16 v[80:83], v[56:59], a[136:139], v[80:83]
    ds_read_b64_tr_b16 v[34:35], v12 offset:49664
    s_add_u32 s59, s48, 2097280
    v_mfma_f32_16x16x32_bf16 v[80:83], v[60:63], a[140:143], v[80:83]
    ds_read_b64_tr_b16 v[36:37], v12 offset:53248
    buffer_load_dwordx4 v10, s[12:15], s59 offen lds
    v_mfma_f32_16x16x32_bf16 v[84:87], v[48:51], a[144:147], 0
    v_mfma_f32_16x16x32_bf16 v[84:87], v[52:55], a[148:151], v[84:87]
    ds_read_b64_tr_b16 v[38:39], v12 offset:53760
    v_mfma_f32_16x16x32_bf16 v[84:87], v[56:59], a[152:155], v[84:87]
    ds_read_b64_tr_b16 v[40:41], v12 offset:57344
    v_mfma_f32_16x16x32_bf16 v[84:87], v[60:63], a[156:159], v[84:87]
    ds_read_b64_tr_b16 v[42:43], v12 offset:57856
    buffer_load_dwordx4 v11, s[12:15], s59 offen offset:1024 lds
    v_mfma_f32_16x16x32_bf16 v[88:91], v[48:51], a[160:163], 0
    v_mfma_f32_16x16x32_bf16 v[88:91], v[52:55], a[164:167], v[88:91]
    ds_read_b64_tr_b16 v[44:45], v12 offset:61440
    s_add_u32 m0, s57, 90112
    v_mfma_f32_16x16x32_bf16 v[88:91], v[56:59], a[168:171], v[88:91]
    ds_read_b64_tr_b16 v[46:47], v12 offset:61952
    s_add_u32 s59, s48, 3145856
    v_mfma_f32_16x16x32_bf16 v[88:91], v[60:63], a[172:175], v[88:91]
    buffer_load_dwordx4 v10, s[12:15], s59 offen lds
    v_mfma_f32_16x16x32_bf16 v[92:95], v[48:51], a[176:179], 0
    v_mfma_f32_16x16x32_bf16 v[92:95], v[52:55], a[180:183], v[92:95]
    v_mfma_f32_16x16x32_bf16 v[92:95], v[56:59], a[184:187], v[92:95]
    v_mfma_f32_16x16x32_bf16 v[92:95], v[60:63], a[188:191], v[92:95]
    buffer_load_dwordx4 v11, s[12:15], s59 offen offset:1024 lds
    s_waitcnt lgkmcnt(4)
    v_mfma_f32_16x16x32_bf16 v[160:163], v[32:35], a[128:131], 0
    v_mfma_f32_16x16x32_bf16 v[160:163], v[36:39], a[132:135], v[160:163]
    ds_read_b64_tr_b16 v[48:49], v13 offset:49152
    s_add_u32 m0, s57, 0
    s_waitcnt lgkmcnt(1)
    v_mfma_f32_16x16x32_bf16 v[160:163], v[40:43], a[136:139], v[160:163]
    ds_read_b64_tr_b16 v[50:51], v13 offset:49664
    s_add_u32 s59, s48, 2097152
    v_mfma_f32_16x16x32_bf16 v[160:163], v[44:47], a[140:143], v[160:163]
    ds_read_b64_tr_b16 v[52:53], v13 offset:53248
    buffer_load_dwordx4 v10, s[8:11], s59 offen lds
    s_waitcnt vmcnt(16)
    v_mfma_f32_16x16x32_bf16 v[164:167], v[32:35], a[144:147], 0
    ds_read_b128 a[192:195], v8 offset:0
    v_mfma_f32_16x16x32_bf16 v[164:167], v[36:39], a[148:151], v[164:167]
    ds_read_b64_tr_b16 v[54:55], v13 offset:53760
    v_mfma_f32_16x16x32_bf16 v[164:167], v[40:43], a[152:155], v[164:167]
    ds_read_b64_tr_b16 v[56:57], v13 offset:57344
    ds_read_b128 a[196:199], v9 offset:0
    v_mfma_f32_16x16x32_bf16 v[164:167], v[44:47], a[156:159], v[164:167]
    ds_read_b64_tr_b16 v[58:59], v13 offset:57856
    buffer_load_dwordx4 v11, s[8:11], s59 offen offset:1024 lds
    v_mfma_f32_16x16x32_bf16 v[168:171], v[32:35], a[160:163], 0
    ds_read_b128 a[208:211], v8 offset:2048
    v_mfma_f32_16x16x32_bf16 v[168:171], v[36:39], a[164:167], v[168:171]
    ds_read_b64_tr_b16 v[60:61], v13 offset:61440
    s_add_u32 m0, s57, 8192
    v_mfma_f32_16x16x32_bf16 v[168:171], v[40:43], a[168:171], v[168:171]
    ds_read_b64_tr_b16 v[62:63], v13 offset:61952
    ds_read_b128 a[212:215], v9 offset:2048
    s_add_u32 s59, s48, 3145728
    v_mfma_f32_16x16x32_bf16 v[168:171], v[44:47], a[172:175], v[168:171]
    buffer_load_dwordx4 v10, s[8:11], s59 offen lds
    v_mfma_f32_16x16x32_bf16 v[172:175], v[32:35], a[176:179], 0
    ds_read_b128 a[224:227], v8 offset:4096
    v_mfma_f32_16x16x32_bf16 v[172:175], v[36:39], a[180:183], v[172:175]
    v_mfma_f32_16x16x32_bf16 v[172:175], v[40:43], a[184:187], v[172:175]
    ds_read_b128 a[228:231], v9 offset:4096
    v_mfma_f32_16x16x32_bf16 v[172:175], v[44:47], a[188:191], v[172:175]
    buffer_load_dwordx4 v11, s[8:11], s59 offen offset:1024 lds
    s_waitcnt lgkmcnt(9)
    v_mfma_f32_16x16x32_bf16 v[128:131], v[48:51], a[128:131], 0
    ds_read_b128 a[240:243], v8 offset:6144
    v_mfma_f32_16x16x32_bf16 v[128:131], v[52:55], a[132:135], v[128:131]
    ds_read_b64_tr_b16 v[32:33], v14 offset:49152
    s_waitcnt lgkmcnt(5)
    v_mfma_f32_16x16x32_bf16 v[128:131], v[56:59], a[136:139], v[128:131]
    ds_read_b64_tr_b16 v[34:35], v14 offset:49664
    ds_read_b128 a[244:247], v9 offset:6144
    v_mfma_f32_16x16x32_bf16 v[128:131], v[60:63], a[140:143], v[128:131]
    ds_read_b64_tr_b16 v[36:37], v14 offset:53248
    v_mfma_f32_16x16x32_bf16 v[132:135], v[48:51], a[144:147], 0
    v_mfma_f32_16x16x32_bf16 v[132:135], v[52:55], a[148:151], v[132:135]
    ds_read_b64_tr_b16 v[38:39], v14 offset:53760
    v_mfma_f32_16x16x32_bf16 v[132:135], v[56:59], a[152:155], v[132:135]
    ds_read_b64_tr_b16 v[40:41], v14 offset:57344
    v_mfma_f32_16x16x32_bf16 v[132:135], v[60:63], a[156:159], v[132:135]
    ds_read_b64_tr_b16 v[42:43], v14 offset:57856
    v_mfma_f32_16x16x32_bf16 v[136:139], v[48:51], a[160:163], 0
    v_mfma_f32_16x16x32_bf16 v[136:139], v[52:55], a[164:167], v[136:139]
    ds_read_b64_tr_b16 v[44:45], v14 offset:61440
    v_mfma_f32_16x16x32_bf16 v[136:139], v[56:59], a[168:171], v[136:139]
    ds_read_b64_tr_b16 v[46:47], v14 offset:61952
    v_mfma_f32_16x16x32_bf16 v[136:139], v[60:63], a[172:175], v[136:139]
    v_mfma_f32_16x16x32_bf16 v[140:143], v[48:51], a[176:179], 0
    v_mfma_f32_16x16x32_bf16 v[140:143], v[52:55], a[180:183], v[140:143]
    s_waitcnt vmcnt(11)
    v_mfma_f32_16x16x32_bf16 v[140:143], v[56:59], a[184:187], v[140:143]
    ds_read_b128 a[200:203], v8 offset:8192
    v_mfma_f32_16x16x32_bf16 v[140:143], v[60:63], a[188:191], v[140:143]
    s_waitcnt lgkmcnt(5)
    v_mfma_f32_16x16x32_bf16 v[176:179], v[32:35], a[128:131], 0
    ds_read_b128 a[204:207], v9 offset:8192
    v_mfma_f32_16x16x32_bf16 v[176:179], v[36:39], a[132:135], v[176:179]
    ds_read_b64_tr_b16 v[48:49], v15 offset:49152
    s_waitcnt lgkmcnt(3)
    v_mfma_f32_16x16x32_bf16 v[176:179], v[40:43], a[136:139], v[176:179]
    ds_read_b64_tr_b16 v[50:51], v15 offset:49664
    ds_read_b128 a[216:219], v8 offset:10240
    v_mfma_f32_16x16x32_bf16 v[176:179], v[44:47], a[140:143], v[176:179]
    ds_read_b64_tr_b16 v[52:53], v15 offset:53248
    v_mfma_f32_16x16x32_bf16 v[180:183], v[32:35], a[144:147], 0
    ds_read_b128 a[220:223], v9 offset:10240
    v_mfma_f32_16x16x32_bf16 v[180:183], v[36:39], a[148:151], v[180:183]
    ds_read_b64_tr_b16 v[54:55], v15 offset:53760
    v_mfma_f32_16x16x32_bf16 v[180:183], v[40:43], a[152:155], v[180:183]
    ds_read_b64_tr_b16 v[56:57], v15 offset:57344
    ds_read_b128 a[232:235], v8 offset:12288
    v_mfma_f32_16x16x32_bf16 v[180:183], v[44:47], a[156:159], v[180:183]
    ds_read_b64_tr_b16 v[58:59], v15 offset:57856
    v_mfma_f32_16x16x32_bf16 v[184:187], v[32:35], a[160:163], 0
    ds_read_b128 a[236:239], v9 offset:12288
    v_mfma_f32_16x16x32_bf16 v[184:187], v[36:39], a[164:167], v[184:187]
    ds_read_b64_tr_b16 v[60:61], v15 offset:61440
    v_mfma_f32_16x16x32_bf16 v[184:187], v[40:43], a[168:171], v[184:187]
    ds_read_b64_tr_b16 v[62:63], v15 offset:61952
    ds_read_b128 a[248:251], v8 offset:14336
    v_mfma_f32_16x16x32_bf16 v[184:187], v[44:47], a[172:175], v[184:187]
    v_mfma_f32_16x16x32_bf16 v[188:191], v[32:35], a[176:179], 0
    ds_read_b128 a[252:255], v9 offset:14336
    v_mfma_f32_16x16x32_bf16 v[188:191], v[36:39], a[180:183], v[188:191]
    v_mfma_f32_16x16x32_bf16 v[188:191], v[40:43], a[184:187], v[188:191]
    v_mfma_f32_16x16x32_bf16 v[188:191], v[44:47], a[188:191], v[188:191]
    s_waitcnt lgkmcnt(8)
    v_mfma_f32_16x16x32_bf16 v[144:147], v[48:51], a[128:131], 0
    s_waitcnt vmcnt(10)
    s_waitcnt vmcnt(25)
    s_barrier
    v_mfma_f32_16x16x32_bf16 v[144:147], v[52:55], a[132:135], v[144:147]
    ds_read_b64_tr_b16 v[32:33], v16 offset:0
    s_add_u32 m0, s57, 16384
    s_cmp_lg_u32 s24, 0
    s_cbranch_scc1 K1_SIG
    s_mov_b64 exec, 1
    buffer_atomic_add v26, v25, s[68:71], 0 offen sc1
    s_mov_b64 exec, -1
K1_SIG:
    s_waitcnt lgkmcnt(3)
    v_mfma_f32_16x16x32_bf16 v[144:147], v[56:59], a[136:139], v[144:147]
    ds_read_b64_tr_b16 v[34:35], v16 offset:512
    s_add_u32 s59, s48, 2097280
    v_mfma_f32_16x16x32_bf16 v[144:147], v[60:63], a[140:143], v[144:147]
    ds_read_b64_tr_b16 v[36:37], v16 offset:4096
    buffer_load_dwordx4 v10, s[8:11], s59 offen lds
    v_mfma_f32_16x16x32_bf16 v[148:151], v[48:51], a[144:147], 0
    v_mfma_f32_16x16x32_bf16 v[148:151], v[52:55], a[148:151], v[148:151]
    ds_read_b64_tr_b16 v[38:39], v16 offset:4608
    v_mfma_f32_16x16x32_bf16 v[148:151], v[56:59], a[152:155], v[148:151]
    ds_read_b64_tr_b16 v[40:41], v16 offset:8192
    v_mfma_f32_16x16x32_bf16 v[148:151], v[60:63], a[156:159], v[148:151]
    ds_read_b64_tr_b16 v[42:43], v16 offset:8704
    buffer_load_dwordx4 v11, s[8:11], s59 offen offset:1024 lds
    v_mfma_f32_16x16x32_bf16 v[152:155], v[48:51], a[160:163], 0
    v_mfma_f32_16x16x32_bf16 v[152:155], v[52:55], a[164:167], v[152:155]
    ds_read_b64_tr_b16 v[44:45], v16 offset:12288
    s_add_u32 m0, s57, 24576
    v_mfma_f32_16x16x32_bf16 v[152:155], v[56:59], a[168:171], v[152:155]
    ds_read_b64_tr_b16 v[46:47], v16 offset:12800
    s_add_u32 s59, s48, 3145856
    v_mfma_f32_16x16x32_bf16 v[152:155], v[60:63], a[172:175], v[152:155]
    buffer_load_dwordx4 v10, s[8:11], s59 offen lds
    v_mfma_f32_16x16x32_bf16 v[156:159], v[48:51], a[176:179], 0
    v_mfma_f32_16x16x32_bf16 v[156:159], v[52:55], a[180:183], v[156:159]
    v_mfma_f32_16x16x32_bf16 v[156:159], v[56:59], a[184:187], v[156:159]
    v_mfma_f32_16x16x32_bf16 v[156:159], v[60:63], a[188:191], v[156:159]
    buffer_load_dwordx4 v11, s[8:11], s59 offen offset:1024 lds
    s_waitcnt lgkmcnt(4)
    v_mfma_f32_16x16x32_bf16 a[0:3], a[192:195], v[32:35], a[0:3]
    v_mfma_f32_16x16x32_bf16 a[0:3], a[196:199], v[36:39], a[0:3]
    ds_read_b64_tr_b16 v[48:49], v17 offset:0
    s_add_u32 m0, s44, 0
    s_waitcnt lgkmcnt(1)
    v_mfma_f32_16x16x32_bf16 a[0:3], a[200:203], v[40:43], a[0:3]
    ds_read_b64_tr_b16 v[50:51], v17 offset:512
    s_add_u32 s58, s40, 128
    v_mfma_f32_16x16x32_bf16 a[0:3], a[204:207], v[44:47], a[0:3]
    ds_read_b64_tr_b16 v[52:53], v17 offset:4096
    buffer_load_dwordx4 v4, s[4:7], s58 offen lds
    v_mfma_f32_16x16x32_bf16 a[4:7], a[208:211], v[32:35], a[4:7]
    v_mfma_f32_16x16x32_bf16 a[4:7], a[212:215], v[36:39], a[4:7]
    ds_read_b64_tr_b16 v[54:55], v17 offset:4608
    v_mfma_f32_16x16x32_bf16 a[4:7], a[216:219], v[40:43], a[4:7]
    ds_read_b64_tr_b16 v[56:57], v17 offset:8192
    v_mfma_f32_16x16x32_bf16 a[4:7], a[220:223], v[44:47], a[4:7]
    ds_read_b64_tr_b16 v[58:59], v17 offset:8704
    buffer_load_dwordx4 v5, s[4:7], s58 offen offset:1024 lds
    v_mfma_f32_16x16x32_bf16 a[8:11], a[224:227], v[32:35], a[8:11]
    v_mfma_f32_16x16x32_bf16 a[8:11], a[228:231], v[36:39], a[8:11]
    ds_read_b64_tr_b16 v[60:61], v17 offset:12288
    s_add_u32 m0, s44, 8192
    v_mfma_f32_16x16x32_bf16 a[8:11], a[232:235], v[40:43], a[8:11]
    ds_read_b64_tr_b16 v[62:63], v17 offset:12800
    s_add_u32 s58, s40, 384
    v_mfma_f32_16x16x32_bf16 a[8:11], a[236:239], v[44:47], a[8:11]
    buffer_load_dwordx4 v4, s[4:7], s58 offen lds
    v_mfma_f32_16x16x32_bf16 a[12:15], a[240:243], v[32:35], a[12:15]
    v_mfma_f32_16x16x32_bf16 a[12:15], a[244:247], v[36:39], a[12:15]
    v_mfma_f32_16x16x32_bf16 a[12:15], a[248:251], v[40:43], a[12:15]
    v_mfma_f32_16x16x32_bf16 a[12:15], a[252:255], v[44:47], a[12:15]
    buffer_load_dwordx4 v5, s[4:7], s58 offen offset:1024 lds
    s_waitcnt lgkmcnt(4)
    v_mfma_f32_16x16x32_bf16 a[16:19], a[192:195], v[48:51], a[16:19]
    v_mfma_f32_16x16x32_bf16 a[16:19], a[196:199], v[52:55], a[16:19]
    ds_read_b64_tr_b16 v[32:33], v18 offset:0
    s_waitcnt lgkmcnt(1)
    v_mfma_f32_16x16x32_bf16 a[16:19], a[200:203], v[56:59], a[16:19]
    ds_read_b64_tr_b16 v[34:35], v18 offset:512
    v_mfma_f32_16x16x32_bf16 a[16:19], a[204:207], v[60:63], a[16:19]
    ds_read_b64_tr_b16 v[36:37], v18 offset:4096
    v_mfma_f32_16x16x32_bf16 a[20:23], a[208:211], v[48:51], a[20:23]
    v_mfma_f32_16x16x32_bf16 a[20:23], a[212:215], v[52:55], a[20:23]
    ds_read_b64_tr_b16 v[38:39], v18 offset:4608
    v_mfma_f32_16x16x32_bf16 a[20:23], a[216:219], v[56:59], a[20:23]
    ds_read_b64_tr_b16 v[40:41], v18 offset:8192
    v_mfma_f32_16x16x32_bf16 a[20:23], a[220:223], v[60:63], a[20:23]
    ds_read_b64_tr_b16 v[42:43], v18 offset:8704
    v_mfma_f32_16x16x32_bf16 a[24:27], a[224:227], v[48:51], a[24:27]
    v_mfma_f32_16x16x32_bf16 a[24:27], a[228:231], v[52:55], a[24:27]
    ds_read_b64_tr_b16 v[44:45], v18 offset:12288
    v_mfma_f32_16x16x32_bf16 a[24:27], a[232:235], v[56:59], a[24:27]
    ds_read_b64_tr_b16 v[46:47], v18 offset:12800
    v_mfma_f32_16x16x32_bf16 a[24:27], a[236:239], v[60:63], a[24:27]
    v_mfma_f32_16x16x32_bf16 a[28:31], a[240:243], v[48:51], a[28:31]
    v_mfma_f32_16x16x32_bf16 a[28:31], a[244:247], v[52:55], a[28:31]
    v_mfma_f32_16x16x32_bf16 a[28:31], a[248:251], v[56:59], a[28:31]
    v_mfma_f32_16x16x32_bf16 a[28:31], a[252:255], v[60:63], a[28:31]
    s_waitcnt lgkmcnt(4)
    v_mfma_f32_16x16x32_bf16 a[32:35], a[192:195], v[32:35], a[32:35]
    v_mfma_f32_16x16x32_bf16 a[32:35], a[196:199], v[36:39], a[32:35]
    ds_read_b64_tr_b16 v[48:49], v19 offset:0
    s_waitcnt lgkmcnt(1)
    v_mfma_f32_16x16x32_bf16 a[32:35], a[200:203], v[40:43], a[32:35]
    ds_read_b64_tr_b16 v[50:51], v19 offset:512
    v_mfma_f32_16x16x32_bf16 a[32:35], a[204:207], v[44:47], a[32:35]
    ds_read_b64_tr_b16 v[52:53], v19 offset:4096
    v_mfma_f32_16x16x32_bf16 a[36:39], a[208:211], v[32:35], a[36:39]
    v_mfma_f32_16x16x32_bf16 a[36:39], a[212:215], v[36:39], a[36:39]
    ds_read_b64_tr_b16 v[54:55], v19 offset:4608
    v_mfma_f32_16x16x32_bf16 a[36:39], a[216:219], v[40:43], a[36:39]
    ds_read_b64_tr_b16 v[56:57], v19 offset:8192
    v_mfma_f32_16x16x32_bf16 a[36:39], a[220:223], v[44:47], a[36:39]
    ds_read_b64_tr_b16 v[58:59], v19 offset:8704
    v_mfma_f32_16x16x32_bf16 a[40:43], a[224:227], v[32:35], a[40:43]
    v_mfma_f32_16x16x32_bf16 a[40:43], a[228:231], v[36:39], a[40:43]
    ds_read_b64_tr_b16 v[60:61], v19 offset:12288
    v_mfma_f32_16x16x32_bf16 a[40:43], a[232:235], v[40:43], a[40:43]
    ds_read_b64_tr_b16 v[62:63], v19 offset:12800
    v_mfma_f32_16x16x32_bf16 a[40:43], a[236:239], v[44:47], a[40:43]
    v_mfma_f32_16x16x32_bf16 a[44:47], a[240:243], v[32:35], a[44:47]
    v_mfma_f32_16x16x32_bf16 a[44:47], a[244:247], v[36:39], a[44:47]
    v_mfma_f32_16x16x32_bf16 a[44:47], a[248:251], v[40:43], a[44:47]
    v_mfma_f32_16x16x32_bf16 a[44:47], a[252:255], v[44:47], a[44:47]
    s_waitcnt lgkmcnt(4)
    v_mfma_f32_16x16x32_bf16 a[48:51], a[192:195], v[48:51], a[48:51]
    s_waitcnt vmcnt(12)
    s_barrier
    v_mfma_f32_16x16x32_bf16 a[48:51], a[196:199], v[52:55], a[48:51]
    ds_read_b64_tr_b16 v[32:33], v16 offset:16384
    s_add_u32 m0, s57, 32768
    s_waitcnt lgkmcnt(1)
    v_mfma_f32_16x16x32_bf16 a[48:51], a[200:203], v[56:59], a[48:51]
    ds_read_b64_tr_b16 v[34:35], v16 offset:16896
    s_add_u32 s59, s48, 524288
    v_mfma_f32_16x16x32_bf16 a[48:51], a[204:207], v[60:63], a[48:51]
    ds_read_b64_tr_b16 v[36:37], v16 offset:20480
    buffer_load_dwordx4 v10, s[12:15], s59 offen lds
    v_mfma_f32_16x16x32_bf16 a[52:55], a[208:211], v[48:51], a[52:55]
    v_mfma_f32_16x16x32_bf16 a[52:55], a[212:215], v[52:55], a[52:55]
    ds_read_b64_tr_b16 v[38:39], v16 offset:20992
    v_mfma_f32_16x16x32_bf16 a[52:55], a[216:219], v[56:59], a[52:55]
    ds_read_b64_tr_b16 v[40:41], v16 offset:24576
    v_mfma_f32_16x16x32_bf16 a[52:55], a[220:223], v[60:63], a[52:55]
    ds_read_b64_tr_b16 v[42:43], v16 offset:25088
    buffer_load_dwordx4 v11, s[12:15], s59 offen offset:1024 lds
    v_mfma_f32_16x16x32_bf16 a[56:59], a[224:227], v[48:51], a[56:59]
    v_mfma_f32_16x16x32_bf16 a[56:59], a[228:231], v[52:55], a[56:59]
    ds_read_b64_tr_b16 v[44:45], v16 offset:28672
    s_add_u32 m0, s57, 40960
    v_mfma_f32_16x16x32_bf16 a[56:59], a[232:235], v[56:59], a[56:59]
    ds_read_b64_tr_b16 v[46:47], v16 offset:29184
    s_add_u32 s59, s48, 1572864
    v_mfma_f32_16x16x32_bf16 a[56:59], a[236:239], v[60:63], a[56:59]
    buffer_load_dwordx4 v10, s[12:15], s59 offen lds
    v_mfma_f32_16x16x32_bf16 a[60:63], a[240:243], v[48:51], a[60:63]
    v_mfma_f32_16x16x32_bf16 a[60:63], a[244:247], v[52:55], a[60:63]
    v_mfma_f32_16x16x32_bf16 a[60:63], a[248:251], v[56:59], a[60:63]
    v_mfma_f32_16x16x32_bf16 a[60:63], a[252:255], v[60:63], a[60:63]
    buffer_load_dwordx4 v11, s[12:15], s59 offen offset:1024 lds
    s_waitcnt lgkmcnt(4)
    v_mfma_f32_16x16x32_bf16 a[64:67], a[192:195], v[32:35], a[64:67]
    v_mfma_f32_16x16x32_bf16 a[64:67], a[196:199], v[36:39], a[64:67]
    ds_read_b64_tr_b16 v[48:49], v17 offset:16384
    s_waitcnt lgkmcnt(1)
    v_mfma_f32_16x16x32_bf16 a[64:67], a[200:203], v[40:43], a[64:67]
    ds_read_b64_tr_b16 v[50:51], v17 offset:16896
    v_mfma_f32_16x16x32_bf16 a[64:67], a[204:207], v[44:47], a[64:67]
    ds_read_b64_tr_b16 v[52:53], v17 offset:20480
    v_mfma_f32_16x16x32_bf16 a[68:71], a[208:211], v[32:35], a[68:71]
    v_mfma_f32_16x16x32_bf16 a[68:71], a[212:215], v[36:39], a[68:71]
    ds_read_b64_tr_b16 v[54:55], v17 offset:20992
    v_mfma_f32_16x16x32_bf16 a[68:71], a[216:219], v[40:43], a[68:71]
    ds_read_b64_tr_b16 v[56:57], v17 offset:24576
    s_add_u32 m0, s45, 0
    v_mfma_f32_16x16x32_bf16 a[68:71], a[220:223], v[44:47], a[68:71]
    ds_read_b64_tr_b16 v[58:59], v17 offset:25088
    s_add_u32 s58, s41, 128
    v_mfma_f32_16x16x32_bf16 a[72:75], a[224:227], v[32:35], a[72:75]
    buffer_load_dwordx4 v4, s[4:7], s58 offen lds
    v_mfma_f32_16x16x32_bf16 a[72:75], a[228:231], v[36:39], a[72:75]
    ds_read_b64_tr_b16 v[60:61], v17 offset:28672
    v_mfma_f32_16x16x32_bf16 a[72:75], a[232:235], v[40:43], a[72:75]
    ds_read_b64_tr_b16 v[62:63], v17 offset:29184
    v_mfma_f32_16x16x32_bf16 a[72:75], a[236:239], v[44:47], a[72:75]
    v_mfma_f32_16x16x32_bf16 a[76:79], a[240:243], v[32:35], a[76:79]
    buffer_load_dwordx4 v5, s[4:7], s58 offen offset:1024 lds
    v_mfma_f32_16x16x32_bf16 a[76:79], a[244:247], v[36:39], a[76:79]
    v_mfma_f32_16x16x32_bf16 a[76:79], a[248:251], v[40:43], a[76:79]
    s_add_u32 m0, s46, 0
    v_mfma_f32_16x16x32_bf16 a[76:79], a[252:255], v[44:47], a[76:79]
    s_add_u32 s58, s42, 128
    s_waitcnt lgkmcnt(4)
    v_mfma_f32_16x16x32_bf16 a[80:83], a[192:195], v[48:51], a[80:83]
    buffer_load_dwordx4 v4, s[4:7], s58 offen lds
    v_mfma_f32_16x16x32_bf16 a[80:83], a[196:199], v[52:55], a[80:83]
    ds_read_b64_tr_b16 v[32:33], v18 offset:16384
    s_waitcnt lgkmcnt(1)
    v_mfma_f32_16x16x32_bf16 a[80:83], a[200:203], v[56:59], a[80:83]
    ds_read_b64_tr_b16 v[34:35], v18 offset:16896
    v_mfma_f32_16x16x32_bf16 a[80:83], a[204:207], v[60:63], a[80:83]
    ds_read_b64_tr_b16 v[36:37], v18 offset:20480
    v_mfma_f32_16x16x32_bf16 a[84:87], a[208:211], v[48:51], a[84:87]
    buffer_load_dwordx4 v5, s[4:7], s58 offen offset:1024 lds
    v_mfma_f32_16x16x32_bf16 a[84:87], a[212:215], v[52:55], a[84:87]
    ds_read_b64_tr_b16 v[38:39], v18 offset:20992
    v_mfma_f32_16x16x32_bf16 a[84:87], a[216:219], v[56:59], a[84:87]
    ds_read_b64_tr_b16 v[40:41], v18 offset:24576
    s_add_u32 m0, s47, 0
    v_mfma_f32_16x16x32_bf16 a[84:87], a[220:223], v[60:63], a[84:87]
    ds_read_b64_tr_b16 v[42:43], v18 offset:25088
    s_add_u32 s58, s43, 128
    v_mfma_f32_16x16x32_bf16 a[88:91], a[224:227], v[48:51], a[88:91]
    buffer_load_dwordx4 v4, s[4:7], s58 offen lds
    v_mfma_f32_16x16x32_bf16 a[88:91], a[228:231], v[52:55], a[88:91]
    ds_read_b64_tr_b16 v[44:45], v18 offset:28672
    v_mfma_f32_16x16x32_bf16 a[88:91], a[232:235], v[56:59], a[88:91]
    ds_read_b64_tr_b16 v[46:47], v18 offset:29184
    v_mfma_f32_16x16x32_bf16 a[88:91], a[236:239], v[60:63], a[88:91]
    v_mfma_f32_16x16x32_bf16 a[92:95], a[240:243], v[48:51], a[92:95]
    buffer_load_dwordx4 v5, s[4:7], s58 offen offset:1024 lds
    v_mfma_f32_16x16x32_bf16 a[92:95], a[244:247], v[52:55], a[92:95]
    v_mfma_f32_16x16x32_bf16 a[92:95], a[248:251], v[56:59], a[92:95]
    v_mfma_f32_16x16x32_bf16 a[92:95], a[252:255], v[60:63], a[92:95]
    s_waitcnt lgkmcnt(4)
    v_mfma_f32_16x16x32_bf16 a[96:99], a[192:195], v[32:35], a[96:99]
    v_mfma_f32_16x16x32_bf16 a[96:99], a[196:199], v[36:39], a[96:99]
    ds_read_b64_tr_b16 v[48:49], v19 offset:16384
    s_waitcnt lgkmcnt(1)
    v_mfma_f32_16x16x32_bf16 a[96:99], a[200:203], v[40:43], a[96:99]
    ds_read_b64_tr_b16 v[50:51], v19 offset:16896
    v_mfma_f32_16x16x32_bf16 a[96:99], a[204:207], v[44:47], a[96:99]
    ds_read_b64_tr_b16 v[52:53], v19 offset:20480
    v_mfma_f32_16x16x32_bf16 a[100:103], a[208:211], v[32:35], a[100:103]
    v_mfma_f32_16x16x32_bf16 a[100:103], a[212:215], v[36:39], a[100:103]
    ds_read_b64_tr_b16 v[54:55], v19 offset:20992
    v_mfma_f32_16x16x32_bf16 a[100:103], a[216:219], v[40:43], a[100:103]
    ds_read_b64_tr_b16 v[56:57], v19 offset:24576
    v_mfma_f32_16x16x32_bf16 a[100:103], a[220:223], v[44:47], a[100:103]
    ds_read_b64_tr_b16 v[58:59], v19 offset:25088
    v_mfma_f32_16x16x32_bf16 a[104:107], a[224:227], v[32:35], a[104:107]
    v_mfma_f32_16x16x32_bf16 a[104:107], a[228:231], v[36:39], a[104:107]
    ds_read_b64_tr_b16 v[60:61], v19 offset:28672
    v_mfma_f32_16x16x32_bf16 a[104:107], a[232:235], v[40:43], a[104:107]
    ds_read_b64_tr_b16 v[62:63], v19 offset:29184
    v_mfma_f32_16x16x32_bf16 a[104:107], a[236:239], v[44:47], a[104:107]
    v_mfma_f32_16x16x32_bf16 a[108:111], a[240:243], v[32:35], a[108:111]
    v_mfma_f32_16x16x32_bf16 a[108:111], a[244:247], v[36:39], a[108:111]
    v_mfma_f32_16x16x32_bf16 a[108:111], a[248:251], v[40:43], a[108:111]
    v_mfma_f32_16x16x32_bf16 a[108:111], a[252:255], v[44:47], a[108:111]
    s_waitcnt lgkmcnt(4)
    v_mfma_f32_16x16x32_bf16 a[112:115], a[192:195], v[48:51], a[112:115]
    s_waitcnt vmcnt(18)
    s_barrier
    v_mfma_f32_16x16x32_bf16 a[112:115], a[196:199], v[52:55], a[112:115]
    ds_read_b64_tr_b16 v[32:33], v12 offset:0
    s_add_u32 m0, s57, 49152
    s_waitcnt lgkmcnt(1)
    v_mfma_f32_16x16x32_bf16 a[112:115], a[200:203], v[56:59], a[112:115]
    ds_read_b64_tr_b16 v[34:35], v12 offset:512
    s_add_u32 s59, s48, 524416
    v_mfma_f32_16x16x32_bf16 a[112:115], a[204:207], v[60:63], a[112:115]
    ds_read_b64_tr_b16 v[36:37], v12 offset:4096
    buffer_load_dwordx4 v10, s[12:15], s59 offen lds
    v_mfma_f32_16x16x32_bf16 a[116:119], a[208:211], v[48:51], a[116:119]
    v_mfma_f32_16x16x32_bf16 a[116:119], a[212:215], v[52:55], a[116:119]
    ds_read_b64_tr_b16 v[38:39], v12 offset:4608
    v_mfma_f32_16x16x32_bf16 a[116:119], a[216:219], v[56:59], a[116:119]
    ds_read_b64_tr_b16 v[40:41], v12 offset:8192
    v_mfma_f32_16x16x32_bf16 a[116:119], a[220:223], v[60:63], a[116:119]
    ds_read_b64_tr_b16 v[42:43], v12 offset:8704
    buffer_load_dwordx4 v11, s[12:15], s59 offen offset:1024 lds
    v_mfma_f32_16x16x32_bf16 a[120:123], a[224:227], v[48:51], a[120:123]
    v_mfma_f32_16x16x32_bf16 a[120:123], a[228:231], v[52:55], a[120:123]
    ds_read_b64_tr_b16 v[44:45], v12 offset:12288
    s_add_u32 m0, s57, 57344
    v_mfma_f32_16x16x32_bf16 a[120:123], a[232:235], v[56:59], a[120:123]
    ds_read_b64_tr_b16 v[46:47], v12 offset:12800
    s_add_u32 s59, s48, 1572992
    v_mfma_f32_16x16x32_bf16 a[120:123], a[236:239], v[60:63], a[120:123]
    buffer_load_dwordx4 v10, s[12:15], s59 offen lds
    v_mfma_f32_16x16x32_bf16 a[124:127], a[240:243], v[48:51], a[124:127]
    v_mfma_f32_16x16x32_bf16 a[124:127], a[244:247], v[52:55], a[124:127]
    v_mfma_f32_16x16x32_bf16 a[124:127], a[248:251], v[56:59], a[124:127]
    v_mfma_f32_16x16x32_bf16 a[124:127], a[252:255], v[60:63], a[124:127]
    buffer_load_dwordx4 v11, s[12:15], s59 offen offset:1024 lds
    s_waitcnt lgkmcnt(4)
    v_mfma_f32_16x16x32_bf16 v[96:99], v[32:35], a[192:195], v[96:99]
    v_mfma_f32_16x16x32_bf16 v[96:99], v[36:39], a[196:199], v[96:99]
    ds_read_b64_tr_b16 v[48:49], v13 offset:0
    s_add_u32 m0, s45, 8192
    s_waitcnt lgkmcnt(1)
    v_mfma_f32_16x16x32_bf16 v[96:99], v[40:43], a[200:203], v[96:99]
    ds_read_b64_tr_b16 v[50:51], v13 offset:512
    s_add_u32 s58, s41, 384
    v_mfma_f32_16x16x32_bf16 v[96:99], v[44:47], a[204:207], v[96:99]
    ds_read_b64_tr_b16 v[52:53], v13 offset:4096
    buffer_load_dwordx4 v4, s[4:7], s58 offen lds
    v_mfma_f32_16x16x32_bf16 v[100:103], v[32:35], a[208:211], v[100:103]
    v_mfma_f32_16x16x32_bf16 v[100:103], v[36:39], a[212:215], v[100:103]
    ds_read_b64_tr_b16 v[54:55], v13 offset:4608
    v_mfma_f32_16x16x32_bf16 v[100:103], v[40:43], a[216:219], v[100:103]
    ds_read_b64_tr_b16 v[56:57], v13 offset:8192
    v_mfma_f32_16x16x32_bf16 v[100:103], v[44:47], a[220:223], v[100:103]
    ds_read_b64_tr_b16 v[58:59], v13 offset:8704
    buffer_load_dwordx4 v5, s[4:7], s58 offen offset:1024 lds
    v_mfma_f32_16x16x32_bf16 v[104:107], v[32:35], a[224:227], v[104:107]
    v_mfma_f32_16x16x32_bf16 v[104:107], v[36:39], a[228:231], v[104:107]
    ds_read_b64_tr_b16 v[60:61], v13 offset:12288
    s_add_u32 m0, s46, 8192
    v_mfma_f32_16x16x32_bf16 v[104:107], v[40:43], a[232:235], v[104:107]
    ds_read_b64_tr_b16 v[62:63], v13 offset:12800
    s_add_u32 s58, s42, 384
    v_mfma_f32_16x16x32_bf16 v[104:107], v[44:47], a[236:239], v[104:107]
    buffer_load_dwordx4 v4, s[4:7], s58 offen lds
    v_mfma_f32_16x16x32_bf16 v[108:111], v[32:35], a[240:243], v[108:111]
    v_mfma_f32_16x16x32_bf16 v[108:111], v[36:39], a[244:247], v[108:111]
    v_mfma_f32_16x16x32_bf16 v[108:111], v[40:43], a[248:251], v[108:111]
    v_mfma_f32_16x16x32_bf16 v[108:111], v[44:47], a[252:255], v[108:111]
    buffer_load_dwordx4 v5, s[4:7], s58 offen offset:1024 lds
    s_waitcnt lgkmcnt(4)
    v_mfma_f32_16x16x32_bf16 v[64:67], v[48:51], a[192:195], v[64:67]
    v_mfma_f32_16x16x32_bf16 v[64:67], v[52:55], a[196:199], v[64:67]
    ds_read_b64_tr_b16 v[32:33], v14 offset:0
    s_add_u32 m0, s47, 8192
    s_waitcnt lgkmcnt(1)
    v_mfma_f32_16x16x32_bf16 v[64:67], v[56:59], a[200:203], v[64:67]
    ds_read_b64_tr_b16 v[34:35], v14 offset:512
    s_add_u32 s58, s43, 384
    v_mfma_f32_16x16x32_bf16 v[64:67], v[60:63], a[204:207], v[64:67]
    ds_read_b64_tr_b16 v[36:37], v14 offset:4096
    buffer_load_dwordx4 v4, s[4:7], s58 offen lds
    v_mfma_f32_16x16x32_bf16 v[68:71], v[48:51], a[208:211], v[68:71]
    v_mfma_f32_16x16x32_bf16 v[68:71], v[52:55], a[212:215], v[68:71]
    ds_read_b64_tr_b16 v[38:39], v14 offset:4608
    v_mfma_f32_16x16x32_bf16 v[68:71], v[56:59], a[216:219], v[68:71]
    ds_read_b64_tr_b16 v[40:41], v14 offset:8192
    v_mfma_f32_16x16x32_bf16 v[68:71], v[60:63], a[220:223], v[68:71]
    ds_read_b64_tr_b16 v[42:43], v14 offset:8704
    buffer_load_dwordx4 v5, s[4:7], s58 offen offset:1024 lds
    v_mfma_f32_16x16x32_bf16 v[72:75], v[48:51], a[224:227], v[72:75]
    v_mfma_f32_16x16x32_bf16 v[72:75], v[52:55], a[228:231], v[72:75]
    ds_read_b64_tr_b16 v[44:45], v14 offset:12288
    v_mfma_f32_16x16x32_bf16 v[72:75], v[56:59], a[232:235], v[72:75]
    ds_read_b64_tr_b16 v[46:47], v14 offset:12800
    s_add_u32 s59, s49, 2621440
    v_mfma_f32_16x16x32_bf16 v[72:75], v[60:63], a[236:239], v[72:75]
    buffer_load_dwordx4 v[20:23], v3, s[12:15], s59 offen
    v_mfma_f32_16x16x32_bf16 v[76:79], v[48:51], a[240:243], v[76:79]
    v_mfma_f32_16x16x32_bf16 v[76:79], v[52:55], a[244:247], v[76:79]
    v_mfma_f32_16x16x32_bf16 v[76:79], v[56:59], a[248:251], v[76:79]
    s_add_u32 s59, s49, 2621440
    v_mfma_f32_16x16x32_bf16 v[76:79], v[60:63], a[252:255], v[76:79]
    buffer_load_dwordx4 v[20:23], v3, s[8:11], s59 offen
    s_waitcnt lgkmcnt(4)
    v_mfma_f32_16x16x32_bf16 v[112:115], v[32:35], a[192:195], v[112:115]
    v_mfma_f32_16x16x32_bf16 v[112:115], v[36:39], a[196:199], v[112:115]
    ds_read_b64_tr_b16 v[48:49], v15 offset:0
    s_waitcnt lgkmcnt(1)
    v_mfma_f32_16x16x32_bf16 v[112:115], v[40:43], a[200:203], v[112:115]
    ds_read_b64_tr_b16 v[50:51], v15 offset:512
    v_mfma_f32_16x16x32_bf16 v[112:115], v[44:47], a[204:207], v[112:115]
    ds_read_b64_tr_b16 v[52:53], v15 offset:4096
    v_mfma_f32_16x16x32_bf16 v[116:119], v[32:35], a[208:211], v[116:119]
    s_add_u32 s20, s54, s63
    s_addc_u32 s21, s55, 0
    v_mfma_f32_16x16x32_bf16 v[116:119], v[36:39], a[212:215], v[116:119]
    ds_read_b64_tr_b16 v[54:55], v15 offset:4608
    s_sub_u32 s22, 4194304, s63
    v_mfma_f32_16x16x32_bf16 v[116:119], v[40:43], a[216:219], v[116:119]
    ds_read_b64_tr_b16 v[56:57], v15 offset:8192
    s_mov_b32 s23, 0x00020000
    v_mfma_f32_16x16x32_bf16 v[116:119], v[44:47], a[220:223], v[116:119]
    ds_read_b64_tr_b16 v[58:59], v15 offset:8704
    s_and_b32 s27, s25, 3
    v_mfma_f32_16x16x32_bf16 v[120:123], v[32:35], a[224:227], v[120:123]
    s_max_u32 s27, s27, 1
    v_mfma_f32_16x16x32_bf16 v[120:123], v[36:39], a[228:231], v[120:123]
    ds_read_b64_tr_b16 v[60:61], v15 offset:12288
    s_lshr_b32 s52, s25, 2
    v_mfma_f32_16x16x32_bf16 v[120:123], v[40:43], a[232:235], v[120:123]
    ds_read_b64_tr_b16 v[62:63], v15 offset:12800
    s_mul_i32 s52, s52, 3
    v_mfma_f32_16x16x32_bf16 v[120:123], v[44:47], a[236:239], v[120:123]
    s_add_u32 s52, s52, s27
    v_mfma_f32_16x16x32_bf16 v[124:127], v[32:35], a[240:243], v[124:127]
    s_sub_u32 s52, s52, 1
    v_mfma_f32_16x16x32_bf16 v[124:127], v[36:39], a[244:247], v[124:127]
    s_lshl_b32 s52, s52, 7
    v_mfma_f32_16x16x32_bf16 v[124:127], v[40:43], a[248:251], v[124:127]
    s_add_u32 s28, s64, s52
    s_addc_u32 s29, s65, 0
    v_mfma_f32_16x16x32_bf16 v[124:127], v[44:47], a[252:255], v[124:127]
    s_sub_u32 s30, 1409024, s52
    s_waitcnt lgkmcnt(4)
    v_mfma_f32_16x16x32_bf16 v[80:83], v[48:51], a[192:195], v[80:83]
    s_mov_b32 s31, 0x00020000
    s_waitcnt vmcnt(26)
    s_barrier
    v_mfma_f32_16x16x32_bf16 v[80:83], v[52:55], a[196:199], v[80:83]
    ds_read_b64_tr_b16 v[32:33], v12 offset:16384
    s_add_u32 m0, s57, 65536
    v_lshrrev_b32 v26, 3, v2
    s_waitcnt lgkmcnt(1)
    v_mfma_f32_16x16x32_bf16 v[80:83], v[56:59], a[200:203], v[80:83]
    ds_read_b64_tr_b16 v[34:35], v12 offset:16896
    s_add_u32 s59, s48, 524288
    v_mul_u32_u24 v26, 2752, v26
    v_mfma_f32_16x16x32_bf16 v[80:83], v[60:63], a[204:207], v[80:83]
    ds_read_b64_tr_b16 v[36:37], v12 offset:20480
    buffer_load_dwordx4 v10, s[8:11], s59 offen lds
    v_and_b32 v1, 7, v2
    v_mfma_f32_16x16x32_bf16 v[84:87], v[48:51], a[208:211], v[84:87]
    v_lshl_add_u32 v26, v1, 4, v26
    v_mfma_f32_16x16x32_bf16 v[84:87], v[52:55], a[212:215], v[84:87]
    ds_read_b64_tr_b16 v[38:39], v12 offset:20992
    s_lshl_b32 s52, s26, 2
    v_mfma_f32_16x16x32_bf16 v[84:87], v[56:59], a[216:219], v[84:87]
    ds_read_b64_tr_b16 v[40:41], v12 offset:24576
    s_add_u32 s52, s52, s24
    v_mfma_f32_16x16x32_bf16 v[84:87], v[60:63], a[220:223], v[84:87]
    ds_read_b64_tr_b16 v[42:43], v12 offset:25088
    buffer_load_dwordx4 v11, s[8:11], s59 offen offset:1024 lds
    s_mul_i32 s53, s52, 44032
    v_mfma_f32_16x16x32_bf16 v[88:91], v[48:51], a[224:227], v[88:91]
    s_lshr_b32 s52, s2, 3
    v_mfma_f32_16x16x32_bf16 v[88:91], v[52:55], a[228:231], v[88:91]
    ds_read_b64_tr_b16 v[44:45], v12 offset:28672
    s_add_u32 m0, s57, 73728
    s_lshl_b32 s52, s52, 2
    v_mfma_f32_16x16x32_bf16 v[88:91], v[56:59], a[232:235], v[88:91]
    ds_read_b64_tr_b16 v[46:47], v12 offset:29184
    s_add_u32 s59, s48, 1572864
    s_add_u32 s52, s52, s24
    v_mfma_f32_16x16x32_bf16 v[88:91], v[60:63], a[236:239], v[88:91]
    buffer_load_dwordx4 v10, s[8:11], s59 offen lds
    s_lshl_b32 s52, s52, 15
    v_mfma_f32_16x16x32_bf16 v[92:95], v[48:51], a[240:243], v[92:95]
    s_and_b32 s27, s25, 3
    v_mfma_f32_16x16x32_bf16 v[92:95], v[52:55], a[244:247], v[92:95]
    s_lshl_b32 s27, s27, 8
    v_mfma_f32_16x16x32_bf16 v[92:95], v[56:59], a[248:251], v[92:95]
    s_sub_u32 s52, s52, s27
    v_mfma_f32_16x16x32_bf16 v[92:95], v[60:63], a[252:255], v[92:95]
    buffer_load_dwordx4 v11, s[8:11], s59 offen offset:1024 lds
    buffer_load_dwordx4 v[20:23], v3, s[20:23], s52 offen
    s_waitcnt lgkmcnt(4)
    v_mfma_f32_16x16x32_bf16 v[160:163], v[32:35], a[192:195], v[160:163]
    v_mfma_f32_16x16x32_bf16 v[160:163], v[36:39], a[196:199], v[160:163]
    ds_read_b64_tr_b16 v[48:49], v13 offset:16384
    s_waitcnt lgkmcnt(1)
    v_mfma_f32_16x16x32_bf16 v[160:163], v[40:43], a[200:203], v[160:163]
    ds_read_b64_tr_b16 v[50:51], v13 offset:16896
    v_mfma_f32_16x16x32_bf16 v[160:163], v[44:47], a[204:207], v[160:163]
    ds_read_b64_tr_b16 v[52:53], v13 offset:20480
    s_add_u32 s52, s52, 8192
    s_waitcnt vmcnt(17)
    v_mfma_f32_16x16x32_bf16 v[164:167], v[32:35], a[208:211], v[164:167]
    ds_read_b128 a[128:131], v8 offset:0
    buffer_load_dwordx4 v[20:23], v3, s[20:23], s52 offen
    v_mfma_f32_16x16x32_bf16 v[164:167], v[36:39], a[212:215], v[164:167]
    ds_read_b64_tr_b16 v[54:55], v13 offset:20992
    v_mfma_f32_16x16x32_bf16 v[164:167], v[40:43], a[216:219], v[164:167]
    ds_read_b64_tr_b16 v[56:57], v13 offset:24576
    ds_read_b128 a[132:135], v9 offset:0
    v_mfma_f32_16x16x32_bf16 v[164:167], v[44:47], a[220:223], v[164:167]
    ds_read_b64_tr_b16 v[58:59], v13 offset:25088
    v_mfma_f32_16x16x32_bf16 v[168:171], v[32:35], a[224:227], v[168:171]
    ds_read_b128 a[144:147], v8 offset:2048
    s_add_u32 s52, s52, 8192
    v_mfma_f32_16x16x32_bf16 v[168:171], v[36:39], a[228:231], v[168:171]
    ds_read_b64_tr_b16 v[60:61], v13 offset:28672
    buffer_load_dwordx4 v[20:23], v3, s[20:23], s52 offen
    v_mfma_f32_16x16x32_bf16 v[168:171], v[40:43], a[232:235], v[168:171]
    ds_read_b64_tr_b16 v[62:63], v13 offset:29184
    ds_read_b128 a[148:151], v9 offset:2048
    v_mfma_f32_16x16x32_bf16 v[168:171], v[44:47], a[236:239], v[168:171]
    v_mfma_f32_16x16x32_bf16 v[172:175], v[32:35], a[240:243], v[172:175]
    ds_read_b128 a[160:163], v8 offset:4096
    v_mfma_f32_16x16x32_bf16 v[172:175], v[36:39], a[244:247], v[172:175]
    s_add_u32 s52, s52, 8192
    v_mfma_f32_16x16x32_bf16 v[172:175], v[40:43], a[248:251], v[172:175]
    ds_read_b128 a[164:167], v9 offset:4096
    buffer_load_dwordx4 v[20:23], v3, s[20:23], s52 offen
    v_mfma_f32_16x16x32_bf16 v[172:175], v[44:47], a[252:255], v[172:175]
    s_waitcnt lgkmcnt(9)
    v_mfma_f32_16x16x32_bf16 v[128:131], v[48:51], a[192:195], v[128:131]
    ds_read_b128 a[176:179], v8 offset:6144
    v_mfma_f32_16x16x32_bf16 v[128:131], v[52:55], a[196:199], v[128:131]
    ds_read_b64_tr_b16 v[32:33], v14 offset:16384
    s_waitcnt lgkmcnt(5)
    v_mfma_f32_16x16x32_bf16 v[128:131], v[56:59], a[200:203], v[128:131]
    ds_read_b64_tr_b16 v[34:35], v14 offset:16896
    ds_read_b128 a[180:183], v9 offset:6144
    s_add_u32 s52, s52, 8192
    v_mfma_f32_16x16x32_bf16 v[128:131], v[60:63], a[204:207], v[128:131]
    ds_read_b64_tr_b16 v[36:37], v14 offset:20480
    buffer_load_dwordx4 v[20:23], v26, s[28:31], s53 offen
    v_mfma_f32_16x16x32_bf16 v[132:135], v[48:51], a[208:211], v[132:135]
    v_mfma_f32_16x16x32_bf16 v[132:135], v[52:55], a[212:215], v[132:135]
    ds_read_b64_tr_b16 v[38:39], v14 offset:20992
    v_mfma_f32_16x16x32_bf16 v[132:135], v[56:59], a[216:219], v[132:135]
    ds_read_b64_tr_b16 v[40:41], v14 offset:24576
    v_mfma_f32_16x16x32_bf16 v[132:135], v[60:63], a[220:223], v[132:135]
    ds_read_b64_tr_b16 v[42:43], v14 offset:25088
    s_add_u32 s53, s53, 22016
    v_mfma_f32_16x16x32_bf16 v[136:139], v[48:51], a[224:227], v[136:139]
    buffer_load_dwordx4 v[20:23], v26, s[28:31], s53 offen
    v_mfma_f32_16x16x32_bf16 v[136:139], v[52:55], a[228:231], v[136:139]
    ds_read_b64_tr_b16 v[44:45], v14 offset:28672
    v_mfma_f32_16x16x32_bf16 v[136:139], v[56:59], a[232:235], v[136:139]
    ds_read_b64_tr_b16 v[46:47], v14 offset:29184
    v_mfma_f32_16x16x32_bf16 v[136:139], v[60:63], a[236:239], v[136:139]
    v_mfma_f32_16x16x32_bf16 v[140:143], v[48:51], a[240:243], v[140:143]
    s_add_u32 s53, s53, 22016
    v_mfma_f32_16x16x32_bf16 v[140:143], v[52:55], a[244:247], v[140:143]
    s_getpc_b64 s[38:39]
K1_PC2:
    s_add_u32 s38, s38, K2_BEGIN-K1_PC2
    s_addc_u32 s39, s39, 0
    s_waitcnt vmcnt(12)
    v_mfma_f32_16x16x32_bf16 v[140:143], v[56:59], a[248:251], v[140:143]
    ds_read_b128 a[136:139], v8 offset:8192
    s_bfe_u32 s27, s2, 0x50003
    v_mfma_f32_16x16x32_bf16 v[140:143], v[60:63], a[252:255], v[140:143]
    s_lshl_b32 s27, s27, 11
    s_waitcnt lgkmcnt(5)
    v_mfma_f32_16x16x32_bf16 v[176:179], v[32:35], a[192:195], v[176:179]
    ds_read_b128 a[140:143], v9 offset:8192
    v_lshlrev_b32 v24, 3, v0
    v_mfma_f32_16x16x32_bf16 v[176:179], v[36:39], a[196:199], v[176:179]
    ds_read_b64_tr_b16 v[48:49], v15 offset:16384
    v_add_u32 v24, s27, v24
    s_waitcnt lgkmcnt(3)
    v_mfma_f32_16x16x32_bf16 v[176:179], v[40:43], a[200:203], v[176:179]
    ds_read_b64_tr_b16 v[50:51], v15 offset:16896
    ds_read_b128 a[152:155], v8 offset:10240
    global_load_dwordx2 v[20:21], v24, s[38:39]
    v_mfma_f32_16x16x32_bf16 v[176:179], v[44:47], a[204:207], v[176:179]
    ds_read_b64_tr_b16 v[52:53], v15 offset:20480
    v_mfma_f32_16x16x32_bf16 v[180:183], v[32:35], a[208:211], v[180:183]
    ds_read_b128 a[156:159], v9 offset:10240
    v_mfma_f32_16x16x32_bf16 v[180:183], v[36:39], a[212:215], v[180:183]
    ds_read_b64_tr_b16 v[54:55], v15 offset:20992
    v_mfma_f32_16x16x32_bf16 v[180:183], v[40:43], a[216:219], v[180:183]
    ds_read_b64_tr_b16 v[56:57], v15 offset:24576
    ds_read_b128 a[168:171], v8 offset:12288
    v_mfma_f32_16x16x32_bf16 v[180:183], v[44:47], a[220:223], v[180:183]
    ds_read_b64_tr_b16 v[58:59], v15 offset:25088
    v_mfma_f32_16x16x32_bf16 v[184:187], v[32:35], a[224:227], v[184:187]
    ds_read_b128 a[172:175], v9 offset:12288
    v_mfma_f32_16x16x32_bf16 v[184:187], v[36:39], a[228:231], v[184:187]
    ds_read_b64_tr_b16 v[60:61], v15 offset:28672
    v_mfma_f32_16x16x32_bf16 v[184:187], v[40:43], a[232:235], v[184:187]
    ds_read_b64_tr_b16 v[62:63], v15 offset:29184
    ds_read_b128 a[184:187], v8 offset:14336
    v_mfma_f32_16x16x32_bf16 v[184:187], v[44:47], a[236:239], v[184:187]
    v_mfma_f32_16x16x32_bf16 v[188:191], v[32:35], a[240:243], v[188:191]
    ds_read_b128 a[188:191], v9 offset:14336
    v_mfma_f32_16x16x32_bf16 v[188:191], v[36:39], a[244:247], v[188:191]
    v_mfma_f32_16x16x32_bf16 v[188:191], v[40:43], a[248:251], v[188:191]
    v_mfma_f32_16x16x32_bf16 v[188:191], v[44:47], a[252:255], v[188:191]
    s_waitcnt lgkmcnt(8)
    v_mfma_f32_16x16x32_bf16 v[144:147], v[48:51], a[192:195], v[144:147]
    s_waitcnt vmcnt(29)
    s_barrier
    v_mfma_f32_16x16x32_bf16 v[144:147], v[52:55], a[196:199], v[144:147]
    ds_read_b64_tr_b16 v[32:33], v12 offset:32768
    s_add_u32 m0, s57, 81920
    s_waitcnt lgkmcnt(3)
    v_mfma_f32_16x16x32_bf16 v[144:147], v[56:59], a[200:203], v[144:147]
    ds_read_b64_tr_b16 v[34:35], v12 offset:33280
    s_add_u32 s59, s48, 524416
    v_mfma_f32_16x16x32_bf16 v[144:147], v[60:63], a[204:207], v[144:147]
    ds_read_b64_tr_b16 v[36:37], v12 offset:36864
    buffer_load_dwordx4 v10, s[8:11], s59 offen lds
    v_mfma_f32_16x16x32_bf16 v[148:151], v[48:51], a[208:211], v[148:151]
    v_mfma_f32_16x16x32_bf16 v[148:151], v[52:55], a[212:215], v[148:151]
    ds_read_b64_tr_b16 v[38:39], v12 offset:37376
    v_mfma_f32_16x16x32_bf16 v[148:151], v[56:59], a[216:219], v[148:151]
    ds_read_b64_tr_b16 v[40:41], v12 offset:40960
    v_mfma_f32_16x16x32_bf16 v[148:151], v[60:63], a[220:223], v[148:151]
    ds_read_b64_tr_b16 v[42:43], v12 offset:41472
    buffer_load_dwordx4 v11, s[8:11], s59 offen offset:1024 lds
    v_mfma_f32_16x16x32_bf16 v[152:155], v[48:51], a[224:227], v[152:155]
    v_mfma_f32_16x16x32_bf16 v[152:155], v[52:55], a[228:231], v[152:155]
    ds_read_b64_tr_b16 v[44:45], v12 offset:45056
    s_add_u32 m0, s57, 90112
    v_mfma_f32_16x16x32_bf16 v[152:155], v[56:59], a[232:235], v[152:155]
    ds_read_b64_tr_b16 v[46:47], v12 offset:45568
    s_add_u32 s59, s48, 1572992
    v_mfma_f32_16x16x32_bf16 v[152:155], v[60:63], a[236:239], v[152:155]
    buffer_load_dwordx4 v10, s[8:11], s59 offen lds
    v_mfma_f32_16x16x32_bf16 v[156:159], v[48:51], a[240:243], v[156:159]
    v_mfma_f32_16x16x32_bf16 v[156:159], v[52:55], a[244:247], v[156:159]
    v_mfma_f32_16x16x32_bf16 v[156:159], v[56:59], a[248:251], v[156:159]
    v_mfma_f32_16x16x32_bf16 v[156:159], v[60:63], a[252:255], v[156:159]
    buffer_load_dwordx4 v11, s[8:11], s59 offen offset:1024 lds
    s_waitcnt lgkmcnt(4)
    v_mfma_f32_16x16x32_bf16 a[0:3], a[128:131], v[32:35], a[0:3]
    v_mfma_f32_16x16x32_bf16 a[0:3], a[132:135], v[36:39], a[0:3]
    ds_read_b64_tr_b16 v[48:49], v13 offset:32768
    s_add_u32 m0, s44, 0
    s_waitcnt lgkmcnt(1)
    v_mfma_f32_16x16x32_bf16 a[0:3], a[136:139], v[40:43], a[0:3]
    ds_read_b64_tr_b16 v[50:51], v13 offset:33280
    s_add_u32 s58, s40, 640
    v_mfma_f32_16x16x32_bf16 a[0:3], a[140:143], v[44:47], a[0:3]
    ds_read_b64_tr_b16 v[52:53], v13 offset:36864
    buffer_load_dwordx4 v4, s[4:7], s58 offen lds
    v_mfma_f32_16x16x32_bf16 a[4:7], a[144:147], v[32:35], a[4:7]
    v_mfma_f32_16x16x32_bf16 a[4:7], a[148:151], v[36:39], a[4:7]
    ds_read_b64_tr_b16 v[54:55], v13 offset:37376
    v_mfma_f32_16x16x32_bf16 a[4:7], a[152:155], v[40:43], a[4:7]
    ds_read_b64_tr_b16 v[56:57], v13 offset:40960
    v_mfma_f32_16x16x32_bf16 a[4:7], a[156:159], v[44:47], a[4:7]
    ds_read_b64_tr_b16 v[58:59], v13 offset:41472
    buffer_load_dwordx4 v5, s[4:7], s58 offen offset:1024 lds
    v_mfma_f32_16x16x32_bf16 a[8:11], a[160:163], v[32:35], a[8:11]
    v_mfma_f32_16x16x32_bf16 a[8:11], a[164:167], v[36:39], a[8:11]
    ds_read_b64_tr_b16 v[60:61], v13 offset:45056
    s_add_u32 m0, s44, 8192
    v_mfma_f32_16x16x32_bf16 a[8:11], a[168:171], v[40:43], a[8:11]
    ds_read_b64_tr_b16 v[62:63], v13 offset:45568
    s_add_u32 s58, s40, 896
    v_mfma_f32_16x16x32_bf16 a[8:11], a[172:175], v[44:47], a[8:11]
    buffer_load_dwordx4 v4, s[4:7], s58 offen lds
    v_mfma_f32_16x16x32_bf16 a[12:15], a[176:179], v[32:35], a[12:15]
    v_mfma_f32_16x16x32_bf16 a[12:15], a[180:183], v[36:39], a[12:15]
    v_mfma_f32_16x16x32_bf16 a[12:15], a[184:187], v[40:43], a[12:15]
    v_mfma_f32_16x16x32_bf16 a[12:15], a[188:191], v[44:47], a[12:15]
    buffer_load_dwordx4 v5, s[4:7], s58 offen offset:1024 lds
    s_waitcnt lgkmcnt(4)
    v_mfma_f32_16x16x32_bf16 a[16:19], a[128:131], v[48:51], a[16:19]
    v_mfma_f32_16x16x32_bf16 a[16:19], a[132:135], v[52:55], a[16:19]
    ds_read_b64_tr_b16 v[32:33], v14 offset:32768
    s_waitcnt lgkmcnt(1)
    v_mfma_f32_16x16x32_bf16 a[16:19], a[136:139], v[56:59], a[16:19]
    ds_read_b64_tr_b16 v[34:35], v14 offset:33280
    v_mfma_f32_16x16x32_bf16 a[16:19], a[140:143], v[60:63], a[16:19]
    ds_read_b64_tr_b16 v[36:37], v14 offset:36864
    v_mfma_f32_16x16x32_bf16 a[20:23], a[144:147], v[48:51], a[20:23]
    v_mfma_f32_16x16x32_bf16 a[20:23], a[148:151], v[52:55], a[20:23]
    ds_read_b64_tr_b16 v[38:39], v14 offset:37376
    v_mfma_f32_16x16x32_bf16 a[20:23], a[152:155], v[56:59], a[20:23]
    ds_read_b64_tr_b16 v[40:41], v14 offset:40960
    v_mfma_f32_16x16x32_bf16 a[20:23], a[156:159], v[60:63], a[20:23]
    ds_read_b64_tr_b16 v[42:43], v14 offset:41472
    v_mfma_f32_16x16x32_bf16 a[24:27], a[160:163], v[48:51], a[24:27]
    v_mfma_f32_16x16x32_bf16 a[24:27], a[164:167], v[52:55], a[24:27]
    ds_read_b64_tr_b16 v[44:45], v14 offset:45056
    v_mfma_f32_16x16x32_bf16 a[24:27], a[168:171], v[56:59], a[24:27]
    ds_read_b64_tr_b16 v[46:47], v14 offset:45568
    v_mfma_f32_16x16x32_bf16 a[24:27], a[172:175], v[60:63], a[24:27]
    v_mfma_f32_16x16x32_bf16 a[28:31], a[176:179], v[48:51], a[28:31]
    v_mfma_f32_16x16x32_bf16 a[28:31], a[180:183], v[52:55], a[28:31]
    v_mfma_f32_16x16x32_bf16 a[28:31], a[184:187], v[56:59], a[28:31]
    v_mfma_f32_16x16x32_bf16 a[28:31], a[188:191], v[60:63], a[28:31]
    s_waitcnt lgkmcnt(4)
    v_mfma_f32_16x16x32_bf16 a[32:35], a[128:131], v[32:35], a[32:35]
    v_mfma_f32_16x16x32_bf16 a[32:35], a[132:135], v[36:39], a[32:35]
    ds_read_b64_tr_b16 v[48:49], v15 offset:32768
    s_waitcnt lgkmcnt(1)
    v_mfma_f32_16x16x32_bf16 a[32:35], a[136:139], v[40:43], a[32:35]
    ds_read_b64_tr_b16 v[50:51], v15 offset:33280
    v_mfma_f32_16x16x32_bf16 a[32:35], a[140:143], v[44:47], a[32:35]
    ds_read_b64_tr_b16 v[52:53], v15 offset:36864
    v_mfma_f32_16x16x32_bf16 a[36:39], a[144:147], v[32:35], a[36:39]
    v_mfma_f32_16x16x32_bf16 a[36:39], a[148:151], v[36:39], a[36:39]
    ds_read_b64_tr_b16 v[54:55], v15 offset:37376
    v_mfma_f32_16x16x32_bf16 a[36:39], a[152:155], v[40:43], a[36:39]
    ds_read_b64_tr_b16 v[56:57], v15 offset:40960
    v_mfma_f32_16x16x32_bf16 a[36:39], a[156:159], v[44:47], a[36:39]
    ds_read_b64_tr_b16 v[58:59], v15 offset:41472
    v_mfma_f32_16x16x32_bf16 a[40:43], a[160:163], v[32:35], a[40:43]
    v_mfma_f32_16x16x32_bf16 a[40:43], a[164:167], v[36:39], a[40:43]
    ds_read_b64_tr_b16 v[60:61], v15 offset:45056
    v_mfma_f32_16x16x32_bf16 a[40:43], a[168:171], v[40:43], a[40:43]
    ds_read_b64_tr_b16 v[62:63], v15 offset:45568
    v_mfma_f32_16x16x32_bf16 a[40:43], a[172:175], v[44:47], a[40:43]
    v_mfma_f32_16x16x32_bf16 a[44:47], a[176:179], v[32:35], a[44:47]
    v_mfma_f32_16x16x32_bf16 a[44:47], a[180:183], v[36:39], a[44:47]
    v_mfma_f32_16x16x32_bf16 a[44:47], a[184:187], v[40:43], a[44:47]
    v_mfma_f32_16x16x32_bf16 a[44:47], a[188:191], v[44:47], a[44:47]
    s_waitcnt lgkmcnt(4)
    v_mfma_f32_16x16x32_bf16 a[48:51], a[128:131], v[48:51], a[48:51]
    s_waitcnt vmcnt(27)
    s_barrier
    v_mfma_f32_16x16x32_bf16 a[48:51], a[132:135], v[52:55], a[48:51]
    ds_read_b64_tr_b16 v[32:33], v12 offset:49152
    s_add_u32 m0, s57, 0
    s_waitcnt lgkmcnt(1)
    v_mfma_f32_16x16x32_bf16 a[48:51], a[136:139], v[56:59], a[48:51]
    ds_read_b64_tr_b16 v[34:35], v12 offset:49664
    s_add_u32 s59, s48, 2621440
    v_mfma_f32_16x16x32_bf16 a[48:51], a[140:143], v[60:63], a[48:51]
    ds_read_b64_tr_b16 v[36:37], v12 offset:53248
    buffer_load_dwordx4 v10, s[12:15], s59 offen lds
    v_mfma_f32_16x16x32_bf16 a[52:55], a[144:147], v[48:51], a[52:55]
    v_mfma_f32_16x16x32_bf16 a[52:55], a[148:151], v[52:55], a[52:55]
    ds_read_b64_tr_b16 v[38:39], v12 offset:53760
    v_mfma_f32_16x16x32_bf16 a[52:55], a[152:155], v[56:59], a[52:55]
    ds_read_b64_tr_b16 v[40:41], v12 offset:57344
    v_mfma_f32_16x16x32_bf16 a[52:55], a[156:159], v[60:63], a[52:55]
    ds_read_b64_tr_b16 v[42:43], v12 offset:57856
    buffer_load_dwordx4 v11, s[12:15], s59 offen offset:1024 lds
    v_mfma_f32_16x16x32_bf16 a[56:59], a[160:163], v[48:51], a[56:59]
    v_mfma_f32_16x16x32_bf16 a[56:59], a[164:167], v[52:55], a[56:59]
    ds_read_b64_tr_b16 v[44:45], v12 offset:61440
    s_add_u32 m0, s57, 8192
    v_mfma_f32_16x16x32_bf16 a[56:59], a[168:171], v[56:59], a[56:59]
    ds_read_b64_tr_b16 v[46:47], v12 offset:61952
    s_add_u32 s59, s48, 3670016
    v_mfma_f32_16x16x32_bf16 a[56:59], a[172:175], v[60:63], a[56:59]
    buffer_load_dwordx4 v10, s[12:15], s59 offen lds
    v_mfma_f32_16x16x32_bf16 a[60:63], a[176:179], v[48:51], a[60:63]
    v_mfma_f32_16x16x32_bf16 a[60:63], a[180:183], v[52:55], a[60:63]
    v_mfma_f32_16x16x32_bf16 a[60:63], a[184:187], v[56:59], a[60:63]
    v_mfma_f32_16x16x32_bf16 a[60:63], a[188:191], v[60:63], a[60:63]
    buffer_load_dwordx4 v11, s[12:15], s59 offen offset:1024 lds
    s_waitcnt lgkmcnt(4)
    v_mfma_f32_16x16x32_bf16 a[64:67], a[128:131], v[32:35], a[64:67]
    v_mfma_f32_16x16x32_bf16 a[64:67], a[132:135], v[36:39], a[64:67]
    ds_read_b64_tr_b16 v[48:49], v13 offset:49152
    s_waitcnt lgkmcnt(1)
    v_mfma_f32_16x16x32_bf16 a[64:67], a[136:139], v[40:43], a[64:67]
    ds_read_b64_tr_b16 v[50:51], v13 offset:49664
    v_mfma_f32_16x16x32_bf16 a[64:67], a[140:143], v[44:47], a[64:67]
    ds_read_b64_tr_b16 v[52:53], v13 offset:53248
    v_mfma_f32_16x16x32_bf16 a[68:71], a[144:147], v[32:35], a[68:71]
    v_mfma_f32_16x16x32_bf16 a[68:71], a[148:151], v[36:39], a[68:71]
    ds_read_b64_tr_b16 v[54:55], v13 offset:53760
    v_mfma_f32_16x16x32_bf16 a[68:71], a[152:155], v[40:43], a[68:71]
    ds_read_b64_tr_b16 v[56:57], v13 offset:57344
    s_add_u32 m0, s45, 0
    v_mfma_f32_16x16x32_bf16 a[68:71], a[156:159], v[44:47], a[68:71]
    ds_read_b64_tr_b16 v[58:59], v13 offset:57856
    s_add_u32 s58, s41, 640
    v_mfma_f32_16x16x32_bf16 a[72:75], a[160:163], v[32:35], a[72:75]
    buffer_load_dwordx4 v4, s[4:7], s58 offen lds
    v_mfma_f32_16x16x32_bf16 a[72:75], a[164:167], v[36:39], a[72:75]
    ds_read_b64_tr_b16 v[60:61], v13 offset:61440
    v_mfma_f32_16x16x32_bf16 a[72:75], a[168:171], v[40:43], a[72:75]
    ds_read_b64_tr_b16 v[62:63], v13 offset:61952
    v_mfma_f32_16x16x32_bf16 a[72:75], a[172:175], v[44:47], a[72:75]
    v_mfma_f32_16x16x32_bf16 a[76:79], a[176:179], v[32:35], a[76:79]
    buffer_load_dwordx4 v5, s[4:7], s58 offen offset:1024 lds
    v_mfma_f32_16x16x32_bf16 a[76:79], a[180:183], v[36:39], a[76:79]
    v_mfma_f32_16x16x32_bf16 a[76:79], a[184:187], v[40:43], a[76:79]
    s_add_u32 m0, s46, 0
    v_mfma_f32_16x16x32_bf16 a[76:79], a[188:191], v[44:47], a[76:79]
    s_add_u32 s58, s42, 640
    s_waitcnt lgkmcnt(4)
    v_mfma_f32_16x16x32_bf16 a[80:83], a[128:131], v[48:51], a[80:83]
    buffer_load_dwordx4 v4, s[4:7], s58 offen lds
    v_mfma_f32_16x16x32_bf16 a[80:83], a[132:135], v[52:55], a[80:83]
    ds_read_b64_tr_b16 v[32:33], v14 offset:49152
    s_waitcnt lgkmcnt(1)
    v_mfma_f32_16x16x32_bf16 a[80:83], a[136:139], v[56:59], a[80:83]
    ds_read_b64_tr_b16 v[34:35], v14 offset:49664
    v_mfma_f32_16x16x32_bf16 a[80:83], a[140:143], v[60:63], a[80:83]
    ds_read_b64_tr_b16 v[36:37], v14 offset:53248
    v_mfma_f32_16x16x32_bf16 a[84:87], a[144:147], v[48:51], a[84:87]
    buffer_load_dwordx4 v5, s[4:7], s58 offen offset:1024 lds
    v_mfma_f32_16x16x32_bf16 a[84:87], a[148:151], v[52:55], a[84:87]
    ds_read_b64_tr_b16 v[38:39], v14 offset:53760
    v_mfma_f32_16x16x32_bf16 a[84:87], a[152:155], v[56:59], a[84:87]
    ds_read_b64_tr_b16 v[40:41], v14 offset:57344
    s_add_u32 m0, s47, 0
    v_mfma_f32_16x16x32_bf16 a[84:87], a[156:159], v[60:63], a[84:87]
    ds_read_b64_tr_b16 v[42:43], v14 offset:57856
    s_add_u32 s58, s43, 640
    v_mfma_f32_16x16x32_bf16 a[88:91], a[160:163], v[48:51], a[88:91]
    buffer_load_dwordx4 v4, s[4:7], s58 offen lds
    s_lshl_b32 s52, s25, 19
    v_mfma_f32_16x16x32_bf16 a[88:91], a[164:167], v[52:55], a[88:91]
    ds_read_b64_tr_b16 v[44:45], v14 offset:61440
    s_lshl_b32 s27, s26, 16
    v_mfma_f32_16x16x32_bf16 a[88:91], a[168:171], v[56:59], a[88:91]
    ds_read_b64_tr_b16 v[46:47], v14 offset:61952
    s_add_u32 s52, s52, s27
    v_mfma_f32_16x16x32_bf16 a[88:91], a[172:175], v[60:63], a[88:91]
    s_lshl_b32 s27, s24, 14
    v_mfma_f32_16x16x32_bf16 a[92:95], a[176:179], v[48:51], a[92:95]
    buffer_load_dwordx4 v5, s[4:7], s58 offen offset:1024 lds
    s_add_u32 s52, s52, s27
    v_mfma_f32_16x16x32_bf16 a[92:95], a[180:183], v[52:55], a[92:95]
    s_add_u32 s52, s52, 18874368
    v_mfma_f32_16x16x32_bf16 a[92:95], a[184:187], v[56:59], a[92:95]
    s_add_u32 s53, s52, 4096
    v_mfma_f32_16x16x32_bf16 a[92:95], a[188:191], v[60:63], a[92:95]
    s_add_u32 s54, s52, 8192
    s_waitcnt lgkmcnt(4)
    v_mfma_f32_16x16x32_bf16 a[96:99], a[128:131], v[32:35], a[96:99]
    s_add_u32 s55, s52, 12288
    v_mfma_f32_16x16x32_bf16 a[96:99], a[132:135], v[36:39], a[96:99]
    ds_read_b64_tr_b16 v[48:49], v15 offset:49152
    s_waitcnt lgkmcnt(1)
    v_mfma_f32_16x16x32_bf16 a[96:99], a[136:139], v[40:43], a[96:99]
    ds_read_b64_tr_b16 v[50:51], v15 offset:49664
    v_mfma_f32_16x16x32_bf16 a[96:99], a[140:143], v[44:47], a[96:99]
    ds_read_b64_tr_b16 v[52:53], v15 offset:53248
    v_mfma_f32_16x16x32_bf16 a[100:103], a[144:147], v[32:35], a[100:103]
    v_mfma_f32_16x16x32_bf16 a[100:103], a[148:151], v[36:39], a[100:103]
    ds_read_b64_tr_b16 v[54:55], v15 offset:53760
    v_mfma_f32_16x16x32_bf16 a[100:103], a[152:155], v[40:43], a[100:103]
    ds_read_b64_tr_b16 v[56:57], v15 offset:57344
    v_mfma_f32_16x16x32_bf16 a[100:103], a[156:159], v[44:47], a[100:103]
    ds_read_b64_tr_b16 v[58:59], v15 offset:57856
    v_mfma_f32_16x16x32_bf16 a[104:107], a[160:163], v[32:35], a[104:107]
    v_mfma_f32_16x16x32_bf16 a[104:107], a[164:167], v[36:39], a[104:107]
    ds_read_b64_tr_b16 v[60:61], v15 offset:61440
    v_mfma_f32_16x16x32_bf16 a[104:107], a[168:171], v[40:43], a[104:107]
    ds_read_b64_tr_b16 v[62:63], v15 offset:61952
    v_mfma_f32_16x16x32_bf16 a[104:107], a[172:175], v[44:47], a[104:107]
    v_mfma_f32_16x16x32_bf16 a[108:111], a[176:179], v[32:35], a[108:111]
    v_mfma_f32_16x16x32_bf16 a[108:111], a[180:183], v[36:39], a[108:111]
    v_mfma_f32_16x16x32_bf16 a[108:111], a[184:187], v[40:43], a[108:111]
    v_mfma_f32_16x16x32_bf16 a[108:111], a[188:191], v[44:47], a[108:111]
    s_waitcnt lgkmcnt(4)
    v_mfma_f32_16x16x32_bf16 a[112:115], a[128:131], v[48:51], a[112:115]
    s_waitcnt vmcnt(25)
    s_barrier
    v_mfma_f32_16x16x32_bf16 a[112:115], a[132:135], v[52:55], a[112:115]
    ds_read_b64_tr_b16 v[32:33], v16 offset:0
    s_add_u32 m0, s57, 16384
    s_waitcnt lgkmcnt(1)
    v_mfma_f32_16x16x32_bf16 a[112:115], a[136:139], v[56:59], a[112:115]
    ds_read_b64_tr_b16 v[34:35], v16 offset:512
    s_add_u32 s59, s48, 2621568
    v_mfma_f32_16x16x32_bf16 a[112:115], a[140:143], v[60:63], a[112:115]
    ds_read_b64_tr_b16 v[36:37], v16 offset:4096
    buffer_load_dwordx4 v10, s[12:15], s59 offen lds
    v_mfma_f32_16x16x32_bf16 a[116:119], a[144:147], v[48:51], a[116:119]
    v_mfma_f32_16x16x32_bf16 a[116:119], a[148:151], v[52:55], a[116:119]
    ds_read_b64_tr_b16 v[38:39], v16 offset:4608
    v_mfma_f32_16x16x32_bf16 a[116:119], a[152:155], v[56:59], a[116:119]
    ds_read_b64_tr_b16 v[40:41], v16 offset:8192
    v_mfma_f32_16x16x32_bf16 a[116:119], a[156:159], v[60:63], a[116:119]
    ds_read_b64_tr_b16 v[42:43], v16 offset:8704
    buffer_load_dwordx4 v11, s[12:15], s59 offen offset:1024 lds
    v_mfma_f32_16x16x32_bf16 a[120:123], a[160:163], v[48:51], a[120:123]
    v_mfma_f32_16x16x32_bf16 a[120:123], a[164:167], v[52:55], a[120:123]
    ds_read_b64_tr_b16 v[44:45], v16 offset:12288
    s_add_u32 m0, s57, 24576
    v_mfma_f32_16x16x32_bf16 a[120:123], a[168:171], v[56:59], a[120:123]
    ds_read_b64_tr_b16 v[46:47], v16 offset:12800
    s_add_u32 s59, s48, 3670144
    v_mfma_f32_16x16x32_bf16 a[120:123], a[172:175], v[60:63], a[120:123]
    buffer_load_dwordx4 v10, s[12:15], s59 offen lds
    v_mfma_f32_16x16x32_bf16 a[124:127], a[176:179], v[48:51], a[124:127]
    v_mfma_f32_16x16x32_bf16 a[124:127], a[180:183], v[52:55], a[124:127]
    v_mfma_f32_16x16x32_bf16 a[124:127], a[184:187], v[56:59], a[124:127]
    v_mfma_f32_16x16x32_bf16 a[124:127], a[188:191], v[60:63], a[124:127]
    buffer_load_dwordx4 v11, s[12:15], s59 offen offset:1024 lds
    s_waitcnt lgkmcnt(4)
    v_mfma_f32_16x16x32_bf16 v[96:99], v[32:35], a[128:131], v[96:99]
    v_mfma_f32_16x16x32_bf16 v[96:99], v[36:39], a[132:135], v[96:99]
    ds_read_b64_tr_b16 v[48:49], v17 offset:0
    s_add_u32 m0, s45, 8192
    s_waitcnt lgkmcnt(1)
    v_mfma_f32_16x16x32_bf16 v[96:99], v[40:43], a[136:139], v[96:99]
    ds_read_b64_tr_b16 v[50:51], v17 offset:512
    s_add_u32 s58, s41, 896
    v_mfma_f32_16x16x32_bf16 v[96:99], v[44:47], a[140:143], v[96:99]
    ds_read_b64_tr_b16 v[52:53], v17 offset:4096
    buffer_load_dwordx4 v4, s[4:7], s58 offen lds
    v_mfma_f32_16x16x32_bf16 v[100:103], v[32:35], a[144:147], v[100:103]
    v_mfma_f32_16x16x32_bf16 v[100:103], v[36:39], a[148:151], v[100:103]
    ds_read_b64_tr_b16 v[54:55], v17 offset:4608
    v_mfma_f32_16x16x32_bf16 v[100:103], v[40:43], a[152:155], v[100:103]
    ds_read_b64_tr_b16 v[56:57], v17 offset:8192
    v_mfma_f32_16x16x32_bf16 v[100:103], v[44:47], a[156:159], v[100:103]
    ds_read_b64_tr_b16 v[58:59], v17 offset:8704
    buffer_load_dwordx4 v5, s[4:7], s58 offen offset:1024 lds
    v_mfma_f32_16x16x32_bf16 v[104:107], v[32:35], a[160:163], v[104:107]
    v_mfma_f32_16x16x32_bf16 v[104:107], v[36:39], a[164:167], v[104:107]
    ds_read_b64_tr_b16 v[60:61], v17 offset:12288
    s_add_u32 m0, s46, 8192
    v_mfma_f32_16x16x32_bf16 v[104:107], v[40:43], a[168:171], v[104:107]
    ds_read_b64_tr_b16 v[62:63], v17 offset:12800
    s_add_u32 s58, s42, 896
    v_mfma_f32_16x16x32_bf16 v[104:107], v[44:47], a[172:175], v[104:107]
    buffer_load_dwordx4 v4, s[4:7], s58 offen lds
    v_mfma_f32_16x16x32_bf16 v[108:111], v[32:35], a[176:179], v[108:111]
    v_mfma_f32_16x16x32_bf16 v[108:111], v[36:39], a[180:183], v[108:111]
    v_mfma_f32_16x16x32_bf16 v[108:111], v[40:43], a[184:187], v[108:111]
    v_mfma_f32_16x16x32_bf16 v[108:111], v[44:47], a[188:191], v[108:111]
    buffer_load_dwordx4 v5, s[4:7], s58 offen offset:1024 lds
    s_waitcnt lgkmcnt(4)
    v_mfma_f32_16x16x32_bf16 v[64:67], v[48:51], a[128:131], v[64:67]
    v_mfma_f32_16x16x32_bf16 v[64:67], v[52:55], a[132:135], v[64:67]
    ds_read_b64_tr_b16 v[32:33], v18 offset:0
    s_add_u32 m0, s47, 8192
    s_waitcnt lgkmcnt(1)
    v_mfma_f32_16x16x32_bf16 v[64:67], v[56:59], a[136:139], v[64:67]
    ds_read_b64_tr_b16 v[34:35], v18 offset:512
    s_add_u32 s58, s43, 896
    v_mfma_f32_16x16x32_bf16 v[64:67], v[60:63], a[140:143], v[64:67]
    ds_read_b64_tr_b16 v[36:37], v18 offset:4096
    buffer_load_dwordx4 v4, s[4:7], s58 offen lds
    v_mfma_f32_16x16x32_bf16 v[68:71], v[48:51], a[144:147], v[68:71]
    v_mfma_f32_16x16x32_bf16 v[68:71], v[52:55], a[148:151], v[68:71]
    ds_read_b64_tr_b16 v[38:39], v18 offset:4608
    v_mfma_f32_16x16x32_bf16 v[68:71], v[56:59], a[152:155], v[68:71]
    ds_read_b64_tr_b16 v[40:41], v18 offset:8192
    v_mfma_f32_16x16x32_bf16 v[68:71], v[60:63], a[156:159], v[68:71]
    ds_read_b64_tr_b16 v[42:43], v18 offset:8704
    buffer_load_dwordx4 v5, s[4:7], s58 offen offset:1024 lds
    v_mfma_f32_16x16x32_bf16 v[72:75], v[48:51], a[160:163], v[72:75]
    v_mfma_f32_16x16x32_bf16 v[72:75], v[52:55], a[164:167], v[72:75]
    ds_read_b64_tr_b16 v[44:45], v18 offset:12288
    v_mfma_f32_16x16x32_bf16 v[72:75], v[56:59], a[168:171], v[72:75]
    ds_read_b64_tr_b16 v[46:47], v18 offset:12800
    v_mfma_f32_16x16x32_bf16 v[72:75], v[60:63], a[172:175], v[72:75]
    v_mfma_f32_16x16x32_bf16 v[76:79], v[48:51], a[176:179], v[76:79]
    v_mfma_f32_16x16x32_bf16 v[76:79], v[52:55], a[180:183], v[76:79]
    v_mfma_f32_16x16x32_bf16 v[76:79], v[56:59], a[184:187], v[76:79]
    v_mfma_f32_16x16x32_bf16 v[76:79], v[60:63], a[188:191], v[76:79]
    s_waitcnt lgkmcnt(4)
    v_mfma_f32_16x16x32_bf16 v[112:115], v[32:35], a[128:131], v[112:115]
    v_mfma_f32_16x16x32_bf16 v[112:115], v[36:39], a[132:135], v[112:115]
    ds_read_b64_tr_b16 v[48:49], v19 offset:0
    s_waitcnt lgkmcnt(1)
    v_mfma_f32_16x16x32_bf16 v[112:115], v[40:43], a[136:139], v[112:115]
    ds_read_b64_tr_b16 v[50:51], v19 offset:512
    v_mfma_f32_16x16x32_bf16 v[112:115], v[44:47], a[140:143], v[112:115]
    ds_read_b64_tr_b16 v[52:53], v19 offset:4096
    v_mfma_f32_16x16x32_bf16 v[116:119], v[32:35], a[144:147], v[116:119]
    v_mfma_f32_16x16x32_bf16 v[116:119], v[36:39], a[148:151], v[116:119]
    ds_read_b64_tr_b16 v[54:55], v19 offset:4608
    v_mfma_f32_16x16x32_bf16 v[116:119], v[40:43], a[152:155], v[116:119]
    ds_read_b64_tr_b16 v[56:57], v19 offset:8192
    v_mfma_f32_16x16x32_bf16 v[116:119], v[44:47], a[156:159], v[116:119]
    ds_read_b64_tr_b16 v[58:59], v19 offset:8704
    v_mfma_f32_16x16x32_bf16 v[120:123], v[32:35], a[160:163], v[120:123]
    v_mfma_f32_16x16x32_bf16 v[120:123], v[36:39], a[164:167], v[120:123]
    ds_read_b64_tr_b16 v[60:61], v19 offset:12288
    v_mfma_f32_16x16x32_bf16 v[120:123], v[40:43], a[168:171], v[120:123]
    ds_read_b64_tr_b16 v[62:63], v19 offset:12800
    v_mfma_f32_16x16x32_bf16 v[120:123], v[44:47], a[172:175], v[120:123]
    v_mfma_f32_16x16x32_bf16 v[124:127], v[32:35], a[176:179], v[124:127]
    v_mfma_f32_16x16x32_bf16 v[124:127], v[36:39], a[180:183], v[124:127]
    v_mfma_f32_16x16x32_bf16 v[124:127], v[40:43], a[184:187], v[124:127]
    v_mfma_f32_16x16x32_bf16 v[124:127], v[44:47], a[188:191], v[124:127]
    s_waitcnt lgkmcnt(4)
    v_mfma_f32_16x16x32_bf16 v[80:83], v[48:51], a[128:131], v[80:83]
    s_waitcnt vmcnt(24)
    s_barrier
    v_mfma_f32_16x16x32_bf16 v[80:83], v[52:55], a[132:135], v[80:83]
    ds_read_b64_tr_b16 v[32:33], v16 offset:16384
    s_add_u32 m0, s57, 32768
    s_waitcnt lgkmcnt(1)
    v_mfma_f32_16x16x32_bf16 v[80:83], v[56:59], a[136:139], v[80:83]
    ds_read_b64_tr_b16 v[34:35], v16 offset:16896
    s_add_u32 s59, s48, 2621440
    v_mfma_f32_16x16x32_bf16 v[80:83], v[60:63], a[140:143], v[80:83]
    ds_read_b64_tr_b16 v[36:37], v16 offset:20480
    buffer_load_dwordx4 v10, s[8:11], s59 offen lds
    v_mfma_f32_16x16x32_bf16 v[84:87], v[48:51], a[144:147], v[84:87]
    v_mfma_f32_16x16x32_bf16 v[84:87], v[52:55], a[148:151], v[84:87]
    ds_read_b64_tr_b16 v[38:39], v16 offset:20992
    v_mfma_f32_16x16x32_bf16 v[84:87], v[56:59], a[152:155], v[84:87]
    ds_read_b64_tr_b16 v[40:41], v16 offset:24576
    v_mfma_f32_16x16x32_bf16 v[84:87], v[60:63], a[156:159], v[84:87]
    ds_read_b64_tr_b16 v[42:43], v16 offset:25088
    buffer_load_dwordx4 v11, s[8:11], s59 offen offset:1024 lds
    v_mfma_f32_16x16x32_bf16 v[88:91], v[48:51], a[160:163], v[88:91]
    v_mfma_f32_16x16x32_bf16 v[88:91], v[52:55], a[164:167], v[88:91]
    ds_read_b64_tr_b16 v[44:45], v16 offset:28672
    s_add_u32 m0, s57, 40960
    v_mfma_f32_16x16x32_bf16 v[88:91], v[56:59], a[168:171], v[88:91]
    ds_read_b64_tr_b16 v[46:47], v16 offset:29184
    s_add_u32 s59, s48, 3670016
    v_mfma_f32_16x16x32_bf16 v[88:91], v[60:63], a[172:175], v[88:91]
    buffer_load_dwordx4 v10, s[8:11], s59 offen lds
    v_mfma_f32_16x16x32_bf16 v[92:95], v[48:51], a[176:179], v[92:95]
    v_mfma_f32_16x16x32_bf16 v[92:95], v[52:55], a[180:183], v[92:95]
    v_mfma_f32_16x16x32_bf16 v[92:95], v[56:59], a[184:187], v[92:95]
    v_mfma_f32_16x16x32_bf16 v[92:95], v[60:63], a[188:191], v[92:95]
    buffer_load_dwordx4 v11, s[8:11], s59 offen offset:1024 lds
    s_waitcnt lgkmcnt(4)
    v_mfma_f32_16x16x32_bf16 v[160:163], v[32:35], a[128:131], v[160:163]
    v_mfma_f32_16x16x32_bf16 v[160:163], v[36:39], a[132:135], v[160:163]
    ds_read_b64_tr_b16 v[48:49], v17 offset:16384
    s_waitcnt lgkmcnt(1)
    v_mfma_f32_16x16x32_bf16 v[160:163], v[40:43], a[136:139], v[160:163]
    ds_read_b64_tr_b16 v[50:51], v17 offset:16896
    v_mfma_f32_16x16x32_bf16 v[160:163], v[44:47], a[140:143], v[160:163]
    ds_read_b64_tr_b16 v[52:53], v17 offset:20480
    s_waitcnt vmcnt(14)
    v_mfma_f32_16x16x32_bf16 v[164:167], v[32:35], a[144:147], v[164:167]
    ds_read_b128 a[192:195], v8 offset:0
    v_mfma_f32_16x16x32_bf16 v[164:167], v[36:39], a[148:151], v[164:167]
    ds_read_b64_tr_b16 v[54:55], v17 offset:20992
    v_mfma_f32_16x16x32_bf16 v[164:167], v[40:43], a[152:155], v[164:167]
    ds_read_b64_tr_b16 v[56:57], v17 offset:24576
    ds_read_b128 a[196:199], v9 offset:0
    v_mfma_f32_16x16x32_bf16 v[164:167], v[44:47], a[156:159], v[164:167]
    ds_read_b64_tr_b16 v[58:59], v17 offset:25088
    v_mfma_f32_16x16x32_bf16 v[168:171], v[32:35], a[160:163], v[168:171]
    ds_read_b128 a[208:211], v8 offset:2048
    v_mfma_f32_16x16x32_bf16 v[168:171], v[36:39], a[164:167], v[168:171]
    ds_read_b64_tr_b16 v[60:61], v17 offset:28672
    v_mfma_f32_16x16x32_bf16 v[168:171], v[40:43], a[168:171], v[168:171]
    ds_read_b64_tr_b16 v[62:63], v17 offset:29184
    ds_read_b128 a[212:215], v9 offset:2048
    v_mfma_f32_16x16x32_bf16 v[168:171], v[44:47], a[172:175], v[168:171]
    v_mfma_f32_16x16x32_bf16 v[172:175], v[32:35], a[176:179], v[172:175]
    ds_read_b128 a[224:227], v8 offset:4096
    v_mfma_f32_16x16x32_bf16 v[172:175], v[36:39], a[180:183], v[172:175]
    v_mfma_f32_16x16x32_bf16 v[172:175], v[40:43], a[184:187], v[172:175]
    ds_read_b128 a[228:231], v9 offset:4096
    v_mfma_f32_16x16x32_bf16 v[172:175], v[44:47], a[188:191], v[172:175]
    s_waitcnt lgkmcnt(9)
    v_mfma_f32_16x16x32_bf16 v[128:131], v[48:51], a[128:131], v[128:131]
    ds_read_b128 a[240:243], v8 offset:6144
    v_mfma_f32_16x16x32_bf16 v[128:131], v[52:55], a[132:135], v[128:131]
    ds_read_b64_tr_b16 v[32:33], v18 offset:16384
    s_waitcnt lgkmcnt(5)
    v_mfma_f32_16x16x32_bf16 v[128:131], v[56:59], a[136:139], v[128:131]
    ds_read_b64_tr_b16 v[34:35], v18 offset:16896
    ds_read_b128 a[244:247], v9 offset:6144
    v_mfma_f32_16x16x32_bf16 v[128:131], v[60:63], a[140:143], v[128:131]
    ds_read_b64_tr_b16 v[36:37], v18 offset:20480
    v_mfma_f32_16x16x32_bf16 v[132:135], v[48:51], a[144:147], v[132:135]
    v_mfma_f32_16x16x32_bf16 v[132:135], v[52:55], a[148:151], v[132:135]
    ds_read_b64_tr_b16 v[38:39], v18 offset:20992
    v_mfma_f32_16x16x32_bf16 v[132:135], v[56:59], a[152:155], v[132:135]
    ds_read_b64_tr_b16 v[40:41], v18 offset:24576
    v_mfma_f32_16x16x32_bf16 v[132:135], v[60:63], a[156:159], v[132:135]
    ds_read_b64_tr_b16 v[42:43], v18 offset:25088
    v_mfma_f32_16x16x32_bf16 v[136:139], v[48:51], a[160:163], v[136:139]
    v_mfma_f32_16x16x32_bf16 v[136:139], v[52:55], a[164:167], v[136:139]
    ds_read_b64_tr_b16 v[44:45], v18 offset:28672
    v_mfma_f32_16x16x32_bf16 v[136:139], v[56:59], a[168:171], v[136:139]
    ds_read_b64_tr_b16 v[46:47], v18 offset:29184
    v_mfma_f32_16x16x32_bf16 v[136:139], v[60:63], a[172:175], v[136:139]
    v_mfma_f32_16x16x32_bf16 v[140:143], v[48:51], a[176:179], v[140:143]
    v_mfma_f32_16x16x32_bf16 v[140:143], v[52:55], a[180:183], v[140:143]
    s_waitcnt vmcnt(4)
    v_mfma_f32_16x16x32_bf16 v[140:143], v[56:59], a[184:187], v[140:143]
    ds_read_b128 a[200:203], v8 offset:8192
    v_mfma_f32_16x16x32_bf16 v[140:143], v[60:63], a[188:191], v[140:143]
    s_waitcnt lgkmcnt(5)
    v_mfma_f32_16x16x32_bf16 v[176:179], v[32:35], a[128:131], v[176:179]
    ds_read_b128 a[204:207], v9 offset:8192
    v_mfma_f32_16x16x32_bf16 v[176:179], v[36:39], a[132:135], v[176:179]
    ds_read_b64_tr_b16 v[48:49], v19 offset:16384
    s_waitcnt lgkmcnt(3)
    v_mfma_f32_16x16x32_bf16 v[176:179], v[40:43], a[136:139], v[176:179]
    ds_read_b64_tr_b16 v[50:51], v19 offset:16896
    ds_read_b128 a[216:219], v8 offset:10240
    v_mfma_f32_16x16x32_bf16 v[176:179], v[44:47], a[140:143], v[176:179]
    ds_read_b64_tr_b16 v[52:53], v19 offset:20480
    v_mfma_f32_16x16x32_bf16 v[180:183], v[32:35], a[144:147], v[180:183]
    ds_read_b128 a[220:223], v9 offset:10240
    v_mfma_f32_16x16x32_bf16 v[180:183], v[36:39], a[148:151], v[180:183]
    ds_read_b64_tr_b16 v[54:55], v19 offset:20992
    v_mfma_f32_16x16x32_bf16 v[180:183], v[40:43], a[152:155], v[180:183]
    ds_read_b64_tr_b16 v[56:57], v19 offset:24576
    ds_read_b128 a[232:235], v8 offset:12288
    v_mfma_f32_16x16x32_bf16 v[180:183], v[44:47], a[156:159], v[180:183]
    ds_read_b64_tr_b16 v[58:59], v19 offset:25088
    v_mfma_f32_16x16x32_bf16 v[184:187], v[32:35], a[160:163], v[184:187]
    ds_read_b128 a[236:239], v9 offset:12288
    v_mfma_f32_16x16x32_bf16 v[184:187], v[36:39], a[164:167], v[184:187]
    ds_read_b64_tr_b16 v[60:61], v19 offset:28672
    v_mfma_f32_16x16x32_bf16 v[184:187], v[40:43], a[168:171], v[184:187]
    ds_read_b64_tr_b16 v[62:63], v19 offset:29184
    ds_read_b128 a[248:251], v8 offset:14336
    v_mfma_f32_16x16x32_bf16 v[184:187], v[44:47], a[172:175], v[184:187]
    v_mfma_f32_16x16x32_bf16 v[188:191], v[32:35], a[176:179], v[188:191]
    ds_read_b128 a[252:255], v9 offset:14336
    v_mfma_f32_16x16x32_bf16 v[188:191], v[36:39], a[180:183], v[188:191]
    v_mfma_f32_16x16x32_bf16 v[188:191], v[40:43], a[184:187], v[188:191]
    v_mfma_f32_16x16x32_bf16 v[188:191], v[44:47], a[188:191], v[188:191]
    s_waitcnt lgkmcnt(8)
    v_mfma_f32_16x16x32_bf16 v[144:147], v[48:51], a[128:131], v[144:147]
    s_waitcnt vmcnt(20)
    s_barrier
    v_mfma_f32_16x16x32_bf16 v[144:147], v[52:55], a[132:135], v[144:147]
    ds_read_b64_tr_b16 v[32:33], v12 offset:0
    s_add_u32 m0, s57, 49152
    s_waitcnt lgkmcnt(3)
    v_mfma_f32_16x16x32_bf16 v[144:147], v[56:59], a[136:139], v[144:147]
    ds_read_b64_tr_b16 v[34:35], v12 offset:512
    s_add_u32 s59, s48, 2621568
    v_mfma_f32_16x16x32_bf16 v[144:147], v[60:63], a[140:143], v[144:147]
    ds_read_b64_tr_b16 v[36:37], v12 offset:4096
    buffer_load_dwordx4 v10, s[8:11], s59 offen lds
    v_mfma_f32_16x16x32_bf16 v[148:151], v[48:51], a[144:147], v[148:151]
    v_mfma_f32_16x16x32_bf16 v[148:151], v[52:55], a[148:151], v[148:151]
    ds_read_b64_tr_b16 v[38:39], v12 offset:4608
    v_mfma_f32_16x16x32_bf16 v[148:151], v[56:59], a[152:155], v[148:151]
    ds_read_b64_tr_b16 v[40:41], v12 offset:8192
    v_mfma_f32_16x16x32_bf16 v[148:151], v[60:63], a[156:159], v[148:151]
    ds_read_b64_tr_b16 v[42:43], v12 offset:8704
    buffer_load_dwordx4 v11, s[8:11], s59 offen offset:1024 lds
    v_mfma_f32_16x16x32_bf16 v[152:155], v[48:51], a[160:163], v[152:155]
    v_mfma_f32_16x16x32_bf16 v[152:155], v[52:55], a[164:167], v[152:155]
    ds_read_b64_tr_b16 v[44:45], v12 offset:12288
    s_add_u32 m0, s57, 57344
    v_mfma_f32_16x16x32_bf16 v[152:155], v[56:59], a[168:171], v[152:155]
    ds_read_b64_tr_b16 v[46:47], v12 offset:12800
    s_add_u32 s59, s48, 3670144
    v_mfma_f32_16x16x32_bf16 v[152:155], v[60:63], a[172:175], v[152:155]
    buffer_load_dwordx4 v10, s[8:11], s59 offen lds
    v_mfma_f32_16x16x32_bf16 v[156:159], v[48:51], a[176:179], v[156:159]
    v_mfma_f32_16x16x32_bf16 v[156:159], v[52:55], a[180:183], v[156:159]
    v_mfma_f32_16x16x32_bf16 v[156:159], v[56:59], a[184:187], v[156:159]
    v_mfma_f32_16x16x32_bf16 v[156:159], v[60:63], a[188:191], v[156:159]
    buffer_load_dwordx4 v11, s[8:11], s59 offen offset:1024 lds
    s_waitcnt lgkmcnt(4)
    v_mfma_f32_16x16x32_bf16 a[0:3], a[192:195], v[32:35], a[0:3]
    v_mfma_f32_16x16x32_bf16 a[0:3], a[196:199], v[36:39], a[0:3]
    ds_read_b64_tr_b16 v[48:49], v13 offset:0
    s_waitcnt lgkmcnt(1)
    v_mfma_f32_16x16x32_bf16 a[0:3], a[200:203], v[40:43], a[0:3]
    ds_read_b64_tr_b16 v[50:51], v13 offset:512
    v_mfma_f32_16x16x32_bf16 a[0:3], a[204:207], v[44:47], a[0:3]
    ds_read_b64_tr_b16 v[52:53], v13 offset:4096
    v_mfma_f32_16x16x32_bf16 a[4:7], a[208:211], v[32:35], a[4:7]
    v_mfma_f32_16x16x32_bf16 a[4:7], a[212:215], v[36:39], a[4:7]
    ds_read_b64_tr_b16 v[54:55], v13 offset:4608
    v_mfma_f32_16x16x32_bf16 a[4:7], a[216:219], v[40:43], a[4:7]
    ds_read_b64_tr_b16 v[56:57], v13 offset:8192
    v_mfma_f32_16x16x32_bf16 a[4:7], a[220:223], v[44:47], a[4:7]
    ds_read_b64_tr_b16 v[58:59], v13 offset:8704
    v_mfma_f32_16x16x32_bf16 a[8:11], a[224:227], v[32:35], a[8:11]
    s_mov_b32 s4, s16
    s_mov_b32 s5, s17
    v_mfma_f32_16x16x32_bf16 a[8:11], a[228:231], v[36:39], a[8:11]
    ds_read_b64_tr_b16 v[60:61], v13 offset:12288
    s_mov_b32 s6, s18
    v_mfma_f32_16x16x32_bf16 a[8:11], a[232:235], v[40:43], a[8:11]
    ds_read_b64_tr_b16 v[62:63], v13 offset:12800
    s_mov_b32 s7, 0x00020000
    v_mfma_f32_16x16x32_bf16 a[8:11], a[236:239], v[44:47], a[8:11]
    s_mov_b32 s8, s20
    v_mfma_f32_16x16x32_bf16 a[12:15], a[240:243], v[32:35], a[12:15]
    s_mov_b32 s9, s21
    v_mfma_f32_16x16x32_bf16 a[12:15], a[244:247], v[36:39], a[12:15]
    s_mov_b32 s10, s22
    s_mov_b32 s11, 0x00020000
    v_mfma_f32_16x16x32_bf16 a[12:15], a[248:251], v[40:43], a[12:15]
    s_mov_b32 s12, s28
    v_mfma_f32_16x16x32_bf16 a[12:15], a[252:255], v[44:47], a[12:15]
    s_mov_b32 s13, s29
    s_waitcnt lgkmcnt(4)
    v_mfma_f32_16x16x32_bf16 a[16:19], a[192:195], v[48:51], a[16:19]
    s_mov_b32 s14, s30
    v_mfma_f32_16x16x32_bf16 a[16:19], a[196:199], v[52:55], a[16:19]
    ds_read_b64_tr_b16 v[32:33], v14 offset:0
    s_mov_b32 s15, 0x00020000
    s_waitcnt lgkmcnt(1)
    v_mfma_f32_16x16x32_bf16 a[16:19], a[200:203], v[56:59], a[16:19]
    ds_read_b64_tr_b16 v[34:35], v14 offset:512
    s_mov_b32 s28, s24
    s_mov_b32 s29, s25
    v_mfma_f32_16x16x32_bf16 a[16:19], a[204:207], v[60:63], a[16:19]
    ds_read_b64_tr_b16 v[36:37], v14 offset:4096
    s_mov_b32 s30, s26
    v_mfma_f32_16x16x32_bf16 a[20:23], a[208:211], v[48:51], a[20:23]
    s_and_b32 s31, s28, 1
    v_mfma_f32_16x16x32_bf16 a[20:23], a[212:215], v[52:55], a[20:23]
    ds_read_b64_tr_b16 v[38:39], v14 offset:4608
    v_mov_b32 v31, v0
    v_mfma_f32_16x16x32_bf16 a[20:23], a[216:219], v[56:59], a[20:23]
    ds_read_b64_tr_b16 v[40:41], v14 offset:8192
    s_add_u32 s45, s29, 0
    v_accvgpr_read_b32 v192, a0
    v_mfma_f32_16x16x32_bf16 a[20:23], a[220:223], v[60:63], a[20:23]
    ds_read_b64_tr_b16 v[42:43], v14 offset:8704
    s_and_b32 s45, s45, 3
    s_lshl_b32 s45, s45, 10
    v_accvgpr_read_b32 v193, a1
    v_mfma_f32_16x16x32_bf16 a[24:27], a[224:227], v[48:51], a[24:27]
    v_add_u32 v4, s45, v3
    v_accvgpr_read_b32 v194, a2
    v_mfma_f32_16x16x32_bf16 a[24:27], a[228:231], v[52:55], a[24:27]
    ds_read_b64_tr_b16 v[44:45], v14 offset:12288
    s_add_u32 s45, s29, 1
    v_accvgpr_read_b32 v195, a3
    v_mfma_f32_16x16x32_bf16 a[24:27], a[232:235], v[56:59], a[24:27]
    ds_read_b64_tr_b16 v[46:47], v14 offset:12800
    s_and_b32 s45, s45, 3
    v_accvgpr_read_b32 v196, a4
    v_mfma_f32_16x16x32_bf16 a[24:27], a[236:239], v[60:63], a[24:27]
    s_lshl_b32 s45, s45, 10
    v_accvgpr_read_b32 v197, a5
    v_mfma_f32_16x16x32_bf16 a[28:31], a[240:243], v[48:51], a[28:31]
    v_add_u32 v5, s45, v3
    s_add_u32 s45, s29, 2
    v_accvgpr_read_b32 v198, a6
    v_mfma_f32_16x16x32_bf16 a[28:31], a[244:247], v[52:55], a[28:31]
    s_and_b32 s45, s45, 3
    v_accvgpr_read_b32 v199, a7
    v_mfma_f32_16x16x32_bf16 a[28:31], a[248:251], v[56:59], a[28:31]
    s_lshl_b32 s45, s45, 10
    v_cvt_pk_bf16_f32 v192, v192, v193
    v_mfma_f32_16x16x32_bf16 a[28:31], a[252:255], v[60:63], a[28:31]
    v_add_u32 v6, s45, v3
    v_cvt_pk_bf16_f32 v193, v194, v195
    s_waitcnt lgkmcnt(4)
    v_mfma_f32_16x16x32_bf16 a[32:35], a[192:195], v[32:35], a[32:35]
    buffer_load_dword v27, v25, s[68:71], 0 offen sc1
    s_add_u32 s45, s29, 3
    v_cvt_pk_bf16_f32 v194, v196, v197
    v_mfma_f32_16x16x32_bf16 a[32:35], a[196:199], v[36:39], a[32:35]
    ds_read_b64_tr_b16 v[48:49], v15 offset:0
    s_and_b32 s45, s45, 3
    s_lshl_b32 s45, s45, 10
    v_cvt_pk_bf16_f32 v195, v198, v199
    s_waitcnt lgkmcnt(1)
    v_mfma_f32_16x16x32_bf16 a[32:35], a[200:203], v[40:43], a[32:35]
    ds_read_b64_tr_b16 v[50:51], v15 offset:512
    v_add_u32 v7, s45, v3
    v_mfma_f32_16x16x32_bf16 a[32:35], a[204:207], v[44:47], a[32:35]
    ds_read_b64_tr_b16 v[52:53], v15 offset:4096
    s_lshr_b32 s45, s28, 1
    buffer_store_dwordx4 v[192:195], v3, s[16:19], s52 offen offset:0 sc1
    v_accvgpr_read_b32 v200, a8
    v_mfma_f32_16x16x32_bf16 a[36:39], a[208:211], v[32:35], a[36:39]
    s_add_u32 s45, s45, s29
    v_accvgpr_read_b32 v201, a9
    v_mfma_f32_16x16x32_bf16 a[36:39], a[212:215], v[36:39], a[36:39]
    ds_read_b64_tr_b16 v[54:55], v15 offset:4608
    s_add_u32 s45, s45, 0
    v_accvgpr_read_b32 v202, a10
    v_mfma_f32_16x16x32_bf16 a[36:39], a[216:219], v[40:43], a[36:39]
    ds_read_b64_tr_b16 v[56:57], v15 offset:8192
    s_and_b32 s45, s45, 3
    s_lshl_b32 s45, s45, 1
    v_accvgpr_read_b32 v203, a11
    v_mfma_f32_16x16x32_bf16 a[36:39], a[220:223], v[44:47], a[36:39]
    ds_read_b64_tr_b16 v[58:59], v15 offset:8704
    s_add_u32 s45, s45, s31
    v_accvgpr_read_b32 v204, a12
    v_mfma_f32_16x16x32_bf16 a[40:43], a[224:227], v[32:35], a[40:43]
    s_lshl_b32 s48, s45, 17
    v_accvgpr_read_b32 v205, a13
    v_mfma_f32_16x16x32_bf16 a[40:43], a[228:231], v[36:39], a[40:43]
    ds_read_b64_tr_b16 v[60:61], v15 offset:12288
    s_mul_i32 s50, s45, 44032
    v_accvgpr_read_b32 v206, a14
    v_mfma_f32_16x16x32_bf16 a[40:43], a[232:235], v[40:43], a[40:43]
    ds_read_b64_tr_b16 v[62:63], v15 offset:12800
    s_lshr_b32 s45, s28, 1
    v_accvgpr_read_b32 v207, a15
    v_mfma_f32_16x16x32_bf16 a[40:43], a[236:239], v[44:47], a[40:43]
    s_add_u32 s45, s45, s29
    s_add_u32 s45, s45, 2
    v_cvt_pk_bf16_f32 v200, v200, v201
    v_mfma_f32_16x16x32_bf16 a[44:47], a[240:243], v[32:35], a[44:47]
    s_and_b32 s45, s45, 3
    v_cvt_pk_bf16_f32 v201, v202, v203
    v_mfma_f32_16x16x32_bf16 a[44:47], a[244:247], v[36:39], a[44:47]
    s_lshl_b32 s45, s45, 1
    v_cvt_pk_bf16_f32 v202, v204, v205
    v_mfma_f32_16x16x32_bf16 a[44:47], a[248:251], v[40:43], a[44:47]
    s_add_u32 s45, s45, s31
    v_cvt_pk_bf16_f32 v203, v206, v207
    v_mfma_f32_16x16x32_bf16 a[44:47], a[252:255], v[44:47], a[44:47]
    s_lshl_b32 s49, s45, 17
    s_waitcnt lgkmcnt(4)
    v_mfma_f32_16x16x32_bf16 a[48:51], a[192:195], v[48:51], a[48:51]
    s_mul_i32 s51, s45, 44032
    buffer_store_dwordx4 v[200:203], v3, s[16:19], s52 offen offset:1024 sc1
    s_waitcnt vmcnt(17)
    s_barrier
    v_mfma_f32_16x16x32_bf16 a[48:51], a[196:199], v[52:55], a[48:51]
    ds_read_b64_tr_b16 v[32:33], v12 offset:16384
    v_bfe_u32 v29, v2, 4, 1
    v_lshlrev_b32 v29, 1, v29
    s_waitcnt lgkmcnt(1)
    v_mfma_f32_16x16x32_bf16 a[48:51], a[200:203], v[56:59], a[48:51]
    ds_read_b64_tr_b16 v[34:35], v12 offset:16896
    v_and_b32 v30, 7, v2
    v_accvgpr_read_b32 v208, a16
    v_mfma_f32_16x16x32_bf16 a[48:51], a[204:207], v[60:63], a[48:51]
    ds_read_b64_tr_b16 v[36:37], v12 offset:20480
    v_xor_b32 v29, v29, v30
    v_accvgpr_read_b32 v209, a17
    v_mfma_f32_16x16x32_bf16 a[52:55], a[208:211], v[48:51], a[52:55]
    v_lshlrev_b32 v29, 4, v29
    v_accvgpr_read_b32 v210, a18
    v_mfma_f32_16x16x32_bf16 a[52:55], a[212:215], v[52:55], a[52:55]
    ds_read_b64_tr_b16 v[38:39], v12 offset:20992
    v_lshrrev_b32 v30, 3, v2
    v_accvgpr_read_b32 v211, a19
    v_mfma_f32_16x16x32_bf16 a[52:55], a[216:219], v[56:59], a[52:55]
    ds_read_b64_tr_b16 v[40:41], v12 offset:24576
    v_mul_u32_u24 v30, 8192, v30
    v_add_u32 v8, v29, v30
    v_accvgpr_read_b32 v212, a20
    v_mfma_f32_16x16x32_bf16 a[52:55], a[220:223], v[60:63], a[52:55]
    ds_read_b64_tr_b16 v[42:43], v12 offset:25088
    v_xor_b32 v29, 64, v29
    v_accvgpr_read_b32 v213, a21
    v_mfma_f32_16x16x32_bf16 a[56:59], a[224:227], v[48:51], a[56:59]
    v_add_u32 v9, v29, v30
    v_accvgpr_read_b32 v214, a22
    v_mfma_f32_16x16x32_bf16 a[56:59], a[228:231], v[52:55], a[56:59]
    ds_read_b64_tr_b16 v[44:45], v12 offset:28672
    v_add_u32 v9, 64512, v9
    v_accvgpr_read_b32 v215, a23
    v_mfma_f32_16x16x32_bf16 a[56:59], a[232:235], v[56:59], a[56:59]
    ds_read_b64_tr_b16 v[46:47], v12 offset:29184
    v_bfe_u32 v29, v2, 4, 1
    v_cvt_pk_bf16_f32 v208, v208, v209
    v_mfma_f32_16x16x32_bf16 a[56:59], a[236:239], v[60:63], a[56:59]
    v_lshlrev_b32 v29, 1, v29
    v_and_b32 v30, 7, v2
    v_cvt_pk_bf16_f32 v209, v210, v211
    v_mfma_f32_16x16x32_bf16 a[60:63], a[240:243], v[48:51], a[60:63]
    v_xor_b32 v29, v29, v30
    v_cvt_pk_bf16_f32 v210, v212, v213
    v_mfma_f32_16x16x32_bf16 a[60:63], a[244:247], v[52:55], a[60:63]
    v_lshlrev_b32 v29, 4, v29
    v_cvt_pk_bf16_f32 v211, v214, v215
    v_mfma_f32_16x16x32_bf16 a[60:63], a[248:251], v[56:59], a[60:63]
    v_lshrrev_b32 v30, 3, v2
    v_mfma_f32_16x16x32_bf16 a[60:63], a[252:255], v[60:63], a[60:63]
    v_mul_u32_u24 v30, 2752, v30
    buffer_store_dwordx4 v[208:211], v3, s[16:19], s52 offen offset:2048 sc1
    v_accvgpr_read_b32 v216, a24
    s_waitcnt lgkmcnt(4)
    v_mfma_f32_16x16x32_bf16 a[64:67], a[192:195], v[32:35], a[64:67]
    v_add_u32 v10, v29, v30
    v_xor_b32 v29, 64, v29
    v_accvgpr_read_b32 v217, a25
    v_mfma_f32_16x16x32_bf16 a[64:67], a[196:199], v[36:39], a[64:67]
    ds_read_b64_tr_b16 v[48:49], v13 offset:16384
    v_add_u32 v11, v29, v30
    v_accvgpr_read_b32 v218, a26
    s_waitcnt lgkmcnt(1)
    v_mfma_f32_16x16x32_bf16 a[64:67], a[200:203], v[40:43], a[64:67]
    ds_read_b64_tr_b16 v[50:51], v13 offset:16896
    v_add_u32 v11, 20992, v11
    v_accvgpr_read_b32 v219, a27
    v_mfma_f32_16x16x32_bf16 a[64:67], a[204:207], v[44:47], a[64:67]
    ds_read_b64_tr_b16 v[52:53], v13 offset:20480
    s_lshl_b32 s45, s30, 3
    v_accvgpr_read_b32 v220, a28
    v_mfma_f32_16x16x32_bf16 a[68:71], a[208:211], v[32:35], a[68:71]
    s_lshl_b32 s46, s28, 1
    v_accvgpr_read_b32 v221, a29
    v_mfma_f32_16x16x32_bf16 a[68:71], a[212:215], v[36:39], a[68:71]
    ds_read_b64_tr_b16 v[54:55], v13 offset:20992
    s_add_u32 s47, s45, s46
    s_sub_u32 s45, 120, s45
    v_accvgpr_read_b32 v222, a30
    v_mfma_f32_16x16x32_bf16 a[68:71], a[216:219], v[40:43], a[68:71]
    ds_read_b64_tr_b16 v[56:57], v13 offset:24576
    s_add_u32 s45, s45, s46
    v_accvgpr_read_b32 v223, a31
    v_mfma_f32_16x16x32_bf16 a[68:71], a[220:223], v[44:47], a[68:71]
    ds_read_b64_tr_b16 v[58:59], v13 offset:25088
    s_lshl_b32 s32, s47, 14
    v_cvt_pk_bf16_f32 v216, v216, v217
    v_mfma_f32_16x16x32_bf16 a[72:75], a[224:227], v[32:35], a[72:75]
    s_add_u32 s33, s32, 16384
    v_cvt_pk_bf16_f32 v217, v218, v219
    v_mfma_f32_16x16x32_bf16 a[72:75], a[228:231], v[36:39], a[72:75]
    ds_read_b64_tr_b16 v[60:61], v13 offset:28672
    s_lshl_b32 s34, s45, 14
    v_cvt_pk_bf16_f32 v218, v220, v221
    v_mfma_f32_16x16x32_bf16 a[72:75], a[232:235], v[40:43], a[72:75]
    ds_read_b64_tr_b16 v[62:63], v13 offset:29184
    s_add_u32 s35, s34, 16384
    s_mul_i32 s36, s47, 176128
    v_cvt_pk_bf16_f32 v219, v222, v223
    v_mfma_f32_16x16x32_bf16 a[72:75], a[236:239], v[44:47], a[72:75]
    s_mul_i32 s40, s45, 176128
    v_mfma_f32_16x16x32_bf16 a[76:79], a[240:243], v[32:35], a[76:79]
    s_lshl_b32 s62, s47, 4
    buffer_store_dwordx4 v[216:219], v3, s[16:19], s52 offen offset:3072 sc1
    v_mfma_f32_16x16x32_bf16 a[76:79], a[244:247], v[36:39], a[76:79]
    s_lshl_b32 s63, s45, 4
    v_mfma_f32_16x16x32_bf16 a[76:79], a[248:251], v[40:43], a[76:79]
    s_lshl_b32 s44, s28, 11
    v_accvgpr_read_b32 v224, a32
    v_mfma_f32_16x16x32_bf16 a[76:79], a[252:255], v[44:47], a[76:79]
    s_and_b32 s45, s29, 3
    s_max_u32 s45, s45, 1
    v_accvgpr_read_b32 v225, a33
    s_waitcnt lgkmcnt(4)
    v_mfma_f32_16x16x32_bf16 a[80:83], a[192:195], v[48:51], a[80:83]
    s_lshr_b32 s46, s29, 2
    v_accvgpr_read_b32 v226, a34
    v_mfma_f32_16x16x32_bf16 a[80:83], a[196:199], v[52:55], a[80:83]
    ds_read_b64_tr_b16 v[32:33], v14 offset:16384
    s_mul_i32 s46, s46, 3
    v_accvgpr_read_b32 v227, a35
    s_waitcnt lgkmcnt(1)
    v_mfma_f32_16x16x32_bf16 a[80:83], a[200:203], v[56:59], a[80:83]
    ds_read_b64_tr_b16 v[34:35], v14 offset:16896
    s_add_u32 s46, s46, s45
    v_accvgpr_read_b32 v228, a36
    v_mfma_f32_16x16x32_bf16 a[80:83], a[204:207], v[60:63], a[80:83]
    ds_read_b64_tr_b16 v[36:37], v14 offset:20480
    s_sub_u32 s46, s46, 1
    v_accvgpr_read_b32 v229, a37
    v_mfma_f32_16x16x32_bf16 a[84:87], a[208:211], v[48:51], a[84:87]
    s_lshl_b32 s46, s46, 7
    v_lshrrev_b32 v29, 4, v2
    v_accvgpr_read_b32 v230, a38
    v_mfma_f32_16x16x32_bf16 a[84:87], a[212:215], v[52:55], a[84:87]
    ds_read_b64_tr_b16 v[38:39], v14 offset:20992
    v_lshlrev_b32 v29, 3, v29
    v_accvgpr_read_b32 v231, a39
    v_mfma_f32_16x16x32_bf16 a[84:87], a[216:219], v[56:59], a[84:87]
    ds_read_b64_tr_b16 v[40:41], v14 offset:24576
    s_mov_b32 s24, s66
    v_cvt_pk_bf16_f32 v224, v224, v225
    v_mfma_f32_16x16x32_bf16 a[84:87], a[220:223], v[60:63], a[84:87]
    ds_read_b64_tr_b16 v[42:43], v14 offset:25088
    s_mov_b32 s25, s67
    v_cvt_pk_bf16_f32 v225, v226, v227
    v_mfma_f32_16x16x32_bf16 a[88:91], a[224:227], v[48:51], a[88:91]
    s_mov_b32 s26, 2752
    v_cvt_pk_bf16_f32 v226, v228, v229
    v_mfma_f32_16x16x32_bf16 a[88:91], a[228:231], v[52:55], a[88:91]
    ds_read_b64_tr_b16 v[44:45], v14 offset:28672
    s_mov_b32 s27, 0x00020000
    v_cvt_pk_bf16_f32 v227, v230, v231
    v_mfma_f32_16x16x32_bf16 a[88:91], a[232:235], v[56:59], a[88:91]
    ds_read_b64_tr_b16 v[46:47], v14 offset:29184
    v_mfma_f32_16x16x32_bf16 a[88:91], a[236:239], v[60:63], a[88:91]
    buffer_store_dwordx4 v[224:227], v3, s[16:19], s53 offen offset:0 sc1
    v_accvgpr_read_b32 v232, a40
    s_waitcnt vmcnt(5)
    s_movk_i32 s60, 0x100
    v_cmp_gt_u32 vcc, s60, v27
    s_cbranch_vccnz K1_LNSPIN_E
K1_LNOK:
    v_mfma_f32_16x16x32_bf16 a[92:95], a[240:243], v[48:51], a[92:95]
    v_accvgpr_read_b32 v233, a41
    v_mfma_f32_16x16x32_bf16 a[92:95], a[244:247], v[52:55], a[92:95]
    v_accvgpr_read_b32 v234, a42
    v_mfma_f32_16x16x32_bf16 a[92:95], a[248:251], v[56:59], a[92:95]
    buffer_load_dwordx4 a[128:131], v4, s[4:7], s32 offen sc1
    v_accvgpr_read_b32 v235, a43
    v_mfma_f32_16x16x32_bf16 a[92:95], a[252:255], v[60:63], a[92:95]
    v_accvgpr_read_b32 v236, a44
    s_waitcnt lgkmcnt(4)
    v_mfma_f32_16x16x32_bf16 a[96:99], a[192:195], v[32:35], a[96:99]
    v_accvgpr_read_b32 v237, a45
    v_mfma_f32_16x16x32_bf16 a[96:99], a[196:199], v[36:39], a[96:99]
    ds_read_b64_tr_b16 v[48:49], v15 offset:16384
    v_accvgpr_read_b32 v238, a46
    s_waitcnt lgkmcnt(1)
    v_mfma_f32_16x16x32_bf16 a[96:99], a[200:203], v[40:43], a[96:99]
    ds_read_b64_tr_b16 v[50:51], v15 offset:16896
    v_accvgpr_read_b32 v239, a47
    v_mfma_f32_16x16x32_bf16 a[96:99], a[204:207], v[44:47], a[96:99]
    ds_read_b64_tr_b16 v[52:53], v15 offset:20480
    buffer_load_dwordx4 a[144:147], v4, s[4:7], s33 offen sc1
    v_cvt_pk_bf16_f32 v232, v232, v233
    v_mfma_f32_16x16x32_bf16 a[100:103], a[208:211], v[32:35], a[100:103]
    v_cvt_pk_bf16_f32 v233, v234, v235
    v_mfma_f32_16x16x32_bf16 a[100:103], a[212:215], v[36:39], a[100:103]
    ds_read_b64_tr_b16 v[54:55], v15 offset:20992
    v_cvt_pk_bf16_f32 v234, v236, v237
    v_mfma_f32_16x16x32_bf16 a[100:103], a[216:219], v[40:43], a[100:103]
    ds_read_b64_tr_b16 v[56:57], v15 offset:24576
    v_cvt_pk_bf16_f32 v235, v238, v239
    v_mfma_f32_16x16x32_bf16 a[100:103], a[220:223], v[44:47], a[100:103]
    ds_read_b64_tr_b16 v[58:59], v15 offset:25088
    v_mfma_f32_16x16x32_bf16 a[104:107], a[224:227], v[32:35], a[104:107]
    buffer_load_dwordx4 a[160:163], v4, s[4:7], s34 offen sc1
    buffer_store_dwordx4 v[232:235], v3, s[16:19], s53 offen offset:1024 sc1
    v_mfma_f32_16x16x32_bf16 a[104:107], a[228:231], v[36:39], a[104:107]
    ds_read_b64_tr_b16 v[60:61], v15 offset:28672
    v_mfma_f32_16x16x32_bf16 a[104:107], a[232:235], v[40:43], a[104:107]
    ds_read_b64_tr_b16 v[62:63], v15 offset:29184
    v_accvgpr_read_b32 v240, a48
    v_mfma_f32_16x16x32_bf16 a[104:107], a[236:239], v[44:47], a[104:107]
    v_accvgpr_read_b32 v241, a49
    v_mfma_f32_16x16x32_bf16 a[108:111], a[240:243], v[32:35], a[108:111]
    v_accvgpr_read_b32 v242, a50
    v_mfma_f32_16x16x32_bf16 a[108:111], a[244:247], v[36:39], a[108:111]
    buffer_load_dwordx4 a[176:179], v4, s[4:7], s35 offen sc1
    v_accvgpr_read_b32 v243, a51
    v_mfma_f32_16x16x32_bf16 a[108:111], a[248:251], v[40:43], a[108:111]
    v_accvgpr_read_b32 v244, a52
    v_mfma_f32_16x16x32_bf16 a[108:111], a[252:255], v[44:47], a[108:111]
    v_accvgpr_read_b32 v245, a53
    s_waitcnt lgkmcnt(4)
    v_mfma_f32_16x16x32_bf16 a[112:115], a[192:195], v[48:51], a[112:115]
    v_accvgpr_read_b32 v246, a54
    s_waitcnt vmcnt(15)
    s_barrier
    v_mfma_f32_16x16x32_bf16 a[112:115], a[196:199], v[52:55], a[112:115]
    ds_read_b64_tr_b16 v[32:33], v12 offset:32768
    v_add_u32 v4, 4096, v4
    v_accvgpr_read_b32 v247, a55
    s_waitcnt lgkmcnt(1)
    v_mfma_f32_16x16x32_bf16 a[112:115], a[200:203], v[56:59], a[112:115]
    ds_read_b64_tr_b16 v[34:35], v12 offset:33280
    buffer_load_dwordx2 v[20:21], v29, s[24:27], s46 offen offset:0
    v_cvt_pk_bf16_f32 v240, v240, v241
    v_mfma_f32_16x16x32_bf16 a[112:115], a[204:207], v[60:63], a[112:115]
    ds_read_b64_tr_b16 v[36:37], v12 offset:36864
    v_cvt_pk_bf16_f32 v241, v242, v243
    v_mfma_f32_16x16x32_bf16 a[116:119], a[208:211], v[48:51], a[116:119]
    v_cvt_pk_bf16_f32 v242, v244, v245
    v_mfma_f32_16x16x32_bf16 a[116:119], a[212:215], v[52:55], a[116:119]
    ds_read_b64_tr_b16 v[38:39], v12 offset:37376
    v_cvt_pk_bf16_f32 v243, v246, v247
    v_mfma_f32_16x16x32_bf16 a[116:119], a[216:219], v[56:59], a[116:119]
    ds_read_b64_tr_b16 v[40:41], v12 offset:40960
    v_mfma_f32_16x16x32_bf16 a[116:119], a[220:223], v[60:63], a[116:119]
    ds_read_b64_tr_b16 v[42:43], v12 offset:41472
    buffer_load_dwordx2 v[22:23], v29, s[24:27], s46 offen offset:32
    buffer_store_dwordx4 v[240:243], v3, s[16:19], s53 offen offset:2048 sc1
    v_accvgpr_read_b32 v248, a56
    v_mfma_f32_16x16x32_bf16 a[120:123], a[224:227], v[48:51], a[120:123]
    v_accvgpr_read_b32 v249, a57
    v_mfma_f32_16x16x32_bf16 a[120:123], a[228:231], v[52:55], a[120:123]
    ds_read_b64_tr_b16 v[44:45], v12 offset:45056
    v_accvgpr_read_b32 v250, a58
    v_mfma_f32_16x16x32_bf16 a[120:123], a[232:235], v[56:59], a[120:123]
    ds_read_b64_tr_b16 v[46:47], v12 offset:45568
    v_accvgpr_read_b32 v251, a59
    v_mfma_f32_16x16x32_bf16 a[120:123], a[236:239], v[60:63], a[120:123]
    v_accvgpr_read_b32 v252, a60
    v_mfma_f32_16x16x32_bf16 a[124:127], a[240:243], v[48:51], a[124:127]
    buffer_load_dwordx2 v[24:25], v29, s[24:27], s46 offen offset:64
    v_accvgpr_read_b32 v253, a61
    v_mfma_f32_16x16x32_bf16 a[124:127], a[244:247], v[52:55], a[124:127]
    v_accvgpr_read_b32 v254, a62
    v_mfma_f32_16x16x32_bf16 a[124:127], a[248:251], v[56:59], a[124:127]
    v_accvgpr_read_b32 v255, a63
    v_mfma_f32_16x16x32_bf16 a[124:127], a[252:255], v[60:63], a[124:127]
    v_cvt_pk_bf16_f32 v248, v248, v249
    s_waitcnt lgkmcnt(4)
    v_mfma_f32_16x16x32_bf16 v[96:99], v[32:35], a[192:195], v[96:99]
    v_cvt_pk_bf16_f32 v249, v250, v251
    v_mfma_f32_16x16x32_bf16 v[96:99], v[36:39], a[196:199], v[96:99]
    ds_read_b64_tr_b16 v[48:49], v13 offset:32768
    buffer_load_dwordx2 v[26:27], v29, s[24:27], s46 offen offset:96
    v_cvt_pk_bf16_f32 v250, v252, v253
    s_waitcnt lgkmcnt(1)
    v_mfma_f32_16x16x32_bf16 v[96:99], v[40:43], a[200:203], v[96:99]
    ds_read_b64_tr_b16 v[50:51], v13 offset:33280
    v_cvt_pk_bf16_f32 v251, v254, v255
    v_mfma_f32_16x16x32_bf16 v[96:99], v[44:47], a[204:207], v[96:99]
    ds_read_b64_tr_b16 v[52:53], v13 offset:36864
    v_mfma_f32_16x16x32_bf16 v[100:103], v[32:35], a[208:211], v[100:103]
    buffer_store_dwordx4 v[248:251], v3, s[16:19], s53 offen offset:3072 sc1
    v_mfma_f32_16x16x32_bf16 v[100:103], v[36:39], a[212:215], v[100:103]
    ds_read_b64_tr_b16 v[54:55], v13 offset:37376
    v_mfma_f32_16x16x32_bf16 v[100:103], v[40:43], a[216:219], v[100:103]
    ds_read_b64_tr_b16 v[56:57], v13 offset:40960
    buffer_load_dwordx4 a[132:135], v5, s[4:7], s32 offen sc1
    v_accvgpr_read_b32 v192, a64
    v_mfma_f32_16x16x32_bf16 v[100:103], v[44:47], a[220:223], v[100:103]
    ds_read_b64_tr_b16 v[58:59], v13 offset:41472
    v_accvgpr_read_b32 v193, a65
    v_mfma_f32_16x16x32_bf16 v[104:107], v[32:35], a[224:227], v[104:107]
    v_accvgpr_read_b32 v194, a66
    v_mfma_f32_16x16x32_bf16 v[104:107], v[36:39], a[228:231], v[104:107]
    ds_read_b64_tr_b16 v[60:61], v13 offset:45056
    v_accvgpr_read_b32 v195, a67
    v_mfma_f32_16x16x32_bf16 v[104:107], v[40:43], a[232:235], v[104:107]
    ds_read_b64_tr_b16 v[62:63], v13 offset:45568
    v_accvgpr_read_b32 v196, a68
    v_mfma_f32_16x16x32_bf16 v[104:107], v[44:47], a[236:239], v[104:107]
    buffer_load_dwordx4 a[148:151], v5, s[4:7], s33 offen sc1
    v_accvgpr_read_b32 v197, a69
    v_mfma_f32_16x16x32_bf16 v[108:111], v[32:35], a[240:243], v[108:111]
    v_accvgpr_read_b32 v198, a70
    v_mfma_f32_16x16x32_bf16 v[108:111], v[36:39], a[244:247], v[108:111]
    v_accvgpr_read_b32 v199, a71
    v_mfma_f32_16x16x32_bf16 v[108:111], v[40:43], a[248:251], v[108:111]
    v_cvt_pk_bf16_f32 v192, v192, v193
    v_mfma_f32_16x16x32_bf16 v[108:111], v[44:47], a[252:255], v[108:111]
    v_cvt_pk_bf16_f32 v193, v194, v195
    s_waitcnt lgkmcnt(4)
    v_mfma_f32_16x16x32_bf16 v[64:67], v[48:51], a[192:195], v[64:67]
    buffer_load_dwordx4 a[164:167], v5, s[4:7], s34 offen sc1
    v_cvt_pk_bf16_f32 v194, v196, v197
    v_mfma_f32_16x16x32_bf16 v[64:67], v[52:55], a[196:199], v[64:67]
    ds_read_b64_tr_b16 v[32:33], v14 offset:32768
    v_cvt_pk_bf16_f32 v195, v198, v199
    s_waitcnt lgkmcnt(1)
    v_mfma_f32_16x16x32_bf16 v[64:67], v[56:59], a[200:203], v[64:67]
    ds_read_b64_tr_b16 v[34:35], v14 offset:33280
    v_mfma_f32_16x16x32_bf16 v[64:67], v[60:63], a[204:207], v[64:67]
    ds_read_b64_tr_b16 v[36:37], v14 offset:36864
    buffer_store_dwordx4 v[192:195], v3, s[16:19], s54 offen offset:0 sc1
    v_accvgpr_read_b32 v200, a72
    v_mfma_f32_16x16x32_bf16 v[68:71], v[48:51], a[208:211], v[68:71]
    v_accvgpr_read_b32 v201, a73
    v_mfma_f32_16x16x32_bf16 v[68:71], v[52:55], a[212:215], v[68:71]
    ds_read_b64_tr_b16 v[38:39], v14 offset:37376
    buffer_load_dwordx4 a[180:183], v5, s[4:7], s35 offen sc1
    v_accvgpr_read_b32 v202, a74
    v_mfma_f32_16x16x32_bf16 v[68:71], v[56:59], a[216:219], v[68:71]
    ds_read_b64_tr_b16 v[40:41], v14 offset:40960
    v_accvgpr_read_b32 v203, a75
    v_mfma_f32_16x16x32_bf16 v[68:71], v[60:63], a[220:223], v[68:71]
    ds_read_b64_tr_b16 v[42:43], v14 offset:41472
    v_accvgpr_read_b32 v204, a76
    v_mfma_f32_16x16x32_bf16 v[72:75], v[48:51], a[224:227], v[72:75]
    v_accvgpr_read_b32 v205, a77
    v_mfma_f32_16x16x32_bf16 v[72:75], v[52:55], a[228:231], v[72:75]
    ds_read_b64_tr_b16 v[44:45], v14 offset:45056
    v_accvgpr_read_b32 v206, a78
    v_mfma_f32_16x16x32_bf16 v[72:75], v[56:59], a[232:235], v[72:75]
    ds_read_b64_tr_b16 v[46:47], v14 offset:45568
    buffer_load_dwordx4 a[136:139], v6, s[4:7], s32 offen sc1
    v_accvgpr_read_b32 v207, a79
    v_mfma_f32_16x16x32_bf16 v[72:75], v[60:63], a[236:239], v[72:75]
    v_cvt_pk_bf16_f32 v200, v200, v201
    v_mfma_f32_16x16x32_bf16 v[76:79], v[48:51], a[240:243], v[76:79]
    v_cvt_pk_bf16_f32 v201, v202, v203
    v_mfma_f32_16x16x32_bf16 v[76:79], v[52:55], a[244:247], v[76:79]
    v_cvt_pk_bf16_f32 v202, v204, v205
    v_mfma_f32_16x16x32_bf16 v[76:79], v[56:59], a[248:251], v[76:79]
    v_cvt_pk_bf16_f32 v203, v206, v207
    v_mfma_f32_16x16x32_bf16 v[76:79], v[60:63], a[252:255], v[76:79]
    buffer_load_dwordx4 a[152:155], v6, s[4:7], s33 offen sc1
    s_waitcnt lgkmcnt(4)
    v_mfma_f32_16x16x32_bf16 v[112:115], v[32:35], a[192:195], v[112:115]
    buffer_store_dwordx4 v[200:203], v3, s[16:19], s54 offen offset:1024 sc1
    v_mfma_f32_16x16x32_bf16 v[112:115], v[36:39], a[196:199], v[112:115]
    ds_read_b64_tr_b16 v[48:49], v15 offset:32768
    s_waitcnt lgkmcnt(1)
    v_mfma_f32_16x16x32_bf16 v[112:115], v[40:43], a[200:203], v[112:115]
    ds_read_b64_tr_b16 v[50:51], v15 offset:33280
    v_accvgpr_read_b32 v208, a80
    v_mfma_f32_16x16x32_bf16 v[112:115], v[44:47], a[204:207], v[112:115]
    ds_read_b64_tr_b16 v[52:53], v15 offset:36864
    v_accvgpr_read_b32 v209, a81
    v_mfma_f32_16x16x32_bf16 v[116:119], v[32:35], a[208:211], v[116:119]
    buffer_load_dwordx4 a[168:171], v6, s[4:7], s34 offen sc1
    v_accvgpr_read_b32 v210, a82
    v_mfma_f32_16x16x32_bf16 v[116:119], v[36:39], a[212:215], v[116:119]
    ds_read_b64_tr_b16 v[54:55], v15 offset:37376
    v_accvgpr_read_b32 v211, a83
    v_mfma_f32_16x16x32_bf16 v[116:119], v[40:43], a[216:219], v[116:119]
    ds_read_b64_tr_b16 v[56:57], v15 offset:40960
    v_accvgpr_read_b32 v212, a84
    v_mfma_f32_16x16x32_bf16 v[116:119], v[44:47], a[220:223], v[116:119]
    ds_read_b64_tr_b16 v[58:59], v15 offset:41472
    v_accvgpr_read_b32 v213, a85
    v_mfma_f32_16x16x32_bf16 v[120:123], v[32:35], a[224:227], v[120:123]
    v_accvgpr_read_b32 v214, a86
    v_mfma_f32_16x16x32_bf16 v[120:123], v[36:39], a[228:231], v[120:123]
    ds_read_b64_tr_b16 v[60:61], v15 offset:45056
    buffer_load_dwordx4 a[184:187], v6, s[4:7], s35 offen sc1
    v_accvgpr_read_b32 v215, a87
    v_mfma_f32_16x16x32_bf16 v[120:123], v[40:43], a[232:235], v[120:123]
    ds_read_b64_tr_b16 v[62:63], v15 offset:45568
    v_cvt_pk_bf16_f32 v208, v208, v209
    v_mfma_f32_16x16x32_bf16 v[120:123], v[44:47], a[236:239], v[120:123]
    v_cvt_pk_bf16_f32 v209, v210, v211
    v_mfma_f32_16x16x32_bf16 v[124:127], v[32:35], a[240:243], v[124:127]
    v_cvt_pk_bf16_f32 v210, v212, v213
    v_mfma_f32_16x16x32_bf16 v[124:127], v[36:39], a[244:247], v[124:127]
    v_cvt_pk_bf16_f32 v211, v214, v215
    v_mfma_f32_16x16x32_bf16 v[124:127], v[40:43], a[248:251], v[124:127]
    buffer_load_dwordx4 a[140:143], v7, s[4:7], s32 offen sc1
    v_mfma_f32_16x16x32_bf16 v[124:127], v[44:47], a[252:255], v[124:127]
    buffer_store_dwordx4 v[208:211], v3, s[16:19], s54 offen offset:2048 sc1
    v_accvgpr_read_b32 v216, a88
    s_waitcnt lgkmcnt(4)
    v_mfma_f32_16x16x32_bf16 v[80:83], v[48:51], a[192:195], v[80:83]
    v_accvgpr_read_b32 v217, a89
    s_waitcnt vmcnt(29)
    s_barrier
    v_mfma_f32_16x16x32_bf16 v[80:83], v[52:55], a[196:199], v[80:83]
    ds_read_b64_tr_b16 v[32:33], v12 offset:49152
    v_accvgpr_read_b32 v218, a90
    s_waitcnt lgkmcnt(1)
    v_mfma_f32_16x16x32_bf16 v[80:83], v[56:59], a[200:203], v[80:83]
    ds_read_b64_tr_b16 v[34:35], v12 offset:49664
    v_accvgpr_read_b32 v219, a91
    v_mfma_f32_16x16x32_bf16 v[80:83], v[60:63], a[204:207], v[80:83]
    ds_read_b64_tr_b16 v[36:37], v12 offset:53248
    buffer_load_dwordx4 a[156:159], v7, s[4:7], s33 offen sc1
    v_accvgpr_read_b32 v220, a92
    v_mfma_f32_16x16x32_bf16 v[84:87], v[48:51], a[208:211], v[84:87]
    v_accvgpr_read_b32 v221, a93
    v_mfma_f32_16x16x32_bf16 v[84:87], v[52:55], a[212:215], v[84:87]
    ds_read_b64_tr_b16 v[38:39], v12 offset:53760
    v_accvgpr_read_b32 v222, a94
    v_mfma_f32_16x16x32_bf16 v[84:87], v[56:59], a[216:219], v[84:87]
    ds_read_b64_tr_b16 v[40:41], v12 offset:57344
    v_accvgpr_read_b32 v223, a95
    v_mfma_f32_16x16x32_bf16 v[84:87], v[60:63], a[220:223], v[84:87]
    ds_read_b64_tr_b16 v[42:43], v12 offset:57856
    v_cvt_pk_bf16_f32 v216, v216, v217
    v_mfma_f32_16x16x32_bf16 v[88:91], v[48:51], a[224:227], v[88:91]
    buffer_load_dwordx4 a[172:175], v7, s[4:7], s34 offen sc1
    v_cvt_pk_bf16_f32 v217, v218, v219
    v_mfma_f32_16x16x32_bf16 v[88:91], v[52:55], a[228:231], v[88:91]
    ds_read_b64_tr_b16 v[44:45], v12 offset:61440
    v_cvt_pk_bf16_f32 v218, v220, v221
    v_mfma_f32_16x16x32_bf16 v[88:91], v[56:59], a[232:235], v[88:91]
    ds_read_b64_tr_b16 v[46:47], v12 offset:61952
    v_cvt_pk_bf16_f32 v219, v222, v223
    v_mfma_f32_16x16x32_bf16 v[88:91], v[60:63], a[236:239], v[88:91]
    v_mfma_f32_16x16x32_bf16 v[92:95], v[48:51], a[240:243], v[92:95]
    buffer_store_dwordx4 v[216:219], v3, s[16:19], s54 offen offset:3072 sc1
    v_mfma_f32_16x16x32_bf16 v[92:95], v[52:55], a[244:247], v[92:95]
    buffer_load_dwordx4 a[188:191], v7, s[4:7], s35 offen sc1
    v_mfma_f32_16x16x32_bf16 v[92:95], v[56:59], a[248:251], v[92:95]
    v_accvgpr_read_b32 v224, a96
    v_mfma_f32_16x16x32_bf16 v[92:95], v[60:63], a[252:255], v[92:95]
    v_accvgpr_read_b32 v225, a97
    s_waitcnt lgkmcnt(4)
    v_mfma_f32_16x16x32_bf16 v[160:163], v[32:35], a[192:195], v[160:163]
    s_add_u32 m0, s44, 0
    v_accvgpr_read_b32 v226, a98
    v_mfma_f32_16x16x32_bf16 v[160:163], v[36:39], a[196:199], v[160:163]
    ds_read_b64_tr_b16 v[48:49], v13 offset:49152
    s_add_u32 s47, s50, 0
    v_accvgpr_read_b32 v227, a99
    s_waitcnt lgkmcnt(1)
    v_mfma_f32_16x16x32_bf16 v[160:163], v[40:43], a[200:203], v[160:163]
    ds_read_b64_tr_b16 v[50:51], v13 offset:49664
    buffer_load_dwordx4 v10, s[12:15], s47 offen lds
    v_accvgpr_read_b32 v228, a100
    v_mfma_f32_16x16x32_bf16 v[160:163], v[44:47], a[204:207], v[160:163]
    ds_read_b64_tr_b16 v[52:53], v13 offset:53248
    v_accvgpr_read_b32 v229, a101
    v_mfma_f32_16x16x32_bf16 v[164:167], v[32:35], a[208:211], v[164:167]
    v_accvgpr_read_b32 v230, a102
    v_mul_f32 v96, s61, v96
    v_mul_f32 v97, s61, v97
    v_mfma_f32_16x16x32_bf16 v[164:167], v[36:39], a[212:215], v[164:167]
    ds_read_b64_tr_b16 v[54:55], v13 offset:53760
    v_accvgpr_read_b32 v231, a103
    v_mul_f32 v98, s61, v98
    v_mul_f32 v99, s61, v99
    v_mfma_f32_16x16x32_bf16 v[164:167], v[40:43], a[216:219], v[164:167]
    ds_read_b64_tr_b16 v[56:57], v13 offset:57344
    v_cvt_pk_bf16_f32 v224, v224, v225
    v_mul_f32 v64, s61, v64
    v_mfma_f32_16x16x32_bf16 v[164:167], v[44:47], a[220:223], v[164:167]
    ds_read_b64_tr_b16 v[58:59], v13 offset:57856
    buffer_load_dwordx4 v11, s[12:15], s47 offen offset:1024 lds
    v_cvt_pk_bf16_f32 v225, v226, v227
    v_mul_f32 v65, s61, v65
    v_mul_f32 v66, s61, v66
    v_mfma_f32_16x16x32_bf16 v[168:171], v[32:35], a[224:227], v[168:171]
    v_cvt_pk_bf16_f32 v226, v228, v229
    v_mul_f32 v67, s61, v67
    v_cvt_pk_bf16_f32 v96, v96, v97
    v_mfma_f32_16x16x32_bf16 v[168:171], v[36:39], a[228:231], v[168:171]
    ds_read_b64_tr_b16 v[60:61], v13 offset:61440
    v_cvt_pk_bf16_f32 v227, v230, v231
    v_cvt_pk_bf16_f32 v97, v98, v99
    v_mfma_f32_16x16x32_bf16 v[168:171], v[40:43], a[232:235], v[168:171]
    ds_read_b64_tr_b16 v[62:63], v13 offset:61952
    s_add_u32 m0, s44, 8192
    v_cvt_pk_bf16_f32 v98, v64, v65
    v_cvt_pk_bf16_f32 v99, v66, v67
    v_mfma_f32_16x16x32_bf16 v[168:171], v[44:47], a[236:239], v[168:171]
    s_add_u32 s47, s51, 0
    buffer_store_dwordx4 v[224:227], v3, s[16:19], s55 offen offset:0 sc1
    v_accvgpr_read_b32 v232, a104
    v_mul_f32 v100, s61, v100
    v_mul_f32 v101, s61, v101
    v_mfma_f32_16x16x32_bf16 v[172:175], v[32:35], a[240:243], v[172:175]
    buffer_load_dwordx4 v10, s[12:15], s47 offen lds
    v_accvgpr_read_b32 v233, a105
    v_mul_f32 v102, s61, v102
    v_mfma_f32_16x16x32_bf16 v[172:175], v[36:39], a[244:247], v[172:175]
    v_accvgpr_read_b32 v234, a106
    v_mul_f32 v103, s61, v103
    v_mul_f32 v68, s61, v68
    v_mfma_f32_16x16x32_bf16 v[172:175], v[40:43], a[248:251], v[172:175]
    v_accvgpr_read_b32 v235, a107
    v_mul_f32 v69, s61, v69
    v_mul_f32 v70, s61, v70
    v_mfma_f32_16x16x32_bf16 v[172:175], v[44:47], a[252:255], v[172:175]
    v_accvgpr_read_b32 v236, a108
    v_mul_f32 v71, s61, v71
    s_waitcnt lgkmcnt(4)
    v_mfma_f32_16x16x32_bf16 v[128:131], v[48:51], a[192:195], v[128:131]
    v_accvgpr_read_b32 v237, a109
    v_cvt_pk_bf16_f32 v100, v100, v101
    v_cvt_pk_bf16_f32 v101, v102, v103
    v_mfma_f32_16x16x32_bf16 v[128:131], v[52:55], a[196:199], v[128:131]
    ds_read_b64_tr_b16 v[32:33], v14 offset:49152
    buffer_load_dwordx4 v11, s[12:15], s47 offen offset:1024 lds
    v_accvgpr_read_b32 v238, a110
    v_cvt_pk_bf16_f32 v102, v68, v69
    v_cvt_pk_bf16_f32 v103, v70, v71
    s_waitcnt lgkmcnt(1)
    v_mfma_f32_16x16x32_bf16 v[128:131], v[56:59], a[200:203], v[128:131]
    ds_read_b64_tr_b16 v[34:35], v14 offset:49664
    v_accvgpr_read_b32 v239, a111
    v_mul_f32 v104, s61, v104
    v_mfma_f32_16x16x32_bf16 v[128:131], v[60:63], a[204:207], v[128:131]
    ds_read_b64_tr_b16 v[36:37], v14 offset:53248
    v_cvt_pk_bf16_f32 v232, v232, v233
    v_mul_f32 v105, s61, v105
    v_mul_f32 v106, s61, v106
    v_mfma_f32_16x16x32_bf16 v[132:135], v[48:51], a[208:211], v[132:135]
    v_cvt_pk_bf16_f32 v233, v234, v235
    v_mul_f32 v107, s61, v107
    v_mul_f32 v72, s61, v72
    v_mfma_f32_16x16x32_bf16 v[132:135], v[52:55], a[212:215], v[132:135]
    ds_read_b64_tr_b16 v[38:39], v14 offset:53760
    v_cvt_pk_bf16_f32 v234, v236, v237
    v_mul_f32 v73, s61, v73
    v_mfma_f32_16x16x32_bf16 v[132:135], v[56:59], a[216:219], v[132:135]
    ds_read_b64_tr_b16 v[40:41], v14 offset:57344
    v_cvt_pk_bf16_f32 v235, v238, v239
    v_mul_f32 v74, s61, v74
    v_mul_f32 v75, s61, v75
    v_mfma_f32_16x16x32_bf16 v[132:135], v[60:63], a[220:223], v[132:135]
    ds_read_b64_tr_b16 v[42:43], v14 offset:57856
    v_cvt_pk_bf16_f32 v104, v104, v105
    v_cvt_pk_bf16_f32 v105, v106, v107
    v_mfma_f32_16x16x32_bf16 v[136:139], v[48:51], a[224:227], v[136:139]
    buffer_store_dwordx4 v[232:235], v3, s[16:19], s55 offen offset:1024 sc1
    v_cvt_pk_bf16_f32 v106, v72, v73
    v_mfma_f32_16x16x32_bf16 v[136:139], v[52:55], a[228:231], v[136:139]
    ds_read_b64_tr_b16 v[44:45], v14 offset:61440
    v_cvt_pk_bf16_f32 v107, v74, v75
    v_mul_f32 v108, s61, v108
    v_mfma_f32_16x16x32_bf16 v[136:139], v[56:59], a[232:235], v[136:139]
    ds_read_b64_tr_b16 v[46:47], v14 offset:61952
    v_accvgpr_read_b32 v240, a112
    v_mul_f32 v109, s61, v109
    v_mul_f32 v110, s61, v110
    v_mfma_f32_16x16x32_bf16 v[136:139], v[60:63], a[236:239], v[136:139]
    v_accvgpr_read_b32 v241, a113
    v_mul_f32 v111, s61, v111
    v_mfma_f32_16x16x32_bf16 v[140:143], v[48:51], a[240:243], v[140:143]
    v_accvgpr_read_b32 v242, a114
    v_mul_f32 v76, s61, v76
    v_mul_f32 v77, s61, v77
    v_mfma_f32_16x16x32_bf16 v[140:143], v[52:55], a[244:247], v[140:143]
    v_accvgpr_read_b32 v243, a115
    v_mul_f32 v78, s61, v78
    v_mul_f32 v79, s61, v79
    v_mfma_f32_16x16x32_bf16 v[140:143], v[56:59], a[248:251], v[140:143]
    v_accvgpr_read_b32 v244, a116
    v_cvt_pk_bf16_f32 v108, v108, v109
    v_mfma_f32_16x16x32_bf16 v[140:143], v[60:63], a[252:255], v[140:143]
    v_accvgpr_read_b32 v245, a117
    v_cvt_pk_bf16_f32 v109, v110, v111
    v_cvt_pk_bf16_f32 v110, v76, v77
    s_waitcnt lgkmcnt(4)
    v_mfma_f32_16x16x32_bf16 v[176:179], v[32:35], a[192:195], v[176:179]
    v_accvgpr_read_b32 v246, a118
    v_cvt_pk_bf16_f32 v111, v78, v79
    v_mfma_f32_16x16x32_bf16 v[176:179], v[36:39], a[196:199], v[176:179]
    ds_read_b64_tr_b16 v[48:49], v15 offset:49152
    v_accvgpr_read_b32 v247, a119
    v_mul_f32 v112, s61, v112
    v_mul_f32 v113, s61, v113
    s_waitcnt lgkmcnt(1)
    v_mfma_f32_16x16x32_bf16 v[176:179], v[40:43], a[200:203], v[176:179]
    ds_read_b64_tr_b16 v[50:51], v15 offset:49664
    v_cvt_pk_bf16_f32 v240, v240, v241
    v_mul_f32 v114, s61, v114
    v_mul_f32 v115, s61, v115
    v_mfma_f32_16x16x32_bf16 v[176:179], v[44:47], a[204:207], v[176:179]
    ds_read_b64_tr_b16 v[52:53], v15 offset:53248
    v_cvt_pk_bf16_f32 v241, v242, v243
    v_mul_f32 v80, s61, v80
    v_mfma_f32_16x16x32_bf16 v[180:183], v[32:35], a[208:211], v[180:183]
    v_cvt_pk_bf16_f32 v242, v244, v245
    v_mul_f32 v81, s61, v81
    v_mul_f32 v82, s61, v82
    v_mfma_f32_16x16x32_bf16 v[180:183], v[36:39], a[212:215], v[180:183]
    ds_read_b64_tr_b16 v[54:55], v15 offset:53760
    v_cvt_pk_bf16_f32 v243, v246, v247
    v_mul_f32 v83, s61, v83
    v_cvt_pk_bf16_f32 v112, v112, v113
    v_mfma_f32_16x16x32_bf16 v[180:183], v[40:43], a[216:219], v[180:183]
    ds_read_b64_tr_b16 v[56:57], v15 offset:57344
    v_cvt_pk_bf16_f32 v113, v114, v115
    v_mfma_f32_16x16x32_bf16 v[180:183], v[44:47], a[220:223], v[180:183]
    ds_read_b64_tr_b16 v[58:59], v15 offset:57856
    buffer_store_dwordx4 v[240:243], v3, s[16:19], s55 offen offset:2048 sc1
    v_accvgpr_read_b32 v248, a120
    v_cvt_pk_bf16_f32 v114, v80, v81
    v_cvt_pk_bf16_f32 v115, v82, v83
    v_mfma_f32_16x16x32_bf16 v[184:187], v[32:35], a[224:227], v[184:187]
    v_accvgpr_read_b32 v249, a121
    v_mul_f32 v116, s61, v116
    v_mul_f32 v117, s61, v117
    v_mfma_f32_16x16x32_bf16 v[184:187], v[36:39], a[228:231], v[184:187]
    ds_read_b64_tr_b16 v[60:61], v15 offset:61440
    v_accvgpr_read_b32 v250, a122
    v_mul_f32 v118, s61, v118
    v_mfma_f32_16x16x32_bf16 v[184:187], v[40:43], a[232:235], v[184:187]
    ds_read_b64_tr_b16 v[62:63], v15 offset:61952
    v_accvgpr_read_b32 v251, a123
    v_mul_f32 v119, s61, v119
    v_mul_f32 v84, s61, v84
    v_mfma_f32_16x16x32_bf16 v[184:187], v[44:47], a[236:239], v[184:187]
    v_accvgpr_read_b32 v252, a124
    v_mul_f32 v85, s61, v85
    v_mul_f32 v86, s61, v86
    v_mfma_f32_16x16x32_bf16 v[188:191], v[32:35], a[240:243], v[188:191]
    v_accvgpr_read_b32 v253, a125
    v_mul_f32 v87, s61, v87
    v_mfma_f32_16x16x32_bf16 v[188:191], v[36:39], a[244:247], v[188:191]
    v_accvgpr_read_b32 v254, a126
    v_cvt_pk_bf16_f32 v116, v116, v117
    v_cvt_pk_bf16_f32 v117, v118, v119
    v_mfma_f32_16x16x32_bf16 v[188:191], v[40:43], a[248:251], v[188:191]
    v_accvgpr_read_b32 v255, a127
    v_cvt_pk_bf16_f32 v118, v84, v85
    v_cvt_pk_bf16_f32 v119, v86, v87
    v_mfma_f32_16x16x32_bf16 v[188:191], v[44:47], a[252:255], v[188:191]
    v_cvt_pk_bf16_f32 v248, v248, v249
    v_mul_f32 v120, s61, v120
    s_waitcnt lgkmcnt(4)
    v_mfma_f32_16x16x32_bf16 v[144:147], v[48:51], a[192:195], v[144:147]
    v_cvt_pk_bf16_f32 v249, v250, v251
    v_mul_f32 v121, s61, v121
    v_mul_f32 v122, s61, v122
    v_mfma_f32_16x16x32_bf16 v[144:147], v[52:55], a[196:199], v[144:147]
    v_cvt_pk_bf16_f32 v250, v252, v253
    v_mul_f32 v123, s61, v123
    v_mul_f32 v88, s61, v88
    s_waitcnt lgkmcnt(0)
    v_mfma_f32_16x16x32_bf16 v[144:147], v[56:59], a[200:203], v[144:147]
    v_cvt_pk_bf16_f32 v251, v254, v255
    v_mul_f32 v89, s61, v89
    v_mfma_f32_16x16x32_bf16 v[144:147], v[60:63], a[204:207], v[144:147]
    v_mul_f32 v90, s61, v90
    v_mul_f32 v91, s61, v91
    v_mfma_f32_16x16x32_bf16 v[148:151], v[48:51], a[208:211], v[148:151]
    buffer_store_dwordx4 v[248:251], v3, s[16:19], s55 offen offset:3072 sc1
    v_cvt_pk_bf16_f32 v120, v120, v121
    v_cvt_pk_bf16_f32 v121, v122, v123
    v_mfma_f32_16x16x32_bf16 v[148:151], v[52:55], a[212:215], v[148:151]
    v_cvt_pk_bf16_f32 v122, v88, v89
    v_mfma_f32_16x16x32_bf16 v[148:151], v[56:59], a[216:219], v[148:151]
    v_cvt_pk_bf16_f32 v123, v90, v91
    v_mul_f32 v124, s61, v124
    v_mfma_f32_16x16x32_bf16 v[148:151], v[60:63], a[220:223], v[148:151]
    v_mul_f32 v125, s61, v125
    v_mul_f32 v126, s61, v126
    v_mfma_f32_16x16x32_bf16 v[152:155], v[48:51], a[224:227], v[152:155]
    v_mul_f32 v127, s61, v127
    v_mfma_f32_16x16x32_bf16 v[152:155], v[52:55], a[228:231], v[152:155]
    v_mul_f32 v92, s61, v92
    v_mul_f32 v93, s61, v93
    v_mfma_f32_16x16x32_bf16 v[152:155], v[56:59], a[232:235], v[152:155]
    v_mul_f32 v94, s61, v94
    v_mul_f32 v95, s61, v95
    v_mfma_f32_16x16x32_bf16 v[152:155], v[60:63], a[236:239], v[152:155]
    v_cvt_pk_bf16_f32 v124, v124, v125
    v_mfma_f32_16x16x32_bf16 v[156:159], v[48:51], a[240:243], v[156:159]
    v_cvt_pk_bf16_f32 v125, v126, v127
    v_cvt_pk_bf16_f32 v126, v92, v93
    v_mfma_f32_16x16x32_bf16 v[156:159], v[52:55], a[244:247], v[156:159]
    v_cvt_pk_bf16_f32 v127, v94, v95
    v_mfma_f32_16x16x32_bf16 v[156:159], v[56:59], a[248:251], v[156:159]
    v_mfma_f32_16x16x32_bf16 v[156:159], v[60:63], a[252:255], v[156:159]
    s_barrier
K2_BEGIN:
    buffer_load_dwordx4 a[192:195], v4, s[4:7], s32 offen sc1
    buffer_load_dwordx4 a[208:211], v4, s[4:7], s33 offen sc1
    buffer_load_dwordx4 a[224:227], v4, s[4:7], s34 offen sc1
    buffer_load_dwordx4 a[240:243], v4, s[4:7], s35 offen sc1
    v_add_u32 v4, 4096, v4
    s_add_u32 m0, s44, 16384
    s_add_u32 s47, s50, 352256
    buffer_load_dwordx4 v10, s[12:15], s47 offen lds
    buffer_load_dwordx4 v11, s[12:15], s47 offen offset:1024 lds
    s_add_u32 m0, s44, 24576
    s_add_u32 s47, s51, 352256
    buffer_load_dwordx4 v10, s[12:15], s47 offen lds
    buffer_load_dwordx4 v11, s[12:15], s47 offen offset:1024 lds
    v_add_u32 v5, 4096, v5
    v_add_u32 v6, 4096, v6
    v_add_u32 v7, 4096, v7
    s_waitcnt vmcnt(33)
    v_lshlrev_b32 v64, 16, v20
    v_and_b32 v65, 0xffff0000, v20
    v_lshlrev_b32 v66, 16, v21
    v_and_b32 v67, 0xffff0000, v21
    v_lshlrev_b32 v68, 16, v22
    v_and_b32 v69, 0xffff0000, v22
    v_lshlrev_b32 v70, 16, v23
    v_and_b32 v71, 0xffff0000, v23
    v_lshlrev_b32 v72, 16, v24
    v_and_b32 v73, 0xffff0000, v24
    v_lshlrev_b32 v74, 16, v25
    v_and_b32 v75, 0xffff0000, v25
    v_lshlrev_b32 v76, 16, v26
    v_and_b32 v77, 0xffff0000, v26
    v_lshlrev_b32 v78, 16, v27
    v_and_b32 v79, 0xffff0000, v27
    s_mov_b32 s56, s62
    s_mov_b32 s57, s63
    v_lshrrev_b32 v29, 4, v2
    v_lshlrev_b32 v29, 10, v29
    v_bfe_u32 v30, v2, 2, 2
    v_lshl_add_u32 v29, v30, 7, v29
    v_and_b32 v30, 3, v2
    v_lshl_add_u32 v29, v30, 3, v29
    v_bfe_u32 v30, v2, 3, 2
    v_lshl_add_u32 v12, v30, 5, v29
    v_xor_b32 v13, 32, v12
    v_xor_b32 v14, 64, v12
    v_xor_b32 v15, 96, v12
    v_add_u32 v16, 0x10000, v12
    v_add_u32 v17, 0x10000, v13
    v_add_u32 v18, 0x10000, v14
    v_add_u32 v19, 0x10000, v15
    v_add_u32 v20, 0x20000, v12
    v_add_u32 v21, 0x20000, v13
    v_add_u32 v22, 0x20000, v14
    v_add_u32 v23, 0x20000, v15
    s_lshl_b32 s45, s29, 19
    s_lshl_b32 s46, s30, 15
    s_sub_u32 s46, 0x80000, s46
    s_add_u32 s47, s45, 2097152
    s_add_u32 s16, s4, s47
    s_addc_u32 s17, s5, 0
    s_mov_b32 s18, s46
    s_mov_b32 s19, 0x00020000
    s_add_u32 s47, s45, 18874368
    s_add_u32 s20, s4, s47
    s_addc_u32 s21, s5, 0
    s_mov_b32 s22, s46
    s_mov_b32 s23, 0x00020000
    s_add_u32 s38, s36, 176128
    s_add_u32 s42, s40, 176128
    s_and_b32 s45, s29, 3
    s_max_u32 s45, s45, 1
    s_lshr_b32 s58, s29, 2
    s_mul_i32 s58, s58, 3
    s_add_u32 s58, s58, s45
    s_sub_u32 s58, s58, 1
    s_lshl_b32 s45, s58, 11
    s_add_u32 s45, s45, 35782656
    s_lshl_b32 s46, s29, 12
    s_add_u32 s46, s46, 35651584
    s_mov_b32 s53, s45
    s_mov_b32 s54, s46
    v_mov_b32 v29, s28
    v_lshl_add_u32 v24, v29, 12, v3
    v_and_b32 v29, 15, v2
    v_lshrrev_b32 v30, 4, v2
    v_lshlrev_b32 v30, 2, v30
    v_sub_u32 v27, v29, v30
    v_mov_b32 v28, 0xff800000
    s_mov_b32 s59, 0x5d800000
    s_mov_b32 s60, 0x3e0293ee
    v_mul_f32 v160, s60, v160
    v_mul_f32 v161, s60, v161
    v_mul_f32 v162, s60, v162
    v_mul_f32 v163, s60, v163
    v_mul_f32 v128, s60, v128
    v_mul_f32 v129, s60, v129
    v_mul_f32 v130, s60, v130
    v_mul_f32 v131, s60, v131
    v_cvt_pk_bf16_f32 v160, v160, v161
    v_cvt_pk_bf16_f32 v161, v162, v163
    v_cvt_pk_bf16_f32 v162, v128, v129
    v_cvt_pk_bf16_f32 v163, v130, v131
    v_mul_f32 v164, s60, v164
    v_mul_f32 v165, s60, v165
    v_mul_f32 v166, s60, v166
    v_mul_f32 v167, s60, v167
    v_mul_f32 v132, s60, v132
    v_mul_f32 v133, s60, v133
    v_mul_f32 v134, s60, v134
    v_mul_f32 v135, s60, v135
    v_cvt_pk_bf16_f32 v164, v164, v165
    v_cvt_pk_bf16_f32 v165, v166, v167
    v_cvt_pk_bf16_f32 v166, v132, v133
    v_cvt_pk_bf16_f32 v167, v134, v135
    v_mul_f32 v168, s60, v168
    v_mul_f32 v169, s60, v169
    v_mul_f32 v170, s60, v170
    v_mul_f32 v171, s60, v171
    v_mul_f32 v136, s60, v136
    v_mul_f32 v137, s60, v137
    v_mul_f32 v138, s60, v138
    v_mul_f32 v139, s60, v139
    v_cvt_pk_bf16_f32 v168, v168, v169
    v_cvt_pk_bf16_f32 v169, v170, v171
    v_cvt_pk_bf16_f32 v170, v136, v137
    v_cvt_pk_bf16_f32 v171, v138, v139
    v_mul_f32 v172, s60, v172
    v_mul_f32 v173, s60, v173
    v_mul_f32 v174, s60, v174
    v_mul_f32 v175, s60, v175
    v_mul_f32 v140, s60, v140
    v_mul_f32 v141, s60, v141
    v_mul_f32 v142, s60, v142
    v_mul_f32 v143, s60, v143
    v_cvt_pk_bf16_f32 v172, v172, v173
    v_cvt_pk_bf16_f32 v173, v174, v175
    v_cvt_pk_bf16_f32 v174, v140, v141
    v_cvt_pk_bf16_f32 v175, v142, v143
    v_mul_f32 v176, s60, v176
    v_mul_f32 v177, s60, v177
    v_mul_f32 v178, s60, v178
    v_mul_f32 v179, s60, v179
    v_mul_f32 v144, s60, v144
    v_mul_f32 v145, s60, v145
    v_mul_f32 v146, s60, v146
    v_mul_f32 v147, s60, v147
    v_cvt_pk_bf16_f32 v176, v176, v177
    v_cvt_pk_bf16_f32 v177, v178, v179
    v_cvt_pk_bf16_f32 v178, v144, v145
    v_cvt_pk_bf16_f32 v179, v146, v147
    v_mul_f32 v180, s60, v180
    v_mul_f32 v181, s60, v181
    v_mul_f32 v182, s60, v182
    v_mul_f32 v183, s60, v183
    v_mul_f32 v148, s60, v148
    v_mul_f32 v149, s60, v149
    v_mul_f32 v150, s60, v150
    v_mul_f32 v151, s60, v151
    v_cvt_pk_bf16_f32 v180, v180, v181
    v_cvt_pk_bf16_f32 v181, v182, v183
    v_cvt_pk_bf16_f32 v182, v148, v149
    v_cvt_pk_bf16_f32 v183, v150, v151
    v_mul_f32 v184, s60, v184
    v_mul_f32 v185, s60, v185
    v_mul_f32 v186, s60, v186
    v_mul_f32 v187, s60, v187
    v_mul_f32 v152, s60, v152
    v_mul_f32 v153, s60, v153
    v_mul_f32 v154, s60, v154
    v_mul_f32 v155, s60, v155
    v_cvt_pk_bf16_f32 v184, v184, v185
    v_cvt_pk_bf16_f32 v185, v186, v187
    v_cvt_pk_bf16_f32 v186, v152, v153
    v_cvt_pk_bf16_f32 v187, v154, v155
    v_mul_f32 v188, s60, v188
    v_mul_f32 v189, s60, v189
    v_mul_f32 v190, s60, v190
    v_mul_f32 v191, s60, v191
    v_mul_f32 v156, s60, v156
    v_mul_f32 v157, s60, v157
    v_mul_f32 v158, s60, v158
    v_mul_f32 v159, s60, v159
    v_cvt_pk_bf16_f32 v188, v188, v189
    v_cvt_pk_bf16_f32 v189, v190, v191
    v_cvt_pk_bf16_f32 v190, v156, v157
    v_cvt_pk_bf16_f32 v191, v158, v159
    s_lshl_b32 s60, s29, 19
    s_lshl_b32 s61, s30, 16
    s_add_u32 s60, s60, s61
    s_lshl_b32 s61, s28, 14
    s_add_u32 s60, s60, s61
    s_add_u32 s60, s60, 2097152
    s_waitcnt vmcnt(11)
    s_barrier
    ds_read_b64_tr_b16 v[32:33], v12 offset:0
    ds_read_b64_tr_b16 v[34:35], v12 offset:512
    ds_read_b64_tr_b16 v[36:37], v12 offset:4096
    ds_read_b64_tr_b16 v[38:39], v12 offset:4608
    ds_read_b64_tr_b16 v[40:41], v12 offset:8192
    ds_read_b64_tr_b16 v[42:43], v12 offset:8704
    ds_read_b64_tr_b16 v[44:45], v12 offset:12288
    ds_read_b64_tr_b16 v[46:47], v12 offset:12800
    s_and_b32 s45, s29, 3
    s_cmp_eq_u32 s45, 1
    s_cbranch_scc1 K2_NOMLP
    s_waitcnt lgkmcnt(4)
    s_waitcnt vmcnt(16)
    v_mfma_f32_16x16x32_bf16 v[192:195], v[32:35], a[128:131], v[64:67]
    v_mfma_f32_16x16x32_bf16 v[192:195], v[36:39], a[132:135], v[192:195]
    ds_read_b64_tr_b16 v[48:49], v13 offset:0
    s_waitcnt lgkmcnt(1)
    v_mfma_f32_16x16x32_bf16 v[192:195], v[40:43], a[136:139], v[192:195]
    ds_read_b64_tr_b16 v[50:51], v13 offset:512
    v_mfma_f32_16x16x32_bf16 v[192:195], v[44:47], a[140:143], v[192:195]
    ds_read_b64_tr_b16 v[52:53], v13 offset:4096
    v_mfma_f32_16x16x32_bf16 v[196:199], v[32:35], a[144:147], v[64:67]
    buffer_load_dwordx4 a[0:3], v4, s[4:7], s32 offen sc1
    v_mfma_f32_16x16x32_bf16 v[196:199], v[36:39], a[148:151], v[196:199]
    ds_read_b64_tr_b16 v[54:55], v13 offset:4608
    v_mfma_f32_16x16x32_bf16 v[196:199], v[40:43], a[152:155], v[196:199]
    ds_read_b64_tr_b16 v[56:57], v13 offset:8192
    v_mfma_f32_16x16x32_bf16 v[196:199], v[44:47], a[156:159], v[196:199]
    ds_read_b64_tr_b16 v[58:59], v13 offset:8704
    buffer_load_dwordx4 a[16:19], v4, s[4:7], s33 offen sc1
    v_mfma_f32_16x16x32_bf16 v[200:203], v[32:35], a[160:163], v[64:67]
    v_mfma_f32_16x16x32_bf16 v[200:203], v[36:39], a[164:167], v[200:203]
    ds_read_b64_tr_b16 v[60:61], v13 offset:12288
    v_mfma_f32_16x16x32_bf16 v[200:203], v[40:43], a[168:171], v[200:203]
    ds_read_b64_tr_b16 v[62:63], v13 offset:12800
    buffer_load_dwordx4 a[32:35], v4, s[4:7], s34 offen sc1
    v_mfma_f32_16x16x32_bf16 v[200:203], v[44:47], a[172:175], v[200:203]
    v_mfma_f32_16x16x32_bf16 v[204:207], v[32:35], a[176:179], v[64:67]
    v_mfma_f32_16x16x32_bf16 v[204:207], v[36:39], a[180:183], v[204:207]
    buffer_load_dwordx4 a[48:51], v4, s[4:7], s35 offen sc1
    v_mfma_f32_16x16x32_bf16 v[204:207], v[40:43], a[184:187], v[204:207]
    v_mfma_f32_16x16x32_bf16 v[204:207], v[44:47], a[188:191], v[204:207]
    v_add_u32 v4, 4096, v4
    s_waitcnt lgkmcnt(4)
    v_mfma_f32_16x16x32_bf16 v[208:211], v[48:51], a[128:131], v[68:71]
    buffer_load_dwordx4 a[196:199], v5, s[4:7], s32 offen sc1
    v_mfma_f32_16x16x32_bf16 v[208:211], v[52:55], a[132:135], v[208:211]
    ds_read_b64_tr_b16 v[32:33], v14 offset:0
    s_waitcnt lgkmcnt(1)
    v_mfma_f32_16x16x32_bf16 v[208:211], v[56:59], a[136:139], v[208:211]
    ds_read_b64_tr_b16 v[34:35], v14 offset:512
    v_mfma_f32_16x16x32_bf16 v[208:211], v[60:63], a[140:143], v[208:211]
    ds_read_b64_tr_b16 v[36:37], v14 offset:4096
    buffer_load_dwordx4 a[212:215], v5, s[4:7], s33 offen sc1
    v_mfma_f32_16x16x32_bf16 v[212:215], v[48:51], a[144:147], v[68:71]
    v_mfma_f32_16x16x32_bf16 v[212:215], v[52:55], a[148:151], v[212:215]
    ds_read_b64_tr_b16 v[38:39], v14 offset:4608
    v_mfma_f32_16x16x32_bf16 v[212:215], v[56:59], a[152:155], v[212:215]
    ds_read_b64_tr_b16 v[40:41], v14 offset:8192
    buffer_load_dwordx4 a[228:231], v5, s[4:7], s34 offen sc1
    v_mfma_f32_16x16x32_bf16 v[212:215], v[60:63], a[156:159], v[212:215]
    ds_read_b64_tr_b16 v[42:43], v14 offset:8704
    v_mfma_f32_16x16x32_bf16 v[216:219], v[48:51], a[160:163], v[68:71]
    v_mfma_f32_16x16x32_bf16 v[216:219], v[52:55], a[164:167], v[216:219]
    ds_read_b64_tr_b16 v[44:45], v14 offset:12288
    buffer_load_dwordx4 a[244:247], v5, s[4:7], s35 offen sc1
    v_mfma_f32_16x16x32_bf16 v[216:219], v[56:59], a[168:171], v[216:219]
    ds_read_b64_tr_b16 v[46:47], v14 offset:12800
    v_mfma_f32_16x16x32_bf16 v[216:219], v[60:63], a[172:175], v[216:219]
    v_mfma_f32_16x16x32_bf16 v[220:223], v[48:51], a[176:179], v[68:71]
    buffer_load_dwordx4 a[200:203], v6, s[4:7], s32 offen sc1
    v_mfma_f32_16x16x32_bf16 v[220:223], v[52:55], a[180:183], v[220:223]
    v_mfma_f32_16x16x32_bf16 v[220:223], v[56:59], a[184:187], v[220:223]
    v_mfma_f32_16x16x32_bf16 v[220:223], v[60:63], a[188:191], v[220:223]
    buffer_load_dwordx4 a[216:219], v6, s[4:7], s33 offen sc1
    s_waitcnt lgkmcnt(4)
    v_mfma_f32_16x16x32_bf16 v[224:227], v[32:35], a[128:131], v[72:75]
    v_mfma_f32_16x16x32_bf16 v[224:227], v[36:39], a[132:135], v[224:227]
    ds_read_b64_tr_b16 v[48:49], v15 offset:0
    s_waitcnt lgkmcnt(1)
    v_mfma_f32_16x16x32_bf16 v[224:227], v[40:43], a[136:139], v[224:227]
    ds_read_b64_tr_b16 v[50:51], v15 offset:512
    buffer_load_dwordx4 a[232:235], v6, s[4:7], s34 offen sc1
    v_mfma_f32_16x16x32_bf16 v[224:227], v[44:47], a[140:143], v[224:227]
    ds_read_b64_tr_b16 v[52:53], v15 offset:4096
    v_mfma_f32_16x16x32_bf16 v[228:231], v[32:35], a[144:147], v[72:75]
    v_mfma_f32_16x16x32_bf16 v[228:231], v[36:39], a[148:151], v[228:231]
    ds_read_b64_tr_b16 v[54:55], v15 offset:4608
    buffer_load_dwordx4 a[248:251], v6, s[4:7], s35 offen sc1
    v_mfma_f32_16x16x32_bf16 v[228:231], v[40:43], a[152:155], v[228:231]
    ds_read_b64_tr_b16 v[56:57], v15 offset:8192
    v_mfma_f32_16x16x32_bf16 v[228:231], v[44:47], a[156:159], v[228:231]
    ds_read_b64_tr_b16 v[58:59], v15 offset:8704
    v_mfma_f32_16x16x32_bf16 v[232:235], v[32:35], a[160:163], v[72:75]
    buffer_load_dwordx4 a[204:207], v7, s[4:7], s32 offen sc1
    v_mfma_f32_16x16x32_bf16 v[232:235], v[36:39], a[164:167], v[232:235]
    ds_read_b64_tr_b16 v[60:61], v15 offset:12288
    v_mfma_f32_16x16x32_bf16 v[232:235], v[40:43], a[168:171], v[232:235]
    ds_read_b64_tr_b16 v[62:63], v15 offset:12800
    v_mfma_f32_16x16x32_bf16 v[232:235], v[44:47], a[172:175], v[232:235]
    buffer_load_dwordx4 a[220:223], v7, s[4:7], s33 offen sc1
    v_mfma_f32_16x16x32_bf16 v[236:239], v[32:35], a[176:179], v[72:75]
    v_mfma_f32_16x16x32_bf16 v[236:239], v[36:39], a[180:183], v[236:239]
    v_mfma_f32_16x16x32_bf16 v[236:239], v[40:43], a[184:187], v[236:239]
    buffer_load_dwordx4 a[236:239], v7, s[4:7], s34 offen sc1
    v_mfma_f32_16x16x32_bf16 v[236:239], v[44:47], a[188:191], v[236:239]
    s_waitcnt lgkmcnt(4)
    v_mfma_f32_16x16x32_bf16 v[240:243], v[48:51], a[128:131], v[76:79]
    s_waitcnt vmcnt(15)
    s_barrier
    v_mfma_f32_16x16x32_bf16 v[240:243], v[52:55], a[132:135], v[240:243]
    ds_read_b64_tr_b16 v[32:33], v12 offset:16384
    buffer_load_dwordx4 a[252:255], v7, s[4:7], s35 offen sc1
    v_add_u32 v5, 4096, v5
    v_add_u32 v6, 4096, v6
    v_add_u32 v7, 4096, v7
    s_waitcnt lgkmcnt(1)
    v_mfma_f32_16x16x32_bf16 v[240:243], v[56:59], a[136:139], v[240:243]
    ds_read_b64_tr_b16 v[34:35], v12 offset:16896
    s_add_u32 m0, s44, 32768
    v_mfma_f32_16x16x32_bf16 v[240:243], v[60:63], a[140:143], v[240:243]
    ds_read_b64_tr_b16 v[36:37], v12 offset:20480
    s_add_u32 s47, s50, 704512
    v_mfma_f32_16x16x32_bf16 v[244:247], v[48:51], a[144:147], v[76:79]
    buffer_load_dwordx4 v10, s[12:15], s47 offen lds
    v_mfma_f32_16x16x32_bf16 v[244:247], v[52:55], a[148:151], v[244:247]
    ds_read_b64_tr_b16 v[38:39], v12 offset:20992
    v_mfma_f32_16x16x32_bf16 v[244:247], v[56:59], a[152:155], v[244:247]
    ds_read_b64_tr_b16 v[40:41], v12 offset:24576
    v_mfma_f32_16x16x32_bf16 v[244:247], v[60:63], a[156:159], v[244:247]
    ds_read_b64_tr_b16 v[42:43], v12 offset:25088
    buffer_load_dwordx4 v11, s[12:15], s47 offen offset:1024 lds
    v_mfma_f32_16x16x32_bf16 v[248:251], v[48:51], a[160:163], v[76:79]
    s_add_u32 m0, s44, 40960
    v_mfma_f32_16x16x32_bf16 v[248:251], v[52:55], a[164:167], v[248:251]
    ds_read_b64_tr_b16 v[44:45], v12 offset:28672
    s_add_u32 s47, s51, 704512
    v_mfma_f32_16x16x32_bf16 v[248:251], v[56:59], a[168:171], v[248:251]
    ds_read_b64_tr_b16 v[46:47], v12 offset:29184
    buffer_load_dwordx4 v10, s[12:15], s47 offen lds
    v_mfma_f32_16x16x32_bf16 v[248:251], v[60:63], a[172:175], v[248:251]
    v_mfma_f32_16x16x32_bf16 v[252:255], v[48:51], a[176:179], v[76:79]
    v_mfma_f32_16x16x32_bf16 v[252:255], v[52:55], a[180:183], v[252:255]
    buffer_load_dwordx4 v11, s[12:15], s47 offen offset:1024 lds
    v_mfma_f32_16x16x32_bf16 v[252:255], v[56:59], a[184:187], v[252:255]
    v_mfma_f32_16x16x32_bf16 v[252:255], v[60:63], a[188:191], v[252:255]
    s_waitcnt lgkmcnt(4)
    s_waitcnt vmcnt(4)
    v_mfma_f32_16x16x32_bf16 v[192:195], v[32:35], a[192:195], v[192:195]
    buffer_load_dwordx4 a[64:67], v4, s[4:7], s32 offen sc1
    v_mfma_f32_16x16x32_bf16 v[192:195], v[36:39], a[196:199], v[192:195]
    ds_read_b64_tr_b16 v[48:49], v13 offset:16384
    s_waitcnt lgkmcnt(1)
    v_mfma_f32_16x16x32_bf16 v[192:195], v[40:43], a[200:203], v[192:195]
    ds_read_b64_tr_b16 v[50:51], v13 offset:16896
    v_mfma_f32_16x16x32_bf16 v[192:195], v[44:47], a[204:207], v[192:195]
    ds_read_b64_tr_b16 v[52:53], v13 offset:20480
    buffer_load_dwordx4 a[80:83], v4, s[4:7], s33 offen sc1
    v_mfma_f32_16x16x32_bf16 v[196:199], v[32:35], a[208:211], v[196:199]
    v_mfma_f32_16x16x32_bf16 v[196:199], v[36:39], a[212:215], v[196:199]
    ds_read_b64_tr_b16 v[54:55], v13 offset:20992
    v_mfma_f32_16x16x32_bf16 v[196:199], v[40:43], a[216:219], v[196:199]
    ds_read_b64_tr_b16 v[56:57], v13 offset:24576
    buffer_load_dwordx4 a[96:99], v4, s[4:7], s34 offen sc1
    v_mfma_f32_16x16x32_bf16 v[196:199], v[44:47], a[220:223], v[196:199]
    ds_read_b64_tr_b16 v[58:59], v13 offset:25088
    v_mfma_f32_16x16x32_bf16 v[200:203], v[32:35], a[224:227], v[200:203]
    v_mfma_f32_16x16x32_bf16 v[200:203], v[36:39], a[228:231], v[200:203]
    ds_read_b64_tr_b16 v[60:61], v13 offset:28672
    buffer_load_dwordx4 a[112:115], v4, s[4:7], s35 offen sc1
    v_mfma_f32_16x16x32_bf16 v[200:203], v[40:43], a[232:235], v[200:203]
    ds_read_b64_tr_b16 v[62:63], v13 offset:29184
    v_mfma_f32_16x16x32_bf16 v[200:203], v[44:47], a[236:239], v[200:203]
    v_add_u32 v4, 4096, v4
    v_mfma_f32_16x16x32_bf16 v[204:207], v[32:35], a[240:243], v[204:207]
    buffer_load_dwordx4 a[4:7], v5, s[4:7], s32 offen sc1
    v_mfma_f32_16x16x32_bf16 v[204:207], v[36:39], a[244:247], v[204:207]
    v_mfma_f32_16x16x32_bf16 v[204:207], v[40:43], a[248:251], v[204:207]
    v_mfma_f32_16x16x32_bf16 v[204:207], v[44:47], a[252:255], v[204:207]
    buffer_load_dwordx4 a[20:23], v5, s[4:7], s33 offen sc1
    s_waitcnt lgkmcnt(4)
    v_mfma_f32_16x16x32_bf16 v[208:211], v[48:51], a[192:195], v[208:211]
    v_mfma_f32_16x16x32_bf16 v[208:211], v[52:55], a[196:199], v[208:211]
    ds_read_b64_tr_b16 v[32:33], v14 offset:16384
    s_waitcnt lgkmcnt(1)
    v_mfma_f32_16x16x32_bf16 v[208:211], v[56:59], a[200:203], v[208:211]
    ds_read_b64_tr_b16 v[34:35], v14 offset:16896
    buffer_load_dwordx4 a[36:39], v5, s[4:7], s34 offen sc1
    v_mfma_f32_16x16x32_bf16 v[208:211], v[60:63], a[204:207], v[208:211]
    ds_read_b64_tr_b16 v[36:37], v14 offset:20480
    v_mfma_f32_16x16x32_bf16 v[212:215], v[48:51], a[208:211], v[212:215]
    v_mfma_f32_16x16x32_bf16 v[212:215], v[52:55], a[212:215], v[212:215]
    ds_read_b64_tr_b16 v[38:39], v14 offset:20992
    buffer_load_dwordx4 a[52:55], v5, s[4:7], s35 offen sc1
    v_mfma_f32_16x16x32_bf16 v[212:215], v[56:59], a[216:219], v[212:215]
    ds_read_b64_tr_b16 v[40:41], v14 offset:24576
    v_mfma_f32_16x16x32_bf16 v[212:215], v[60:63], a[220:223], v[212:215]
    ds_read_b64_tr_b16 v[42:43], v14 offset:25088
    v_mfma_f32_16x16x32_bf16 v[216:219], v[48:51], a[224:227], v[216:219]
    buffer_load_dwordx4 a[8:11], v6, s[4:7], s32 offen sc1
    v_mfma_f32_16x16x32_bf16 v[216:219], v[52:55], a[228:231], v[216:219]
    ds_read_b64_tr_b16 v[44:45], v14 offset:28672
    v_mfma_f32_16x16x32_bf16 v[216:219], v[56:59], a[232:235], v[216:219]
    ds_read_b64_tr_b16 v[46:47], v14 offset:29184
    v_mfma_f32_16x16x32_bf16 v[216:219], v[60:63], a[236:239], v[216:219]
    buffer_load_dwordx4 a[24:27], v6, s[4:7], s33 offen sc1
    v_mfma_f32_16x16x32_bf16 v[220:223], v[48:51], a[240:243], v[220:223]
    v_mfma_f32_16x16x32_bf16 v[220:223], v[52:55], a[244:247], v[220:223]
    v_mfma_f32_16x16x32_bf16 v[220:223], v[56:59], a[248:251], v[220:223]
    buffer_load_dwordx4 a[40:43], v6, s[4:7], s34 offen sc1
    v_mfma_f32_16x16x32_bf16 v[220:223], v[60:63], a[252:255], v[220:223]
    s_waitcnt lgkmcnt(4)
    v_mfma_f32_16x16x32_bf16 v[224:227], v[32:35], a[192:195], v[224:227]
    v_mfma_f32_16x16x32_bf16 v[224:227], v[36:39], a[196:199], v[224:227]
    ds_read_b64_tr_b16 v[48:49], v15 offset:16384
    buffer_load_dwordx4 a[56:59], v6, s[4:7], s35 offen sc1
    s_waitcnt lgkmcnt(1)
    v_mfma_f32_16x16x32_bf16 v[224:227], v[40:43], a[200:203], v[224:227]
    ds_read_b64_tr_b16 v[50:51], v15 offset:16896
    v_mfma_f32_16x16x32_bf16 v[224:227], v[44:47], a[204:207], v[224:227]
    ds_read_b64_tr_b16 v[52:53], v15 offset:20480
    v_mfma_f32_16x16x32_bf16 v[228:231], v[32:35], a[208:211], v[228:231]
    buffer_load_dwordx4 a[12:15], v7, s[4:7], s32 offen sc1
    v_mfma_f32_16x16x32_bf16 v[228:231], v[36:39], a[212:215], v[228:231]
    ds_read_b64_tr_b16 v[54:55], v15 offset:20992
    v_mfma_f32_16x16x32_bf16 v[228:231], v[40:43], a[216:219], v[228:231]
    ds_read_b64_tr_b16 v[56:57], v15 offset:24576
    v_mfma_f32_16x16x32_bf16 v[228:231], v[44:47], a[220:223], v[228:231]
    ds_read_b64_tr_b16 v[58:59], v15 offset:25088
    buffer_load_dwordx4 a[28:31], v7, s[4:7], s33 offen sc1
    v_mfma_f32_16x16x32_bf16 v[232:235], v[32:35], a[224:227], v[232:235]
    v_mfma_f32_16x16x32_bf16 v[232:235], v[36:39], a[228:231], v[232:235]
    ds_read_b64_tr_b16 v[60:61], v15 offset:28672
    v_mfma_f32_16x16x32_bf16 v[232:235], v[40:43], a[232:235], v[232:235]
    ds_read_b64_tr_b16 v[62:63], v15 offset:29184
    buffer_load_dwordx4 a[44:47], v7, s[4:7], s34 offen sc1
    v_mfma_f32_16x16x32_bf16 v[232:235], v[44:47], a[236:239], v[232:235]
    v_mfma_f32_16x16x32_bf16 v[236:239], v[32:35], a[240:243], v[236:239]
    v_mfma_f32_16x16x32_bf16 v[236:239], v[36:39], a[244:247], v[236:239]
    buffer_load_dwordx4 a[60:63], v7, s[4:7], s35 offen sc1
    v_add_u32 v5, 4096, v5
    v_add_u32 v6, 4096, v6
    v_add_u32 v7, 4096, v7
    v_mfma_f32_16x16x32_bf16 v[236:239], v[40:43], a[248:251], v[236:239]
    s_add_u32 m0, s44, 65536
    v_mfma_f32_16x16x32_bf16 v[236:239], v[44:47], a[252:255], v[236:239]
    s_add_u32 s47, s50, 1056768
    s_waitcnt lgkmcnt(4)
    v_mfma_f32_16x16x32_bf16 v[240:243], v[48:51], a[192:195], v[240:243]
    buffer_load_dwordx4 v10, s[12:15], s47 offen lds
    s_waitcnt vmcnt(17)
    s_barrier
    v_mfma_f32_16x16x32_bf16 v[240:243], v[52:55], a[196:199], v[240:243]
    ds_read_b64_tr_b16 v[32:33], v12 offset:32768
    s_waitcnt lgkmcnt(1)
    v_mfma_f32_16x16x32_bf16 v[240:243], v[56:59], a[200:203], v[240:243]
    ds_read_b64_tr_b16 v[34:35], v12 offset:33280
    v_mfma_f32_16x16x32_bf16 v[240:243], v[60:63], a[204:207], v[240:243]
    ds_read_b64_tr_b16 v[36:37], v12 offset:36864
    buffer_load_dwordx4 v11, s[12:15], s47 offen offset:1024 lds
    v_mfma_f32_16x16x32_bf16 v[244:247], v[48:51], a[208:211], v[244:247]
    s_add_u32 m0, s44, 73728
    v_mfma_f32_16x16x32_bf16 v[244:247], v[52:55], a[212:215], v[244:247]
    ds_read_b64_tr_b16 v[38:39], v12 offset:37376
    s_add_u32 s47, s51, 1056768
    v_mfma_f32_16x16x32_bf16 v[244:247], v[56:59], a[216:219], v[244:247]
    ds_read_b64_tr_b16 v[40:41], v12 offset:40960
    buffer_load_dwordx4 v10, s[12:15], s47 offen lds
    v_mfma_f32_16x16x32_bf16 v[244:247], v[60:63], a[220:223], v[244:247]
    ds_read_b64_tr_b16 v[42:43], v12 offset:41472
    v_mfma_f32_16x16x32_bf16 v[248:251], v[48:51], a[224:227], v[248:251]
    v_mfma_f32_16x16x32_bf16 v[248:251], v[52:55], a[228:231], v[248:251]
    ds_read_b64_tr_b16 v[44:45], v12 offset:45056
    buffer_load_dwordx4 v11, s[12:15], s47 offen offset:1024 lds
    v_mfma_f32_16x16x32_bf16 v[248:251], v[56:59], a[232:235], v[248:251]
    ds_read_b64_tr_b16 v[46:47], v12 offset:45568
    v_mfma_f32_16x16x32_bf16 v[248:251], v[60:63], a[236:239], v[248:251]
    v_mfma_f32_16x16x32_bf16 v[252:255], v[48:51], a[240:243], v[252:255]
    buffer_load_dwordx4 a[68:71], v5, s[4:7], s32 offen sc1
    v_mfma_f32_16x16x32_bf16 v[252:255], v[52:55], a[244:247], v[252:255]
    v_mfma_f32_16x16x32_bf16 v[252:255], v[56:59], a[248:251], v[252:255]
    v_mfma_f32_16x16x32_bf16 v[252:255], v[60:63], a[252:255], v[252:255]
    buffer_load_dwordx4 a[84:87], v5, s[4:7], s33 offen sc1
    s_waitcnt lgkmcnt(4)
    s_waitcnt vmcnt(6)
    v_mfma_f32_16x16x32_bf16 v[192:195], v[32:35], a[0:3], v[192:195]
    v_mfma_f32_16x16x32_bf16 v[192:195], v[36:39], a[4:7], v[192:195]
    ds_read_b64_tr_b16 v[48:49], v13 offset:32768
    s_waitcnt lgkmcnt(1)
    v_mfma_f32_16x16x32_bf16 v[192:195], v[40:43], a[8:11], v[192:195]
    ds_read_b64_tr_b16 v[50:51], v13 offset:33280
    buffer_load_dwordx4 a[100:103], v5, s[4:7], s34 offen sc1
    v_mfma_f32_16x16x32_bf16 v[192:195], v[44:47], a[12:15], v[192:195]
    ds_read_b64_tr_b16 v[52:53], v13 offset:36864
    v_mfma_f32_16x16x32_bf16 v[196:199], v[32:35], a[16:19], v[196:199]
    v_mfma_f32_16x16x32_bf16 v[196:199], v[36:39], a[20:23], v[196:199]
    ds_read_b64_tr_b16 v[54:55], v13 offset:37376
    buffer_load_dwordx4 a[116:119], v5, s[4:7], s35 offen sc1
    v_mfma_f32_16x16x32_bf16 v[196:199], v[40:43], a[24:27], v[196:199]
    ds_read_b64_tr_b16 v[56:57], v13 offset:40960
    v_mfma_f32_16x16x32_bf16 v[196:199], v[44:47], a[28:31], v[196:199]
    ds_read_b64_tr_b16 v[58:59], v13 offset:41472
    v_mfma_f32_16x16x32_bf16 v[200:203], v[32:35], a[32:35], v[200:203]
    buffer_load_dwordx4 a[72:75], v6, s[4:7], s32 offen sc1
    v_mfma_f32_16x16x32_bf16 v[200:203], v[36:39], a[36:39], v[200:203]
    ds_read_b64_tr_b16 v[60:61], v13 offset:45056
    v_mfma_f32_16x16x32_bf16 v[200:203], v[40:43], a[40:43], v[200:203]
    ds_read_b64_tr_b16 v[62:63], v13 offset:45568
    v_mfma_f32_16x16x32_bf16 v[200:203], v[44:47], a[44:47], v[200:203]
    buffer_load_dwordx4 a[88:91], v6, s[4:7], s33 offen sc1
    v_mfma_f32_16x16x32_bf16 v[204:207], v[32:35], a[48:51], v[204:207]
    v_mfma_f32_16x16x32_bf16 v[204:207], v[36:39], a[52:55], v[204:207]
    v_mfma_f32_16x16x32_bf16 v[204:207], v[40:43], a[56:59], v[204:207]
    buffer_load_dwordx4 a[104:107], v6, s[4:7], s34 offen sc1
    v_mfma_f32_16x16x32_bf16 v[204:207], v[44:47], a[60:63], v[204:207]
    s_waitcnt lgkmcnt(4)
    v_mfma_f32_16x16x32_bf16 v[208:211], v[48:51], a[0:3], v[208:211]
    v_mfma_f32_16x16x32_bf16 v[208:211], v[52:55], a[4:7], v[208:211]
    ds_read_b64_tr_b16 v[32:33], v14 offset:32768
    buffer_load_dwordx4 a[120:123], v6, s[4:7], s35 offen sc1
    s_waitcnt lgkmcnt(1)
    v_mfma_f32_16x16x32_bf16 v[208:211], v[56:59], a[8:11], v[208:211]
    ds_read_b64_tr_b16 v[34:35], v14 offset:33280
    v_mfma_f32_16x16x32_bf16 v[208:211], v[60:63], a[12:15], v[208:211]
    ds_read_b64_tr_b16 v[36:37], v14 offset:36864
    v_mfma_f32_16x16x32_bf16 v[212:215], v[48:51], a[16:19], v[212:215]
    buffer_load_dwordx4 a[76:79], v7, s[4:7], s32 offen sc1
    v_mfma_f32_16x16x32_bf16 v[212:215], v[52:55], a[20:23], v[212:215]
    ds_read_b64_tr_b16 v[38:39], v14 offset:37376
    v_mfma_f32_16x16x32_bf16 v[212:215], v[56:59], a[24:27], v[212:215]
    ds_read_b64_tr_b16 v[40:41], v14 offset:40960
    v_mfma_f32_16x16x32_bf16 v[212:215], v[60:63], a[28:31], v[212:215]
    ds_read_b64_tr_b16 v[42:43], v14 offset:41472
    buffer_load_dwordx4 a[92:95], v7, s[4:7], s33 offen sc1
    v_mfma_f32_16x16x32_bf16 v[216:219], v[48:51], a[32:35], v[216:219]
    v_mfma_f32_16x16x32_bf16 v[216:219], v[52:55], a[36:39], v[216:219]
    ds_read_b64_tr_b16 v[44:45], v14 offset:45056
    v_mfma_f32_16x16x32_bf16 v[216:219], v[56:59], a[40:43], v[216:219]
    ds_read_b64_tr_b16 v[46:47], v14 offset:45568
    buffer_load_dwordx4 a[108:111], v7, s[4:7], s34 offen sc1
    v_mfma_f32_16x16x32_bf16 v[216:219], v[60:63], a[44:47], v[216:219]
    v_mfma_f32_16x16x32_bf16 v[220:223], v[48:51], a[48:51], v[220:223]
    v_mfma_f32_16x16x32_bf16 v[220:223], v[52:55], a[52:55], v[220:223]
    buffer_load_dwordx4 a[124:127], v7, s[4:7], s35 offen sc1
    v_mfma_f32_16x16x32_bf16 v[220:223], v[56:59], a[56:59], v[220:223]
    s_add_u32 m0, s44, 81920
    v_mfma_f32_16x16x32_bf16 v[220:223], v[60:63], a[60:63], v[220:223]
    s_add_u32 s47, s48, 0
    s_waitcnt lgkmcnt(4)
    v_mfma_f32_16x16x32_bf16 v[224:227], v[32:35], a[0:3], v[224:227]
    buffer_load_dwordx4 v8, s[8:11], s47 offen lds
    v_mfma_f32_16x16x32_bf16 v[224:227], v[36:39], a[4:7], v[224:227]
    ds_read_b64_tr_b16 v[48:49], v15 offset:32768
    s_waitcnt lgkmcnt(1)
    v_mfma_f32_16x16x32_bf16 v[224:227], v[40:43], a[8:11], v[224:227]
    ds_read_b64_tr_b16 v[50:51], v15 offset:33280
    v_mfma_f32_16x16x32_bf16 v[224:227], v[44:47], a[12:15], v[224:227]
    ds_read_b64_tr_b16 v[52:53], v15 offset:36864
    buffer_load_dwordx4 v9, s[8:11], s47 offen offset:1024 lds
    v_mfma_f32_16x16x32_bf16 v[228:231], v[32:35], a[16:19], v[228:231]
    s_add_u32 m0, s44, 90112
    v_mfma_f32_16x16x32_bf16 v[228:231], v[36:39], a[20:23], v[228:231]
    ds_read_b64_tr_b16 v[54:55], v15 offset:37376
    s_add_u32 s47, s49, 0
    v_mfma_f32_16x16x32_bf16 v[228:231], v[40:43], a[24:27], v[228:231]
    ds_read_b64_tr_b16 v[56:57], v15 offset:40960
    buffer_load_dwordx4 v8, s[8:11], s47 offen lds
    v_mfma_f32_16x16x32_bf16 v[228:231], v[44:47], a[28:31], v[228:231]
    ds_read_b64_tr_b16 v[58:59], v15 offset:41472
    v_mfma_f32_16x16x32_bf16 v[232:235], v[32:35], a[32:35], v[232:235]
    v_mfma_f32_16x16x32_bf16 v[232:235], v[36:39], a[36:39], v[232:235]
    ds_read_b64_tr_b16 v[60:61], v15 offset:45056
    buffer_load_dwordx4 v9, s[8:11], s47 offen offset:1024 lds
    v_mfma_f32_16x16x32_bf16 v[232:235], v[40:43], a[40:43], v[232:235]
    ds_read_b64_tr_b16 v[62:63], v15 offset:45568
    s_add_u32 m0, s44, 98304
    v_mfma_f32_16x16x32_bf16 v[232:235], v[44:47], a[44:47], v[232:235]
    s_add_u32 s47, s48, 1048576
    v_mfma_f32_16x16x32_bf16 v[236:239], v[32:35], a[48:51], v[236:239]
    buffer_load_dwordx4 v8, s[8:11], s47 offen lds
    v_mfma_f32_16x16x32_bf16 v[236:239], v[36:39], a[52:55], v[236:239]
    v_mfma_f32_16x16x32_bf16 v[236:239], v[40:43], a[56:59], v[236:239]
    v_mfma_f32_16x16x32_bf16 v[236:239], v[44:47], a[60:63], v[236:239]
    buffer_load_dwordx4 v9, s[8:11], s47 offen offset:1024 lds
    s_waitcnt lgkmcnt(4)
    v_mfma_f32_16x16x32_bf16 v[240:243], v[48:51], a[0:3], v[240:243]
    s_add_u32 m0, s44, 106496
    s_waitcnt vmcnt(18)
    s_barrier
    v_mfma_f32_16x16x32_bf16 v[240:243], v[52:55], a[4:7], v[240:243]
    ds_read_b64_tr_b16 v[32:33], v16 offset:0
    s_add_u32 s47, s49, 1048576
    s_waitcnt lgkmcnt(1)
    v_mfma_f32_16x16x32_bf16 v[240:243], v[56:59], a[8:11], v[240:243]
    ds_read_b64_tr_b16 v[34:35], v16 offset:512
    buffer_load_dwordx4 v8, s[8:11], s47 offen lds
    v_mfma_f32_16x16x32_bf16 v[240:243], v[60:63], a[12:15], v[240:243]
    ds_read_b64_tr_b16 v[36:37], v16 offset:4096
    v_mfma_f32_16x16x32_bf16 v[244:247], v[48:51], a[16:19], v[244:247]
    v_mfma_f32_16x16x32_bf16 v[244:247], v[52:55], a[20:23], v[244:247]
    ds_read_b64_tr_b16 v[38:39], v16 offset:4608
    buffer_load_dwordx4 v9, s[8:11], s47 offen offset:1024 lds
    v_mfma_f32_16x16x32_bf16 v[244:247], v[56:59], a[24:27], v[244:247]
    ds_read_b64_tr_b16 v[40:41], v16 offset:8192
    s_add_u32 m0, s44, 0
    v_mfma_f32_16x16x32_bf16 v[244:247], v[60:63], a[28:31], v[244:247]
    ds_read_b64_tr_b16 v[42:43], v16 offset:8704
    s_add_u32 s47, s48, 2097152
    v_mfma_f32_16x16x32_bf16 v[248:251], v[48:51], a[32:35], v[248:251]
    buffer_load_dwordx4 v8, s[8:11], s47 offen lds
    v_mfma_f32_16x16x32_bf16 v[248:251], v[52:55], a[36:39], v[248:251]
    ds_read_b64_tr_b16 v[44:45], v16 offset:12288
    v_mfma_f32_16x16x32_bf16 v[248:251], v[56:59], a[40:43], v[248:251]
    ds_read_b64_tr_b16 v[46:47], v16 offset:12800
    v_mfma_f32_16x16x32_bf16 v[248:251], v[60:63], a[44:47], v[248:251]
    buffer_load_dwordx4 v9, s[8:11], s47 offen offset:1024 lds
    v_mfma_f32_16x16x32_bf16 v[252:255], v[48:51], a[48:51], v[252:255]
    s_add_u32 m0, s44, 8192
    v_mfma_f32_16x16x32_bf16 v[252:255], v[52:55], a[52:55], v[252:255]
    s_add_u32 s47, s49, 2097152
    v_mfma_f32_16x16x32_bf16 v[252:255], v[56:59], a[56:59], v[252:255]
    buffer_load_dwordx4 v8, s[8:11], s47 offen lds
    v_mfma_f32_16x16x32_bf16 v[252:255], v[60:63], a[60:63], v[252:255]
    s_waitcnt lgkmcnt(4)
    s_waitcnt vmcnt(11)
    v_mfma_f32_16x16x32_bf16 v[192:195], v[32:35], a[64:67], v[192:195]
    v_mfma_f32_16x16x32_bf16 v[192:195], v[36:39], a[68:71], v[192:195]
    ds_read_b64_tr_b16 v[48:49], v17 offset:0
    buffer_load_dwordx4 v9, s[8:11], s47 offen offset:1024 lds
    s_waitcnt lgkmcnt(1)
    v_mfma_f32_16x16x32_bf16 v[192:195], v[40:43], a[72:75], v[192:195]
    ds_read_b64_tr_b16 v[50:51], v17 offset:512
    s_add_u32 m0, s44, 16384
    v_mfma_f32_16x16x32_bf16 v[192:195], v[44:47], a[76:79], v[192:195]
    ds_read_b64_tr_b16 v[52:53], v17 offset:4096
    s_add_u32 s47, s48, 3145728
    v_mfma_f32_16x16x32_bf16 v[196:199], v[32:35], a[80:83], v[196:199]
    buffer_load_dwordx4 v8, s[8:11], s47 offen lds
    v_mfma_f32_16x16x32_bf16 v[196:199], v[36:39], a[84:87], v[196:199]
    ds_read_b64_tr_b16 v[54:55], v17 offset:4608
    v_mfma_f32_16x16x32_bf16 v[196:199], v[40:43], a[88:91], v[196:199]
    ds_read_b64_tr_b16 v[56:57], v17 offset:8192
    v_mfma_f32_16x16x32_bf16 v[196:199], v[44:47], a[92:95], v[196:199]
    ds_read_b64_tr_b16 v[58:59], v17 offset:8704
    buffer_load_dwordx4 v9, s[8:11], s47 offen offset:1024 lds
    v_mfma_f32_16x16x32_bf16 v[200:203], v[32:35], a[96:99], v[200:203]
    s_add_u32 m0, s44, 24576
    v_mfma_f32_16x16x32_bf16 v[200:203], v[36:39], a[100:103], v[200:203]
    ds_read_b64_tr_b16 v[60:61], v17 offset:12288
    s_add_u32 s47, s49, 3145728
    v_mfma_f32_16x16x32_bf16 v[200:203], v[40:43], a[104:107], v[200:203]
    ds_read_b64_tr_b16 v[62:63], v17 offset:12800
    buffer_load_dwordx4 v8, s[8:11], s47 offen lds
    v_mfma_f32_16x16x32_bf16 v[200:203], v[44:47], a[108:111], v[200:203]
    v_mfma_f32_16x16x32_bf16 v[204:207], v[32:35], a[112:115], v[204:207]
    v_mfma_f32_16x16x32_bf16 v[204:207], v[36:39], a[116:119], v[204:207]
    buffer_load_dwordx4 v9, s[8:11], s47 offen offset:1024 lds
    v_mfma_f32_16x16x32_bf16 v[204:207], v[40:43], a[120:123], v[204:207]
    s_add_u32 m0, s44, 49152
    v_mfma_f32_16x16x32_bf16 v[204:207], v[44:47], a[124:127], v[204:207]
    s_add_u32 s47, s48, 128
    s_waitcnt lgkmcnt(4)
    v_mfma_f32_16x16x32_bf16 v[208:211], v[48:51], a[64:67], v[208:211]
    buffer_load_dwordx4 v8, s[8:11], s47 offen lds
    v_mfma_f32_16x16x32_bf16 v[208:211], v[52:55], a[68:71], v[208:211]
    ds_read_b64_tr_b16 v[32:33], v18 offset:0
    s_waitcnt lgkmcnt(1)
    v_mfma_f32_16x16x32_bf16 v[208:211], v[56:59], a[72:75], v[208:211]
    ds_read_b64_tr_b16 v[34:35], v18 offset:512
    v_mfma_f32_16x16x32_bf16 v[208:211], v[60:63], a[76:79], v[208:211]
    ds_read_b64_tr_b16 v[36:37], v18 offset:4096
    buffer_load_dwordx4 v9, s[8:11], s47 offen offset:1024 lds
    v_mfma_f32_16x16x32_bf16 v[212:215], v[48:51], a[80:83], v[212:215]
    s_add_u32 m0, s44, 57344
    v_mfma_f32_16x16x32_bf16 v[212:215], v[52:55], a[84:87], v[212:215]
    ds_read_b64_tr_b16 v[38:39], v18 offset:4608
    s_add_u32 s47, s49, 128
    v_mfma_f32_16x16x32_bf16 v[212:215], v[56:59], a[88:91], v[212:215]
    ds_read_b64_tr_b16 v[40:41], v18 offset:8192
    buffer_load_dwordx4 v8, s[8:11], s47 offen lds
    v_mfma_f32_16x16x32_bf16 v[212:215], v[60:63], a[92:95], v[212:215]
    ds_read_b64_tr_b16 v[42:43], v18 offset:8704
    v_mfma_f32_16x16x32_bf16 v[216:219], v[48:51], a[96:99], v[216:219]
    v_mfma_f32_16x16x32_bf16 v[216:219], v[52:55], a[100:103], v[216:219]
    ds_read_b64_tr_b16 v[44:45], v18 offset:12288
    buffer_load_dwordx4 v9, s[8:11], s47 offen offset:1024 lds
    v_mfma_f32_16x16x32_bf16 v[216:219], v[56:59], a[104:107], v[216:219]
    ds_read_b64_tr_b16 v[46:47], v18 offset:12800
    s_add_u32 m0, s44, 114688
    v_mfma_f32_16x16x32_bf16 v[216:219], v[60:63], a[108:111], v[216:219]
    s_add_u32 s47, s48, 1048704
    v_mfma_f32_16x16x32_bf16 v[220:223], v[48:51], a[112:115], v[220:223]
    buffer_load_dwordx4 v8, s[8:11], s47 offen lds
    v_mfma_f32_16x16x32_bf16 v[220:223], v[52:55], a[116:119], v[220:223]
    v_mfma_f32_16x16x32_bf16 v[220:223], v[56:59], a[120:123], v[220:223]
    v_mfma_f32_16x16x32_bf16 v[220:223], v[60:63], a[124:127], v[220:223]
    buffer_load_dwordx4 v9, s[8:11], s47 offen offset:1024 lds
    s_waitcnt lgkmcnt(4)
    v_mfma_f32_16x16x32_bf16 v[224:227], v[32:35], a[64:67], v[224:227]
    s_add_u32 m0, s44, 122880
    v_mfma_f32_16x16x32_bf16 v[224:227], v[36:39], a[68:71], v[224:227]
    ds_read_b64_tr_b16 v[48:49], v19 offset:0
    s_add_u32 s47, s49, 1048704
    s_waitcnt lgkmcnt(1)
    v_mfma_f32_16x16x32_bf16 v[224:227], v[40:43], a[72:75], v[224:227]
    ds_read_b64_tr_b16 v[50:51], v19 offset:512
    buffer_load_dwordx4 v8, s[8:11], s47 offen lds
    v_mfma_f32_16x16x32_bf16 v[224:227], v[44:47], a[76:79], v[224:227]
    ds_read_b64_tr_b16 v[52:53], v19 offset:4096
    v_mfma_f32_16x16x32_bf16 v[228:231], v[32:35], a[80:83], v[228:231]
    v_mfma_f32_16x16x32_bf16 v[228:231], v[36:39], a[84:87], v[228:231]
    ds_read_b64_tr_b16 v[54:55], v19 offset:4608
    buffer_load_dwordx4 v9, s[8:11], s47 offen offset:1024 lds
    v_mfma_f32_16x16x32_bf16 v[228:231], v[40:43], a[88:91], v[228:231]
    ds_read_b64_tr_b16 v[56:57], v19 offset:8192
    s_add_u32 m0, s44, 131072
    v_mfma_f32_16x16x32_bf16 v[228:231], v[44:47], a[92:95], v[228:231]
    ds_read_b64_tr_b16 v[58:59], v19 offset:8704
    s_add_u32 s47, s48, 2097280
    v_mfma_f32_16x16x32_bf16 v[232:235], v[32:35], a[96:99], v[232:235]
    buffer_load_dwordx4 v8, s[8:11], s47 offen lds
    v_mfma_f32_16x16x32_bf16 v[232:235], v[36:39], a[100:103], v[232:235]
    ds_read_b64_tr_b16 v[60:61], v19 offset:12288
    v_mfma_f32_16x16x32_bf16 v[232:235], v[40:43], a[104:107], v[232:235]
    ds_read_b64_tr_b16 v[62:63], v19 offset:12800
    v_mfma_f32_16x16x32_bf16 v[232:235], v[44:47], a[108:111], v[232:235]
    buffer_load_dwordx4 v9, s[8:11], s47 offen offset:1024 lds
    v_mfma_f32_16x16x32_bf16 v[236:239], v[32:35], a[112:115], v[236:239]
    s_add_u32 m0, s44, 139264
    v_mfma_f32_16x16x32_bf16 v[236:239], v[36:39], a[116:119], v[236:239]
    s_add_u32 s47, s49, 2097280
    v_mfma_f32_16x16x32_bf16 v[236:239], v[40:43], a[120:123], v[236:239]
    buffer_load_dwordx4 v8, s[8:11], s47 offen lds
    v_mfma_f32_16x16x32_bf16 v[236:239], v[44:47], a[124:127], v[236:239]
    s_waitcnt lgkmcnt(4)
    v_mfma_f32_16x16x32_bf16 v[240:243], v[48:51], a[64:67], v[240:243]
    s_add_u32 s32, s36, s54
    s_add_u32 s33, s38, s54
    s_waitcnt vmcnt(23)
    s_barrier
    v_mfma_f32_16x16x32_bf16 v[240:243], v[52:55], a[68:71], v[240:243]
    ds_read_b64_tr_b16 v[32:33], v16 offset:16384
    buffer_load_dwordx4 v9, s[8:11], s47 offen offset:1024 lds
    s_add_u32 s34, s40, s54
    s_add_u32 s35, s42, s54
    s_waitcnt lgkmcnt(1)
    v_mfma_f32_16x16x32_bf16 v[240:243], v[56:59], a[72:75], v[240:243]
    ds_read_b64_tr_b16 v[34:35], v16 offset:16896
    s_add_u32 m0, s44, 147456
    s_add_u32 s36, s36, s53
    s_add_u32 s37, s36, 1024
    v_mfma_f32_16x16x32_bf16 v[240:243], v[60:63], a[76:79], v[240:243]
    ds_read_b64_tr_b16 v[36:37], v16 offset:20480
    s_add_u32 s47, s48, 3145856
    s_cmp_gt_u32 s58, 21
    s_cselect_b32 s36, 0x10000000, s36
    v_mfma_f32_16x16x32_bf16 v[244:247], v[48:51], a[80:83], v[244:247]
    buffer_load_dwordx4 v8, s[8:11], s47 offen lds
    s_cmp_gt_u32 s58, 20
    s_cselect_b32 s37, 0x10000000, s37
    v_mfma_f32_16x16x32_bf16 v[244:247], v[52:55], a[84:87], v[244:247]
    ds_read_b64_tr_b16 v[38:39], v16 offset:20992
    s_add_u32 s38, s38, s53
    s_add_u32 s39, s38, 1024
    v_mfma_f32_16x16x32_bf16 v[244:247], v[56:59], a[88:91], v[244:247]
    ds_read_b64_tr_b16 v[40:41], v16 offset:24576
    s_cmp_gt_u32 s58, 21
    s_cselect_b32 s38, 0x10000000, s38
    v_mfma_f32_16x16x32_bf16 v[244:247], v[60:63], a[92:95], v[244:247]
    ds_read_b64_tr_b16 v[42:43], v16 offset:25088
    buffer_load_dwordx4 v9, s[8:11], s47 offen offset:1024 lds
    s_cmp_gt_u32 s58, 20
    s_cselect_b32 s39, 0x10000000, s39
    v_mfma_f32_16x16x32_bf16 v[248:251], v[48:51], a[96:99], v[248:251]
    s_add_u32 m0, s44, 155648
    s_add_u32 s40, s40, s53
    s_add_u32 s41, s40, 1024
    v_mfma_f32_16x16x32_bf16 v[248:251], v[52:55], a[100:103], v[248:251]
    ds_read_b64_tr_b16 v[44:45], v16 offset:28672
    s_add_u32 s47, s49, 3145856
    s_cmp_gt_u32 s58, 21
    s_cselect_b32 s40, 0x10000000, s40
    v_mfma_f32_16x16x32_bf16 v[248:251], v[56:59], a[104:107], v[248:251]
    ds_read_b64_tr_b16 v[46:47], v16 offset:29184
    buffer_load_dwordx4 v8, s[8:11], s47 offen lds
    s_cmp_gt_u32 s58, 20
    s_cselect_b32 s41, 0x10000000, s41
    v_mfma_f32_16x16x32_bf16 v[248:251], v[60:63], a[108:111], v[248:251]
    s_add_u32 s42, s42, s53
    s_add_u32 s43, s42, 1024
    v_mfma_f32_16x16x32_bf16 v[252:255], v[48:51], a[112:115], v[252:255]
    s_cmp_gt_u32 s58, 21
    s_cselect_b32 s42, 0x10000000, s42
    v_mfma_f32_16x16x32_bf16 v[252:255], v[52:55], a[116:119], v[252:255]
    buffer_load_dwordx4 v9, s[8:11], s47 offen offset:1024 lds
    s_cmp_gt_u32 s58, 20
    s_cselect_b32 s43, 0x10000000, s43
    v_mfma_f32_16x16x32_bf16 v[252:255], v[56:59], a[120:123], v[252:255]
    v_mfma_f32_16x16x32_bf16 v[252:255], v[60:63], a[124:127], v[252:255]
    s_waitcnt lgkmcnt(4)
    v_mfma_f32_16x16x32_bf16 v[64:67], v[32:35], a[128:131], 0
    v_mfma_f32_16x16x32_bf16 v[64:67], v[36:39], a[132:135], v[64:67]
    ds_read_b64_tr_b16 v[48:49], v17 offset:16384
    s_waitcnt lgkmcnt(1)
    v_mfma_f32_16x16x32_bf16 v[64:67], v[40:43], a[136:139], v[64:67]
    ds_read_b64_tr_b16 v[50:51], v17 offset:16896
    v_mfma_f32_16x16x32_bf16 v[64:67], v[44:47], a[140:143], v[64:67]
    ds_read_b64_tr_b16 v[52:53], v17 offset:20480
    v_mfma_f32_16x16x32_bf16 v[68:71], v[32:35], a[144:147], 0
    v_mfma_f32_16x16x32_bf16 v[68:71], v[36:39], a[148:151], v[68:71]
    ds_read_b64_tr_b16 v[54:55], v17 offset:20992
    v_mfma_f32_16x16x32_bf16 v[68:71], v[40:43], a[152:155], v[68:71]
    ds_read_b64_tr_b16 v[56:57], v17 offset:24576
    v_mfma_f32_16x16x32_bf16 v[68:71], v[44:47], a[156:159], v[68:71]
    ds_read_b64_tr_b16 v[58:59], v17 offset:25088
    v_mfma_f32_16x16x32_bf16 v[72:75], v[32:35], a[160:163], 0
    v_mul_f32 v0, 0x3fb8aa3b, v192
    v_mul_f32 v1, 0x3fb8aa3b, v193
    v_mfma_f32_16x16x32_bf16 v[72:75], v[36:39], a[164:167], v[72:75]
    ds_read_b64_tr_b16 v[60:61], v17 offset:28672
    v_mul_f32 v29, 0x3fb8aa3b, v194
    v_mfma_f32_16x16x32_bf16 v[72:75], v[40:43], a[168:171], v[72:75]
    ds_read_b64_tr_b16 v[62:63], v17 offset:29184
    v_mul_f32 v30, 0x3fb8aa3b, v195
    v_mfma_f32_16x16x32_bf16 v[72:75], v[44:47], a[172:175], v[72:75]
    v_exp_f32 v0, v0
    v_mfma_f32_16x16x32_bf16 v[76:79], v[32:35], a[176:179], 0
    v_exp_f32 v1, v1
    v_mfma_f32_16x16x32_bf16 v[76:79], v[36:39], a[180:183], v[76:79]
    v_exp_f32 v29, v29
    v_mfma_f32_16x16x32_bf16 v[76:79], v[40:43], a[184:187], v[76:79]
    v_exp_f32 v30, v30
    v_mfma_f32_16x16x32_bf16 v[76:79], v[44:47], a[188:191], v[76:79]
    v_add_f32 v0, 1.0, v0
    s_waitcnt lgkmcnt(4)
    v_mfma_f32_16x16x32_bf16 v[128:131], v[48:51], a[128:131], 0
    v_add_f32 v1, 1.0, v1
    v_mfma_f32_16x16x32_bf16 v[128:131], v[52:55], a[132:135], v[128:131]
    ds_read_b64_tr_b16 v[32:33], v18 offset:16384
    v_add_f32 v29, 1.0, v29
    s_waitcnt lgkmcnt(1)
    v_mfma_f32_16x16x32_bf16 v[128:131], v[56:59], a[136:139], v[128:131]
    ds_read_b64_tr_b16 v[34:35], v18 offset:16896
    v_add_f32 v30, 1.0, v30
    v_mfma_f32_16x16x32_bf16 v[128:131], v[60:63], a[140:143], v[128:131]
    ds_read_b64_tr_b16 v[36:37], v18 offset:20480
    v_fma_f32 v0, v0, v0, 1.0
    v_mfma_f32_16x16x32_bf16 v[132:135], v[48:51], a[144:147], 0
    v_fma_f32 v1, v1, v1, 1.0
    v_mfma_f32_16x16x32_bf16 v[132:135], v[52:55], a[148:151], v[132:135]
    ds_read_b64_tr_b16 v[38:39], v18 offset:20992
    v_fma_f32 v29, v29, v29, 1.0
    v_mfma_f32_16x16x32_bf16 v[132:135], v[56:59], a[152:155], v[132:135]
    ds_read_b64_tr_b16 v[40:41], v18 offset:24576
    v_fma_f32 v30, v30, v30, 1.0
    v_mfma_f32_16x16x32_bf16 v[132:135], v[60:63], a[156:159], v[132:135]
    ds_read_b64_tr_b16 v[42:43], v18 offset:25088
    v_rcp_f32 v0, v0
    v_mfma_f32_16x16x32_bf16 v[136:139], v[48:51], a[160:163], 0
    v_rcp_f32 v1, v1
    v_mfma_f32_16x16x32_bf16 v[136:139], v[52:55], a[164:167], v[136:139]
    ds_read_b64_tr_b16 v[44:45], v18 offset:28672
    v_rcp_f32 v29, v29
    v_mfma_f32_16x16x32_bf16 v[136:139], v[56:59], a[168:171], v[136:139]
    ds_read_b64_tr_b16 v[46:47], v18 offset:29184
    v_rcp_f32 v30, v30
    v_mfma_f32_16x16x32_bf16 v[136:139], v[60:63], a[172:175], v[136:139]
    v_mul_f32 v0, v0, v192
    v_mfma_f32_16x16x32_bf16 v[140:143], v[48:51], a[176:179], 0
    v_mul_f32 v1, v1, v193
    v_mfma_f32_16x16x32_bf16 v[140:143], v[52:55], a[180:183], v[140:143]
    v_mul_f32 v29, v29, v194
    v_mfma_f32_16x16x32_bf16 v[140:143], v[56:59], a[184:187], v[140:143]
    v_mul_f32 v30, v30, v195
    v_mfma_f32_16x16x32_bf16 v[140:143], v[60:63], a[188:191], v[140:143]
    v_fma_f32 v192, v0, -2.0, v192
    s_waitcnt lgkmcnt(4)
    v_mfma_f32_16x16x32_bf16 v[80:83], v[32:35], a[128:131], 0
    v_fma_f32 v193, v1, -2.0, v193
    v_mfma_f32_16x16x32_bf16 v[80:83], v[36:39], a[132:135], v[80:83]
    ds_read_b64_tr_b16 v[48:49], v19 offset:16384
    v_fma_f32 v194, v29, -2.0, v194
    s_waitcnt lgkmcnt(1)
    v_mfma_f32_16x16x32_bf16 v[80:83], v[40:43], a[136:139], v[80:83]
    ds_read_b64_tr_b16 v[50:51], v19 offset:16896
    v_fma_f32 v195, v30, -2.0, v195
    v_mfma_f32_16x16x32_bf16 v[80:83], v[44:47], a[140:143], v[80:83]
    ds_read_b64_tr_b16 v[52:53], v19 offset:20480
    v_mul_f32 v0, 0x3fb8aa3b, v208
    v_mfma_f32_16x16x32_bf16 v[84:87], v[32:35], a[144:147], 0
    v_mul_f32 v1, 0x3fb8aa3b, v209
    v_mfma_f32_16x16x32_bf16 v[84:87], v[36:39], a[148:151], v[84:87]
    ds_read_b64_tr_b16 v[54:55], v19 offset:20992
    v_mul_f32 v29, 0x3fb8aa3b, v210
    v_mfma_f32_16x16x32_bf16 v[84:87], v[40:43], a[152:155], v[84:87]
    ds_read_b64_tr_b16 v[56:57], v19 offset:24576
    v_mul_f32 v30, 0x3fb8aa3b, v211
    v_mfma_f32_16x16x32_bf16 v[84:87], v[44:47], a[156:159], v[84:87]
    ds_read_b64_tr_b16 v[58:59], v19 offset:25088
    v_exp_f32 v0, v0
    v_mfma_f32_16x16x32_bf16 v[88:91], v[32:35], a[160:163], 0
    v_exp_f32 v1, v1
    v_mfma_f32_16x16x32_bf16 v[88:91], v[36:39], a[164:167], v[88:91]
    ds_read_b64_tr_b16 v[60:61], v19 offset:28672
    v_exp_f32 v29, v29
    v_mfma_f32_16x16x32_bf16 v[88:91], v[40:43], a[168:171], v[88:91]
    ds_read_b64_tr_b16 v[62:63], v19 offset:29184
    v_exp_f32 v30, v30
    v_mfma_f32_16x16x32_bf16 v[88:91], v[44:47], a[172:175], v[88:91]
    v_add_f32 v0, 1.0, v0
    v_mfma_f32_16x16x32_bf16 v[92:95], v[32:35], a[176:179], 0
    v_add_f32 v1, 1.0, v1
    v_mfma_f32_16x16x32_bf16 v[92:95], v[36:39], a[180:183], v[92:95]
    v_add_f32 v29, 1.0, v29
    v_mfma_f32_16x16x32_bf16 v[92:95], v[40:43], a[184:187], v[92:95]
    v_add_f32 v30, 1.0, v30
    v_mfma_f32_16x16x32_bf16 v[92:95], v[44:47], a[188:191], v[92:95]
    v_fma_f32 v0, v0, v0, 1.0
    v_fma_f32 v1, v1, v1, 1.0
    s_waitcnt lgkmcnt(4)
    v_mfma_f32_16x16x32_bf16 v[144:147], v[48:51], a[128:131], 0
    v_fma_f32 v29, v29, v29, 1.0
    s_waitcnt vmcnt(24)
    s_barrier
    v_mfma_f32_16x16x32_bf16 v[144:147], v[52:55], a[132:135], v[144:147]
    ds_read_b64_tr_b16 v[32:33], v16 offset:32768
    v_fma_f32 v30, v30, v30, 1.0
    s_waitcnt lgkmcnt(1)
    v_mfma_f32_16x16x32_bf16 v[144:147], v[56:59], a[136:139], v[144:147]
    ds_read_b64_tr_b16 v[34:35], v16 offset:33280
    v_rcp_f32 v0, v0
    v_mfma_f32_16x16x32_bf16 v[144:147], v[60:63], a[140:143], v[144:147]
    ds_read_b64_tr_b16 v[36:37], v16 offset:36864
    v_rcp_f32 v1, v1
    v_mfma_f32_16x16x32_bf16 v[148:151], v[48:51], a[144:147], 0
    v_rcp_f32 v29, v29
    v_mfma_f32_16x16x32_bf16 v[148:151], v[52:55], a[148:151], v[148:151]
    ds_read_b64_tr_b16 v[38:39], v16 offset:37376
    v_rcp_f32 v30, v30
    v_mfma_f32_16x16x32_bf16 v[148:151], v[56:59], a[152:155], v[148:151]
    ds_read_b64_tr_b16 v[40:41], v16 offset:40960
    v_mul_f32 v0, v0, v208
    v_mfma_f32_16x16x32_bf16 v[148:151], v[60:63], a[156:159], v[148:151]
    ds_read_b64_tr_b16 v[42:43], v16 offset:41472
    v_mul_f32 v1, v1, v209
    v_mfma_f32_16x16x32_bf16 v[152:155], v[48:51], a[160:163], 0
    v_mul_f32 v29, v29, v210
    v_mfma_f32_16x16x32_bf16 v[152:155], v[52:55], a[164:167], v[152:155]
    ds_read_b64_tr_b16 v[44:45], v16 offset:45056
    v_mul_f32 v30, v30, v211
    v_mfma_f32_16x16x32_bf16 v[152:155], v[56:59], a[168:171], v[152:155]
    ds_read_b64_tr_b16 v[46:47], v16 offset:45568
    v_fma_f32 v208, v0, -2.0, v208
    v_mfma_f32_16x16x32_bf16 v[152:155], v[60:63], a[172:175], v[152:155]
    v_fma_f32 v209, v1, -2.0, v209
    v_mfma_f32_16x16x32_bf16 v[156:159], v[48:51], a[176:179], 0
    v_fma_f32 v210, v29, -2.0, v210
    v_mfma_f32_16x16x32_bf16 v[156:159], v[52:55], a[180:183], v[156:159]
    v_fma_f32 v211, v30, -2.0, v211
    v_mfma_f32_16x16x32_bf16 v[156:159], v[56:59], a[184:187], v[156:159]
    v_cvt_pk_bf16_f32 v192, v192, v193
    v_mfma_f32_16x16x32_bf16 v[156:159], v[60:63], a[188:191], v[156:159]
    v_cvt_pk_bf16_f32 v193, v194, v195
    s_waitcnt lgkmcnt(4)
    v_mfma_f32_16x16x32_bf16 v[64:67], v[32:35], a[192:195], v[64:67]
    buffer_store_dwordx4 v[96:99], v3, s[4:7], s60 offen offset:0 sc1
    v_cvt_pk_bf16_f32 v194, v208, v209
    v_mfma_f32_16x16x32_bf16 v[64:67], v[36:39], a[196:199], v[64:67]
    ds_read_b64_tr_b16 v[48:49], v17 offset:32768
    v_cvt_pk_bf16_f32 v195, v210, v211
    s_waitcnt lgkmcnt(1)
    v_mfma_f32_16x16x32_bf16 v[64:67], v[40:43], a[200:203], v[64:67]
    ds_read_b64_tr_b16 v[50:51], v17 offset:33280
    v_mfma_f32_16x16x32_bf16 v[64:67], v[44:47], a[204:207], v[64:67]
    ds_read_b64_tr_b16 v[52:53], v17 offset:36864
    buffer_store_dwordx4 v[192:195], v3, s[4:7], s36 offen sc1
    v_mul_f32 v0, 0x3fb8aa3b, v196
    v_mfma_f32_16x16x32_bf16 v[68:71], v[32:35], a[208:211], v[68:71]
    v_mul_f32 v1, 0x3fb8aa3b, v197
    v_mfma_f32_16x16x32_bf16 v[68:71], v[36:39], a[212:215], v[68:71]
    ds_read_b64_tr_b16 v[54:55], v17 offset:37376
    v_mul_f32 v29, 0x3fb8aa3b, v198
    v_mfma_f32_16x16x32_bf16 v[68:71], v[40:43], a[216:219], v[68:71]
    ds_read_b64_tr_b16 v[56:57], v17 offset:40960
    v_mul_f32 v30, 0x3fb8aa3b, v199
    v_mfma_f32_16x16x32_bf16 v[68:71], v[44:47], a[220:223], v[68:71]
    ds_read_b64_tr_b16 v[58:59], v17 offset:41472
    buffer_store_dwordx4 v[112:115], v3, s[4:7], s60 offen offset:1024 sc1
    v_exp_f32 v0, v0
    v_mfma_f32_16x16x32_bf16 v[72:75], v[32:35], a[224:227], v[72:75]
    v_exp_f32 v1, v1
    v_mfma_f32_16x16x32_bf16 v[72:75], v[36:39], a[228:231], v[72:75]
    ds_read_b64_tr_b16 v[60:61], v17 offset:45056
    v_exp_f32 v29, v29
    v_mfma_f32_16x16x32_bf16 v[72:75], v[40:43], a[232:235], v[72:75]
    ds_read_b64_tr_b16 v[62:63], v17 offset:45568
    v_exp_f32 v30, v30
    v_mfma_f32_16x16x32_bf16 v[72:75], v[44:47], a[236:239], v[72:75]
    v_add_f32 v0, 1.0, v0
    v_mfma_f32_16x16x32_bf16 v[76:79], v[32:35], a[240:243], v[76:79]
    v_add_f32 v1, 1.0, v1
    v_mfma_f32_16x16x32_bf16 v[76:79], v[36:39], a[244:247], v[76:79]
    v_add_f32 v29, 1.0, v29
    v_mfma_f32_16x16x32_bf16 v[76:79], v[40:43], a[248:251], v[76:79]
    buffer_store_dwordx4 v[160:163], v3, s[4:7], s60 offen offset:2048 sc1
    v_add_f32 v30, 1.0, v30
    v_mfma_f32_16x16x32_bf16 v[76:79], v[44:47], a[252:255], v[76:79]
    v_fma_f32 v0, v0, v0, 1.0
    s_waitcnt lgkmcnt(4)
    v_mfma_f32_16x16x32_bf16 v[128:131], v[48:51], a[192:195], v[128:131]
    v_fma_f32 v1, v1, v1, 1.0
    v_mfma_f32_16x16x32_bf16 v[128:131], v[52:55], a[196:199], v[128:131]
    ds_read_b64_tr_b16 v[32:33], v18 offset:32768
    v_fma_f32 v29, v29, v29, 1.0
    s_waitcnt lgkmcnt(1)
    v_mfma_f32_16x16x32_bf16 v[128:131], v[56:59], a[200:203], v[128:131]
    ds_read_b64_tr_b16 v[34:35], v18 offset:33280
    v_fma_f32 v30, v30, v30, 1.0
    v_mfma_f32_16x16x32_bf16 v[128:131], v[60:63], a[204:207], v[128:131]
    ds_read_b64_tr_b16 v[36:37], v18 offset:36864
    v_rcp_f32 v0, v0
    v_mfma_f32_16x16x32_bf16 v[132:135], v[48:51], a[208:211], v[132:135]
    v_rcp_f32 v1, v1
    v_mfma_f32_16x16x32_bf16 v[132:135], v[52:55], a[212:215], v[132:135]
    ds_read_b64_tr_b16 v[38:39], v18 offset:37376
    buffer_store_dwordx4 v[176:179], v3, s[4:7], s60 offen offset:3072 sc1
    v_rcp_f32 v29, v29
    v_mfma_f32_16x16x32_bf16 v[132:135], v[56:59], a[216:219], v[132:135]
    ds_read_b64_tr_b16 v[40:41], v18 offset:40960
    v_rcp_f32 v30, v30
    v_mfma_f32_16x16x32_bf16 v[132:135], v[60:63], a[220:223], v[132:135]
    ds_read_b64_tr_b16 v[42:43], v18 offset:41472
    v_mul_f32 v0, v0, v196
    v_mul_f32 v1, v1, v197
    v_mfma_f32_16x16x32_bf16 v[136:139], v[48:51], a[224:227], v[136:139]
    v_mul_f32 v29, v29, v198
    v_mfma_f32_16x16x32_bf16 v[136:139], v[52:55], a[228:231], v[136:139]
    ds_read_b64_tr_b16 v[44:45], v18 offset:45056
    v_mul_f32 v30, v30, v199
    v_mfma_f32_16x16x32_bf16 v[136:139], v[56:59], a[232:235], v[136:139]
    ds_read_b64_tr_b16 v[46:47], v18 offset:45568
    v_fma_f32 v196, v0, -2.0, v196
    v_mfma_f32_16x16x32_bf16 v[136:139], v[60:63], a[236:239], v[136:139]
    v_fma_f32 v197, v1, -2.0, v197
    v_mfma_f32_16x16x32_bf16 v[140:143], v[48:51], a[240:243], v[140:143]
    s_add_u32 s60, s60, 4096
    buffer_store_dwordx4 v[100:103], v3, s[4:7], s60 offen offset:0 sc1
    v_fma_f32 v198, v29, -2.0, v198
    v_mfma_f32_16x16x32_bf16 v[140:143], v[52:55], a[244:247], v[140:143]
    v_fma_f32 v199, v30, -2.0, v199
    v_mfma_f32_16x16x32_bf16 v[140:143], v[56:59], a[248:251], v[140:143]
    v_mul_f32 v0, 0x3fb8aa3b, v212
    v_mfma_f32_16x16x32_bf16 v[140:143], v[60:63], a[252:255], v[140:143]
    v_mul_f32 v1, 0x3fb8aa3b, v213
    s_waitcnt lgkmcnt(4)
    v_mfma_f32_16x16x32_bf16 v[80:83], v[32:35], a[192:195], v[80:83]
    v_mul_f32 v29, 0x3fb8aa3b, v214
    v_mfma_f32_16x16x32_bf16 v[80:83], v[36:39], a[196:199], v[80:83]
    ds_read_b64_tr_b16 v[48:49], v19 offset:32768
    v_mul_f32 v30, 0x3fb8aa3b, v215
    s_waitcnt lgkmcnt(1)
    v_mfma_f32_16x16x32_bf16 v[80:83], v[40:43], a[200:203], v[80:83]
    ds_read_b64_tr_b16 v[50:51], v19 offset:33280
    v_exp_f32 v0, v0
    v_mfma_f32_16x16x32_bf16 v[80:83], v[44:47], a[204:207], v[80:83]
    ds_read_b64_tr_b16 v[52:53], v19 offset:36864
    buffer_store_dwordx4 v[116:119], v3, s[4:7], s60 offen offset:1024 sc1
    v_exp_f32 v1, v1
    v_mfma_f32_16x16x32_bf16 v[84:87], v[32:35], a[208:211], v[84:87]
    v_exp_f32 v29, v29
    v_mfma_f32_16x16x32_bf16 v[84:87], v[36:39], a[212:215], v[84:87]
    ds_read_b64_tr_b16 v[54:55], v19 offset:37376
    v_exp_f32 v30, v30
    v_mfma_f32_16x16x32_bf16 v[84:87], v[40:43], a[216:219], v[84:87]
    ds_read_b64_tr_b16 v[56:57], v19 offset:40960
    v_add_f32 v0, 1.0, v0
    v_mfma_f32_16x16x32_bf16 v[84:87], v[44:47], a[220:223], v[84:87]
    ds_read_b64_tr_b16 v[58:59], v19 offset:41472
    v_add_f32 v1, 1.0, v1
    v_mfma_f32_16x16x32_bf16 v[88:91], v[32:35], a[224:227], v[88:91]
    s_load_dwordx2 s[8:9], s[0:1], 40
    v_add_f32 v29, 1.0, v29
    v_mfma_f32_16x16x32_bf16 v[88:91], v[36:39], a[228:231], v[88:91]
    ds_read_b64_tr_b16 v[60:61], v19 offset:45056
    v_add_f32 v30, 1.0, v30
    v_mfma_f32_16x16x32_bf16 v[88:91], v[40:43], a[232:235], v[88:91]
    ds_read_b64_tr_b16 v[62:63], v19 offset:45568
    buffer_store_dwordx4 v[164:167], v3, s[4:7], s60 offen offset:2048 sc1
    s_load_dwordx2 s[12:13], s[0:1], 72
    v_fma_f32 v0, v0, v0, 1.0
    v_mfma_f32_16x16x32_bf16 v[88:91], v[44:47], a[236:239], v[88:91]
    v_fma_f32 v1, v1, v1, 1.0
    v_mfma_f32_16x16x32_bf16 v[92:95], v[32:35], a[240:243], v[92:95]
    s_bfe_u32 s26, s2, 0x20001
    v_fma_f32 v29, v29, v29, 1.0
    v_mfma_f32_16x16x32_bf16 v[92:95], v[36:39], a[244:247], v[92:95]
    v_fma_f32 v30, v30, v30, 1.0
    v_mfma_f32_16x16x32_bf16 v[92:95], v[40:43], a[248:251], v[92:95]
    s_lshr_b32 s27, s2, 3
    v_rcp_f32 v0, v0
    v_mfma_f32_16x16x32_bf16 v[92:95], v[44:47], a[252:255], v[92:95]
    v_rcp_f32 v1, v1
    s_waitcnt lgkmcnt(4)
    v_mfma_f32_16x16x32_bf16 v[144:147], v[48:51], a[192:195], v[144:147]
    s_lshl_b32 s27, s27, 2
    v_rcp_f32 v29, v29
    s_waitcnt vmcnt(28)
    s_barrier
    v_mfma_f32_16x16x32_bf16 v[144:147], v[52:55], a[196:199], v[144:147]
    ds_read_b64_tr_b16 v[32:33], v12 offset:0
    buffer_store_dwordx4 v[180:183], v3, s[4:7], s60 offen offset:3072 sc1
    v_rcp_f32 v30, v30
    s_waitcnt lgkmcnt(1)
    v_mfma_f32_16x16x32_bf16 v[144:147], v[56:59], a[200:203], v[144:147]
    ds_read_b64_tr_b16 v[34:35], v12 offset:512
    s_add_u32 s27, s27, s28
    v_mul_f32 v0, v0, v212
    v_mfma_f32_16x16x32_bf16 v[144:147], v[60:63], a[204:207], v[144:147]
    ds_read_b64_tr_b16 v[36:37], v12 offset:4096
    v_mul_f32 v1, v1, v213
    v_mfma_f32_16x16x32_bf16 v[148:151], v[48:51], a[208:211], v[148:151]
    s_mul_i32 s24, s26, 352
    v_mul_f32 v29, v29, v214
    v_mfma_f32_16x16x32_bf16 v[148:151], v[52:55], a[212:215], v[148:151]
    ds_read_b64_tr_b16 v[38:39], v12 offset:4608
    v_mul_f32 v30, v30, v215
    v_mfma_f32_16x16x32_bf16 v[148:151], v[56:59], a[216:219], v[148:151]
    ds_read_b64_tr_b16 v[40:41], v12 offset:8192
    s_mul_i32 s25, s27, 3
    v_fma_f32 v212, v0, -2.0, v212
    v_mfma_f32_16x16x32_bf16 v[148:151], v[60:63], a[220:223], v[148:151]
    ds_read_b64_tr_b16 v[42:43], v12 offset:8704
    v_fma_f32 v213, v1, -2.0, v213
    v_mfma_f32_16x16x32_bf16 v[152:155], v[48:51], a[224:227], v[152:155]
    s_add_u32 s60, s60, 4096
    buffer_store_dwordx4 v[104:107], v3, s[4:7], s60 offen offset:0 sc1
    s_add_u32 s24, s24, s25
    v_fma_f32 v214, v29, -2.0, v214
    v_mfma_f32_16x16x32_bf16 v[152:155], v[52:55], a[228:231], v[152:155]
    ds_read_b64_tr_b16 v[44:45], v12 offset:12288
    v_fma_f32 v215, v30, -2.0, v215
    v_mfma_f32_16x16x32_bf16 v[152:155], v[56:59], a[232:235], v[152:155]
    ds_read_b64_tr_b16 v[46:47], v12 offset:12800
    s_lshl_b32 s24, s24, 10
    v_cvt_pk_bf16_f32 v196, v196, v197
    v_mfma_f32_16x16x32_bf16 v[152:155], v[60:63], a[236:239], v[152:155]
    v_cvt_pk_bf16_f32 v197, v198, v199
    v_mfma_f32_16x16x32_bf16 v[156:159], v[48:51], a[240:243], v[156:159]
    s_lshl_b32 s26, s26, 20
    v_cvt_pk_bf16_f32 v198, v212, v213
    v_mfma_f32_16x16x32_bf16 v[156:159], v[52:55], a[244:247], v[156:159]
    v_cvt_pk_bf16_f32 v199, v214, v215
    v_mfma_f32_16x16x32_bf16 v[156:159], v[56:59], a[248:251], v[156:159]
    s_lshl_b32 s27, s27, 13
    v_mfma_f32_16x16x32_bf16 v[156:159], v[60:63], a[252:255], v[156:159]
    buffer_store_dwordx4 v[120:123], v3, s[4:7], s60 offen offset:1024 sc1
    buffer_store_dwordx4 v[196:199], v3, s[4:7], s38 offen sc1
    v_mul_f32 v0, 0x3fb8aa3b, v200
    v_mul_f32 v1, 0x3fb8aa3b, v201
    s_waitcnt lgkmcnt(4)
    v_mfma_f32_16x16x32_bf16 v[64:67], v[32:35], a[0:3], v[64:67]
    s_add_u32 s26, s26, s27
    v_mul_f32 v29, 0x3fb8aa3b, v202
    v_mfma_f32_16x16x32_bf16 v[64:67], v[36:39], a[4:7], v[64:67]
    ds_read_b64_tr_b16 v[48:49], v13 offset:0
    v_mul_f32 v30, 0x3fb8aa3b, v203
    s_waitcnt lgkmcnt(1)
    v_mfma_f32_16x16x32_bf16 v[64:67], v[40:43], a[8:11], v[64:67]
    ds_read_b64_tr_b16 v[50:51], v13 offset:512
    s_add_u32 s10, s26, 8192
    v_exp_f32 v0, v0
    v_mfma_f32_16x16x32_bf16 v[64:67], v[44:47], a[12:15], v[64:67]
    ds_read_b64_tr_b16 v[52:53], v13 offset:4096
    v_exp_f32 v1, v1
    v_mfma_f32_16x16x32_bf16 v[68:71], v[32:35], a[16:19], v[68:71]
    s_mov_b32 s11, 0x00020000
    v_exp_f32 v29, v29
    v_mfma_f32_16x16x32_bf16 v[68:71], v[36:39], a[20:23], v[68:71]
    ds_read_b64_tr_b16 v[54:55], v13 offset:4608
    v_exp_f32 v30, v30
    v_mfma_f32_16x16x32_bf16 v[68:71], v[40:43], a[24:27], v[68:71]
    ds_read_b64_tr_b16 v[56:57], v13 offset:8192
    buffer_store_dwordx4 v[168:171], v3, s[4:7], s60 offen offset:2048 sc1
    s_add_u32 s14, s24, 3072
    v_add_f32 v0, 1.0, v0
    v_mfma_f32_16x16x32_bf16 v[68:71], v[44:47], a[28:31], v[68:71]
    ds_read_b64_tr_b16 v[58:59], v13 offset:8704
    v_add_f32 v1, 1.0, v1
    v_mfma_f32_16x16x32_bf16 v[72:75], v[32:35], a[32:35], v[72:75]
    s_min_u32 s14, s14, 1409024
    v_add_f32 v29, 1.0, v29
    v_mfma_f32_16x16x32_bf16 v[72:75], v[36:39], a[36:39], v[72:75]
    ds_read_b64_tr_b16 v[60:61], v13 offset:12288
    v_add_f32 v30, 1.0, v30
    v_mfma_f32_16x16x32_bf16 v[72:75], v[40:43], a[40:43], v[72:75]
    ds_read_b64_tr_b16 v[62:63], v13 offset:12800
    s_mov_b32 s15, 0x00020000
    v_fma_f32 v0, v0, v0, 1.0
    v_mfma_f32_16x16x32_bf16 v[72:75], v[44:47], a[44:47], v[72:75]
    v_fma_f32 v1, v1, v1, 1.0
    v_mfma_f32_16x16x32_bf16 v[76:79], v[32:35], a[48:51], v[76:79]
    v_mov_b32 v8, 0x3f803f80
    v_fma_f32 v29, v29, v29, 1.0
    v_mfma_f32_16x16x32_bf16 v[76:79], v[36:39], a[52:55], v[76:79]
    buffer_store_dwordx4 v[184:187], v3, s[4:7], s60 offen offset:3072 sc1
    v_fma_f32 v30, v30, v30, 1.0
    v_mfma_f32_16x16x32_bf16 v[76:79], v[40:43], a[56:59], v[76:79]
    v_mov_b32 v9, 0x3f803f80
    v_rcp_f32 v0, v0
    v_mfma_f32_16x16x32_bf16 v[76:79], v[44:47], a[60:63], v[76:79]
    v_rcp_f32 v1, v1
    s_waitcnt lgkmcnt(4)
    v_mfma_f32_16x16x32_bf16 v[128:131], v[48:51], a[0:3], v[128:131]
    v_mov_b32 v10, 0x3f803f80
    v_rcp_f32 v29, v29
    v_mfma_f32_16x16x32_bf16 v[128:131], v[52:55], a[4:7], v[128:131]
    ds_read_b64_tr_b16 v[32:33], v14 offset:0
    v_rcp_f32 v30, v30
    s_waitcnt lgkmcnt(1)
    v_mfma_f32_16x16x32_bf16 v[128:131], v[56:59], a[8:11], v[128:131]
    ds_read_b64_tr_b16 v[34:35], v14 offset:512
    v_mov_b32 v11, 0x3f803f80
    v_mul_f32 v0, v0, v200
    v_mfma_f32_16x16x32_bf16 v[128:131], v[60:63], a[12:15], v[128:131]
    ds_read_b64_tr_b16 v[36:37], v14 offset:4096
    v_mul_f32 v1, v1, v201
    v_mfma_f32_16x16x32_bf16 v[132:135], v[48:51], a[16:19], v[132:135]
    s_add_u32 s60, s60, 4096
    buffer_store_dwordx4 v[108:111], v3, s[4:7], s60 offen offset:0 sc1
    v_cmp_le_i32 s[62:63], 0, v27
    v_mul_f32 v29, v29, v202
    v_mfma_f32_16x16x32_bf16 v[132:135], v[52:55], a[20:23], v[132:135]
    ds_read_b64_tr_b16 v[38:39], v14 offset:4608
    v_mul_f32 v30, v30, v203
    v_mfma_f32_16x16x32_bf16 v[132:135], v[56:59], a[24:27], v[132:135]
    ds_read_b64_tr_b16 v[40:41], v14 offset:8192
    v_cmp_le_i32 s[64:65], 1, v27
    v_fma_f32 v200, v0, -2.0, v200
    v_mfma_f32_16x16x32_bf16 v[132:135], v[60:63], a[28:31], v[132:135]
    ds_read_b64_tr_b16 v[42:43], v14 offset:8704
    v_fma_f32 v201, v1, -2.0, v201
    v_mfma_f32_16x16x32_bf16 v[136:139], v[48:51], a[32:35], v[136:139]
    v_cmp_le_i32 s[66:67], 2, v27
    v_fma_f32 v202, v29, -2.0, v202
    v_mfma_f32_16x16x32_bf16 v[136:139], v[52:55], a[36:39], v[136:139]
    ds_read_b64_tr_b16 v[44:45], v14 offset:12288
    v_fma_f32 v203, v30, -2.0, v203
    v_mfma_f32_16x16x32_bf16 v[136:139], v[56:59], a[40:43], v[136:139]
    ds_read_b64_tr_b16 v[46:47], v14 offset:12800
    v_cmp_le_i32 s[68:69], 3, v27
    v_mul_f32 v0, 0x3fb8aa3b, v216
    v_mfma_f32_16x16x32_bf16 v[136:139], v[60:63], a[44:47], v[136:139]
    buffer_store_dwordx4 v[124:127], v3, s[4:7], s60 offen offset:1024 sc1
    v_mul_f32 v1, 0x3fb8aa3b, v217
    v_mfma_f32_16x16x32_bf16 v[140:143], v[48:51], a[48:51], v[140:143]
    s_lshl_b32 s50, s28, 12
    v_mul_f32 v29, 0x3fb8aa3b, v218
    v_mfma_f32_16x16x32_bf16 v[140:143], v[52:55], a[52:55], v[140:143]
    v_mul_f32 v30, 0x3fb8aa3b, v219
    v_mfma_f32_16x16x32_bf16 v[140:143], v[56:59], a[56:59], v[140:143]
    s_add_u32 s50, s50, 49152
    v_exp_f32 v0, v0
    v_mfma_f32_16x16x32_bf16 v[140:143], v[60:63], a[60:63], v[140:143]
    v_exp_f32 v1, v1
    s_waitcnt lgkmcnt(4)
    v_mfma_f32_16x16x32_bf16 v[80:83], v[32:35], a[0:3], v[80:83]
    s_mov_b32 s51, s50
    v_exp_f32 v29, v29
    v_mfma_f32_16x16x32_bf16 v[80:83], v[36:39], a[4:7], v[80:83]
    ds_read_b64_tr_b16 v[48:49], v15 offset:0
    v_exp_f32 v30, v30
    s_waitcnt lgkmcnt(1)
    v_mfma_f32_16x16x32_bf16 v[80:83], v[40:43], a[8:11], v[80:83]
    ds_read_b64_tr_b16 v[50:51], v15 offset:512
    buffer_store_dwordx4 v[172:175], v3, s[4:7], s60 offen offset:2048 sc1
    v_add_u32 v4, 0x10000, v3
    v_add_f32 v0, 1.0, v0
    v_mfma_f32_16x16x32_bf16 v[80:83], v[44:47], a[12:15], v[80:83]
    ds_read_b64_tr_b16 v[52:53], v15 offset:4096
    v_add_f32 v1, 1.0, v1
    v_mfma_f32_16x16x32_bf16 v[84:87], v[32:35], a[16:19], v[84:87]
    s_mov_b32 s53, 16384
    v_add_f32 v29, 1.0, v29
    v_mfma_f32_16x16x32_bf16 v[84:87], v[36:39], a[20:23], v[84:87]
    ds_read_b64_tr_b16 v[54:55], v15 offset:4608
    v_add_f32 v30, 1.0, v30
    v_mfma_f32_16x16x32_bf16 v[84:87], v[40:43], a[24:27], v[84:87]
    ds_read_b64_tr_b16 v[56:57], v15 offset:8192
    s_mov_b32 s54, 0
    v_fma_f32 v0, v0, v0, 1.0
    v_fma_f32 v1, v1, v1, 1.0
    v_mfma_f32_16x16x32_bf16 v[84:87], v[44:47], a[28:31], v[84:87]
    ds_read_b64_tr_b16 v[58:59], v15 offset:8704
    v_fma_f32 v29, v29, v29, 1.0
    v_mfma_f32_16x16x32_bf16 v[88:91], v[32:35], a[32:35], v[88:91]
    s_lshl_b32 s27, s31, 13
    v_fma_f32 v30, v30, v30, 1.0
    v_mfma_f32_16x16x32_bf16 v[88:91], v[36:39], a[36:39], v[88:91]
    ds_read_b64_tr_b16 v[60:61], v15 offset:12288
    buffer_store_dwordx4 v[188:191], v3, s[4:7], s60 offen offset:3072 sc1
    v_rcp_f32 v0, v0
    v_mfma_f32_16x16x32_bf16 v[88:91], v[40:43], a[40:43], v[88:91]
    ds_read_b64_tr_b16 v[62:63], v15 offset:12800
    s_lshr_b32 s25, s28, 1
    v_rcp_f32 v1, v1
    v_mfma_f32_16x16x32_bf16 v[88:91], v[44:47], a[44:47], v[88:91]
    v_rcp_f32 v29, v29
    v_mfma_f32_16x16x32_bf16 v[92:95], v[32:35], a[48:51], v[92:95]
    s_lshl_b32 s25, s25, 16
    v_rcp_f32 v30, v30
    v_mfma_f32_16x16x32_bf16 v[92:95], v[36:39], a[52:55], v[92:95]
    v_mul_f32 v0, v0, v216
    v_mfma_f32_16x16x32_bf16 v[92:95], v[40:43], a[56:59], v[92:95]
    s_add_u32 s27, s27, s25
    v_mul_f32 v1, v1, v217
    v_mfma_f32_16x16x32_bf16 v[92:95], v[44:47], a[60:63], v[92:95]
    v_mul_f32 v29, v29, v218
    s_waitcnt lgkmcnt(4)
    v_mfma_f32_16x16x32_bf16 v[144:147], v[48:51], a[0:3], v[144:147]
    s_add_u32 s27, s27, 49152
    v_mul_f32 v30, v30, v219
    s_waitcnt vmcnt(34)
    s_barrier
    v_mfma_f32_16x16x32_bf16 v[144:147], v[52:55], a[4:7], v[144:147]
    ds_read_b64_tr_b16 v[32:33], v12 offset:16384
    v_fma_f32 v216, v0, -2.0, v216
    s_waitcnt lgkmcnt(1)
    v_mfma_f32_16x16x32_bf16 v[144:147], v[56:59], a[8:11], v[144:147]
    ds_read_b64_tr_b16 v[34:35], v12 offset:16896
    v_add_u32 v5, s27, v3
    v_fma_f32 v217, v1, -2.0, v217
    v_mfma_f32_16x16x32_bf16 v[144:147], v[60:63], a[12:15], v[144:147]
    ds_read_b64_tr_b16 v[36:37], v12 offset:20480
    v_fma_f32 v218, v29, -2.0, v218
    v_mfma_f32_16x16x32_bf16 v[148:151], v[48:51], a[16:19], v[148:151]
    v_fma_f32 v219, v30, -2.0, v219
    v_mfma_f32_16x16x32_bf16 v[148:151], v[52:55], a[20:23], v[148:151]
    ds_read_b64_tr_b16 v[38:39], v12 offset:20992
    v_cvt_pk_bf16_f32 v200, v200, v201
    v_mfma_f32_16x16x32_bf16 v[148:151], v[56:59], a[24:27], v[148:151]
    ds_read_b64_tr_b16 v[40:41], v12 offset:24576
    v_cvt_pk_bf16_f32 v201, v202, v203
    v_mfma_f32_16x16x32_bf16 v[148:151], v[60:63], a[28:31], v[148:151]
    ds_read_b64_tr_b16 v[42:43], v12 offset:25088
    v_cvt_pk_bf16_f32 v202, v216, v217
    v_mfma_f32_16x16x32_bf16 v[152:155], v[48:51], a[32:35], v[152:155]
    v_cvt_pk_bf16_f32 v203, v218, v219
    v_mfma_f32_16x16x32_bf16 v[152:155], v[52:55], a[36:39], v[152:155]
    ds_read_b64_tr_b16 v[44:45], v12 offset:28672
    v_mfma_f32_16x16x32_bf16 v[152:155], v[56:59], a[40:43], v[152:155]
    ds_read_b64_tr_b16 v[46:47], v12 offset:29184
    buffer_store_dwordx4 v[200:203], v3, s[4:7], s40 offen sc1
    v_mul_f32 v0, 0x3fb8aa3b, v204
    v_mfma_f32_16x16x32_bf16 v[152:155], v[60:63], a[44:47], v[152:155]
    v_mul_f32 v1, 0x3fb8aa3b, v205
    v_mfma_f32_16x16x32_bf16 v[156:159], v[48:51], a[48:51], v[156:159]
    v_mul_f32 v29, 0x3fb8aa3b, v206
    v_mfma_f32_16x16x32_bf16 v[156:159], v[52:55], a[52:55], v[156:159]
    v_mul_f32 v30, 0x3fb8aa3b, v207
    v_mfma_f32_16x16x32_bf16 v[156:159], v[56:59], a[56:59], v[156:159]
    v_exp_f32 v0, v0
    v_mfma_f32_16x16x32_bf16 v[156:159], v[60:63], a[60:63], v[156:159]
    v_exp_f32 v1, v1
    s_waitcnt lgkmcnt(4)
    v_mfma_f32_16x16x32_bf16 v[64:67], v[32:35], a[64:67], v[64:67]
    v_exp_f32 v29, v29
    v_mfma_f32_16x16x32_bf16 v[64:67], v[36:39], a[68:71], v[64:67]
    ds_read_b64_tr_b16 v[48:49], v13 offset:16384
    v_exp_f32 v30, v30
    s_waitcnt lgkmcnt(1)
    v_mfma_f32_16x16x32_bf16 v[64:67], v[40:43], a[72:75], v[64:67]
    ds_read_b64_tr_b16 v[50:51], v13 offset:16896
    v_add_f32 v0, 1.0, v0
    v_mfma_f32_16x16x32_bf16 v[64:67], v[44:47], a[76:79], v[64:67]
    ds_read_b64_tr_b16 v[52:53], v13 offset:20480
    v_add_f32 v1, 1.0, v1
    v_mfma_f32_16x16x32_bf16 v[68:71], v[32:35], a[80:83], v[68:71]
    v_add_f32 v29, 1.0, v29
    v_mfma_f32_16x16x32_bf16 v[68:71], v[36:39], a[84:87], v[68:71]
    ds_read_b64_tr_b16 v[54:55], v13 offset:20992
    v_add_f32 v30, 1.0, v30
    v_mfma_f32_16x16x32_bf16 v[68:71], v[40:43], a[88:91], v[68:71]
    ds_read_b64_tr_b16 v[56:57], v13 offset:24576
    v_fma_f32 v0, v0, v0, 1.0
    v_mfma_f32_16x16x32_bf16 v[68:71], v[44:47], a[92:95], v[68:71]
    ds_read_b64_tr_b16 v[58:59], v13 offset:25088
    v_fma_f32 v1, v1, v1, 1.0
    v_mfma_f32_16x16x32_bf16 v[72:75], v[32:35], a[96:99], v[72:75]
    v_fma_f32 v29, v29, v29, 1.0
    v_mfma_f32_16x16x32_bf16 v[72:75], v[36:39], a[100:103], v[72:75]
    ds_read_b64_tr_b16 v[60:61], v13 offset:28672
    v_fma_f32 v30, v30, v30, 1.0
    v_mfma_f32_16x16x32_bf16 v[72:75], v[40:43], a[104:107], v[72:75]
    ds_read_b64_tr_b16 v[62:63], v13 offset:29184
    v_rcp_f32 v0, v0
    v_mfma_f32_16x16x32_bf16 v[72:75], v[44:47], a[108:111], v[72:75]
    v_rcp_f32 v1, v1
    v_mfma_f32_16x16x32_bf16 v[76:79], v[32:35], a[112:115], v[76:79]
    v_rcp_f32 v29, v29
    v_mfma_f32_16x16x32_bf16 v[76:79], v[36:39], a[116:119], v[76:79]
    v_rcp_f32 v30, v30
    v_mfma_f32_16x16x32_bf16 v[76:79], v[40:43], a[120:123], v[76:79]
    v_mul_f32 v0, v0, v204
    v_mul_f32 v1, v1, v205
    v_mfma_f32_16x16x32_bf16 v[76:79], v[44:47], a[124:127], v[76:79]
    v_mul_f32 v29, v29, v206
    s_waitcnt lgkmcnt(4)
    v_mfma_f32_16x16x32_bf16 v[128:131], v[48:51], a[64:67], v[128:131]
    v_mul_f32 v30, v30, v207
    v_mfma_f32_16x16x32_bf16 v[128:131], v[52:55], a[68:71], v[128:131]
    ds_read_b64_tr_b16 v[32:33], v14 offset:16384
    v_fma_f32 v204, v0, -2.0, v204
    s_waitcnt lgkmcnt(1)
    v_mfma_f32_16x16x32_bf16 v[128:131], v[56:59], a[72:75], v[128:131]
    ds_read_b64_tr_b16 v[34:35], v14 offset:16896
    v_fma_f32 v205, v1, -2.0, v205
    v_mfma_f32_16x16x32_bf16 v[128:131], v[60:63], a[76:79], v[128:131]
    ds_read_b64_tr_b16 v[36:37], v14 offset:20480
    v_fma_f32 v206, v29, -2.0, v206
    v_mfma_f32_16x16x32_bf16 v[132:135], v[48:51], a[80:83], v[132:135]
    v_fma_f32 v207, v30, -2.0, v207
    v_mfma_f32_16x16x32_bf16 v[132:135], v[52:55], a[84:87], v[132:135]
    ds_read_b64_tr_b16 v[38:39], v14 offset:20992
    v_mul_f32 v0, 0x3fb8aa3b, v220
    v_mfma_f32_16x16x32_bf16 v[132:135], v[56:59], a[88:91], v[132:135]
    ds_read_b64_tr_b16 v[40:41], v14 offset:24576
    v_mul_f32 v1, 0x3fb8aa3b, v221
    v_mfma_f32_16x16x32_bf16 v[132:135], v[60:63], a[92:95], v[132:135]
    ds_read_b64_tr_b16 v[42:43], v14 offset:25088
    v_mul_f32 v29, 0x3fb8aa3b, v222
    v_mfma_f32_16x16x32_bf16 v[136:139], v[48:51], a[96:99], v[136:139]
    v_mul_f32 v30, 0x3fb8aa3b, v223
    v_mfma_f32_16x16x32_bf16 v[136:139], v[52:55], a[100:103], v[136:139]
    ds_read_b64_tr_b16 v[44:45], v14 offset:28672
    v_exp_f32 v0, v0
    v_mfma_f32_16x16x32_bf16 v[136:139], v[56:59], a[104:107], v[136:139]
    ds_read_b64_tr_b16 v[46:47], v14 offset:29184
    v_exp_f32 v1, v1
    v_mfma_f32_16x16x32_bf16 v[136:139], v[60:63], a[108:111], v[136:139]
    v_exp_f32 v29, v29
    v_mfma_f32_16x16x32_bf16 v[140:143], v[48:51], a[112:115], v[140:143]
    v_exp_f32 v30, v30
    v_mfma_f32_16x16x32_bf16 v[140:143], v[52:55], a[116:119], v[140:143]
    v_add_f32 v0, 1.0, v0
    v_mfma_f32_16x16x32_bf16 v[140:143], v[56:59], a[120:123], v[140:143]
    v_add_f32 v1, 1.0, v1
    v_mfma_f32_16x16x32_bf16 v[140:143], v[60:63], a[124:127], v[140:143]
    v_add_f32 v29, 1.0, v29
    s_waitcnt lgkmcnt(4)
    v_mfma_f32_16x16x32_bf16 v[80:83], v[32:35], a[64:67], v[80:83]
    v_add_f32 v30, 1.0, v30
    v_mfma_f32_16x16x32_bf16 v[80:83], v[36:39], a[68:71], v[80:83]
    ds_read_b64_tr_b16 v[48:49], v15 offset:16384
    v_fma_f32 v0, v0, v0, 1.0
    s_waitcnt lgkmcnt(1)
    v_mfma_f32_16x16x32_bf16 v[80:83], v[40:43], a[72:75], v[80:83]
    ds_read_b64_tr_b16 v[50:51], v15 offset:16896
    v_fma_f32 v1, v1, v1, 1.0
    v_mfma_f32_16x16x32_bf16 v[80:83], v[44:47], a[76:79], v[80:83]
    ds_read_b64_tr_b16 v[52:53], v15 offset:20480
    v_fma_f32 v29, v29, v29, 1.0
    v_mfma_f32_16x16x32_bf16 v[84:87], v[32:35], a[80:83], v[84:87]
    v_fma_f32 v30, v30, v30, 1.0
    v_mfma_f32_16x16x32_bf16 v[84:87], v[36:39], a[84:87], v[84:87]
    ds_read_b64_tr_b16 v[54:55], v15 offset:20992
    s_lshl_b32 s52, s29, 7
    v_rcp_f32 v0, v0
    v_mfma_f32_16x16x32_bf16 v[84:87], v[40:43], a[88:91], v[84:87]
    ds_read_b64_tr_b16 v[56:57], v15 offset:24576
    s_add_u32 s52, s52, 83886080
    v_rcp_f32 v1, v1
    v_mfma_f32_16x16x32_bf16 v[84:87], v[44:47], a[92:95], v[84:87]
    ds_read_b64_tr_b16 v[58:59], v15 offset:25088
    s_lshl_b32 s55, s30, 2
    v_rcp_f32 v29, v29
    v_mfma_f32_16x16x32_bf16 v[88:91], v[32:35], a[96:99], v[88:91]
    s_add_u32 s55, s55, s52
    v_rcp_f32 v30, v30
    v_mfma_f32_16x16x32_bf16 v[88:91], v[36:39], a[100:103], v[88:91]
    ds_read_b64_tr_b16 v[60:61], v15 offset:28672
    v_mov_b32 v25, 1
    v_mul_f32 v0, v0, v220
    v_mfma_f32_16x16x32_bf16 v[88:91], v[40:43], a[104:107], v[88:91]
    ds_read_b64_tr_b16 v[62:63], v15 offset:29184
    v_mov_b32 v26, 0
    v_mul_f32 v1, v1, v221
    v_mfma_f32_16x16x32_bf16 v[88:91], v[44:47], a[108:111], v[88:91]
    v_mul_f32 v29, v29, v222
    v_mfma_f32_16x16x32_bf16 v[92:95], v[32:35], a[112:115], v[92:95]
    v_mul_f32 v30, v30, v223
    v_mfma_f32_16x16x32_bf16 v[92:95], v[36:39], a[116:119], v[92:95]
    v_fma_f32 v220, v0, -2.0, v220
    v_mfma_f32_16x16x32_bf16 v[92:95], v[40:43], a[120:123], v[92:95]
    v_fma_f32 v221, v1, -2.0, v221
    v_mfma_f32_16x16x32_bf16 v[92:95], v[44:47], a[124:127], v[92:95]
    v_fma_f32 v222, v29, -2.0, v222
    s_waitcnt lgkmcnt(4)
    v_mfma_f32_16x16x32_bf16 v[144:147], v[48:51], a[64:67], v[144:147]
    v_fma_f32 v223, v30, -2.0, v223
    s_waitcnt vmcnt(1)
    s_waitcnt vmcnt(19)
    s_barrier
    v_mfma_f32_16x16x32_bf16 v[144:147], v[52:55], a[68:71], v[144:147]
    ds_read_b64_tr_b16 v[32:33], v12 offset:49152
    s_cmp_lg_u32 s28, 0
    s_cbranch_scc1 K2_SIG
    s_mov_b64 exec, 1
    buffer_store_dword v25, v26, s[4:7], s55 offen sc1
    s_mov_b64 exec, -1
K2_SIG:
    v_and_b32 v26, 7, v2
    v_lshlrev_b32 v26, 2, v26
    v_cvt_pk_bf16_f32 v204, v204, v205
    s_waitcnt lgkmcnt(1)
    v_mfma_f32_16x16x32_bf16 v[144:147], v[56:59], a[72:75], v[144:147]
    ds_read_b64_tr_b16 v[34:35], v12 offset:49664
    v_cvt_pk_bf16_f32 v205, v206, v207
    v_mfma_f32_16x16x32_bf16 v[144:147], v[60:63], a[76:79], v[144:147]
    ds_read_b64_tr_b16 v[36:37], v12 offset:53248
    v_cvt_pk_bf16_f32 v206, v220, v221
    v_mfma_f32_16x16x32_bf16 v[148:151], v[48:51], a[80:83], v[148:151]
    v_cvt_pk_bf16_f32 v207, v222, v223
    v_mfma_f32_16x16x32_bf16 v[148:151], v[52:55], a[84:87], v[148:151]
    ds_read_b64_tr_b16 v[38:39], v12 offset:53760
    v_mfma_f32_16x16x32_bf16 v[148:151], v[56:59], a[88:91], v[148:151]
    ds_read_b64_tr_b16 v[40:41], v12 offset:57344
    buffer_store_dwordx4 v[204:207], v3, s[4:7], s42 offen sc1
    v_mul_f32 v0, 0x3fb8aa3b, v224
    v_mul_f32 v1, 0x3fb8aa3b, v225
    v_mfma_f32_16x16x32_bf16 v[148:151], v[60:63], a[92:95], v[148:151]
    ds_read_b64_tr_b16 v[42:43], v12 offset:57856
    v_mul_f32 v29, 0x3fb8aa3b, v226
    v_mfma_f32_16x16x32_bf16 v[152:155], v[48:51], a[96:99], v[152:155]
    v_mul_f32 v30, 0x3fb8aa3b, v227
    v_mfma_f32_16x16x32_bf16 v[152:155], v[52:55], a[100:103], v[152:155]
    ds_read_b64_tr_b16 v[44:45], v12 offset:61440
    v_exp_f32 v0, v0
    v_mfma_f32_16x16x32_bf16 v[152:155], v[56:59], a[104:107], v[152:155]
    ds_read_b64_tr_b16 v[46:47], v12 offset:61952
    v_exp_f32 v1, v1
    v_mfma_f32_16x16x32_bf16 v[152:155], v[60:63], a[108:111], v[152:155]
    v_exp_f32 v29, v29
    v_mfma_f32_16x16x32_bf16 v[156:159], v[48:51], a[112:115], v[156:159]
    v_exp_f32 v30, v30
    v_mfma_f32_16x16x32_bf16 v[156:159], v[52:55], a[116:119], v[156:159]
    v_add_f32 v0, 1.0, v0
    v_mfma_f32_16x16x32_bf16 v[156:159], v[56:59], a[120:123], v[156:159]
    v_add_f32 v1, 1.0, v1
    v_mfma_f32_16x16x32_bf16 v[156:159], v[60:63], a[124:127], v[156:159]
    v_add_f32 v29, 1.0, v29
    s_waitcnt lgkmcnt(4)
    v_mfma_f32_16x16x32_bf16 v[96:99], v[32:35], a[128:131], 0
    v_add_f32 v30, 1.0, v30
    v_mfma_f32_16x16x32_bf16 v[96:99], v[36:39], a[132:135], v[96:99]
    ds_read_b64_tr_b16 v[48:49], v16 offset:49152
    v_fma_f32 v0, v0, v0, 1.0
    s_waitcnt lgkmcnt(1)
    v_mfma_f32_16x16x32_bf16 v[96:99], v[40:43], a[136:139], v[96:99]
    ds_read_b64_tr_b16 v[50:51], v16 offset:49664
    v_fma_f32 v1, v1, v1, 1.0
    v_mfma_f32_16x16x32_bf16 v[96:99], v[44:47], a[140:143], v[96:99]
    ds_read_b64_tr_b16 v[52:53], v16 offset:53248
    v_fma_f32 v29, v29, v29, 1.0
    v_mfma_f32_16x16x32_bf16 v[100:103], v[32:35], a[144:147], 0
    v_fma_f32 v30, v30, v30, 1.0
    v_mfma_f32_16x16x32_bf16 v[100:103], v[36:39], a[148:151], v[100:103]
    ds_read_b64_tr_b16 v[54:55], v16 offset:53760
    v_rcp_f32 v0, v0
    v_mfma_f32_16x16x32_bf16 v[100:103], v[40:43], a[152:155], v[100:103]
    ds_read_b64_tr_b16 v[56:57], v16 offset:57344
    v_rcp_f32 v1, v1
    v_mfma_f32_16x16x32_bf16 v[100:103], v[44:47], a[156:159], v[100:103]
    ds_read_b64_tr_b16 v[58:59], v16 offset:57856
    v_rcp_f32 v29, v29
    v_mfma_f32_16x16x32_bf16 v[104:107], v[32:35], a[160:163], 0
    v_rcp_f32 v30, v30
    v_cvt_pk_bf16_f32 v64, v64, v65
    v_mfma_f32_16x16x32_bf16 v[104:107], v[36:39], a[164:167], v[104:107]
    ds_read_b64_tr_b16 v[60:61], v16 offset:61440
    v_mul_f32 v0, v0, v224
    v_mfma_f32_16x16x32_bf16 v[104:107], v[40:43], a[168:171], v[104:107]
    ds_read_b64_tr_b16 v[62:63], v16 offset:61952
    v_mul_f32 v1, v1, v225
    v_mfma_f32_16x16x32_bf16 v[104:107], v[44:47], a[172:175], v[104:107]
    v_mul_f32 v29, v29, v226
    v_cvt_pk_bf16_f32 v65, v66, v67
    v_mfma_f32_16x16x32_bf16 v[108:111], v[32:35], a[176:179], 0
    v_mul_f32 v30, v30, v227
    v_mfma_f32_16x16x32_bf16 v[108:111], v[36:39], a[180:183], v[108:111]
    v_fma_f32 v224, v0, -2.0, v224
    v_mfma_f32_16x16x32_bf16 v[108:111], v[40:43], a[184:187], v[108:111]
    v_fma_f32 v225, v1, -2.0, v225
    v_mfma_f32_16x16x32_bf16 v[108:111], v[44:47], a[188:191], v[108:111]
    v_fma_f32 v226, v29, -2.0, v226
    v_cvt_pk_bf16_f32 v66, v128, v129
    s_waitcnt lgkmcnt(4)
    v_mfma_f32_16x16x32_bf16 v[96:99], v[48:51], a[192:195], v[96:99]
    v_fma_f32 v227, v30, -2.0, v227
    v_mfma_f32_16x16x32_bf16 v[96:99], v[52:55], a[196:199], v[96:99]
    ds_read_b64_tr_b16 v[32:33], v20 offset:0
    v_mul_f32 v0, 0x3fb8aa3b, v240
    s_waitcnt lgkmcnt(1)
    v_mfma_f32_16x16x32_bf16 v[96:99], v[56:59], a[200:203], v[96:99]
    ds_read_b64_tr_b16 v[34:35], v20 offset:512
    v_mul_f32 v1, 0x3fb8aa3b, v241
    v_mfma_f32_16x16x32_bf16 v[96:99], v[60:63], a[204:207], v[96:99]
    ds_read_b64_tr_b16 v[36:37], v20 offset:4096
    v_mul_f32 v29, 0x3fb8aa3b, v242
    v_cvt_pk_bf16_f32 v67, v130, v131
    v_mfma_f32_16x16x32_bf16 v[100:103], v[48:51], a[208:211], v[100:103]
    v_mul_f32 v30, 0x3fb8aa3b, v243
    v_mfma_f32_16x16x32_bf16 v[100:103], v[52:55], a[212:215], v[100:103]
    ds_read_b64_tr_b16 v[38:39], v20 offset:4608
    v_exp_f32 v0, v0
    v_mfma_f32_16x16x32_bf16 v[100:103], v[56:59], a[216:219], v[100:103]
    ds_read_b64_tr_b16 v[40:41], v20 offset:8192
    v_exp_f32 v1, v1
    v_mfma_f32_16x16x32_bf16 v[100:103], v[60:63], a[220:223], v[100:103]
    ds_read_b64_tr_b16 v[42:43], v20 offset:8704
    v_exp_f32 v29, v29
    v_cvt_pk_bf16_f32 v68, v68, v69
    v_mfma_f32_16x16x32_bf16 v[104:107], v[48:51], a[224:227], v[104:107]
    v_exp_f32 v30, v30
    v_mfma_f32_16x16x32_bf16 v[104:107], v[52:55], a[228:231], v[104:107]
    ds_read_b64_tr_b16 v[44:45], v20 offset:12288
    v_add_f32 v0, 1.0, v0
    v_mfma_f32_16x16x32_bf16 v[104:107], v[56:59], a[232:235], v[104:107]
    ds_read_b64_tr_b16 v[46:47], v20 offset:12800
    v_add_f32 v1, 1.0, v1
    v_cvt_pk_bf16_f32 v69, v70, v71
    v_mfma_f32_16x16x32_bf16 v[104:107], v[60:63], a[236:239], v[104:107]
    v_add_f32 v29, 1.0, v29
    v_mfma_f32_16x16x32_bf16 v[108:111], v[48:51], a[240:243], v[108:111]
    v_add_f32 v30, 1.0, v30
    v_mfma_f32_16x16x32_bf16 v[108:111], v[52:55], a[244:247], v[108:111]
    v_fma_f32 v0, v0, v0, 1.0
    v_fma_f32 v1, v1, v1, 1.0
    v_mfma_f32_16x16x32_bf16 v[108:111], v[56:59], a[248:251], v[108:111]
    v_fma_f32 v29, v29, v29, 1.0
    v_cvt_pk_bf16_f32 v70, v132, v133
    v_mfma_f32_16x16x32_bf16 v[108:111], v[60:63], a[252:255], v[108:111]
    v_fma_f32 v30, v30, v30, 1.0
    s_waitcnt lgkmcnt(4)
    v_mfma_f32_16x16x32_bf16 v[96:99], v[32:35], a[0:3], v[96:99]
    v_rcp_f32 v0, v0
    v_mfma_f32_16x16x32_bf16 v[96:99], v[36:39], a[4:7], v[96:99]
    ds_read_b64_tr_b16 v[48:49], v20 offset:16384
    v_rcp_f32 v1, v1
    s_waitcnt lgkmcnt(1)
    v_mfma_f32_16x16x32_bf16 v[96:99], v[40:43], a[8:11], v[96:99]
    ds_read_b64_tr_b16 v[50:51], v20 offset:16896
    v_rcp_f32 v29, v29
    v_cvt_pk_bf16_f32 v71, v134, v135
    v_mfma_f32_16x16x32_bf16 v[96:99], v[44:47], a[12:15], v[96:99]
    ds_read_b64_tr_b16 v[52:53], v20 offset:20480
    v_rcp_f32 v30, v30
    v_mfma_f32_16x16x32_bf16 v[100:103], v[32:35], a[16:19], v[100:103]
    v_mul_f32 v0, v0, v240
    v_mfma_f32_16x16x32_bf16 v[100:103], v[36:39], a[20:23], v[100:103]
    ds_read_b64_tr_b16 v[54:55], v20 offset:20992
    v_mul_f32 v1, v1, v241
    v_mfma_f32_16x16x32_bf16 v[100:103], v[40:43], a[24:27], v[100:103]
    ds_read_b64_tr_b16 v[56:57], v20 offset:24576
    v_mul_f32 v29, v29, v242
    v_cvt_pk_bf16_f32 v72, v72, v73
    v_mfma_f32_16x16x32_bf16 v[100:103], v[44:47], a[28:31], v[100:103]
    ds_read_b64_tr_b16 v[58:59], v20 offset:25088
    v_mul_f32 v30, v30, v243
    s_barrier
    v_mfma_f32_16x16x32_bf16 v[104:107], v[32:35], a[32:35], v[104:107]
    v_fma_f32 v240, v0, -2.0, v240
    v_mfma_f32_16x16x32_bf16 v[104:107], v[36:39], a[36:39], v[104:107]
    ds_read_b64_tr_b16 v[60:61], v20 offset:28672
    v_fma_f32 v241, v1, -2.0, v241
    v_cvt_pk_bf16_f32 v73, v74, v75
    v_mfma_f32_16x16x32_bf16 v[104:107], v[40:43], a[40:43], v[104:107]
    ds_read_b64_tr_b16 v[62:63], v20 offset:29184
    v_fma_f32 v242, v29, -2.0, v242
    v_mfma_f32_16x16x32_bf16 v[104:107], v[44:47], a[44:47], v[104:107]
    v_fma_f32 v243, v30, -2.0, v243
    v_mfma_f32_16x16x32_bf16 v[108:111], v[32:35], a[48:51], v[108:111]
    v_cvt_pk_bf16_f32 v224, v224, v225
    v_mfma_f32_16x16x32_bf16 v[108:111], v[36:39], a[52:55], v[108:111]
    v_cvt_pk_bf16_f32 v225, v226, v227
    v_cvt_pk_bf16_f32 v74, v136, v137
    v_mfma_f32_16x16x32_bf16 v[108:111], v[40:43], a[56:59], v[108:111]
    v_cvt_pk_bf16_f32 v226, v240, v241
    v_mfma_f32_16x16x32_bf16 v[108:111], v[44:47], a[60:63], v[108:111]
    v_cvt_pk_bf16_f32 v227, v242, v243
    s_waitcnt lgkmcnt(4)
    v_mfma_f32_16x16x32_bf16 v[96:99], v[48:51], a[64:67], v[96:99]
    v_mfma_f32_16x16x32_bf16 v[96:99], v[52:55], a[68:71], v[96:99]
    ds_read_b64_tr_b16 v[32:33], v13 offset:49152
    buffer_store_dwordx4 v[224:227], v3, s[4:7], s37 offen sc1
    v_mul_f32 v0, 0x3fb8aa3b, v228
    v_cvt_pk_bf16_f32 v75, v138, v139
    s_waitcnt lgkmcnt(1)
    v_mfma_f32_16x16x32_bf16 v[96:99], v[56:59], a[72:75], v[96:99]
    ds_read_b64_tr_b16 v[34:35], v13 offset:49664
    v_mul_f32 v1, 0x3fb8aa3b, v229
    v_mfma_f32_16x16x32_bf16 v[96:99], v[60:63], a[76:79], v[96:99]
    ds_read_b64_tr_b16 v[36:37], v13 offset:53248
    v_mul_f32 v29, 0x3fb8aa3b, v230
    v_mfma_f32_16x16x32_bf16 v[100:103], v[48:51], a[80:83], v[100:103]
    v_mul_f32 v30, 0x3fb8aa3b, v231
    v_mfma_f32_16x16x32_bf16 v[100:103], v[52:55], a[84:87], v[100:103]
    ds_read_b64_tr_b16 v[38:39], v13 offset:53760
    v_exp_f32 v0, v0
    v_cvt_pk_bf16_f32 v76, v76, v77
    v_mfma_f32_16x16x32_bf16 v[100:103], v[56:59], a[88:91], v[100:103]
    ds_read_b64_tr_b16 v[40:41], v13 offset:57344
    v_exp_f32 v1, v1
    v_mfma_f32_16x16x32_bf16 v[100:103], v[60:63], a[92:95], v[100:103]
    ds_read_b64_tr_b16 v[42:43], v13 offset:57856
    v_exp_f32 v29, v29
    v_mfma_f32_16x16x32_bf16 v[104:107], v[48:51], a[96:99], v[104:107]
    v_exp_f32 v30, v30
    v_cvt_pk_bf16_f32 v77, v78, v79
    v_mfma_f32_16x16x32_bf16 v[104:107], v[52:55], a[100:103], v[104:107]
    ds_read_b64_tr_b16 v[44:45], v13 offset:61440
    v_add_f32 v0, 1.0, v0
    v_mfma_f32_16x16x32_bf16 v[104:107], v[56:59], a[104:107], v[104:107]
    ds_read_b64_tr_b16 v[46:47], v13 offset:61952
    v_add_f32 v1, 1.0, v1
    v_mfma_f32_16x16x32_bf16 v[104:107], v[60:63], a[108:111], v[104:107]
    v_add_f32 v29, 1.0, v29
    v_mfma_f32_16x16x32_bf16 v[108:111], v[48:51], a[112:115], v[108:111]
    v_add_f32 v30, 1.0, v30
    v_cvt_pk_bf16_f32 v78, v140, v141
    v_mfma_f32_16x16x32_bf16 v[108:111], v[52:55], a[116:119], v[108:111]
    v_fma_f32 v0, v0, v0, 1.0
    v_mfma_f32_16x16x32_bf16 v[108:111], v[56:59], a[120:123], v[108:111]
    v_fma_f32 v1, v1, v1, 1.0
    v_mfma_f32_16x16x32_bf16 v[108:111], v[60:63], a[124:127], v[108:111]
    v_fma_f32 v29, v29, v29, 1.0
    s_waitcnt lgkmcnt(4)
    v_mfma_f32_16x16x32_bf16 v[160:163], v[32:35], a[128:131], 0
    v_fma_f32 v30, v30, v30, 1.0
    v_cvt_pk_bf16_f32 v79, v142, v143
    v_mfma_f32_16x16x32_bf16 v[160:163], v[36:39], a[132:135], v[160:163]
    ds_read_b64_tr_b16 v[48:49], v17 offset:49152
    v_rcp_f32 v0, v0
    s_waitcnt lgkmcnt(1)
    v_mfma_f32_16x16x32_bf16 v[160:163], v[40:43], a[136:139], v[160:163]
    ds_read_b64_tr_b16 v[50:51], v17 offset:49664
    v_rcp_f32 v1, v1
    v_mfma_f32_16x16x32_bf16 v[160:163], v[44:47], a[140:143], v[160:163]
    ds_read_b64_tr_b16 v[52:53], v17 offset:53248
    v_rcp_f32 v29, v29
    v_mfma_f32_16x16x32_bf16 v[164:167], v[32:35], a[144:147], 0
    v_rcp_f32 v30, v30
    v_cvt_pk_bf16_f32 v80, v80, v81
    v_mfma_f32_16x16x32_bf16 v[164:167], v[36:39], a[148:151], v[164:167]
    ds_read_b64_tr_b16 v[54:55], v17 offset:53760
    v_mul_f32 v0, v0, v228
    v_mul_f32 v1, v1, v229
    v_mfma_f32_16x16x32_bf16 v[164:167], v[40:43], a[152:155], v[164:167]
    ds_read_b64_tr_b16 v[56:57], v17 offset:57344
    v_mul_f32 v29, v29, v230
    v_mfma_f32_16x16x32_bf16 v[164:167], v[44:47], a[156:159], v[164:167]
    ds_read_b64_tr_b16 v[58:59], v17 offset:57856
    v_mul_f32 v30, v30, v231
    v_cvt_pk_bf16_f32 v81, v82, v83
    v_mfma_f32_16x16x32_bf16 v[168:171], v[32:35], a[160:163], 0
    v_fma_f32 v228, v0, -2.0, v228
    v_mfma_f32_16x16x32_bf16 v[168:171], v[36:39], a[164:167], v[168:171]
    ds_read_b64_tr_b16 v[60:61], v17 offset:61440
    v_fma_f32 v229, v1, -2.0, v229
    v_mfma_f32_16x16x32_bf16 v[168:171], v[40:43], a[168:171], v[168:171]
    ds_read_b64_tr_b16 v[62:63], v17 offset:61952
    v_fma_f32 v230, v29, -2.0, v230
    v_mfma_f32_16x16x32_bf16 v[168:171], v[44:47], a[172:175], v[168:171]
    v_fma_f32 v231, v30, -2.0, v231
    v_cvt_pk_bf16_f32 v82, v144, v145
    v_mfma_f32_16x16x32_bf16 v[172:175], v[32:35], a[176:179], 0
    v_mul_f32 v0, 0x3fb8aa3b, v244
    v_mfma_f32_16x16x32_bf16 v[172:175], v[36:39], a[180:183], v[172:175]
    v_mul_f32 v1, 0x3fb8aa3b, v245
    v_mfma_f32_16x16x32_bf16 v[172:175], v[40:43], a[184:187], v[172:175]
    v_mul_f32 v29, 0x3fb8aa3b, v246
    v_mfma_f32_16x16x32_bf16 v[172:175], v[44:47], a[188:191], v[172:175]
    v_mul_f32 v30, 0x3fb8aa3b, v247
    v_cvt_pk_bf16_f32 v83, v146, v147
    s_waitcnt lgkmcnt(4)
    v_mfma_f32_16x16x32_bf16 v[160:163], v[48:51], a[192:195], v[160:163]
    v_exp_f32 v0, v0
    v_mfma_f32_16x16x32_bf16 v[160:163], v[52:55], a[196:199], v[160:163]
    ds_read_b64_tr_b16 v[32:33], v21 offset:0
    v_exp_f32 v1, v1
    s_waitcnt lgkmcnt(1)
    v_mfma_f32_16x16x32_bf16 v[160:163], v[56:59], a[200:203], v[160:163]
    ds_read_b64_tr_b16 v[34:35], v21 offset:512
    v_exp_f32 v29, v29
    v_mfma_f32_16x16x32_bf16 v[160:163], v[60:63], a[204:207], v[160:163]
    ds_read_b64_tr_b16 v[36:37], v21 offset:4096
    v_exp_f32 v30, v30
    v_cvt_pk_bf16_f32 v84, v84, v85
    v_mfma_f32_16x16x32_bf16 v[164:167], v[48:51], a[208:211], v[164:167]
    v_add_f32 v0, 1.0, v0
    v_mfma_f32_16x16x32_bf16 v[164:167], v[52:55], a[212:215], v[164:167]
    ds_read_b64_tr_b16 v[38:39], v21 offset:4608
    v_add_f32 v1, 1.0, v1
    v_mfma_f32_16x16x32_bf16 v[164:167], v[56:59], a[216:219], v[164:167]
    ds_read_b64_tr_b16 v[40:41], v21 offset:8192
    v_add_f32 v29, 1.0, v29
    v_cvt_pk_bf16_f32 v85, v86, v87
    v_mfma_f32_16x16x32_bf16 v[164:167], v[60:63], a[220:223], v[164:167]
    ds_read_b64_tr_b16 v[42:43], v21 offset:8704
    v_add_f32 v30, 1.0, v30
    v_mfma_f32_16x16x32_bf16 v[168:171], v[48:51], a[224:227], v[168:171]
    buffer_load_dword v25, v26, s[4:7], s52 offen sc1
    v_fma_f32 v0, v0, v0, 1.0
    v_mfma_f32_16x16x32_bf16 v[168:171], v[52:55], a[228:231], v[168:171]
    ds_read_b64_tr_b16 v[44:45], v21 offset:12288
    v_fma_f32 v1, v1, v1, 1.0
    v_mfma_f32_16x16x32_bf16 v[168:171], v[56:59], a[232:235], v[168:171]
    ds_read_b64_tr_b16 v[46:47], v21 offset:12800
    v_fma_f32 v29, v29, v29, 1.0
    v_cvt_pk_bf16_f32 v86, v148, v149
    v_mfma_f32_16x16x32_bf16 v[168:171], v[60:63], a[236:239], v[168:171]
    v_fma_f32 v30, v30, v30, 1.0
    v_mfma_f32_16x16x32_bf16 v[172:175], v[48:51], a[240:243], v[172:175]
    v_rcp_f32 v0, v0
    v_mfma_f32_16x16x32_bf16 v[172:175], v[52:55], a[244:247], v[172:175]
    v_rcp_f32 v1, v1
    v_mfma_f32_16x16x32_bf16 v[172:175], v[56:59], a[248:251], v[172:175]
    v_rcp_f32 v29, v29
    v_cvt_pk_bf16_f32 v87, v150, v151
    v_mfma_f32_16x16x32_bf16 v[172:175], v[60:63], a[252:255], v[172:175]
    v_rcp_f32 v30, v30
    s_waitcnt lgkmcnt(4)
    v_mfma_f32_16x16x32_bf16 v[160:163], v[32:35], a[0:3], v[160:163]
    v_mul_f32 v0, v0, v244
    v_mfma_f32_16x16x32_bf16 v[160:163], v[36:39], a[4:7], v[160:163]
    ds_read_b64_tr_b16 v[48:49], v21 offset:16384
    v_mul_f32 v1, v1, v245
    s_waitcnt lgkmcnt(1)
    v_mfma_f32_16x16x32_bf16 v[160:163], v[40:43], a[8:11], v[160:163]
    ds_read_b64_tr_b16 v[50:51], v21 offset:16896
    v_mul_f32 v29, v29, v246
    v_cvt_pk_bf16_f32 v88, v88, v89
    v_mfma_f32_16x16x32_bf16 v[160:163], v[44:47], a[12:15], v[160:163]
    ds_read_b64_tr_b16 v[52:53], v21 offset:20480
    v_mul_f32 v30, v30, v247
    v_mfma_f32_16x16x32_bf16 v[164:167], v[32:35], a[16:19], v[164:167]
    v_fma_f32 v244, v0, -2.0, v244
    v_mfma_f32_16x16x32_bf16 v[164:167], v[36:39], a[20:23], v[164:167]
    ds_read_b64_tr_b16 v[54:55], v21 offset:20992
    v_fma_f32 v245, v1, -2.0, v245
    v_cvt_pk_bf16_f32 v89, v90, v91
    v_mfma_f32_16x16x32_bf16 v[164:167], v[40:43], a[24:27], v[164:167]
    ds_read_b64_tr_b16 v[56:57], v21 offset:24576
    v_fma_f32 v246, v29, -2.0, v246
    v_mfma_f32_16x16x32_bf16 v[164:167], v[44:47], a[28:31], v[164:167]
    ds_read_b64_tr_b16 v[58:59], v21 offset:25088
    v_fma_f32 v247, v30, -2.0, v247
    v_mfma_f32_16x16x32_bf16 v[168:171], v[32:35], a[32:35], v[168:171]
    v_cvt_pk_bf16_f32 v228, v228, v229
    v_mfma_f32_16x16x32_bf16 v[168:171], v[36:39], a[36:39], v[168:171]
    ds_read_b64_tr_b16 v[60:61], v21 offset:28672
    v_cvt_pk_bf16_f32 v229, v230, v231
    v_cvt_pk_bf16_f32 v90, v152, v153
    v_mfma_f32_16x16x32_bf16 v[168:171], v[40:43], a[40:43], v[168:171]
    ds_read_b64_tr_b16 v[62:63], v21 offset:29184
    v_cvt_pk_bf16_f32 v230, v244, v245
    v_mfma_f32_16x16x32_bf16 v[168:171], v[44:47], a[44:47], v[168:171]
    v_cvt_pk_bf16_f32 v231, v246, v247
    v_mfma_f32_16x16x32_bf16 v[172:175], v[32:35], a[48:51], v[172:175]
    v_mfma_f32_16x16x32_bf16 v[172:175], v[36:39], a[52:55], v[172:175]
    buffer_store_dwordx4 v[228:231], v3, s[4:7], s39 offen sc1
    v_mul_f32 v0, 0x3fb8aa3b, v232
    v_mul_f32 v1, 0x3fb8aa3b, v233
    v_cvt_pk_bf16_f32 v91, v154, v155
    v_mfma_f32_16x16x32_bf16 v[172:175], v[40:43], a[56:59], v[172:175]
    v_mul_f32 v29, 0x3fb8aa3b, v234
    v_mfma_f32_16x16x32_bf16 v[172:175], v[44:47], a[60:63], v[172:175]
    v_mul_f32 v30, 0x3fb8aa3b, v235
    s_waitcnt lgkmcnt(4)
    v_mfma_f32_16x16x32_bf16 v[160:163], v[48:51], a[64:67], v[160:163]
    v_exp_f32 v0, v0
    v_mfma_f32_16x16x32_bf16 v[160:163], v[52:55], a[68:71], v[160:163]
    ds_read_b64_tr_b16 v[32:33], v14 offset:49152
    v_exp_f32 v1, v1
    v_cvt_pk_bf16_f32 v92, v92, v93
    s_waitcnt lgkmcnt(1)
    v_mfma_f32_16x16x32_bf16 v[160:163], v[56:59], a[72:75], v[160:163]
    ds_read_b64_tr_b16 v[34:35], v14 offset:49664
    v_exp_f32 v29, v29
    v_mfma_f32_16x16x32_bf16 v[160:163], v[60:63], a[76:79], v[160:163]
    ds_read_b64_tr_b16 v[36:37], v14 offset:53248
    v_exp_f32 v30, v30
    v_mfma_f32_16x16x32_bf16 v[164:167], v[48:51], a[80:83], v[164:167]
    v_add_f32 v0, 1.0, v0
    v_cvt_pk_bf16_f32 v93, v94, v95
    v_mfma_f32_16x16x32_bf16 v[164:167], v[52:55], a[84:87], v[164:167]
    ds_read_b64_tr_b16 v[38:39], v14 offset:53760
    v_add_f32 v1, 1.0, v1
    v_mfma_f32_16x16x32_bf16 v[164:167], v[56:59], a[88:91], v[164:167]
    ds_read_b64_tr_b16 v[40:41], v14 offset:57344
    v_add_f32 v29, 1.0, v29
    v_mfma_f32_16x16x32_bf16 v[164:167], v[60:63], a[92:95], v[164:167]
    ds_read_b64_tr_b16 v[42:43], v14 offset:57856
    v_add_f32 v30, 1.0, v30
    v_mfma_f32_16x16x32_bf16 v[168:171], v[48:51], a[96:99], v[168:171]
    v_fma_f32 v0, v0, v0, 1.0
    v_cvt_pk_bf16_f32 v94, v156, v157
    v_mfma_f32_16x16x32_bf16 v[168:171], v[52:55], a[100:103], v[168:171]
    ds_read_b64_tr_b16 v[44:45], v14 offset:61440
    v_fma_f32 v1, v1, v1, 1.0
    v_mfma_f32_16x16x32_bf16 v[168:171], v[56:59], a[104:107], v[168:171]
    ds_read_b64_tr_b16 v[46:47], v14 offset:61952
    v_fma_f32 v29, v29, v29, 1.0
    v_mfma_f32_16x16x32_bf16 v[168:171], v[60:63], a[108:111], v[168:171]
    v_fma_f32 v30, v30, v30, 1.0
    v_mfma_f32_16x16x32_bf16 v[172:175], v[48:51], a[112:115], v[172:175]
    v_rcp_f32 v0, v0
    v_cvt_pk_bf16_f32 v95, v158, v159
    v_mfma_f32_16x16x32_bf16 v[172:175], v[52:55], a[116:119], v[172:175]
    v_rcp_f32 v1, v1
    v_mfma_f32_16x16x32_bf16 v[172:175], v[56:59], a[120:123], v[172:175]
    v_rcp_f32 v29, v29
    v_mfma_f32_16x16x32_bf16 v[172:175], v[60:63], a[124:127], v[172:175]
    v_rcp_f32 v30, v30
    s_waitcnt lgkmcnt(4)
    s_waitcnt vmcnt(1)
    v_cmp_ne_u32 vcc, 1, v25
    s_cbranch_vccnz K2_KVSPIN_E
K2_KVOK:
    v_mfma_f32_16x16x32_bf16 v[112:115], v[32:35], a[128:131], 0
    s_lshl_b32 s47, s28, 12
    s_add_u32 m0, s47, 0
    v_mul_f32 v0, v0, v232
    v_mfma_f32_16x16x32_bf16 v[112:115], v[36:39], a[132:135], v[112:115]
    ds_read_b64_tr_b16 v[48:49], v18 offset:49152
    s_mov_b32 s47, 0
    v_mul_f32 v1, v1, v233
    s_waitcnt lgkmcnt(1)
    v_mfma_f32_16x16x32_bf16 v[112:115], v[40:43], a[136:139], v[112:115]
    ds_read_b64_tr_b16 v[50:51], v18 offset:49664
    buffer_load_dwordx4 v24, s[16:19], s47 offen offset:0 sc1 lds
    v_mul_f32 v29, v29, v234
    v_mfma_f32_16x16x32_bf16 v[112:115], v[44:47], a[140:143], v[112:115]
    ds_read_b64_tr_b16 v[52:53], v18 offset:53248
    v_mul_f32 v30, v30, v235
    v_mfma_f32_16x16x32_bf16 v[116:119], v[32:35], a[144:147], 0
    v_fma_f32 v232, v0, -2.0, v232
    v_mfma_f32_16x16x32_bf16 v[116:119], v[36:39], a[148:151], v[116:119]
    ds_read_b64_tr_b16 v[54:55], v18 offset:53760
    v_fma_f32 v233, v1, -2.0, v233
    v_mfma_f32_16x16x32_bf16 v[116:119], v[40:43], a[152:155], v[116:119]
    ds_read_b64_tr_b16 v[56:57], v18 offset:57344
    buffer_load_dwordx4 v24, s[16:19], s47 offen offset:1024 sc1 lds
    v_fma_f32 v234, v29, -2.0, v234
    v_mfma_f32_16x16x32_bf16 v[116:119], v[44:47], a[156:159], v[116:119]
    ds_read_b64_tr_b16 v[58:59], v18 offset:57856
    v_fma_f32 v235, v30, -2.0, v235
    v_mfma_f32_16x16x32_bf16 v[120:123], v[32:35], a[160:163], 0
    v_mul_f32 v0, 0x3fb8aa3b, v248
    v_cvt_pk_bf16_f32 v104, v104, v105
    v_mfma_f32_16x16x32_bf16 v[120:123], v[36:39], a[164:167], v[120:123]
    ds_read_b64_tr_b16 v[60:61], v18 offset:61440
    v_mul_f32 v1, 0x3fb8aa3b, v249
    v_mfma_f32_16x16x32_bf16 v[120:123], v[40:43], a[168:171], v[120:123]
    ds_read_b64_tr_b16 v[62:63], v18 offset:61952
    buffer_load_dwordx4 v24, s[16:19], s47 offen offset:2048 sc1 lds
    v_mul_f32 v29, 0x3fb8aa3b, v250
    v_mfma_f32_16x16x32_bf16 v[120:123], v[44:47], a[172:175], v[120:123]
    v_mul_f32 v30, 0x3fb8aa3b, v251
    v_mfma_f32_16x16x32_bf16 v[124:127], v[32:35], a[176:179], 0
    v_exp_f32 v0, v0
    v_cvt_pk_bf16_f32 v105, v106, v107
    v_mfma_f32_16x16x32_bf16 v[124:127], v[36:39], a[180:183], v[124:127]
    v_exp_f32 v1, v1
    v_mfma_f32_16x16x32_bf16 v[124:127], v[40:43], a[184:187], v[124:127]
    buffer_load_dwordx4 v24, s[16:19], s47 offen offset:3072 sc1 lds
    v_exp_f32 v29, v29
    v_mfma_f32_16x16x32_bf16 v[124:127], v[44:47], a[188:191], v[124:127]
    s_lshl_b32 s47, s28, 12
    v_exp_f32 v30, v30
    s_waitcnt lgkmcnt(4)
    v_mfma_f32_16x16x32_bf16 v[112:115], v[48:51], a[192:195], v[112:115]
    s_add_u32 m0, s47, 65536
    v_add_f32 v0, 1.0, v0
    v_cvt_pk_bf16_f32 v106, v168, v169
    v_mfma_f32_16x16x32_bf16 v[112:115], v[52:55], a[196:199], v[112:115]
    ds_read_b64_tr_b16 v[32:33], v22 offset:0
    s_mov_b32 s47, 0
    v_add_f32 v1, 1.0, v1
    s_waitcnt lgkmcnt(1)
    v_mfma_f32_16x16x32_bf16 v[112:115], v[56:59], a[200:203], v[112:115]
    ds_read_b64_tr_b16 v[34:35], v22 offset:512
    buffer_load_dwordx4 v24, s[20:23], s47 offen offset:0 sc1 lds
    v_add_f32 v29, 1.0, v29
    v_mfma_f32_16x16x32_bf16 v[112:115], v[60:63], a[204:207], v[112:115]
    ds_read_b64_tr_b16 v[36:37], v22 offset:4096
    v_add_f32 v30, 1.0, v30
    v_mfma_f32_16x16x32_bf16 v[116:119], v[48:51], a[208:211], v[116:119]
    v_fma_f32 v0, v0, v0, 1.0
    v_fma_f32 v1, v1, v1, 1.0
    v_cvt_pk_bf16_f32 v107, v170, v171
    v_mfma_f32_16x16x32_bf16 v[116:119], v[52:55], a[212:215], v[116:119]
    ds_read_b64_tr_b16 v[38:39], v22 offset:4608
    v_fma_f32 v29, v29, v29, 1.0
    v_mfma_f32_16x16x32_bf16 v[116:119], v[56:59], a[216:219], v[116:119]
    ds_read_b64_tr_b16 v[40:41], v22 offset:8192
    buffer_load_dwordx4 v24, s[20:23], s47 offen offset:1024 sc1 lds
    v_fma_f32 v30, v30, v30, 1.0
    v_mfma_f32_16x16x32_bf16 v[116:119], v[60:63], a[220:223], v[116:119]
    ds_read_b64_tr_b16 v[42:43], v22 offset:8704
    v_rcp_f32 v0, v0
    v_mfma_f32_16x16x32_bf16 v[120:123], v[48:51], a[224:227], v[120:123]
    v_rcp_f32 v1, v1
    v_mfma_f32_16x16x32_bf16 v[120:123], v[52:55], a[228:231], v[120:123]
    ds_read_b64_tr_b16 v[44:45], v22 offset:12288
    v_rcp_f32 v29, v29
    v_cvt_pk_bf16_f32 v108, v108, v109
    v_mfma_f32_16x16x32_bf16 v[120:123], v[56:59], a[232:235], v[120:123]
    ds_read_b64_tr_b16 v[46:47], v22 offset:12800
    buffer_load_dwordx4 v24, s[20:23], s47 offen offset:2048 sc1 lds
    v_rcp_f32 v30, v30
    v_mfma_f32_16x16x32_bf16 v[120:123], v[60:63], a[236:239], v[120:123]
    v_mul_f32 v0, v0, v248
    v_mfma_f32_16x16x32_bf16 v[124:127], v[48:51], a[240:243], v[124:127]
    v_mul_f32 v1, v1, v249
    v_mfma_f32_16x16x32_bf16 v[124:127], v[52:55], a[244:247], v[124:127]
    v_mul_f32 v29, v29, v250
    v_cvt_pk_bf16_f32 v109, v110, v111
    v_mfma_f32_16x16x32_bf16 v[124:127], v[56:59], a[248:251], v[124:127]
    buffer_load_dwordx4 v24, s[20:23], s47 offen offset:3072 sc1 lds
    v_mul_f32 v30, v30, v251
    v_mfma_f32_16x16x32_bf16 v[124:127], v[60:63], a[252:255], v[124:127]
    s_lshl_b32 s47, s28, 12
    v_fma_f32 v248, v0, -2.0, v248
    s_waitcnt lgkmcnt(4)
    v_mfma_f32_16x16x32_bf16 v[112:115], v[32:35], a[0:3], v[112:115]
    s_add_u32 m0, s47, 16384
    v_fma_f32 v249, v1, -2.0, v249
    v_mfma_f32_16x16x32_bf16 v[112:115], v[36:39], a[4:7], v[112:115]
    ds_read_b64_tr_b16 v[48:49], v22 offset:16384
    s_mov_b32 s47, 16384
    v_fma_f32 v250, v29, -2.0, v250
    v_cvt_pk_bf16_f32 v110, v172, v173
    s_waitcnt lgkmcnt(1)
    v_mfma_f32_16x16x32_bf16 v[112:115], v[40:43], a[8:11], v[112:115]
    ds_read_b64_tr_b16 v[50:51], v22 offset:16896
    buffer_load_dwordx4 v24, s[16:19], s47 offen offset:0 sc1 lds
    v_fma_f32 v251, v30, -2.0, v251
    v_mfma_f32_16x16x32_bf16 v[112:115], v[44:47], a[12:15], v[112:115]
    ds_read_b64_tr_b16 v[52:53], v22 offset:20480
    v_cvt_pk_bf16_f32 v232, v232, v233
    v_mfma_f32_16x16x32_bf16 v[116:119], v[32:35], a[16:19], v[116:119]
    v_cvt_pk_bf16_f32 v233, v234, v235
    v_mfma_f32_16x16x32_bf16 v[116:119], v[36:39], a[20:23], v[116:119]
    ds_read_b64_tr_b16 v[54:55], v22 offset:20992
    v_cvt_pk_bf16_f32 v234, v248, v249
    v_cvt_pk_bf16_f32 v111, v174, v175
    v_mfma_f32_16x16x32_bf16 v[116:119], v[40:43], a[24:27], v[116:119]
    ds_read_b64_tr_b16 v[56:57], v22 offset:24576
    buffer_load_dwordx4 v24, s[16:19], s47 offen offset:1024 sc1 lds
    v_cvt_pk_bf16_f32 v235, v250, v251
    v_mfma_f32_16x16x32_bf16 v[116:119], v[44:47], a[28:31], v[116:119]
    ds_read_b64_tr_b16 v[58:59], v22 offset:25088
    v_mfma_f32_16x16x32_bf16 v[120:123], v[32:35], a[32:35], v[120:123]
    buffer_store_dwordx4 v[232:235], v3, s[4:7], s41 offen sc1
    v_mul_f32 v0, 0x3fb8aa3b, v236
    v_mfma_f32_16x16x32_bf16 v[120:123], v[36:39], a[36:39], v[120:123]
    ds_read_b64_tr_b16 v[60:61], v22 offset:28672
    v_mul_f32 v1, 0x3fb8aa3b, v237
    v_mfma_f32_16x16x32_bf16 v[120:123], v[40:43], a[40:43], v[120:123]
    ds_read_b64_tr_b16 v[62:63], v22 offset:29184
    buffer_load_dwordx4 v24, s[16:19], s47 offen offset:2048 sc1 lds
    v_mul_f32 v29, 0x3fb8aa3b, v238
    v_cvt_pk_bf16_f32 v96, v96, v97
    v_mfma_f32_16x16x32_bf16 v[120:123], v[44:47], a[44:47], v[120:123]
    v_mul_f32 v30, 0x3fb8aa3b, v239
    v_mfma_f32_16x16x32_bf16 v[124:127], v[32:35], a[48:51], v[124:127]
    v_exp_f32 v0, v0
    v_mfma_f32_16x16x32_bf16 v[124:127], v[36:39], a[52:55], v[124:127]
    v_exp_f32 v1, v1
    v_mfma_f32_16x16x32_bf16 v[124:127], v[40:43], a[56:59], v[124:127]
    buffer_load_dwordx4 v24, s[16:19], s47 offen offset:3072 sc1 lds
    v_exp_f32 v29, v29
    v_cvt_pk_bf16_f32 v97, v98, v99
    v_mfma_f32_16x16x32_bf16 v[124:127], v[44:47], a[60:63], v[124:127]
    s_lshl_b32 s47, s28, 12
    v_exp_f32 v30, v30
    s_waitcnt lgkmcnt(4)
    v_mfma_f32_16x16x32_bf16 v[112:115], v[48:51], a[64:67], v[112:115]
    s_add_u32 m0, s47, 32768
    v_add_f32 v0, 1.0, v0
    v_mfma_f32_16x16x32_bf16 v[112:115], v[52:55], a[68:71], v[112:115]
    ds_read_b64_tr_b16 v[32:33], v15 offset:49152
    s_mov_b32 s47, 32768
    v_add_f32 v1, 1.0, v1
    s_waitcnt lgkmcnt(1)
    v_mfma_f32_16x16x32_bf16 v[112:115], v[56:59], a[72:75], v[112:115]
    ds_read_b64_tr_b16 v[34:35], v15 offset:49664
    buffer_load_dwordx4 v24, s[16:19], s47 offen offset:0 sc1 lds
    v_add_f32 v29, 1.0, v29
    v_cvt_pk_bf16_f32 v98, v160, v161
    v_mfma_f32_16x16x32_bf16 v[112:115], v[60:63], a[76:79], v[112:115]
    ds_read_b64_tr_b16 v[36:37], v15 offset:53248
    v_add_f32 v30, 1.0, v30
    v_mfma_f32_16x16x32_bf16 v[116:119], v[48:51], a[80:83], v[116:119]
    v_fma_f32 v0, v0, v0, 1.0
    v_mfma_f32_16x16x32_bf16 v[116:119], v[52:55], a[84:87], v[116:119]
    ds_read_b64_tr_b16 v[38:39], v15 offset:53760
    v_fma_f32 v1, v1, v1, 1.0
    v_mfma_f32_16x16x32_bf16 v[116:119], v[56:59], a[88:91], v[116:119]
    ds_read_b64_tr_b16 v[40:41], v15 offset:57344
    buffer_load_dwordx4 v24, s[16:19], s47 offen offset:1024 sc1 lds
    v_fma_f32 v29, v29, v29, 1.0
    v_cvt_pk_bf16_f32 v99, v162, v163
    v_mfma_f32_16x16x32_bf16 v[116:119], v[60:63], a[92:95], v[116:119]
    ds_read_b64_tr_b16 v[42:43], v15 offset:57856
    v_fma_f32 v30, v30, v30, 1.0
    v_mfma_f32_16x16x32_bf16 v[120:123], v[48:51], a[96:99], v[120:123]
    v_rcp_f32 v0, v0
    v_mfma_f32_16x16x32_bf16 v[120:123], v[52:55], a[100:103], v[120:123]
    ds_read_b64_tr_b16 v[44:45], v15 offset:61440
    v_rcp_f32 v1, v1
    v_mfma_f32_16x16x32_bf16 v[120:123], v[56:59], a[104:107], v[120:123]
    ds_read_b64_tr_b16 v[46:47], v15 offset:61952
    buffer_load_dwordx4 v24, s[16:19], s47 offen offset:2048 sc1 lds
    v_rcp_f32 v29, v29
    v_mfma_f32_16x16x32_bf16 v[120:123], v[60:63], a[108:111], v[120:123]
    v_rcp_f32 v30, v30
    v_cvt_pk_bf16_f32 v100, v100, v101
    v_mfma_f32_16x16x32_bf16 v[124:127], v[48:51], a[112:115], v[124:127]
    v_mul_f32 v0, v0, v236
    v_mul_f32 v1, v1, v237
    v_mfma_f32_16x16x32_bf16 v[124:127], v[52:55], a[116:119], v[124:127]
    v_mul_f32 v29, v29, v238
    v_mfma_f32_16x16x32_bf16 v[124:127], v[56:59], a[120:123], v[124:127]
    buffer_load_dwordx4 v24, s[16:19], s47 offen offset:3072 sc1 lds
    v_mul_f32 v30, v30, v239
    v_mfma_f32_16x16x32_bf16 v[124:127], v[60:63], a[124:127], v[124:127]
    s_lshl_b32 s47, s28, 12
    v_fma_f32 v236, v0, -2.0, v236
    v_cvt_pk_bf16_f32 v101, v102, v103
    s_waitcnt lgkmcnt(4)
    v_mfma_f32_16x16x32_bf16 v[176:179], v[32:35], a[128:131], 0
    s_add_u32 m0, s47, 81920
    v_fma_f32 v237, v1, -2.0, v237
    v_mfma_f32_16x16x32_bf16 v[176:179], v[36:39], a[132:135], v[176:179]
    ds_read_b64_tr_b16 v[48:49], v19 offset:49152
    s_mov_b32 s47, 16384
    v_fma_f32 v238, v29, -2.0, v238
    s_waitcnt lgkmcnt(1)
    v_mfma_f32_16x16x32_bf16 v[176:179], v[40:43], a[136:139], v[176:179]
    ds_read_b64_tr_b16 v[50:51], v19 offset:49664
    buffer_load_dwordx4 v24, s[20:23], s47 offen offset:0 sc1 lds
    v_fma_f32 v239, v30, -2.0, v239
    v_mfma_f32_16x16x32_bf16 v[176:179], v[44:47], a[140:143], v[176:179]
    ds_read_b64_tr_b16 v[52:53], v19 offset:53248
    v_mul_f32 v0, 0x3fb8aa3b, v252
    v_cvt_pk_bf16_f32 v102, v164, v165
    v_mfma_f32_16x16x32_bf16 v[180:183], v[32:35], a[144:147], 0
    v_mul_f32 v1, 0x3fb8aa3b, v253
    v_mfma_f32_16x16x32_bf16 v[180:183], v[36:39], a[148:151], v[180:183]
    ds_read_b64_tr_b16 v[54:55], v19 offset:53760
    v_mul_f32 v29, 0x3fb8aa3b, v254
    v_mfma_f32_16x16x32_bf16 v[180:183], v[40:43], a[152:155], v[180:183]
    ds_read_b64_tr_b16 v[56:57], v19 offset:57344
    buffer_load_dwordx4 v24, s[20:23], s47 offen offset:1024 sc1 lds
    v_mul_f32 v30, 0x3fb8aa3b, v255
    v_mfma_f32_16x16x32_bf16 v[180:183], v[44:47], a[156:159], v[180:183]
    ds_read_b64_tr_b16 v[58:59], v19 offset:57856
    v_exp_f32 v0, v0
    v_cvt_pk_bf16_f32 v103, v166, v167
    v_mfma_f32_16x16x32_bf16 v[184:187], v[32:35], a[160:163], 0
    v_exp_f32 v1, v1
    v_mfma_f32_16x16x32_bf16 v[184:187], v[36:39], a[164:167], v[184:187]
    ds_read_b64_tr_b16 v[60:61], v19 offset:61440
    v_exp_f32 v29, v29
    v_mfma_f32_16x16x32_bf16 v[184:187], v[40:43], a[168:171], v[184:187]
    ds_read_b64_tr_b16 v[62:63], v19 offset:61952
    buffer_load_dwordx4 v24, s[20:23], s47 offen offset:2048 sc1 lds
    v_exp_f32 v30, v30
    v_mfma_f32_16x16x32_bf16 v[184:187], v[44:47], a[172:175], v[184:187]
    v_add_f32 v0, 1.0, v0
    v_mfma_f32_16x16x32_bf16 v[188:191], v[32:35], a[176:179], 0
    v_add_f32 v1, 1.0, v1
    v_mfma_f32_16x16x32_bf16 v[188:191], v[36:39], a[180:183], v[188:191]
    v_add_f32 v29, 1.0, v29
    v_mfma_f32_16x16x32_bf16 v[188:191], v[40:43], a[184:187], v[188:191]
    buffer_load_dwordx4 v24, s[20:23], s47 offen offset:3072 sc1 lds
    v_add_f32 v30, 1.0, v30
    v_mfma_f32_16x16x32_bf16 v[188:191], v[44:47], a[188:191], v[188:191]
    s_lshl_b32 s47, s28, 12
    v_fma_f32 v0, v0, v0, 1.0
    s_waitcnt lgkmcnt(4)
    v_mfma_f32_16x16x32_bf16 v[176:179], v[48:51], a[192:195], v[176:179]
    s_add_u32 m0, s47, 98304
    v_fma_f32 v1, v1, v1, 1.0
    v_mfma_f32_16x16x32_bf16 v[176:179], v[52:55], a[196:199], v[176:179]
    ds_read_b64_tr_b16 v[32:33], v23 offset:0
    s_mov_b32 s47, 32768
    v_fma_f32 v29, v29, v29, 1.0
    s_waitcnt lgkmcnt(1)
    s_waitcnt vmcnt(17) lgkmcnt(0)
    s_barrier
    v_mfma_f32_16x16x32_bf16 v[176:179], v[56:59], a[200:203], v[176:179]
    ds_read_b64_tr_b16 v[34:35], v23 offset:512
    buffer_load_dwordx4 v24, s[20:23], s47 offen offset:0 sc1 lds
    v_fma_f32 v30, v30, v30, 1.0
    v_mfma_f32_16x16x32_bf16 v[176:179], v[60:63], a[204:207], v[176:179]
    ds_read_b64_tr_b16 v[36:37], v23 offset:4096
    v_rcp_f32 v0, v0
    v_mfma_f32_16x16x32_bf16 v[180:183], v[48:51], a[208:211], v[180:183]
    ds_read_b128 a[128:131], v3 offset:0
    v_rcp_f32 v1, v1
    v_mfma_f32_16x16x32_bf16 v[180:183], v[52:55], a[212:215], v[180:183]
    ds_read_b64_tr_b16 v[38:39], v23 offset:4608
    ds_write_b128 v5, v[72:75] offset:0
    v_rcp_f32 v29, v29
    v_mfma_f32_16x16x32_bf16 v[180:183], v[56:59], a[216:219], v[180:183]
    ds_read_b64_tr_b16 v[40:41], v23 offset:8192
    buffer_load_dwordx4 v24, s[20:23], s47 offen offset:1024 sc1 lds
    ds_read_b128 a[132:135], v3 offset:1024
    v_rcp_f32 v30, v30
    v_mfma_f32_16x16x32_bf16 v[180:183], v[60:63], a[220:223], v[180:183]
    ds_read_b64_tr_b16 v[42:43], v23 offset:8704
    v_mul_f32 v0, v0, v252
    v_mfma_f32_16x16x32_bf16 v[184:187], v[48:51], a[224:227], v[184:187]
    ds_read_b128 a[136:139], v3 offset:2048
    v_mul_f32 v1, v1, v253
    v_mfma_f32_16x16x32_bf16 v[184:187], v[52:55], a[228:231], v[184:187]
    ds_read_b64_tr_b16 v[44:45], v23 offset:12288
    ds_write_b128 v5, v[76:79] offset:1024
    v_mul_f32 v29, v29, v254
    v_mfma_f32_16x16x32_bf16 v[184:187], v[56:59], a[232:235], v[184:187]
    ds_read_b64_tr_b16 v[46:47], v23 offset:12800
    buffer_load_dwordx4 v24, s[20:23], s47 offen offset:2048 sc1 lds
    ds_read_b128 a[140:143], v3 offset:3072
    v_mul_f32 v30, v30, v255
    v_mfma_f32_16x16x32_bf16 v[184:187], v[60:63], a[236:239], v[184:187]
    v_fma_f32 v252, v0, -2.0, v252
    v_mfma_f32_16x16x32_bf16 v[188:191], v[48:51], a[240:243], v[188:191]
    ds_read_b128 a[144:147], v3 offset:4096
    v_fma_f32 v253, v1, -2.0, v253
    v_mfma_f32_16x16x32_bf16 v[188:191], v[52:55], a[244:247], v[188:191]
    ds_write_b128 v5, v[88:91] offset:2048
    v_fma_f32 v254, v29, -2.0, v254
    v_mfma_f32_16x16x32_bf16 v[188:191], v[56:59], a[248:251], v[188:191]
    buffer_load_dwordx4 v24, s[20:23], s47 offen offset:3072 sc1 lds
    ds_read_b128 a[148:151], v3 offset:5120
    v_fma_f32 v255, v30, -2.0, v255
    v_mfma_f32_16x16x32_bf16 v[188:191], v[60:63], a[252:255], v[188:191]
    v_cvt_pk_bf16_f32 v236, v236, v237
    s_waitcnt lgkmcnt(12)
    v_mfma_f32_16x16x32_bf16 v[176:179], v[32:35], a[0:3], v[176:179]
    ds_read_b128 a[152:155], v3 offset:6144
    v_cvt_pk_bf16_f32 v237, v238, v239
    v_mfma_f32_16x16x32_bf16 v[176:179], v[36:39], a[4:7], v[176:179]
    ds_read_b64_tr_b16 v[48:49], v23 offset:16384
    ds_write_b128 v5, v[92:95] offset:3072
    v_cvt_pk_bf16_f32 v238, v252, v253
    s_waitcnt lgkmcnt(7)
    v_mfma_f32_16x16x32_bf16 v[176:179], v[40:43], a[8:11], v[176:179]
    ds_read_b64_tr_b16 v[50:51], v23 offset:16896
    ds_read_b128 a[156:159], v3 offset:7168
    v_cvt_pk_bf16_f32 v239, v254, v255
    v_mfma_f32_16x16x32_bf16 v[176:179], v[44:47], a[12:15], v[176:179]
    ds_read_b64_tr_b16 v[52:53], v23 offset:20480
    v_mfma_f32_16x16x32_bf16 v[180:183], v[32:35], a[16:19], v[180:183]
    buffer_store_dwordx4 v[236:239], v3, s[4:7], s43 offen sc1
    ds_read_b128 a[160:163], v3 offset:8192
    v_mfma_f32_16x16x32_bf16 v[180:183], v[36:39], a[20:23], v[180:183]
    ds_read_b64_tr_b16 v[54:55], v23 offset:20992
    ds_write_b128 v5, v[104:107] offset:4096
    v_mfma_f32_16x16x32_bf16 v[180:183], v[40:43], a[24:27], v[180:183]
    ds_read_b64_tr_b16 v[56:57], v23 offset:24576
    ds_read_b128 a[164:167], v3 offset:9216
    v_mfma_f32_16x16x32_bf16 v[180:183], v[44:47], a[28:31], v[180:183]
    ds_read_b64_tr_b16 v[58:59], v23 offset:25088
    v_mfma_f32_16x16x32_bf16 v[184:187], v[32:35], a[32:35], v[184:187]
    ds_read_b128 a[168:171], v3 offset:10240
    v_mfma_f32_16x16x32_bf16 v[184:187], v[36:39], a[36:39], v[184:187]
    ds_read_b64_tr_b16 v[60:61], v23 offset:28672
    ds_write_b128 v5, v[108:111] offset:5120
    v_mfma_f32_16x16x32_bf16 v[184:187], v[40:43], a[40:43], v[184:187]
    ds_read_b64_tr_b16 v[62:63], v23 offset:29184
    ds_read_b128 a[172:175], v3 offset:11264
    v_mfma_f32_16x16x32_bf16 v[184:187], v[44:47], a[44:47], v[184:187]
    v_mfma_f32_16x16x32_bf16 v[188:191], v[32:35], a[48:51], v[188:191]
    ds_read_b128 a[176:179], v3 offset:12288
    v_mfma_f32_16x16x32_bf16 v[188:191], v[36:39], a[52:55], v[188:191]
    v_mfma_f32_16x16x32_bf16 v[188:191], v[40:43], a[56:59], v[188:191]
    ds_read_b128 a[180:183], v3 offset:13312
    v_mfma_f32_16x16x32_bf16 v[188:191], v[44:47], a[60:63], v[188:191]
    s_waitcnt lgkmcnt(11)
    v_mfma_f32_16x16x32_bf16 v[176:179], v[48:51], a[64:67], v[176:179]
    ds_read_b128 a[184:187], v3 offset:14336
    v_mfma_f32_16x16x32_bf16 v[176:179], v[52:55], a[68:71], v[176:179]
    s_waitcnt lgkmcnt(4)
    v_mfma_f32_16x16x32_bf16 v[176:179], v[56:59], a[72:75], v[176:179]
    ds_read_b128 a[188:191], v3 offset:15360
    v_mfma_f32_16x16x32_bf16 v[176:179], v[60:63], a[76:79], v[176:179]
    v_mfma_f32_16x16x32_bf16 v[180:183], v[48:51], a[80:83], v[180:183]
    v_mfma_f32_16x16x32_bf16 v[180:183], v[52:55], a[84:87], v[180:183]
    v_mfma_f32_16x16x32_bf16 v[180:183], v[56:59], a[88:91], v[180:183]
    v_mfma_f32_16x16x32_bf16 v[180:183], v[60:63], a[92:95], v[180:183]
    v_mfma_f32_16x16x32_bf16 v[184:187], v[48:51], a[96:99], v[184:187]
    v_mfma_f32_16x16x32_bf16 v[184:187], v[52:55], a[100:103], v[184:187]
    v_mfma_f32_16x16x32_bf16 v[184:187], v[56:59], a[104:107], v[184:187]
    v_mfma_f32_16x16x32_bf16 v[184:187], v[60:63], a[108:111], v[184:187]
    v_mfma_f32_16x16x32_bf16 v[188:191], v[48:51], a[112:115], v[188:191]
    v_mfma_f32_16x16x32_bf16 v[188:191], v[52:55], a[116:119], v[188:191]
    v_mfma_f32_16x16x32_bf16 v[188:191], v[56:59], a[120:123], v[188:191]
    v_mfma_f32_16x16x32_bf16 v[188:191], v[60:63], a[124:127], v[188:191]
    v_cvt_pk_bf16_f32 v120, v120, v121
    v_cvt_pk_bf16_f32 v121, v122, v123
    s_nop 1
    v_cvt_pk_bf16_f32 v122, v184, v185
    v_cvt_pk_bf16_f32 v123, v186, v187
    v_cvt_pk_bf16_f32 v124, v124, v125
    v_cvt_pk_bf16_f32 v125, v126, v127
    v_cvt_pk_bf16_f32 v126, v188, v189
    v_cvt_pk_bf16_f32 v127, v190, v191
    ds_write_b128 v5, v[120:123] offset:6144
    ds_write_b128 v5, v[124:127] offset:7168
    v_cvt_pk_bf16_f32 v112, v112, v113
    v_cvt_pk_bf16_f32 v113, v114, v115
    v_cvt_pk_bf16_f32 v114, v176, v177
    v_cvt_pk_bf16_f32 v115, v178, v179
    v_cvt_pk_bf16_f32 v116, v116, v117
    v_cvt_pk_bf16_f32 v117, v118, v119
    v_cvt_pk_bf16_f32 v118, v180, v181
    v_cvt_pk_bf16_f32 v119, v182, v183
    v_mfma_f32_16x16x32_bf16 v[128:131], a[128:131], v[64:67], 0
    v_mov_b32 v20, 0
    v_mov_b32 v21, 0
    v_mfma_f32_16x16x32_bf16 v[128:131], a[132:135], v[80:83], v[128:131]
    v_mov_b32 v22, 0
    v_mov_b32 v23, 0
    v_mfma_f32_16x16x32_bf16 v[128:131], a[136:139], v[96:99], v[128:131]
    v_mov_b32 v248, 0
    v_mov_b32 v249, 0
    v_mfma_f32_16x16x32_bf16 v[128:131], a[140:143], v[112:115], v[128:131]
    v_mov_b32 v250, 0
    v_mov_b32 v251, 0
    v_mfma_f32_16x16x32_bf16 v[132:135], a[128:131], v[68:71], 0
    s_mov_b32 s52, 49152
    s_lshl_b32 s58, s30, 1
    v_mfma_f32_16x16x32_bf16 v[132:135], a[132:135], v[84:87], v[132:135]
    s_sub_u32 s58, s58, 1
    v_xor_b32 v5, 0x2000, v5
    v_mfma_f32_16x16x32_bf16 v[132:135], a[136:139], v[100:103], v[132:135]
    v_mfma_f32_16x16x32_bf16 v[132:135], a[140:143], v[116:119], v[132:135]
    s_waitcnt lgkmcnt(0)
    s_barrier
    v_mfma_f32_16x16x32_bf16 v[160:163], a[128:131], v[72:75], 0
    ds_read_b128 v[192:195], v5 offset:0
    ds_read_b128 v[196:199], v5 offset:1024
    v_mfma_f32_16x16x32_bf16 v[160:163], a[132:135], v[88:91], v[160:163]
    ds_read_b128 v[200:203], v5 offset:2048
    ds_read_b128 v[204:207], v5 offset:3072
    v_mfma_f32_16x16x32_bf16 v[160:163], a[136:139], v[104:107], v[160:163]
    ds_read_b128 v[208:211], v5 offset:4096
    ds_read_b128 v[212:215], v5 offset:5120
    v_mfma_f32_16x16x32_bf16 v[160:163], a[140:143], v[120:123], v[160:163]
    ds_read_b128 v[216:219], v5 offset:6144
    ds_read_b128 v[220:223], v5 offset:7168
    v_mfma_f32_16x16x32_bf16 v[164:167], a[128:131], v[76:79], 0
    v_add_u32 v29, s56, v27
    v_cmp_le_i32 vcc, 0, v29
    v_mfma_f32_16x16x32_bf16 v[164:167], a[132:135], v[92:95], v[164:167]
    v_cmp_le_i32 s[60:61], 1, v29
    v_cndmask_b32 v128, v28, v128, vcc
    v_mfma_f32_16x16x32_bf16 v[164:167], a[136:139], v[108:111], v[164:167]
    v_cndmask_b32 v129, v28, v129, s[60:61]
    v_cmp_le_i32 vcc, 2, v29
    v_mfma_f32_16x16x32_bf16 v[164:167], a[140:143], v[124:127], v[164:167]
    v_cmp_le_i32 s[60:61], 3, v29
    v_cndmask_b32 v130, v28, v130, vcc
    s_nop 0
    v_cndmask_b32 v131, v28, v131, s[60:61]
    v_cmp_le_i32 vcc, -16, v29
    v_cmp_le_i32 s[60:61], -15, v29
    s_nop 0
    v_cndmask_b32 v132, v28, v132, vcc
    v_cndmask_b32 v133, v28, v133, s[60:61]
    v_cmp_le_i32 vcc, -14, v29
    v_cmp_le_i32 s[60:61], -13, v29
    s_nop 0
    v_cndmask_b32 v134, v28, v134, vcc
    v_cndmask_b32 v135, v28, v135, s[60:61]
    v_max3_f32 v252, v128, v129, v130
    v_max3_f32 v253, v132, v133, v134
    v_max_f32 v252, v252, v131
    v_max_f32 v253, v253, v135
    v_mov_b32 v29, v252
    v_mov_b32 v30, v253
    s_nop 0
    v_permlane16_swap_b32 v29, v252
    v_permlane16_swap_b32 v30, v253
    v_max_f32 v252, v252, v29
    v_max_f32 v253, v253, v30
    v_mov_b32 v29, v252
    v_mov_b32 v30, v253
    s_nop 0
    v_permlane32_swap_b32 v29, v252
    v_permlane32_swap_b32 v30, v253
    v_max_f32 v252, v252, v29
    v_max_f32 v253, v253, v30
    v_max_f32 v252, 0xf149f2ca, v252
    v_max_f32 v253, 0xf149f2ca, v253
    v_sub_f32 v224, 0, v252
    v_sub_f32 v228, 0, v253
    v_sub_f32 v225, 0, v252
    v_sub_f32 v229, 0, v253
    v_sub_f32 v226, 0, v252
    v_sub_f32 v230, 0, v253
    v_sub_f32 v227, 0, v252
    v_sub_f32 v231, 0, v253
    s_waitcnt lgkmcnt(0)
    v_mfma_f32_16x16x32_bf16 v[128:131], a[128:131], v[64:67], v[224:227]
    v_mfma_f32_16x16x32_bf16 v[128:131], a[132:135], v[80:83], v[128:131]
    v_mfma_f32_16x16x32_bf16 v[128:131], a[136:139], v[96:99], v[128:131]
    v_mfma_f32_16x16x32_bf16 v[128:131], a[140:143], v[112:115], v[128:131]
    s_waitcnt vmcnt(13) lgkmcnt(0)
    s_barrier
    v_mfma_f32_16x16x32_bf16 v[132:135], a[128:131], v[68:71], v[228:231]
    v_max3_f32 v254, v160, v161, v162
    v_max3_f32 v255, v164, v165, v166
    v_mfma_f32_16x16x32_bf16 v[132:135], a[132:135], v[84:87], v[132:135]
    v_max_f32 v254, v254, v163
    v_max_f32 v255, v255, v167
    v_add_u32 v26, s54, v4
    v_mfma_f32_16x16x32_bf16 v[132:135], a[136:139], v[100:103], v[132:135]
    v_mov_b32 v29, v254
    v_mov_b32 v30, v255
    v_mfma_f32_16x16x32_bf16 v[132:135], a[140:143], v[116:119], v[132:135]
    v_permlane16_swap_b32 v29, v254
    v_permlane16_swap_b32 v30, v255
    v_add_u32 v25, s53, v3
    v_mfma_f32_16x16x32_bf16 v[136:139], a[144:147], v[64:67], v[224:227]
    v_max_f32 v254, v254, v29
    v_max_f32 v255, v255, v30
    v_mfma_f32_16x16x32_bf16 v[136:139], a[148:151], v[80:83], v[136:139]
    v_mov_b32 v29, v254
    v_mov_b32 v30, v255
    s_mov_b32 m0, s50
    v_mfma_f32_16x16x32_bf16 v[136:139], a[152:155], v[96:99], v[136:139]
    v_permlane32_swap_b32 v29, v254
    v_permlane32_swap_b32 v30, v255
    v_mfma_f32_16x16x32_bf16 v[136:139], a[156:159], v[112:115], v[136:139]
    v_max_f32 v254, v254, v29
    v_max_f32 v255, v255, v30
    buffer_load_dwordx4 v24, s[16:19], s52 offen offset:0 sc1 lds
    v_mfma_f32_16x16x32_bf16 v[140:143], a[144:147], v[68:71], v[228:231]
    v_max_f32 v254, 0xf149f2ca, v254
    v_max_f32 v255, 0xf149f2ca, v255
    v_mfma_f32_16x16x32_bf16 v[140:143], a[148:151], v[84:87], v[140:143]
    v_sub_f32 v232, 0, v254
    v_sub_f32 v236, 0, v255
    s_add_u32 s53, s53, 16384
    v_mfma_f32_16x16x32_bf16 v[140:143], a[152:155], v[100:103], v[140:143]
    v_sub_f32 v233, 0, v254
    v_sub_f32 v237, 0, v255
    v_mfma_f32_16x16x32_bf16 v[140:143], a[156:159], v[116:119], v[140:143]
    v_sub_f32 v234, 0, v254
    v_sub_f32 v238, 0, v255
    s_and_b32 s53, s53, 0xffff
    s_add_u32 s54, s54, 16384
    v_mfma_f32_16x16x32_bf16 v[144:147], a[160:163], v[64:67], v[224:227]
    v_sub_f32 v235, 0, v254
    v_sub_f32 v239, 0, v255
    v_mfma_f32_16x16x32_bf16 v[144:147], a[164:167], v[80:83], v[144:147]
    buffer_load_dword v6, v3, s[12:15], s24 offen offset:0
    buffer_load_dword v6, v3, s[12:15], s24 offen offset:1024
    s_sub_u32 s46, s54, 98304
    v_mfma_f32_16x16x32_bf16 v[144:147], a[168:171], v[96:99], v[144:147]
    buffer_load_dword v6, v3, s[12:15], s24 offen offset:2048
    v_mfma_f32_16x16x32_bf16 v[144:147], a[172:175], v[112:115], v[144:147]
    s_min_u32 s54, s54, s46
    v_mfma_f32_16x16x32_bf16 v[148:151], a[160:163], v[68:71], v[228:231]
    v_mfma_f32_16x16x32_bf16 v[148:151], a[164:167], v[84:87], v[148:151]
    v_mfma_f32_16x16x32_bf16 v[148:151], a[168:171], v[100:103], v[148:151]
    v_mfma_f32_16x16x32_bf16 v[148:151], a[172:175], v[116:119], v[148:151]
    buffer_load_dwordx4 v24, s[16:19], s52 offen offset:1024 sc1 lds
    s_cmp_le_i32 s56, 0
    s_cbranch_scc1 PR_mka0
PR_mka0_r:
    v_exp_f32 v240, v128
    v_mfma_f32_16x16x32_bf16 v[152:155], a[176:179], v[64:67], v[224:227]
    v_exp_f32 v241, v129
    v_mfma_f32_16x16x32_bf16 v[152:155], a[180:183], v[80:83], v[152:155]
    v_cvt_pk_bf16_f32 v32, v240, v241
    v_mfma_f32_16x16x32_bf16 v[152:155], a[184:187], v[96:99], v[152:155]
    v_exp_f32 v242, v130
    v_mfma_f32_16x16x32_bf16 v[152:155], a[188:191], v[112:115], v[152:155]
    v_mfma_f32_16x16x32_bf16 v[156:159], a[176:179], v[68:71], v[228:231]
    v_exp_f32 v243, v131
    v_mfma_f32_16x16x32_bf16 v[156:159], a[180:183], v[84:87], v[156:159]
    v_cvt_pk_bf16_f32 v33, v242, v243
    v_mfma_f32_16x16x32_bf16 v[156:159], a[184:187], v[100:103], v[156:159]
    v_exp_f32 v240, v132
    v_mfma_f32_16x16x32_bf16 v[156:159], a[188:191], v[116:119], v[156:159]
    v_exp_f32 v241, v133
    s_nop 0
    v_cvt_pk_bf16_f32 v40, v240, v241
    v_mfma_f32_32x32x16_bf16 a[0:15], v[20:23], v[20:23], 0
    v_exp_f32 v242, v134
    buffer_load_dwordx4 v24, s[16:19], s52 offen offset:2048 sc1 lds
    v_exp_f32 v243, v135
    s_nop 0
    v_cvt_pk_bf16_f32 v41, v242, v243
    v_mfma_f32_32x32x16_bf16 a[16:31], v[20:23], v[20:23], 0
    v_exp_f32 v240, v136
    ds_read_b128 a[192:195], v26 offset:0
    ds_read_b128 a[196:199], v26 offset:1024
    v_exp_f32 v241, v137
    ds_read_b128 a[200:203], v26 offset:2048
    v_cvt_pk_bf16_f32 v34, v240, v241
    v_mfma_f32_32x32x16_bf16 a[32:47], v[20:23], v[20:23], 0
    v_exp_f32 v242, v138
    ds_read_b128 a[204:207], v26 offset:3072
    v_exp_f32 v243, v139
    ds_read_b128 a[208:211], v26 offset:4096
    v_cvt_pk_bf16_f32 v35, v242, v243
    v_mfma_f32_32x32x16_bf16 a[48:63], v[20:23], v[20:23], 0
    v_exp_f32 v240, v140
    ds_read_b128 a[212:215], v26 offset:5120
    v_exp_f32 v241, v141
    ds_read_b128 a[216:219], v26 offset:6144
    v_cvt_pk_bf16_f32 v42, v240, v241
    v_mfma_f32_32x32x16_bf16 a[64:79], v[20:23], v[20:23], 0
    v_exp_f32 v242, v142
    buffer_load_dwordx4 v24, s[16:19], s52 offen offset:3072 sc1 lds
    v_exp_f32 v243, v143
    s_cmp_le_i32 s56, 32
    s_cbranch_scc1 PR_mka1
PR_mka1_r:
    v_cvt_pk_bf16_f32 v43, v242, v243
    v_mfma_f32_32x32x16_bf16 a[80:95], v[20:23], v[20:23], 0
    v_exp_f32 v240, v144
    buffer_load_dword v5, v3, s[8:11], s26 offen
    v_exp_f32 v241, v145
    s_add_u32 s26, s26, 1024
    v_cvt_pk_bf16_f32 v36, v240, v241
    v_mfma_f32_32x32x16_bf16 a[96:111], v[20:23], v[20:23], 0
    v_exp_f32 v242, v146
    s_add_u32 s50, s50, 16384
    s_and_b32 s50, s50, 0xffff
    v_exp_f32 v243, v147
    s_add_u32 m0, s51, 0x10000
    v_cvt_pk_bf16_f32 v37, v242, v243
    v_mfma_f32_32x32x16_bf16 a[112:127], v[20:23], v[20:23], 0
    v_exp_f32 v240, v148
    buffer_load_dwordx4 v24, s[20:23], s52 offen offset:0 sc1 lds
    s_lshl_b32 s56, s28, 5
    s_cmp_eq_u32 s30, 0
    s_cbranch_scc1 K2_DM_MID
    s_branch K2_D_MID
K2_D:
    s_waitcnt lgkmcnt(0)
    v_mfma_f32_16x16x32_bf16 v[128:131], a[128:131], v[64:67], v[224:227]
    v_exp_f32 v241, v181
    v_mfma_f32_16x16x32_bf16 v[128:131], a[132:135], v[80:83], v[128:131]
    v_cvt_pk_bf16_f32 v60, v240, v241
    v_mfma_f32_16x16x32_bf16 v[128:131], a[136:139], v[96:99], v[128:131]
    v_exp_f32 v242, v182
    v_mfma_f32_16x16x32_bf16 v[128:131], a[140:143], v[112:115], v[128:131]
    s_waitcnt vmcnt(5)
    s_barrier
    v_mfma_f32_16x16x32_bf16 v[132:135], a[128:131], v[68:71], v[228:231]
    v_exp_f32 v243, v183
    v_mfma_f32_16x16x32_bf16 v[132:135], a[132:135], v[84:87], v[132:135]
    v_add_u32 v26, s54, v4
    v_cvt_pk_bf16_f32 v61, v242, v243
    v_mfma_f32_16x16x32_bf16 v[132:135], a[136:139], v[100:103], v[132:135]
    v_exp_f32 v240, v184
    v_mfma_f32_16x16x32_bf16 v[132:135], a[140:143], v[116:119], v[132:135]
    v_add_u32 v25, s53, v3
    v_mfma_f32_16x16x32_bf16 v[136:139], a[144:147], v[64:67], v[224:227]
    v_exp_f32 v241, v185
    v_mfma_f32_16x16x32_bf16 v[136:139], a[148:151], v[80:83], v[136:139]
    s_mov_b32 m0, s50
    v_cvt_pk_bf16_f32 v54, v240, v241
    v_mfma_f32_16x16x32_bf16 v[136:139], a[152:155], v[96:99], v[136:139]
    v_exp_f32 v242, v186
    v_mfma_f32_16x16x32_bf16 v[136:139], a[156:159], v[112:115], v[136:139]
    buffer_load_dwordx4 v24, s[16:19], s52 offen offset:0 sc1 lds
    v_mfma_f32_16x16x32_bf16 v[140:143], a[144:147], v[68:71], v[228:231]
    v_exp_f32 v243, v187
    v_mfma_f32_16x16x32_bf16 v[140:143], a[148:151], v[84:87], v[140:143]
    s_add_u32 s53, s53, 16384
    v_cvt_pk_bf16_f32 v55, v242, v243
    v_mfma_f32_16x16x32_bf16 v[140:143], a[152:155], v[100:103], v[140:143]
    v_exp_f32 v240, v188
    v_mfma_f32_16x16x32_bf16 v[140:143], a[156:159], v[116:119], v[140:143]
    s_and_b32 s53, s53, 0xffff
    s_add_u32 s54, s54, 16384
    v_mfma_f32_16x16x32_bf16 v[144:147], a[160:163], v[64:67], v[224:227]
    v_exp_f32 v241, v189
    v_mfma_f32_16x16x32_bf16 v[144:147], a[164:167], v[80:83], v[144:147]
    s_sub_u32 s46, s54, 98304
    v_cvt_pk_bf16_f32 v62, v240, v241
    v_mfma_f32_16x16x32_bf16 v[144:147], a[168:171], v[96:99], v[144:147]
    v_exp_f32 v242, v190
    v_mfma_f32_16x16x32_bf16 v[144:147], a[172:175], v[112:115], v[144:147]
    s_min_u32 s54, s54, s46
    v_mfma_f32_16x16x32_bf16 v[148:151], a[160:163], v[68:71], v[228:231]
    v_exp_f32 v243, v191
    v_mfma_f32_16x16x32_bf16 v[148:151], a[164:167], v[84:87], v[148:151]
    v_cvt_pk_bf16_f32 v63, v242, v243
    v_mfma_f32_16x16x32_bf16 v[148:151], a[168:171], v[100:103], v[148:151]
    v_mfma_f32_16x16x32_bf16 v[148:151], a[172:175], v[116:119], v[148:151]
    buffer_load_dwordx4 v24, s[16:19], s52 offen offset:1024 sc1 lds
    v_mfma_f32_16x16x32_bf16 v[12:15], v[8:11], v[48:51], 0
    v_mfma_f32_16x16x32_bf16 v[12:15], v[8:11], v[52:55], v[12:15]
    v_mfma_f32_16x16x32_bf16 v[16:19], v[8:11], v[56:59], 0
    v_exp_f32 v240, v128
    v_mfma_f32_16x16x32_bf16 v[16:19], v[8:11], v[60:63], v[16:19]
    v_mfma_f32_16x16x32_bf16 v[152:155], a[176:179], v[64:67], v[224:227]
    v_exp_f32 v241, v129
    v_mfma_f32_16x16x32_bf16 v[152:155], a[180:183], v[80:83], v[152:155]
    v_cvt_pk_bf16_f32 v32, v240, v241
    v_mfma_f32_16x16x32_bf16 v[152:155], a[184:187], v[96:99], v[152:155]
    v_exp_f32 v242, v130
    v_mfma_f32_16x16x32_bf16 v[152:155], a[188:191], v[112:115], v[152:155]
    s_nop 0
    v_max_f32 v1, v12, v16
    v_cmp_lt_f32 vcc, s59, v1
    v_mfma_f32_16x16x32_bf16 v[156:159], a[176:179], v[68:71], v[228:231]
    v_exp_f32 v243, v131
    v_mfma_f32_16x16x32_bf16 v[156:159], a[180:183], v[84:87], v[156:159]
    s_cbranch_vccnz D_rdb
D_rdb_r:
    v_cvt_pk_bf16_f32 v33, v242, v243
    v_mfma_f32_16x16x32_bf16 v[156:159], a[184:187], v[100:103], v[156:159]
    v_exp_f32 v240, v132
    v_mfma_f32_16x16x32_bf16 v[156:159], a[188:191], v[116:119], v[156:159]
    v_add_f32 v250, v250, v12
    v_add_f32 v251, v251, v16
    v_mfma_f32_16x16x32_bf16 a[64:67], a[192:195], v[48:51], a[64:67]
    v_exp_f32 v241, v133
    v_mfma_f32_16x16x32_bf16 a[64:67], a[196:199], v[52:55], a[64:67]
    v_cvt_pk_bf16_f32 v40, v240, v241
    v_mfma_f32_16x16x32_bf16 a[68:71], a[192:195], v[56:59], a[68:71]
    v_exp_f32 v242, v134
    v_mfma_f32_16x16x32_bf16 a[68:71], a[196:199], v[60:63], a[68:71]
    buffer_load_dwordx4 v24, s[16:19], s52 offen offset:2048 sc1 lds
    v_mfma_f32_16x16x32_bf16 a[72:75], a[200:203], v[48:51], a[72:75]
    v_exp_f32 v243, v135
    v_mfma_f32_16x16x32_bf16 a[72:75], a[204:207], v[52:55], a[72:75]
    v_cvt_pk_bf16_f32 v41, v242, v243
    v_mfma_f32_16x16x32_bf16 a[76:79], a[200:203], v[56:59], a[76:79]
    v_exp_f32 v240, v136
    v_mfma_f32_16x16x32_bf16 a[76:79], a[204:207], v[60:63], a[76:79]
    ds_read_b128 a[192:195], v26 offset:0
    ds_read_b128 a[196:199], v26 offset:1024
    v_mfma_f32_16x16x32_bf16 a[80:83], a[208:211], v[48:51], a[80:83]
    v_exp_f32 v241, v137
    v_mfma_f32_16x16x32_bf16 a[80:83], a[212:215], v[52:55], a[80:83]
    ds_read_b128 a[200:203], v26 offset:2048
    v_cvt_pk_bf16_f32 v34, v240, v241
    v_mfma_f32_16x16x32_bf16 a[84:87], a[208:211], v[56:59], a[84:87]
    v_exp_f32 v242, v138
    v_mfma_f32_16x16x32_bf16 a[84:87], a[212:215], v[60:63], a[84:87]
    ds_read_b128 a[204:207], v26 offset:3072
    v_mfma_f32_16x16x32_bf16 a[88:91], a[216:219], v[48:51], a[88:91]
    v_exp_f32 v243, v139
    v_mfma_f32_16x16x32_bf16 a[88:91], a[220:223], v[52:55], a[88:91]
    ds_read_b128 a[208:211], v26 offset:4096
    v_cvt_pk_bf16_f32 v35, v242, v243
    v_mfma_f32_16x16x32_bf16 a[92:95], a[216:219], v[56:59], a[92:95]
    v_exp_f32 v240, v140
    v_mfma_f32_16x16x32_bf16 a[92:95], a[220:223], v[60:63], a[92:95]
    ds_read_b128 a[212:215], v26 offset:5120
    v_mfma_f32_16x16x32_bf16 a[96:99], a[224:227], v[48:51], a[96:99]
    v_exp_f32 v241, v141
    v_mfma_f32_16x16x32_bf16 a[96:99], a[228:231], v[52:55], a[96:99]
    ds_read_b128 a[216:219], v26 offset:6144
    v_cvt_pk_bf16_f32 v42, v240, v241
    v_mfma_f32_16x16x32_bf16 a[100:103], a[224:227], v[56:59], a[100:103]
    v_exp_f32 v242, v142
    v_mfma_f32_16x16x32_bf16 a[100:103], a[228:231], v[60:63], a[100:103]
    buffer_load_dwordx4 v24, s[16:19], s52 offen offset:3072 sc1 lds
    v_mfma_f32_16x16x32_bf16 a[104:107], a[232:235], v[48:51], a[104:107]
    v_exp_f32 v243, v143
    v_mfma_f32_16x16x32_bf16 a[104:107], a[236:239], v[52:55], a[104:107]
    v_cvt_pk_bf16_f32 v43, v242, v243
    v_mfma_f32_16x16x32_bf16 a[108:111], a[232:235], v[56:59], a[108:111]
    v_exp_f32 v240, v144
    v_mfma_f32_16x16x32_bf16 a[108:111], a[236:239], v[60:63], a[108:111]
    buffer_load_dword v5, v3, s[8:11], s26 offen
    v_mfma_f32_16x16x32_bf16 a[112:115], a[240:243], v[48:51], a[112:115]
    v_exp_f32 v241, v145
    v_mfma_f32_16x16x32_bf16 a[112:115], a[244:247], v[52:55], a[112:115]
    s_add_u32 s26, s26, 1024
    v_cvt_pk_bf16_f32 v36, v240, v241
    v_mfma_f32_16x16x32_bf16 a[116:119], a[240:243], v[56:59], a[116:119]
    v_exp_f32 v242, v146
    v_mfma_f32_16x16x32_bf16 a[116:119], a[244:247], v[60:63], a[116:119]
    s_add_u32 s50, s50, 16384
    s_and_b32 s50, s50, 0xffff
    v_mfma_f32_16x16x32_bf16 a[120:123], a[248:251], v[48:51], a[120:123]
    v_exp_f32 v243, v147
    v_mfma_f32_16x16x32_bf16 a[120:123], a[252:255], v[52:55], a[120:123]
    s_add_u32 m0, s51, 0x10000
    v_cvt_pk_bf16_f32 v37, v242, v243
    v_mfma_f32_16x16x32_bf16 a[124:127], a[248:251], v[56:59], a[124:127]
    v_exp_f32 v240, v148
    v_mfma_f32_16x16x32_bf16 a[124:127], a[252:255], v[60:63], a[124:127]
    buffer_load_dwordx4 v24, s[20:23], s52 offen offset:0 sc1 lds
K2_D_MID:
    v_mfma_f32_16x16x32_bf16 v[160:163], a[128:131], v[72:75], v[232:235]
    v_exp_f32 v241, v149
    v_mfma_f32_16x16x32_bf16 v[160:163], a[132:135], v[88:91], v[160:163]
    ds_read_b128 a[220:223], v26 offset:7168
    v_cvt_pk_bf16_f32 v44, v240, v241
    v_mfma_f32_16x16x32_bf16 v[160:163], a[136:139], v[104:107], v[160:163]
    v_exp_f32 v242, v150
    v_mfma_f32_16x16x32_bf16 v[160:163], a[140:143], v[120:123], v[160:163]
    ds_read_b128 a[224:227], v26 offset:8192
    ds_read_b128 a[228:231], v26 offset:9216
    v_mfma_f32_16x16x32_bf16 v[164:167], a[128:131], v[76:79], v[236:239]
    v_exp_f32 v243, v151
    v_mfma_f32_16x16x32_bf16 v[164:167], a[132:135], v[92:95], v[164:167]
    ds_read_b128 a[232:235], v26 offset:10240
    v_cvt_pk_bf16_f32 v45, v242, v243
    v_mfma_f32_16x16x32_bf16 v[164:167], a[136:139], v[108:111], v[164:167]
    v_exp_f32 v240, v152
    v_mfma_f32_16x16x32_bf16 v[164:167], a[140:143], v[124:127], v[164:167]
    ds_read_b128 a[236:239], v26 offset:11264
    ds_read_b128 a[240:243], v26 offset:12288
    v_mfma_f32_16x16x32_bf16 v[168:171], a[144:147], v[72:75], v[232:235]
    v_exp_f32 v241, v153
    v_mfma_f32_16x16x32_bf16 v[168:171], a[148:151], v[88:91], v[168:171]
    ds_read_b128 a[244:247], v26 offset:13312
    v_cvt_pk_bf16_f32 v38, v240, v241
    v_mfma_f32_16x16x32_bf16 v[168:171], a[152:155], v[104:107], v[168:171]
    v_exp_f32 v242, v154
    v_mfma_f32_16x16x32_bf16 v[168:171], a[156:159], v[120:123], v[168:171]
    ds_read_b128 a[248:251], v26 offset:14336
    ds_read_b128 a[252:255], v26 offset:15360
    v_mfma_f32_16x16x32_bf16 v[172:175], a[144:147], v[76:79], v[236:239]
    v_exp_f32 v243, v155
    v_mfma_f32_16x16x32_bf16 v[172:175], a[148:151], v[92:95], v[172:175]
    ds_read_b128 a[128:131], v25 offset:0
    v_cvt_pk_bf16_f32 v39, v242, v243
    v_mfma_f32_16x16x32_bf16 v[172:175], a[152:155], v[108:111], v[172:175]
    v_exp_f32 v240, v156
    v_mfma_f32_16x16x32_bf16 v[172:175], a[156:159], v[124:127], v[172:175]
    buffer_load_dwordx4 v24, s[20:23], s52 offen offset:1024 sc1 lds
    v_mfma_f32_16x16x32_bf16 v[176:179], a[160:163], v[72:75], v[232:235]
    v_exp_f32 v241, v157
    v_mfma_f32_16x16x32_bf16 v[176:179], a[164:167], v[88:91], v[176:179]
    ds_read_b128 a[132:135], v25 offset:1024
    v_cvt_pk_bf16_f32 v46, v240, v241
    v_mfma_f32_16x16x32_bf16 v[176:179], a[168:171], v[104:107], v[176:179]
    v_exp_f32 v242, v158
    v_mfma_f32_16x16x32_bf16 v[176:179], a[172:175], v[120:123], v[176:179]
    ds_read_b128 a[136:139], v25 offset:2048
    ds_read_b128 a[140:143], v25 offset:3072
    v_mfma_f32_16x16x32_bf16 v[180:183], a[160:163], v[76:79], v[236:239]
    v_exp_f32 v243, v159
    v_mfma_f32_16x16x32_bf16 v[180:183], a[164:167], v[92:95], v[180:183]
    ds_read_b128 a[144:147], v25 offset:4096
    v_cvt_pk_bf16_f32 v47, v242, v243
    v_mfma_f32_16x16x32_bf16 v[180:183], a[168:171], v[108:111], v[180:183]
    ds_read_b128 a[148:151], v25 offset:5120
    ds_read_b128 a[152:155], v25 offset:6144
    v_mfma_f32_16x16x32_bf16 v[180:183], a[172:175], v[124:127], v[180:183]
    ds_read_b128 a[156:159], v25 offset:7168
    ds_read_b128 a[160:163], v25 offset:8192
    v_mfma_f32_16x16x32_bf16 v[12:15], v[8:11], v[32:35], 0
    ds_read_b128 a[164:167], v25 offset:9216
    ds_read_b128 a[168:171], v25 offset:10240
    v_mfma_f32_16x16x32_bf16 v[12:15], v[8:11], v[36:39], v[12:15]
    ds_read_b128 a[172:175], v25 offset:11264
    v_mfma_f32_16x16x32_bf16 v[16:19], v[8:11], v[40:43], 0
    v_exp_f32 v240, v160
    v_mfma_f32_16x16x32_bf16 v[16:19], v[8:11], v[44:47], v[16:19]
    v_mfma_f32_16x16x32_bf16 v[184:187], a[176:179], v[72:75], v[232:235]
    v_exp_f32 v241, v161
    v_mfma_f32_16x16x32_bf16 v[184:187], a[180:183], v[88:91], v[184:187]
    v_cvt_pk_bf16_f32 v48, v240, v241
    v_mfma_f32_16x16x32_bf16 v[184:187], a[184:187], v[104:107], v[184:187]
    v_exp_f32 v242, v162
    v_mfma_f32_16x16x32_bf16 v[184:187], a[188:191], v[120:123], v[184:187]
    s_nop 0
    v_max_f32 v1, v12, v16
    v_cmp_lt_f32 vcc, s59, v1
    v_mfma_f32_16x16x32_bf16 v[188:191], a[176:179], v[76:79], v[236:239]
    v_exp_f32 v243, v163
    v_mfma_f32_16x16x32_bf16 v[188:191], a[180:183], v[92:95], v[188:191]
    s_cbranch_vccnz D_rda
D_rda_r:
    v_cvt_pk_bf16_f32 v49, v242, v243
    v_mfma_f32_16x16x32_bf16 v[188:191], a[184:187], v[108:111], v[188:191]
    v_exp_f32 v240, v164
    v_mfma_f32_16x16x32_bf16 v[188:191], a[188:191], v[124:127], v[188:191]
    v_add_f32 v248, v248, v12
    v_add_f32 v249, v249, v16
    s_waitcnt lgkmcnt(12)
    v_mfma_f32_16x16x32_bf16 a[0:3], a[192:195], v[32:35], a[0:3]
    v_exp_f32 v241, v165
    v_mfma_f32_16x16x32_bf16 a[0:3], a[196:199], v[36:39], a[0:3]
    ds_read_b128 a[176:179], v25 offset:12288
    v_cvt_pk_bf16_f32 v56, v240, v241
    v_mfma_f32_16x16x32_bf16 a[4:7], a[192:195], v[40:43], a[4:7]
    v_exp_f32 v242, v166
    v_mfma_f32_16x16x32_bf16 a[4:7], a[196:199], v[44:47], a[4:7]
    buffer_load_dwordx4 v24, s[20:23], s52 offen offset:2048 sc1 lds
    v_mfma_f32_16x16x32_bf16 a[8:11], a[200:203], v[32:35], a[8:11]
    v_exp_f32 v243, v167
    v_mfma_f32_16x16x32_bf16 a[8:11], a[204:207], v[36:39], a[8:11]
    ds_read_b128 a[180:183], v25 offset:13312
    v_cvt_pk_bf16_f32 v57, v242, v243
    v_mfma_f32_16x16x32_bf16 a[12:15], a[200:203], v[40:43], a[12:15]
    v_exp_f32 v240, v168
    v_mfma_f32_16x16x32_bf16 a[12:15], a[204:207], v[44:47], a[12:15]
    buffer_load_dwordx4 v24, s[20:23], s52 offen offset:3072 sc1 lds
    v_mfma_f32_16x16x32_bf16 a[16:19], a[208:211], v[32:35], a[16:19]
    v_exp_f32 v241, v169
    v_mfma_f32_16x16x32_bf16 a[16:19], a[212:215], v[36:39], a[16:19]
    s_add_u32 s51, s51, 16384
    v_cvt_pk_bf16_f32 v50, v240, v241
    v_mfma_f32_16x16x32_bf16 a[20:23], a[208:211], v[40:43], a[20:23]
    v_exp_f32 v242, v170
    v_mfma_f32_16x16x32_bf16 a[20:23], a[212:215], v[44:47], a[20:23]
    s_sub_u32 s45, s51, 98304
    s_min_u32 s51, s51, s45
    v_mfma_f32_16x16x32_bf16 a[24:27], a[216:219], v[32:35], a[24:27]
    v_exp_f32 v243, v171
    v_mfma_f32_16x16x32_bf16 a[24:27], a[220:223], v[36:39], a[24:27]
    s_add_u32 s52, s52, 16384
    v_cvt_pk_bf16_f32 v51, v242, v243
    v_mfma_f32_16x16x32_bf16 a[28:31], a[216:219], v[40:43], a[28:31]
    v_exp_f32 v240, v172
    v_mfma_f32_16x16x32_bf16 a[28:31], a[220:223], v[44:47], a[28:31]
    ds_read_b128 a[184:187], v25 offset:14336
    ds_read_b128 a[188:191], v25 offset:15360
    v_mfma_f32_16x16x32_bf16 a[32:35], a[224:227], v[32:35], a[32:35]
    v_exp_f32 v241, v173
    v_mfma_f32_16x16x32_bf16 a[32:35], a[228:231], v[36:39], a[32:35]
    v_cvt_pk_bf16_f32 v58, v240, v241
    v_mfma_f32_16x16x32_bf16 a[36:39], a[224:227], v[40:43], a[36:39]
    v_exp_f32 v242, v174
    v_mfma_f32_16x16x32_bf16 a[36:39], a[228:231], v[44:47], a[36:39]
    v_mfma_f32_16x16x32_bf16 a[40:43], a[232:235], v[32:35], a[40:43]
    v_exp_f32 v243, v175
    v_mfma_f32_16x16x32_bf16 a[40:43], a[236:239], v[36:39], a[40:43]
    v_cvt_pk_bf16_f32 v59, v242, v243
    v_mfma_f32_16x16x32_bf16 a[44:47], a[232:235], v[40:43], a[44:47]
    v_exp_f32 v240, v176
    v_mfma_f32_16x16x32_bf16 a[44:47], a[236:239], v[44:47], a[44:47]
    v_mfma_f32_16x16x32_bf16 a[48:51], a[240:243], v[32:35], a[48:51]
    v_exp_f32 v241, v177
    v_mfma_f32_16x16x32_bf16 a[48:51], a[244:247], v[36:39], a[48:51]
    v_cvt_pk_bf16_f32 v52, v240, v241
    v_mfma_f32_16x16x32_bf16 a[52:55], a[240:243], v[40:43], a[52:55]
    v_exp_f32 v242, v178
    v_mfma_f32_16x16x32_bf16 a[52:55], a[244:247], v[44:47], a[52:55]
    v_mfma_f32_16x16x32_bf16 a[56:59], a[248:251], v[32:35], a[56:59]
    v_exp_f32 v243, v179
    v_mfma_f32_16x16x32_bf16 a[56:59], a[252:255], v[36:39], a[56:59]
    v_cvt_pk_bf16_f32 v53, v242, v243
    v_mfma_f32_16x16x32_bf16 a[60:63], a[248:251], v[40:43], a[60:63]
    v_exp_f32 v240, v180
    v_mfma_f32_16x16x32_bf16 a[60:63], a[252:255], v[44:47], a[60:63]
    s_sub_u32 s58, s58, 1
    s_cbranch_scc0 K2_D
    s_waitcnt lgkmcnt(0)
    v_mfma_f32_16x16x32_bf16 v[128:131], a[128:131], v[64:67], v[224:227]
    v_exp_f32 v241, v181
    v_mfma_f32_16x16x32_bf16 v[128:131], a[132:135], v[80:83], v[128:131]
    v_cvt_pk_bf16_f32 v60, v240, v241
    v_mfma_f32_16x16x32_bf16 v[128:131], a[136:139], v[96:99], v[128:131]
    v_exp_f32 v242, v182
    v_mfma_f32_16x16x32_bf16 v[128:131], a[140:143], v[112:115], v[128:131]
    s_waitcnt vmcnt(5)
    s_barrier
    v_mfma_f32_16x16x32_bf16 v[132:135], a[128:131], v[68:71], v[228:231]
    v_exp_f32 v243, v183
    v_mfma_f32_16x16x32_bf16 v[132:135], a[132:135], v[84:87], v[132:135]
    v_add_u32 v26, s54, v4
    v_cvt_pk_bf16_f32 v61, v242, v243
    v_mfma_f32_16x16x32_bf16 v[132:135], a[136:139], v[100:103], v[132:135]
    v_exp_f32 v240, v184
    v_mfma_f32_16x16x32_bf16 v[132:135], a[140:143], v[116:119], v[132:135]
    v_add_u32 v25, s53, v3
    v_mfma_f32_16x16x32_bf16 v[136:139], a[144:147], v[64:67], v[224:227]
    v_exp_f32 v241, v185
    v_mfma_f32_16x16x32_bf16 v[136:139], a[148:151], v[80:83], v[136:139]
    s_mov_b32 m0, s50
    v_cvt_pk_bf16_f32 v54, v240, v241
    v_mfma_f32_16x16x32_bf16 v[136:139], a[152:155], v[96:99], v[136:139]
    v_exp_f32 v242, v186
    v_mfma_f32_16x16x32_bf16 v[136:139], a[156:159], v[112:115], v[136:139]
    buffer_load_dwordx4 v24, s[16:19], s52 offen offset:0 sc1 lds
    v_mfma_f32_16x16x32_bf16 v[140:143], a[144:147], v[68:71], v[228:231]
    v_exp_f32 v243, v187
    v_mfma_f32_16x16x32_bf16 v[140:143], a[148:151], v[84:87], v[140:143]
    s_add_u32 s53, s53, 16384
    v_cvt_pk_bf16_f32 v55, v242, v243
    v_mfma_f32_16x16x32_bf16 v[140:143], a[152:155], v[100:103], v[140:143]
    v_exp_f32 v240, v188
    v_mfma_f32_16x16x32_bf16 v[140:143], a[156:159], v[116:119], v[140:143]
    s_and_b32 s53, s53, 0xffff
    s_add_u32 s54, s54, 16384
    v_mfma_f32_16x16x32_bf16 v[144:147], a[160:163], v[64:67], v[224:227]
    v_exp_f32 v241, v189
    v_mfma_f32_16x16x32_bf16 v[144:147], a[164:167], v[80:83], v[144:147]
    s_sub_u32 s46, s54, 98304
    v_cvt_pk_bf16_f32 v62, v240, v241
    v_mfma_f32_16x16x32_bf16 v[144:147], a[168:171], v[96:99], v[144:147]
    v_exp_f32 v242, v190
    v_mfma_f32_16x16x32_bf16 v[144:147], a[172:175], v[112:115], v[144:147]
    s_min_u32 s54, s54, s46
    v_mfma_f32_16x16x32_bf16 v[148:151], a[160:163], v[68:71], v[228:231]
    v_exp_f32 v243, v191
    v_mfma_f32_16x16x32_bf16 v[148:151], a[164:167], v[84:87], v[148:151]
    v_cvt_pk_bf16_f32 v63, v242, v243
    v_mfma_f32_16x16x32_bf16 v[148:151], a[168:171], v[100:103], v[148:151]
    v_mfma_f32_16x16x32_bf16 v[148:151], a[172:175], v[116:119], v[148:151]
    buffer_load_dwordx4 v24, s[16:19], s52 offen offset:1024 sc1 lds
    v_mfma_f32_16x16x32_bf16 v[12:15], v[8:11], v[48:51], 0
    v_mfma_f32_16x16x32_bf16 v[12:15], v[8:11], v[52:55], v[12:15]
    s_cmp_le_i32 s56, 0
    s_cbranch_scc1 Dm_mka0
Dm_mka0_r:
    v_mfma_f32_16x16x32_bf16 v[16:19], v[8:11], v[56:59], 0
    v_exp_f32 v240, v128
    v_mfma_f32_16x16x32_bf16 v[16:19], v[8:11], v[60:63], v[16:19]
    v_mfma_f32_16x16x32_bf16 v[152:155], a[176:179], v[64:67], v[224:227]
    v_exp_f32 v241, v129
    v_mfma_f32_16x16x32_bf16 v[152:155], a[180:183], v[80:83], v[152:155]
    v_cvt_pk_bf16_f32 v32, v240, v241
    v_mfma_f32_16x16x32_bf16 v[152:155], a[184:187], v[96:99], v[152:155]
    v_exp_f32 v242, v130
    v_mfma_f32_16x16x32_bf16 v[152:155], a[188:191], v[112:115], v[152:155]
    s_nop 0
    v_max_f32 v1, v12, v16
    v_cmp_lt_f32 vcc, s59, v1
    v_mfma_f32_16x16x32_bf16 v[156:159], a[176:179], v[68:71], v[228:231]
    v_exp_f32 v243, v131
    v_mfma_f32_16x16x32_bf16 v[156:159], a[180:183], v[84:87], v[156:159]
    s_cbranch_vccnz Dm_rdb
Dm_rdb_r:
    v_cvt_pk_bf16_f32 v33, v242, v243
    v_mfma_f32_16x16x32_bf16 v[156:159], a[184:187], v[100:103], v[156:159]
    v_exp_f32 v240, v132
    v_mfma_f32_16x16x32_bf16 v[156:159], a[188:191], v[116:119], v[156:159]
    v_add_f32 v250, v250, v12
    v_add_f32 v251, v251, v16
    v_mfma_f32_16x16x32_bf16 a[64:67], a[192:195], v[48:51], a[64:67]
    v_exp_f32 v241, v133
    v_mfma_f32_16x16x32_bf16 a[64:67], a[196:199], v[52:55], a[64:67]
    v_cvt_pk_bf16_f32 v40, v240, v241
    v_mfma_f32_16x16x32_bf16 a[68:71], a[192:195], v[56:59], a[68:71]
    v_exp_f32 v242, v134
    v_mfma_f32_16x16x32_bf16 a[68:71], a[196:199], v[60:63], a[68:71]
    buffer_load_dwordx4 v24, s[16:19], s52 offen offset:2048 sc1 lds
    v_mfma_f32_16x16x32_bf16 a[72:75], a[200:203], v[48:51], a[72:75]
    v_exp_f32 v243, v135
    v_mfma_f32_16x16x32_bf16 a[72:75], a[204:207], v[52:55], a[72:75]
    v_cvt_pk_bf16_f32 v41, v242, v243
    v_mfma_f32_16x16x32_bf16 a[76:79], a[200:203], v[56:59], a[76:79]
    v_exp_f32 v240, v136
    v_mfma_f32_16x16x32_bf16 a[76:79], a[204:207], v[60:63], a[76:79]
    ds_read_b128 a[192:195], v26 offset:0
    ds_read_b128 a[196:199], v26 offset:1024
    v_mfma_f32_16x16x32_bf16 a[80:83], a[208:211], v[48:51], a[80:83]
    v_exp_f32 v241, v137
    v_mfma_f32_16x16x32_bf16 a[80:83], a[212:215], v[52:55], a[80:83]
    ds_read_b128 a[200:203], v26 offset:2048
    v_cvt_pk_bf16_f32 v34, v240, v241
    v_mfma_f32_16x16x32_bf16 a[84:87], a[208:211], v[56:59], a[84:87]
    v_exp_f32 v242, v138
    v_mfma_f32_16x16x32_bf16 a[84:87], a[212:215], v[60:63], a[84:87]
    ds_read_b128 a[204:207], v26 offset:3072
    v_mfma_f32_16x16x32_bf16 a[88:91], a[216:219], v[48:51], a[88:91]
    v_exp_f32 v243, v139
    v_mfma_f32_16x16x32_bf16 a[88:91], a[220:223], v[52:55], a[88:91]
    ds_read_b128 a[208:211], v26 offset:4096
    v_cvt_pk_bf16_f32 v35, v242, v243
    v_mfma_f32_16x16x32_bf16 a[92:95], a[216:219], v[56:59], a[92:95]
    v_exp_f32 v240, v140
    v_mfma_f32_16x16x32_bf16 a[92:95], a[220:223], v[60:63], a[92:95]
    ds_read_b128 a[212:215], v26 offset:5120
    v_mfma_f32_16x16x32_bf16 a[96:99], a[224:227], v[48:51], a[96:99]
    v_exp_f32 v241, v141
    v_mfma_f32_16x16x32_bf16 a[96:99], a[228:231], v[52:55], a[96:99]
    ds_read_b128 a[216:219], v26 offset:6144
    v_cvt_pk_bf16_f32 v42, v240, v241
    v_mfma_f32_16x16x32_bf16 a[100:103], a[224:227], v[56:59], a[100:103]
    v_exp_f32 v242, v142
    v_mfma_f32_16x16x32_bf16 a[100:103], a[228:231], v[60:63], a[100:103]
    buffer_load_dwordx4 v24, s[16:19], s52 offen offset:3072 sc1 lds
    v_mfma_f32_16x16x32_bf16 a[104:107], a[232:235], v[48:51], a[104:107]
    v_exp_f32 v243, v143
    v_mfma_f32_16x16x32_bf16 a[104:107], a[236:239], v[52:55], a[104:107]
    s_cmp_le_i32 s56, 32
    s_cbranch_scc1 Dm_mka1
Dm_mka1_r:
    v_cvt_pk_bf16_f32 v43, v242, v243
    v_mfma_f32_16x16x32_bf16 a[108:111], a[232:235], v[56:59], a[108:111]
    v_exp_f32 v240, v144
    v_mfma_f32_16x16x32_bf16 a[108:111], a[236:239], v[60:63], a[108:111]
    buffer_load_dword v5, v3, s[8:11], s26 offen
    v_mfma_f32_16x16x32_bf16 a[112:115], a[240:243], v[48:51], a[112:115]
    v_exp_f32 v241, v145
    v_mfma_f32_16x16x32_bf16 a[112:115], a[244:247], v[52:55], a[112:115]
    s_add_u32 s26, s26, 1024
    v_cvt_pk_bf16_f32 v36, v240, v241
    v_mfma_f32_16x16x32_bf16 a[116:119], a[240:243], v[56:59], a[116:119]
    v_exp_f32 v242, v146
    v_mfma_f32_16x16x32_bf16 a[116:119], a[244:247], v[60:63], a[116:119]
    s_add_u32 s50, s50, 16384
    s_and_b32 s50, s50, 0xffff
    v_mfma_f32_16x16x32_bf16 a[120:123], a[248:251], v[48:51], a[120:123]
    v_exp_f32 v243, v147
    v_mfma_f32_16x16x32_bf16 a[120:123], a[252:255], v[52:55], a[120:123]
    s_add_u32 m0, s51, 0x10000
    v_cvt_pk_bf16_f32 v37, v242, v243
    v_mfma_f32_16x16x32_bf16 a[124:127], a[248:251], v[56:59], a[124:127]
    v_exp_f32 v240, v148
    v_mfma_f32_16x16x32_bf16 a[124:127], a[252:255], v[60:63], a[124:127]
    buffer_load_dwordx4 v24, s[20:23], s52 offen offset:0 sc1 lds
K2_DM_MID:
    v_mfma_f32_16x16x32_bf16 v[160:163], a[128:131], v[72:75], v[232:235]
    v_exp_f32 v241, v149
    v_mfma_f32_16x16x32_bf16 v[160:163], a[132:135], v[88:91], v[160:163]
    ds_read_b128 a[220:223], v26 offset:7168
    v_cvt_pk_bf16_f32 v44, v240, v241
    v_mfma_f32_16x16x32_bf16 v[160:163], a[136:139], v[104:107], v[160:163]
    v_exp_f32 v242, v150
    v_mfma_f32_16x16x32_bf16 v[160:163], a[140:143], v[120:123], v[160:163]
    ds_read_b128 a[224:227], v26 offset:8192
    ds_read_b128 a[228:231], v26 offset:9216
    v_mfma_f32_16x16x32_bf16 v[164:167], a[128:131], v[76:79], v[236:239]
    v_exp_f32 v243, v151
    v_mfma_f32_16x16x32_bf16 v[164:167], a[132:135], v[92:95], v[164:167]
    ds_read_b128 a[232:235], v26 offset:10240
    v_cvt_pk_bf16_f32 v45, v242, v243
    v_mfma_f32_16x16x32_bf16 v[164:167], a[136:139], v[108:111], v[164:167]
    v_exp_f32 v240, v152
    v_mfma_f32_16x16x32_bf16 v[164:167], a[140:143], v[124:127], v[164:167]
    ds_read_b128 a[236:239], v26 offset:11264
    ds_read_b128 a[240:243], v26 offset:12288
    v_mfma_f32_16x16x32_bf16 v[168:171], a[144:147], v[72:75], v[232:235]
    v_exp_f32 v241, v153
    v_mfma_f32_16x16x32_bf16 v[168:171], a[148:151], v[88:91], v[168:171]
    ds_read_b128 a[244:247], v26 offset:13312
    v_cvt_pk_bf16_f32 v38, v240, v241
    v_mfma_f32_16x16x32_bf16 v[168:171], a[152:155], v[104:107], v[168:171]
    v_exp_f32 v242, v154
    v_mfma_f32_16x16x32_bf16 v[168:171], a[156:159], v[120:123], v[168:171]
    ds_read_b128 a[248:251], v26 offset:14336
    ds_read_b128 a[252:255], v26 offset:15360
    v_mfma_f32_16x16x32_bf16 v[172:175], a[144:147], v[76:79], v[236:239]
    v_exp_f32 v243, v155
    v_mfma_f32_16x16x32_bf16 v[172:175], a[148:151], v[92:95], v[172:175]
    ds_read_b128 a[128:131], v25 offset:0
    v_cvt_pk_bf16_f32 v39, v242, v243
    v_mfma_f32_16x16x32_bf16 v[172:175], a[152:155], v[108:111], v[172:175]
    v_exp_f32 v240, v156
    v_mfma_f32_16x16x32_bf16 v[172:175], a[156:159], v[124:127], v[172:175]
    buffer_load_dwordx4 v24, s[20:23], s52 offen offset:1024 sc1 lds
    v_mfma_f32_16x16x32_bf16 v[176:179], a[160:163], v[72:75], v[232:235]
    v_exp_f32 v241, v157
    v_mfma_f32_16x16x32_bf16 v[176:179], a[164:167], v[88:91], v[176:179]
    ds_read_b128 a[132:135], v25 offset:1024
    v_cvt_pk_bf16_f32 v46, v240, v241
    v_mfma_f32_16x16x32_bf16 v[176:179], a[168:171], v[104:107], v[176:179]
    v_exp_f32 v242, v158
    v_mfma_f32_16x16x32_bf16 v[176:179], a[172:175], v[120:123], v[176:179]
    ds_read_b128 a[136:139], v25 offset:2048
    ds_read_b128 a[140:143], v25 offset:3072
    v_mfma_f32_16x16x32_bf16 v[180:183], a[160:163], v[76:79], v[236:239]
    v_exp_f32 v243, v159
    v_mfma_f32_16x16x32_bf16 v[180:183], a[164:167], v[92:95], v[180:183]
    ds_read_b128 a[144:147], v25 offset:4096
    v_cvt_pk_bf16_f32 v47, v242, v243
    v_mfma_f32_16x16x32_bf16 v[180:183], a[168:171], v[108:111], v[180:183]
    ds_read_b128 a[148:151], v25 offset:5120
    ds_read_b128 a[152:155], v25 offset:6144
    v_mfma_f32_16x16x32_bf16 v[180:183], a[172:175], v[124:127], v[180:183]
    ds_read_b128 a[156:159], v25 offset:7168
    ds_read_b128 a[160:163], v25 offset:8192
    v_mfma_f32_16x16x32_bf16 v[12:15], v[8:11], v[32:35], 0
    ds_read_b128 a[164:167], v25 offset:9216
    ds_read_b128 a[168:171], v25 offset:10240
    v_mfma_f32_16x16x32_bf16 v[12:15], v[8:11], v[36:39], v[12:15]
    ds_read_b128 a[172:175], v25 offset:11264
    v_mfma_f32_16x16x32_bf16 v[16:19], v[8:11], v[40:43], 0
    v_exp_f32 v240, v160
    v_mfma_f32_16x16x32_bf16 v[16:19], v[8:11], v[44:47], v[16:19]
    v_mfma_f32_16x16x32_bf16 v[184:187], a[176:179], v[72:75], v[232:235]
    v_exp_f32 v241, v161
    v_mfma_f32_16x16x32_bf16 v[184:187], a[180:183], v[88:91], v[184:187]
    v_cvt_pk_bf16_f32 v48, v240, v241
    v_mfma_f32_16x16x32_bf16 v[184:187], a[184:187], v[104:107], v[184:187]
    v_exp_f32 v242, v162
    v_mfma_f32_16x16x32_bf16 v[184:187], a[188:191], v[120:123], v[184:187]
    s_nop 0
    v_max_f32 v1, v12, v16
    v_cmp_lt_f32 vcc, s59, v1
    v_mfma_f32_16x16x32_bf16 v[188:191], a[176:179], v[76:79], v[236:239]
    v_exp_f32 v243, v163
    v_mfma_f32_16x16x32_bf16 v[188:191], a[180:183], v[92:95], v[188:191]
    s_cbranch_vccnz Dm_rda
Dm_rda_r:
    v_cvt_pk_bf16_f32 v49, v242, v243
    v_mfma_f32_16x16x32_bf16 v[188:191], a[184:187], v[108:111], v[188:191]
    v_exp_f32 v240, v164
    v_mfma_f32_16x16x32_bf16 v[188:191], a[188:191], v[124:127], v[188:191]
    v_add_f32 v248, v248, v12
    v_add_f32 v249, v249, v16
    s_waitcnt lgkmcnt(12)
    v_mfma_f32_16x16x32_bf16 a[0:3], a[192:195], v[32:35], a[0:3]
    v_exp_f32 v241, v165
    v_mfma_f32_16x16x32_bf16 a[0:3], a[196:199], v[36:39], a[0:3]
    ds_read_b128 a[176:179], v25 offset:12288
    v_cvt_pk_bf16_f32 v56, v240, v241
    v_mfma_f32_16x16x32_bf16 a[4:7], a[192:195], v[40:43], a[4:7]
    v_exp_f32 v242, v166
    v_mfma_f32_16x16x32_bf16 a[4:7], a[196:199], v[44:47], a[4:7]
    buffer_load_dwordx4 v24, s[20:23], s52 offen offset:2048 sc1 lds
    v_mfma_f32_16x16x32_bf16 a[8:11], a[200:203], v[32:35], a[8:11]
    v_exp_f32 v243, v167
    v_mfma_f32_16x16x32_bf16 a[8:11], a[204:207], v[36:39], a[8:11]
    ds_read_b128 a[180:183], v25 offset:13312
    v_cvt_pk_bf16_f32 v57, v242, v243
    v_mfma_f32_16x16x32_bf16 a[12:15], a[200:203], v[40:43], a[12:15]
    v_exp_f32 v240, v168
    v_mfma_f32_16x16x32_bf16 a[12:15], a[204:207], v[44:47], a[12:15]
    buffer_load_dwordx4 v24, s[20:23], s52 offen offset:3072 sc1 lds
    v_mfma_f32_16x16x32_bf16 a[16:19], a[208:211], v[32:35], a[16:19]
    v_exp_f32 v241, v169
    v_mfma_f32_16x16x32_bf16 a[16:19], a[212:215], v[36:39], a[16:19]
    s_add_u32 s51, s51, 16384
    v_cvt_pk_bf16_f32 v50, v240, v241
    v_mfma_f32_16x16x32_bf16 a[20:23], a[208:211], v[40:43], a[20:23]
    v_exp_f32 v242, v170
    v_mfma_f32_16x16x32_bf16 a[20:23], a[212:215], v[44:47], a[20:23]
    s_sub_u32 s45, s51, 98304
    s_min_u32 s51, s51, s45
    v_mfma_f32_16x16x32_bf16 a[24:27], a[216:219], v[32:35], a[24:27]
    v_exp_f32 v243, v171
    v_mfma_f32_16x16x32_bf16 a[24:27], a[220:223], v[36:39], a[24:27]
    s_add_u32 s52, s52, 16384
    v_cvt_pk_bf16_f32 v51, v242, v243
    v_mfma_f32_16x16x32_bf16 a[28:31], a[216:219], v[40:43], a[28:31]
    v_exp_f32 v240, v172
    v_mfma_f32_16x16x32_bf16 a[28:31], a[220:223], v[44:47], a[28:31]
    ds_read_b128 a[184:187], v25 offset:14336
    ds_read_b128 a[188:191], v25 offset:15360
    v_mfma_f32_16x16x32_bf16 a[32:35], a[224:227], v[32:35], a[32:35]
    v_exp_f32 v241, v173
    v_mfma_f32_16x16x32_bf16 a[32:35], a[228:231], v[36:39], a[32:35]
    v_cvt_pk_bf16_f32 v58, v240, v241
    v_mfma_f32_16x16x32_bf16 a[36:39], a[224:227], v[40:43], a[36:39]
    v_exp_f32 v242, v174
    v_mfma_f32_16x16x32_bf16 a[36:39], a[228:231], v[44:47], a[36:39]
    v_mfma_f32_16x16x32_bf16 a[40:43], a[232:235], v[32:35], a[40:43]
    v_exp_f32 v243, v175
    v_mfma_f32_16x16x32_bf16 a[40:43], a[236:239], v[36:39], a[40:43]
    v_cvt_pk_bf16_f32 v59, v242, v243
    v_mfma_f32_16x16x32_bf16 a[44:47], a[232:235], v[40:43], a[44:47]
    v_exp_f32 v240, v176
    v_mfma_f32_16x16x32_bf16 a[44:47], a[236:239], v[44:47], a[44:47]
    v_mfma_f32_16x16x32_bf16 a[48:51], a[240:243], v[32:35], a[48:51]
    v_exp_f32 v241, v177
    v_mfma_f32_16x16x32_bf16 a[48:51], a[244:247], v[36:39], a[48:51]
    v_cvt_pk_bf16_f32 v52, v240, v241
    v_mfma_f32_16x16x32_bf16 a[52:55], a[240:243], v[40:43], a[52:55]
    v_exp_f32 v242, v178
    v_mfma_f32_16x16x32_bf16 a[52:55], a[244:247], v[44:47], a[52:55]
    v_mfma_f32_16x16x32_bf16 a[56:59], a[248:251], v[32:35], a[56:59]
    v_exp_f32 v243, v179
    v_mfma_f32_16x16x32_bf16 a[56:59], a[252:255], v[36:39], a[56:59]
    v_cvt_pk_bf16_f32 v53, v242, v243
    v_mfma_f32_16x16x32_bf16 a[60:63], a[248:251], v[40:43], a[60:63]
    v_exp_f32 v240, v180
    v_mfma_f32_16x16x32_bf16 a[60:63], a[252:255], v[44:47], a[60:63]
    s_lshl_b32 s45, s31, 14
    s_add_u32 s53, s53, s45
    s_and_b32 s53, s53, 0xffff
    s_sub_u32 s56, s56, 64
    s_waitcnt lgkmcnt(0)
    v_mfma_f32_16x16x32_bf16 v[128:131], a[128:131], v[64:67], v[224:227]
    v_exp_f32 v241, v181
    v_mfma_f32_16x16x32_bf16 v[128:131], a[132:135], v[80:83], v[128:131]
    v_cvt_pk_bf16_f32 v60, v240, v241
    v_mfma_f32_16x16x32_bf16 v[128:131], a[136:139], v[96:99], v[128:131]
    v_exp_f32 v242, v182
    v_mfma_f32_16x16x32_bf16 v[128:131], a[140:143], v[112:115], v[128:131]
    s_waitcnt vmcnt(5)
    s_barrier
    v_mfma_f32_16x16x32_bf16 v[132:135], a[128:131], v[68:71], v[228:231]
    v_exp_f32 v243, v183
    v_mfma_f32_16x16x32_bf16 v[132:135], a[132:135], v[84:87], v[132:135]
    v_add_u32 v26, s54, v4
    v_cvt_pk_bf16_f32 v61, v242, v243
    v_mfma_f32_16x16x32_bf16 v[132:135], a[136:139], v[100:103], v[132:135]
    v_exp_f32 v240, v184
    v_mfma_f32_16x16x32_bf16 v[132:135], a[140:143], v[116:119], v[132:135]
    v_add_u32 v25, s53, v3
    v_mfma_f32_16x16x32_bf16 v[136:139], a[144:147], v[64:67], v[224:227]
    v_exp_f32 v241, v185
    v_mfma_f32_16x16x32_bf16 v[136:139], a[148:151], v[80:83], v[136:139]
    s_add_u32 s47, s52, 16384
    v_cvt_pk_bf16_f32 v54, v240, v241
    v_mfma_f32_16x16x32_bf16 v[136:139], a[152:155], v[96:99], v[136:139]
    v_exp_f32 v242, v186
    v_mfma_f32_16x16x32_bf16 v[136:139], a[156:159], v[112:115], v[136:139]
    s_mov_b32 m0, s50
    s_xor_b32 s53, s53, 0x8000
    v_mfma_f32_16x16x32_bf16 v[140:143], a[144:147], v[68:71], v[228:231]
    v_exp_f32 v243, v187
    v_mfma_f32_16x16x32_bf16 v[140:143], a[148:151], v[84:87], v[140:143]
    s_add_u32 s54, s54, 32768
    v_cvt_pk_bf16_f32 v55, v242, v243
    v_mfma_f32_16x16x32_bf16 v[140:143], a[152:155], v[100:103], v[140:143]
    v_exp_f32 v240, v188
    v_mfma_f32_16x16x32_bf16 v[140:143], a[156:159], v[116:119], v[140:143]
    buffer_load_dwordx4 v24, s[16:19], s52 offen offset:0 sc1 lds
    v_mfma_f32_16x16x32_bf16 v[144:147], a[160:163], v[64:67], v[224:227]
    v_exp_f32 v241, v189
    v_mfma_f32_16x16x32_bf16 v[144:147], a[164:167], v[80:83], v[144:147]
    s_sub_u32 s46, s54, 98304
    v_cvt_pk_bf16_f32 v62, v240, v241
    v_mfma_f32_16x16x32_bf16 v[144:147], a[168:171], v[96:99], v[144:147]
    v_exp_f32 v242, v190
    v_mfma_f32_16x16x32_bf16 v[144:147], a[172:175], v[112:115], v[144:147]
    buffer_load_dwordx4 v24, s[16:19], s52 offen offset:1024 sc1 lds
    v_mfma_f32_16x16x32_bf16 v[148:151], a[160:163], v[68:71], v[228:231]
    v_exp_f32 v243, v191
    v_mfma_f32_16x16x32_bf16 v[148:151], a[164:167], v[84:87], v[148:151]
    s_min_u32 s54, s54, s46
    v_cvt_pk_bf16_f32 v63, v242, v243
    v_mfma_f32_16x16x32_bf16 v[148:151], a[168:171], v[100:103], v[148:151]
    v_mfma_f32_16x16x32_bf16 v[148:151], a[172:175], v[116:119], v[148:151]
    buffer_load_dwordx4 v24, s[16:19], s52 offen offset:2048 sc1 lds
    v_mfma_f32_16x16x32_bf16 v[12:15], v[8:11], v[48:51], 0
    v_mfma_f32_16x16x32_bf16 v[12:15], v[8:11], v[52:55], v[12:15]
    s_cmp_le_i32 s56, 0
    s_cbranch_scc1 S1_mka0
S1_mka0_r:
    v_mfma_f32_16x16x32_bf16 v[16:19], v[8:11], v[56:59], 0
    v_exp_f32 v240, v128
    v_mfma_f32_16x16x32_bf16 v[16:19], v[8:11], v[60:63], v[16:19]
    v_mfma_f32_16x16x32_bf16 v[152:155], a[176:179], v[64:67], v[224:227]
    v_exp_f32 v241, v129
    v_mfma_f32_16x16x32_bf16 v[152:155], a[180:183], v[80:83], v[152:155]
    v_cvt_pk_bf16_f32 v32, v240, v241
    v_mfma_f32_16x16x32_bf16 v[152:155], a[184:187], v[96:99], v[152:155]
    v_exp_f32 v242, v130
    v_mfma_f32_16x16x32_bf16 v[152:155], a[188:191], v[112:115], v[152:155]
    s_nop 0
    v_max_f32 v1, v12, v16
    v_cmp_lt_f32 vcc, s59, v1
    v_mfma_f32_16x16x32_bf16 v[156:159], a[176:179], v[68:71], v[228:231]
    v_exp_f32 v243, v131
    v_mfma_f32_16x16x32_bf16 v[156:159], a[180:183], v[84:87], v[156:159]
    s_cbranch_vccnz S1_rdb
S1_rdb_r:
    v_cvt_pk_bf16_f32 v33, v242, v243
    v_mfma_f32_16x16x32_bf16 v[156:159], a[184:187], v[100:103], v[156:159]
    v_exp_f32 v240, v132
    v_mfma_f32_16x16x32_bf16 v[156:159], a[188:191], v[116:119], v[156:159]
    v_add_f32 v250, v250, v12
    v_add_f32 v251, v251, v16
    v_mfma_f32_16x16x32_bf16 a[64:67], a[192:195], v[48:51], a[64:67]
    v_exp_f32 v241, v133
    v_mfma_f32_16x16x32_bf16 a[64:67], a[196:199], v[52:55], a[64:67]
    v_cvt_pk_bf16_f32 v40, v240, v241
    v_mfma_f32_16x16x32_bf16 a[68:71], a[192:195], v[56:59], a[68:71]
    v_exp_f32 v242, v134
    v_mfma_f32_16x16x32_bf16 a[68:71], a[196:199], v[60:63], a[68:71]
    buffer_load_dwordx4 v24, s[16:19], s52 offen offset:3072 sc1 lds
    v_mfma_f32_16x16x32_bf16 a[72:75], a[200:203], v[48:51], a[72:75]
    v_exp_f32 v243, v135
    v_mfma_f32_16x16x32_bf16 a[72:75], a[204:207], v[52:55], a[72:75]
    s_add_u32 m0, s50, 16384
    v_cvt_pk_bf16_f32 v41, v242, v243
    v_mfma_f32_16x16x32_bf16 a[76:79], a[200:203], v[56:59], a[76:79]
    v_exp_f32 v240, v136
    v_mfma_f32_16x16x32_bf16 a[76:79], a[204:207], v[60:63], a[76:79]
    buffer_load_dwordx4 v24, s[16:19], s47 offen offset:0 sc1 lds
    v_mfma_f32_16x16x32_bf16 a[80:83], a[208:211], v[48:51], a[80:83]
    v_exp_f32 v241, v137
    v_mfma_f32_16x16x32_bf16 a[80:83], a[212:215], v[52:55], a[80:83]
    ds_read_b128 a[192:195], v26 offset:0
    v_cvt_pk_bf16_f32 v34, v240, v241
    v_mfma_f32_16x16x32_bf16 a[84:87], a[208:211], v[56:59], a[84:87]
    v_exp_f32 v242, v138
    v_mfma_f32_16x16x32_bf16 a[84:87], a[212:215], v[60:63], a[84:87]
    buffer_load_dwordx4 v24, s[16:19], s47 offen offset:1024 sc1 lds
    v_mfma_f32_16x16x32_bf16 a[88:91], a[216:219], v[48:51], a[88:91]
    v_exp_f32 v243, v139
    v_mfma_f32_16x16x32_bf16 a[88:91], a[220:223], v[52:55], a[88:91]
    ds_read_b128 a[196:199], v26 offset:1024
    v_cvt_pk_bf16_f32 v35, v242, v243
    v_mfma_f32_16x16x32_bf16 a[92:95], a[216:219], v[56:59], a[92:95]
    v_exp_f32 v240, v140
    v_mfma_f32_16x16x32_bf16 a[92:95], a[220:223], v[60:63], a[92:95]
    ds_read_b128 a[200:203], v26 offset:2048
    ds_read_b128 a[204:207], v26 offset:3072
    v_mfma_f32_16x16x32_bf16 a[96:99], a[224:227], v[48:51], a[96:99]
    v_exp_f32 v241, v141
    v_mfma_f32_16x16x32_bf16 a[96:99], a[228:231], v[52:55], a[96:99]
    ds_read_b128 a[208:211], v26 offset:4096
    v_cvt_pk_bf16_f32 v42, v240, v241
    v_mfma_f32_16x16x32_bf16 a[100:103], a[224:227], v[56:59], a[100:103]
    v_exp_f32 v242, v142
    v_mfma_f32_16x16x32_bf16 a[100:103], a[228:231], v[60:63], a[100:103]
    buffer_load_dwordx4 v24, s[16:19], s47 offen offset:2048 sc1 lds
    v_mfma_f32_16x16x32_bf16 a[104:107], a[232:235], v[48:51], a[104:107]
    v_exp_f32 v243, v143
    v_mfma_f32_16x16x32_bf16 a[104:107], a[236:239], v[52:55], a[104:107]
    s_cmp_le_i32 s56, 32
    s_cbranch_scc1 S1_mka1
S1_mka1_r:
    v_cvt_pk_bf16_f32 v43, v242, v243
    v_mfma_f32_16x16x32_bf16 a[108:111], a[232:235], v[56:59], a[108:111]
    v_exp_f32 v240, v144
    v_mfma_f32_16x16x32_bf16 a[108:111], a[236:239], v[60:63], a[108:111]
    buffer_load_dwordx4 v24, s[16:19], s47 offen offset:3072 sc1 lds
    v_mfma_f32_16x16x32_bf16 a[112:115], a[240:243], v[48:51], a[112:115]
    v_exp_f32 v241, v145
    v_mfma_f32_16x16x32_bf16 a[112:115], a[244:247], v[52:55], a[112:115]
    ds_read_b128 a[212:215], v26 offset:5120
    v_cvt_pk_bf16_f32 v36, v240, v241
    v_mfma_f32_16x16x32_bf16 a[116:119], a[240:243], v[56:59], a[116:119]
    v_exp_f32 v242, v146
    v_mfma_f32_16x16x32_bf16 a[116:119], a[244:247], v[60:63], a[116:119]
    buffer_load_dword v5, v3, s[8:11], s26 offen
    v_mfma_f32_16x16x32_bf16 a[120:123], a[248:251], v[48:51], a[120:123]
    v_exp_f32 v243, v147
    v_mfma_f32_16x16x32_bf16 a[120:123], a[252:255], v[52:55], a[120:123]
    s_add_u32 s26, s26, 1024
    v_cvt_pk_bf16_f32 v37, v242, v243
    v_mfma_f32_16x16x32_bf16 a[124:127], a[248:251], v[56:59], a[124:127]
    v_exp_f32 v240, v148
    v_mfma_f32_16x16x32_bf16 a[124:127], a[252:255], v[60:63], a[124:127]
    s_xor_b32 s50, s50, 0x8000
    s_add_u32 m0, s51, 0x10000
    v_mfma_f32_16x16x32_bf16 v[160:163], a[128:131], v[72:75], v[232:235]
    v_exp_f32 v241, v149
    v_mfma_f32_16x16x32_bf16 v[160:163], a[132:135], v[88:91], v[160:163]
    ds_read_b128 a[216:219], v26 offset:6144
    v_cvt_pk_bf16_f32 v44, v240, v241
    v_mfma_f32_16x16x32_bf16 v[160:163], a[136:139], v[104:107], v[160:163]
    v_exp_f32 v242, v150
    v_mfma_f32_16x16x32_bf16 v[160:163], a[140:143], v[120:123], v[160:163]
    buffer_load_dwordx4 v24, s[20:23], s52 offen offset:0 sc1 lds
    v_mfma_f32_16x16x32_bf16 v[164:167], a[128:131], v[76:79], v[236:239]
    v_exp_f32 v243, v151
    v_mfma_f32_16x16x32_bf16 v[164:167], a[132:135], v[92:95], v[164:167]
    ds_read_b128 a[220:223], v26 offset:7168
    v_cvt_pk_bf16_f32 v45, v242, v243
    v_mfma_f32_16x16x32_bf16 v[164:167], a[136:139], v[108:111], v[164:167]
    v_exp_f32 v240, v152
    v_mfma_f32_16x16x32_bf16 v[164:167], a[140:143], v[124:127], v[164:167]
    buffer_load_dwordx4 v24, s[20:23], s52 offen offset:1024 sc1 lds
    v_mfma_f32_16x16x32_bf16 v[168:171], a[144:147], v[72:75], v[232:235]
    v_exp_f32 v241, v153
    v_mfma_f32_16x16x32_bf16 v[168:171], a[148:151], v[88:91], v[168:171]
    ds_read_b128 a[224:227], v26 offset:8192
    v_cvt_pk_bf16_f32 v38, v240, v241
    v_mfma_f32_16x16x32_bf16 v[168:171], a[152:155], v[104:107], v[168:171]
    v_exp_f32 v242, v154
    v_mfma_f32_16x16x32_bf16 v[168:171], a[156:159], v[120:123], v[168:171]
    ds_read_b128 a[228:231], v26 offset:9216
    ds_read_b128 a[232:235], v26 offset:10240
    v_mfma_f32_16x16x32_bf16 v[172:175], a[144:147], v[76:79], v[236:239]
    v_exp_f32 v243, v155
    v_mfma_f32_16x16x32_bf16 v[172:175], a[148:151], v[92:95], v[172:175]
    ds_read_b128 a[236:239], v26 offset:11264
    v_cvt_pk_bf16_f32 v39, v242, v243
    v_mfma_f32_16x16x32_bf16 v[172:175], a[152:155], v[108:111], v[172:175]
    v_exp_f32 v240, v156
    v_mfma_f32_16x16x32_bf16 v[172:175], a[156:159], v[124:127], v[172:175]
    buffer_load_dwordx4 v24, s[20:23], s52 offen offset:2048 sc1 lds
    v_mfma_f32_16x16x32_bf16 v[176:179], a[160:163], v[72:75], v[232:235]
    v_exp_f32 v241, v157
    v_mfma_f32_16x16x32_bf16 v[176:179], a[164:167], v[88:91], v[176:179]
    ds_read_b128 a[240:243], v26 offset:12288
    v_cvt_pk_bf16_f32 v46, v240, v241
    v_mfma_f32_16x16x32_bf16 v[176:179], a[168:171], v[104:107], v[176:179]
    v_exp_f32 v242, v158
    v_mfma_f32_16x16x32_bf16 v[176:179], a[172:175], v[120:123], v[176:179]
    ds_read_b128 a[244:247], v26 offset:13312
    ds_read_b128 a[248:251], v26 offset:14336
    v_mfma_f32_16x16x32_bf16 v[180:183], a[160:163], v[76:79], v[236:239]
    v_exp_f32 v243, v159
    v_mfma_f32_16x16x32_bf16 v[180:183], a[164:167], v[92:95], v[180:183]
    ds_read_b128 a[252:255], v26 offset:15360
    v_cvt_pk_bf16_f32 v47, v242, v243
    v_mfma_f32_16x16x32_bf16 v[180:183], a[168:171], v[108:111], v[180:183]
    buffer_load_dwordx4 v24, s[20:23], s52 offen offset:3072 sc1 lds
    v_mfma_f32_16x16x32_bf16 v[180:183], a[172:175], v[124:127], v[180:183]
    s_add_u32 m0, s51, 0x14000
    ds_read_b128 a[128:131], v25 offset:0
    v_mfma_f32_16x16x32_bf16 v[12:15], v[8:11], v[32:35], 0
    ds_read_b128 a[132:135], v25 offset:1024
    ds_read_b128 a[136:139], v25 offset:2048
    v_mfma_f32_16x16x32_bf16 v[12:15], v[8:11], v[36:39], v[12:15]
    ds_read_b128 a[140:143], v25 offset:3072
    ds_read_b128 a[144:147], v25 offset:4096
    v_mfma_f32_16x16x32_bf16 v[16:19], v[8:11], v[40:43], 0
    v_exp_f32 v240, v160
    v_mfma_f32_16x16x32_bf16 v[16:19], v[8:11], v[44:47], v[16:19]
    ds_read_b128 a[148:151], v25 offset:5120
    ds_read_b128 a[152:155], v25 offset:6144
    v_mfma_f32_16x16x32_bf16 v[184:187], a[176:179], v[72:75], v[232:235]
    v_exp_f32 v241, v161
    v_mfma_f32_16x16x32_bf16 v[184:187], a[180:183], v[88:91], v[184:187]
    ds_read_b128 a[156:159], v25 offset:7168
    v_cvt_pk_bf16_f32 v48, v240, v241
    v_mfma_f32_16x16x32_bf16 v[184:187], a[184:187], v[104:107], v[184:187]
    v_exp_f32 v242, v162
    v_mfma_f32_16x16x32_bf16 v[184:187], a[188:191], v[120:123], v[184:187]
    v_max_f32 v1, v12, v16
    v_cmp_lt_f32 vcc, s59, v1
    v_mfma_f32_16x16x32_bf16 v[188:191], a[176:179], v[76:79], v[236:239]
    v_exp_f32 v243, v163
    v_mfma_f32_16x16x32_bf16 v[188:191], a[180:183], v[92:95], v[188:191]
    s_cbranch_vccnz S1_rda
S1_rda_r:
    v_cvt_pk_bf16_f32 v49, v242, v243
    v_mfma_f32_16x16x32_bf16 v[188:191], a[184:187], v[108:111], v[188:191]
    v_exp_f32 v240, v164
    v_mfma_f32_16x16x32_bf16 v[188:191], a[188:191], v[124:127], v[188:191]
    v_add_f32 v248, v248, v12
    v_add_f32 v249, v249, v16
    s_waitcnt lgkmcnt(8)
    v_mfma_f32_16x16x32_bf16 a[0:3], a[192:195], v[32:35], a[0:3]
    v_exp_f32 v241, v165
    v_mfma_f32_16x16x32_bf16 a[0:3], a[196:199], v[36:39], a[0:3]
    ds_read_b128 a[160:163], v25 offset:8192
    v_cvt_pk_bf16_f32 v56, v240, v241
    v_mfma_f32_16x16x32_bf16 a[4:7], a[192:195], v[40:43], a[4:7]
    v_exp_f32 v242, v166
    v_mfma_f32_16x16x32_bf16 a[4:7], a[196:199], v[44:47], a[4:7]
    buffer_load_dwordx4 v24, s[20:23], s47 offen offset:0 sc1 lds
    v_mfma_f32_16x16x32_bf16 a[8:11], a[200:203], v[32:35], a[8:11]
    v_exp_f32 v243, v167
    v_mfma_f32_16x16x32_bf16 a[8:11], a[204:207], v[36:39], a[8:11]
    ds_read_b128 a[164:167], v25 offset:9216
    v_cvt_pk_bf16_f32 v57, v242, v243
    v_mfma_f32_16x16x32_bf16 a[12:15], a[200:203], v[40:43], a[12:15]
    v_exp_f32 v240, v168
    v_mfma_f32_16x16x32_bf16 a[12:15], a[204:207], v[44:47], a[12:15]
    buffer_load_dwordx4 v24, s[20:23], s47 offen offset:1024 sc1 lds
    v_mfma_f32_16x16x32_bf16 a[16:19], a[208:211], v[32:35], a[16:19]
    v_exp_f32 v241, v169
    v_mfma_f32_16x16x32_bf16 a[16:19], a[212:215], v[36:39], a[16:19]
    ds_read_b128 a[168:171], v25 offset:10240
    v_cvt_pk_bf16_f32 v50, v240, v241
    v_mfma_f32_16x16x32_bf16 a[20:23], a[208:211], v[40:43], a[20:23]
    v_exp_f32 v242, v170
    v_mfma_f32_16x16x32_bf16 a[20:23], a[212:215], v[44:47], a[20:23]
    buffer_load_dwordx4 v24, s[20:23], s47 offen offset:2048 sc1 lds
    v_mfma_f32_16x16x32_bf16 a[24:27], a[216:219], v[32:35], a[24:27]
    v_exp_f32 v243, v171
    v_mfma_f32_16x16x32_bf16 a[24:27], a[220:223], v[36:39], a[24:27]
    ds_read_b128 a[172:175], v25 offset:11264
    v_cvt_pk_bf16_f32 v51, v242, v243
    v_mfma_f32_16x16x32_bf16 a[28:31], a[216:219], v[40:43], a[28:31]
    v_exp_f32 v240, v172
    v_mfma_f32_16x16x32_bf16 a[28:31], a[220:223], v[44:47], a[28:31]
    buffer_load_dwordx4 v24, s[20:23], s47 offen offset:3072 sc1 lds
    v_mfma_f32_16x16x32_bf16 a[32:35], a[224:227], v[32:35], a[32:35]
    v_exp_f32 v241, v173
    v_mfma_f32_16x16x32_bf16 a[32:35], a[228:231], v[36:39], a[32:35]
    s_add_u32 s51, s51, 32768
    v_cvt_pk_bf16_f32 v58, v240, v241
    v_mfma_f32_16x16x32_bf16 a[36:39], a[224:227], v[40:43], a[36:39]
    v_exp_f32 v242, v174
    v_mfma_f32_16x16x32_bf16 a[36:39], a[228:231], v[44:47], a[36:39]
    s_sub_u32 s45, s51, 98304
    s_min_u32 s51, s51, s45
    v_mfma_f32_16x16x32_bf16 a[40:43], a[232:235], v[32:35], a[40:43]
    v_exp_f32 v243, v175
    v_mfma_f32_16x16x32_bf16 a[40:43], a[236:239], v[36:39], a[40:43]
    s_add_u32 s52, s52, 32768
    v_cvt_pk_bf16_f32 v59, v242, v243
    v_mfma_f32_16x16x32_bf16 a[44:47], a[232:235], v[40:43], a[44:47]
    v_exp_f32 v240, v176
    v_mfma_f32_16x16x32_bf16 a[44:47], a[236:239], v[44:47], a[44:47]
    ds_read_b128 a[176:179], v25 offset:12288
    ds_read_b128 a[180:183], v25 offset:13312
    v_mfma_f32_16x16x32_bf16 a[48:51], a[240:243], v[32:35], a[48:51]
    v_exp_f32 v241, v177
    v_mfma_f32_16x16x32_bf16 a[48:51], a[244:247], v[36:39], a[48:51]
    ds_read_b128 a[184:187], v25 offset:14336
    v_cvt_pk_bf16_f32 v52, v240, v241
    v_mfma_f32_16x16x32_bf16 a[52:55], a[240:243], v[40:43], a[52:55]
    v_exp_f32 v242, v178
    v_mfma_f32_16x16x32_bf16 a[52:55], a[244:247], v[44:47], a[52:55]
    ds_read_b128 a[188:191], v25 offset:15360
    v_mfma_f32_16x16x32_bf16 a[56:59], a[248:251], v[32:35], a[56:59]
    v_exp_f32 v243, v179
    v_mfma_f32_16x16x32_bf16 a[56:59], a[252:255], v[36:39], a[56:59]
    v_cvt_pk_bf16_f32 v53, v242, v243
    v_mfma_f32_16x16x32_bf16 a[60:63], a[248:251], v[40:43], a[60:63]
    v_exp_f32 v240, v180
    v_mfma_f32_16x16x32_bf16 a[60:63], a[252:255], v[44:47], a[60:63]
    s_waitcnt lgkmcnt(0)
    v_mfma_f32_16x16x32_bf16 v[128:131], a[128:131], v[192:195], 0
    s_lshl_b32 s45, s30, 7
    s_sub_u32 s56, s57, s45
    v_mfma_f32_16x16x32_bf16 v[128:131], a[132:135], v[200:203], v[128:131]
    s_lshl_b32 s45, s31, 7
    s_sub_u32 s56, s56, s45
    v_mfma_f32_16x16x32_bf16 v[128:131], a[136:139], v[208:211], v[128:131]
    s_sub_u32 s56, s56, 96
    v_rcp_f32 v244, v248
    v_mfma_f32_16x16x32_bf16 v[128:131], a[140:143], v[216:219], v[128:131]
    v_rcp_f32 v245, v249
    v_mov_b32 v248, 0
    v_mfma_f32_16x16x32_bf16 v[132:135], a[128:131], v[196:199], 0
    v_mov_b32 v249, 0
    v_mov_b32 v12, -1
    v_mfma_f32_16x16x32_bf16 v[132:135], a[132:135], v[204:207], v[132:135]
    v_mov_b32 v13, -1
    v_mov_b32 v14, -1
    v_mfma_f32_16x16x32_bf16 v[132:135], a[136:139], v[212:215], v[132:135]
    v_mov_b32 v15, -1
    s_lshl_b32 s25, s2, 15
    v_mfma_f32_16x16x32_bf16 v[132:135], a[140:143], v[220:223], v[132:135]
    s_lshl_b32 s27, s28, 13
    s_add_u32 s25, s25, s27
    v_add_u32 v29, s56, v27
    v_accvgpr_read_b32 v136, a0
    v_cmp_le_i32 vcc, 0, v29
    v_accvgpr_read_b32 v137, a1
    v_cmp_le_i32 s[60:61], 1, v29
    v_accvgpr_read_b32 v138, a2
    v_cndmask_b32 v128, v28, v128, vcc
    v_accvgpr_read_b32 v139, a3
    v_cndmask_b32 v129, v28, v129, s[60:61]
    v_accvgpr_read_b32 v140, a8
    v_cmp_le_i32 vcc, 2, v29
    v_accvgpr_read_b32 v141, a9
    v_cmp_le_i32 s[60:61], 3, v29
    v_accvgpr_read_b32 v142, a10
    v_cndmask_b32 v130, v28, v130, vcc
    v_accvgpr_read_b32 v143, a11
    v_cndmask_b32 v131, v28, v131, s[60:61]
    v_pk_mul_f32 v[136:137], v[136:137], v[244:245] op_sel_hi:[1,0]
    v_cmp_le_i32 vcc, -16, v29
    v_pk_mul_f32 v[138:139], v[138:139], v[244:245] op_sel_hi:[1,0]
    v_cmp_le_i32 s[60:61], -15, v29
    v_pk_mul_f32 v[140:141], v[140:141], v[244:245] op_sel_hi:[1,0]
    v_cndmask_b32 v132, v28, v132, vcc
    v_pk_mul_f32 v[142:143], v[142:143], v[244:245] op_sel_hi:[1,0]
    v_cndmask_b32 v133, v28, v133, s[60:61]
    v_cvt_pk_bf16_f32 v152, v136, v137
    v_cmp_le_i32 vcc, -14, v29
    v_cvt_pk_bf16_f32 v153, v138, v139
    v_cmp_le_i32 s[60:61], -13, v29
    v_cvt_pk_bf16_f32 v154, v140, v141
    v_cndmask_b32 v134, v28, v134, vcc
    v_cvt_pk_bf16_f32 v155, v142, v143
    v_cndmask_b32 v135, v28, v135, s[60:61]
    buffer_store_dwordx4 v[152:155], v3, s[4:7], s32 offen offset:0 sc1
    v_max3_f32 v252, v128, v129, v130
    v_accvgpr_read_b32 v144, a4
    v_max3_f32 v253, v132, v133, v134
    v_accvgpr_read_b32 v145, a5
    v_max_f32 v252, v252, v131
    v_accvgpr_read_b32 v146, a6
    v_max_f32 v253, v253, v135
    v_accvgpr_read_b32 v147, a7
    v_mov_b32 v29, v252
    v_accvgpr_read_b32 v148, a12
    v_mov_b32 v30, v253
    v_accvgpr_read_b32 v149, a13
    v_permlane16_swap_b32 v29, v252
    v_accvgpr_read_b32 v150, a14
    v_permlane16_swap_b32 v30, v253
    v_accvgpr_read_b32 v151, a15
    v_max_f32 v252, v252, v29
    v_pk_mul_f32 v[144:145], v[144:145], v[244:245] op_sel:[0,1] op_sel_hi:[1,1]
    v_max_f32 v253, v253, v30
    v_pk_mul_f32 v[146:147], v[146:147], v[244:245] op_sel:[0,1] op_sel_hi:[1,1]
    v_mov_b32 v29, v252
    v_pk_mul_f32 v[148:149], v[148:149], v[244:245] op_sel:[0,1] op_sel_hi:[1,1]
    v_mov_b32 v30, v253
    v_pk_mul_f32 v[150:151], v[150:151], v[244:245] op_sel:[0,1] op_sel_hi:[1,1]
    v_permlane32_swap_b32 v29, v252
    v_cvt_pk_bf16_f32 v156, v144, v145
    v_permlane32_swap_b32 v30, v253
    v_cvt_pk_bf16_f32 v157, v146, v147
    v_max_f32 v252, v252, v29
    v_cvt_pk_bf16_f32 v158, v148, v149
    v_max_f32 v253, v253, v30
    v_cvt_pk_bf16_f32 v159, v150, v151
    v_max_f32 v252, 0xf149f2ca, v252
    buffer_store_dwordx4 v[156:159], v3, s[4:7], s33 offen offset:0 sc1
    v_max_f32 v253, 0xf149f2ca, v253
    v_mfma_f32_32x32x16_bf16 a[0:15], v[20:23], v[20:23], 0
    v_sub_f32 v224, 0, v252
    v_accvgpr_read_b32 v136, a16
    v_sub_f32 v228, 0, v253
    v_accvgpr_read_b32 v137, a17
    v_sub_f32 v225, 0, v252
    v_accvgpr_read_b32 v138, a18
    v_sub_f32 v229, 0, v253
    v_accvgpr_read_b32 v139, a19
    v_sub_f32 v226, 0, v252
    v_accvgpr_read_b32 v140, a24
    v_sub_f32 v230, 0, v253
    v_accvgpr_read_b32 v141, a25
    v_sub_f32 v227, 0, v252
    v_accvgpr_read_b32 v142, a26
    v_sub_f32 v231, 0, v253
    v_accvgpr_read_b32 v143, a27
    s_add_u32 s25, s25, 67110912
    s_add_u32 s27, s25, 4096
    v_pk_mul_f32 v[136:137], v[136:137], v[244:245] op_sel_hi:[1,0]
    v_pk_mul_f32 v[138:139], v[138:139], v[244:245] op_sel_hi:[1,0]
    v_pk_mul_f32 v[140:141], v[140:141], v[244:245] op_sel_hi:[1,0]
    v_pk_mul_f32 v[142:143], v[142:143], v[244:245] op_sel_hi:[1,0]
    v_cvt_pk_bf16_f32 v152, v136, v137
    v_cvt_pk_bf16_f32 v153, v138, v139
    v_cvt_pk_bf16_f32 v154, v140, v141
    v_cvt_pk_bf16_f32 v155, v142, v143
    buffer_store_dwordx4 v[152:155], v3, s[4:7], s32 offen offset:1024 sc1
    buffer_store_dwordx4 v[12:15], v3, s[4:7], s25 offen offset:0 sc1
    v_accvgpr_read_b32 v144, a20
    v_accvgpr_read_b32 v145, a21
    v_accvgpr_read_b32 v146, a22
    v_accvgpr_read_b32 v147, a23
    v_accvgpr_read_b32 v148, a28
    v_accvgpr_read_b32 v149, a29
    v_accvgpr_read_b32 v150, a30
    v_accvgpr_read_b32 v151, a31
    v_pk_mul_f32 v[144:145], v[144:145], v[244:245] op_sel:[0,1] op_sel_hi:[1,1]
    v_pk_mul_f32 v[146:147], v[146:147], v[244:245] op_sel:[0,1] op_sel_hi:[1,1]
    v_pk_mul_f32 v[148:149], v[148:149], v[244:245] op_sel:[0,1] op_sel_hi:[1,1]
    v_pk_mul_f32 v[150:151], v[150:151], v[244:245] op_sel:[0,1] op_sel_hi:[1,1]
    v_cvt_pk_bf16_f32 v156, v144, v145
    v_cvt_pk_bf16_f32 v157, v146, v147
    v_cvt_pk_bf16_f32 v158, v148, v149
    v_cvt_pk_bf16_f32 v159, v150, v151
    buffer_store_dwordx4 v[156:159], v3, s[4:7], s33 offen offset:1024 sc1
    v_mfma_f32_32x32x16_bf16 a[16:31], v[20:23], v[20:23], 0
    v_accvgpr_read_b32 v136, a32
    v_accvgpr_read_b32 v137, a33
    buffer_store_dwordx4 v[12:15], v3, s[4:7], s25 offen offset:1024 sc1
    v_accvgpr_read_b32 v138, a34
    v_accvgpr_read_b32 v139, a35
    v_accvgpr_read_b32 v140, a40
    v_accvgpr_read_b32 v141, a41
    v_accvgpr_read_b32 v142, a42
    v_accvgpr_read_b32 v143, a43
    v_pk_mul_f32 v[136:137], v[136:137], v[244:245] op_sel_hi:[1,0]
    v_pk_mul_f32 v[138:139], v[138:139], v[244:245] op_sel_hi:[1,0]
    v_pk_mul_f32 v[140:141], v[140:141], v[244:245] op_sel_hi:[1,0]
    v_pk_mul_f32 v[142:143], v[142:143], v[244:245] op_sel_hi:[1,0]
    v_cvt_pk_bf16_f32 v152, v136, v137
    v_cvt_pk_bf16_f32 v153, v138, v139
    v_cvt_pk_bf16_f32 v154, v140, v141
    v_cvt_pk_bf16_f32 v155, v142, v143
    buffer_store_dwordx4 v[152:155], v3, s[4:7], s32 offen offset:2048 sc1
    v_accvgpr_read_b32 v144, a36
    v_accvgpr_read_b32 v145, a37
    v_accvgpr_read_b32 v146, a38
    v_accvgpr_read_b32 v147, a39
    v_accvgpr_read_b32 v148, a44
    buffer_store_dwordx4 v[12:15], v3, s[4:7], s25 offen offset:2048 sc1
    v_accvgpr_read_b32 v149, a45
    v_accvgpr_read_b32 v150, a46
    v_accvgpr_read_b32 v151, a47
    v_pk_mul_f32 v[144:145], v[144:145], v[244:245] op_sel:[0,1] op_sel_hi:[1,1]
    v_pk_mul_f32 v[146:147], v[146:147], v[244:245] op_sel:[0,1] op_sel_hi:[1,1]
    v_pk_mul_f32 v[148:149], v[148:149], v[244:245] op_sel:[0,1] op_sel_hi:[1,1]
    v_pk_mul_f32 v[150:151], v[150:151], v[244:245] op_sel:[0,1] op_sel_hi:[1,1]
    v_cvt_pk_bf16_f32 v156, v144, v145
    v_cvt_pk_bf16_f32 v157, v146, v147
    v_cvt_pk_bf16_f32 v158, v148, v149
    v_cvt_pk_bf16_f32 v159, v150, v151
    buffer_store_dwordx4 v[156:159], v3, s[4:7], s33 offen offset:2048 sc1
    v_mfma_f32_32x32x16_bf16 a[32:47], v[20:23], v[20:23], 0
    v_accvgpr_read_b32 v136, a48
    v_accvgpr_read_b32 v137, a49
    v_accvgpr_read_b32 v138, a50
    v_accvgpr_read_b32 v139, a51
    v_accvgpr_read_b32 v140, a56
    v_accvgpr_read_b32 v141, a57
    v_accvgpr_read_b32 v142, a58
    buffer_store_dwordx4 v[12:15], v3, s[4:7], s25 offen offset:3072 sc1
    v_accvgpr_read_b32 v143, a59
    v_pk_mul_f32 v[136:137], v[136:137], v[244:245] op_sel_hi:[1,0]
    v_pk_mul_f32 v[138:139], v[138:139], v[244:245] op_sel_hi:[1,0]
    v_pk_mul_f32 v[140:141], v[140:141], v[244:245] op_sel_hi:[1,0]
    v_pk_mul_f32 v[142:143], v[142:143], v[244:245] op_sel_hi:[1,0]
    v_cvt_pk_bf16_f32 v152, v136, v137
    v_cvt_pk_bf16_f32 v153, v138, v139
    v_cvt_pk_bf16_f32 v154, v140, v141
    v_cvt_pk_bf16_f32 v155, v142, v143
    buffer_store_dwordx4 v[152:155], v3, s[4:7], s32 offen offset:3072 sc1
    v_accvgpr_read_b32 v144, a52
    v_accvgpr_read_b32 v145, a53
    v_accvgpr_read_b32 v146, a54
    v_accvgpr_read_b32 v147, a55
    v_accvgpr_read_b32 v148, a60
    v_accvgpr_read_b32 v149, a61
    v_accvgpr_read_b32 v150, a62
    v_accvgpr_read_b32 v151, a63
    v_pk_mul_f32 v[144:145], v[144:145], v[244:245] op_sel:[0,1] op_sel_hi:[1,1]
    v_pk_mul_f32 v[146:147], v[146:147], v[244:245] op_sel:[0,1] op_sel_hi:[1,1]
    buffer_store_dwordx4 v[12:15], v3, s[4:7], s27 offen offset:0 sc1
    v_pk_mul_f32 v[148:149], v[148:149], v[244:245] op_sel:[0,1] op_sel_hi:[1,1]
    v_pk_mul_f32 v[150:151], v[150:151], v[244:245] op_sel:[0,1] op_sel_hi:[1,1]
    v_cvt_pk_bf16_f32 v156, v144, v145
    v_cvt_pk_bf16_f32 v157, v146, v147
    v_cvt_pk_bf16_f32 v158, v148, v149
    v_cvt_pk_bf16_f32 v159, v150, v151
    buffer_store_dwordx4 v[156:159], v3, s[4:7], s33 offen offset:3072 sc1
    v_mfma_f32_32x32x16_bf16 a[48:63], v[20:23], v[20:23], 0
    buffer_store_dwordx4 v[12:15], v3, s[4:7], s27 offen offset:1024 sc1
    s_lshl_b32 s45, s31, 14
    s_add_u32 s54, s54, s45
    s_add_u32 s54, s54, 81920
    s_sub_u32 s46, s54, 98304
    s_min_u32 s54, s54, s46
    s_lshl_b32 s58, s30, 1
    s_sub_u32 s58, 13, s58
    s_lshl_b32 s45, s29, 2
    s_add_u32 s45, s45, 83890176
    s_lshl_b32 s46, s30, 7
    s_sub_u32 s47, 1920, s46
    v_mov_b32 v6, s46
    s_nop 0
    v_writelane_b32 v6, s47, 1
    v_mov_b32 v7, 1
    s_cmp_lg_u32 s28, 0
    s_cbranch_scc1 K2_SIGA
    s_mov_b64 exec, 3
    buffer_store_dword v7, v6, s[4:7], s45 offen sc1
    s_mov_b64 exec, -1
K2_SIGA:
    s_getpc_b64 s[60:61]
K2_PC2:
    s_add_u32 s60, s60, K3_BEGIN-K2_PC2
    s_addc_u32 s61, s61, 0
    s_bfe_u32 s47, s2, 0x50003
    s_lshl_b32 s47, s47, 10
    v_lshlrev_b32 v31, 2, v31
    v_add_u32 v31, s47, v31
    global_load_dword v31, v31, s[60:61]
    s_lshl_b32 s57, s28, 5
    s_lshl_b32 s45, s31, 6
    s_sub_u32 s57, s57, s45
    s_add_u32 s56, s57, 32
    s_sub_u32 s56, s56, s45
    s_cmp_eq_u32 s30, 7
    s_cbranch_scc1 K2_SF
K2_S:
    s_waitcnt lgkmcnt(0)
    v_mfma_f32_16x16x32_bf16 v[128:131], a[128:131], v[192:195], v[224:227]
    v_exp_f32 v241, v181
    v_mfma_f32_16x16x32_bf16 v[128:131], a[132:135], v[200:203], v[128:131]
    v_cvt_pk_bf16_f32 v60, v240, v241
    v_mfma_f32_16x16x32_bf16 v[128:131], a[136:139], v[208:211], v[128:131]
    v_exp_f32 v242, v182
    v_mfma_f32_16x16x32_bf16 v[128:131], a[140:143], v[216:219], v[128:131]
    s_waitcnt vmcnt(9)
    s_barrier
    v_mfma_f32_16x16x32_bf16 v[132:135], a[128:131], v[196:199], v[228:231]
    v_exp_f32 v243, v183
    v_mfma_f32_16x16x32_bf16 v[132:135], a[132:135], v[204:207], v[132:135]
    v_add_u32 v26, s54, v4
    v_cvt_pk_bf16_f32 v61, v242, v243
    v_mfma_f32_16x16x32_bf16 v[132:135], a[136:139], v[212:215], v[132:135]
    v_exp_f32 v240, v184
    v_mfma_f32_16x16x32_bf16 v[132:135], a[140:143], v[220:223], v[132:135]
    v_add_u32 v25, s53, v3
    v_mfma_f32_16x16x32_bf16 v[136:139], a[144:147], v[192:195], v[224:227]
    v_exp_f32 v241, v185
    v_mfma_f32_16x16x32_bf16 v[136:139], a[148:151], v[200:203], v[136:139]
    s_add_u32 s47, s52, 16384
    v_cvt_pk_bf16_f32 v54, v240, v241
    v_mfma_f32_16x16x32_bf16 v[136:139], a[152:155], v[208:211], v[136:139]
    v_exp_f32 v242, v186
    v_mfma_f32_16x16x32_bf16 v[136:139], a[156:159], v[216:219], v[136:139]
    s_mov_b32 m0, s50
    s_xor_b32 s53, s53, 0x8000
    v_mfma_f32_16x16x32_bf16 v[140:143], a[144:147], v[196:199], v[228:231]
    v_exp_f32 v243, v187
    v_mfma_f32_16x16x32_bf16 v[140:143], a[148:151], v[204:207], v[140:143]
    s_add_u32 s54, s54, 32768
    v_cvt_pk_bf16_f32 v55, v242, v243
    v_mfma_f32_16x16x32_bf16 v[140:143], a[152:155], v[212:215], v[140:143]
    v_exp_f32 v240, v188
    v_mfma_f32_16x16x32_bf16 v[140:143], a[156:159], v[220:223], v[140:143]
    buffer_load_dwordx4 v24, s[16:19], s52 offen offset:0 sc1 lds
    v_mfma_f32_16x16x32_bf16 v[144:147], a[160:163], v[192:195], v[224:227]
    v_exp_f32 v241, v189
    v_mfma_f32_16x16x32_bf16 v[144:147], a[164:167], v[200:203], v[144:147]
    s_sub_u32 s46, s54, 98304
    v_cvt_pk_bf16_f32 v62, v240, v241
    v_mfma_f32_16x16x32_bf16 v[144:147], a[168:171], v[208:211], v[144:147]
    v_exp_f32 v242, v190
    v_mfma_f32_16x16x32_bf16 v[144:147], a[172:175], v[216:219], v[144:147]
    buffer_load_dwordx4 v24, s[16:19], s52 offen offset:1024 sc1 lds
    v_mfma_f32_16x16x32_bf16 v[148:151], a[160:163], v[196:199], v[228:231]
    v_exp_f32 v243, v191
    v_mfma_f32_16x16x32_bf16 v[148:151], a[164:167], v[204:207], v[148:151]
    s_min_u32 s54, s54, s46
    v_cvt_pk_bf16_f32 v63, v242, v243
    v_mfma_f32_16x16x32_bf16 v[148:151], a[168:171], v[212:215], v[148:151]
    v_mfma_f32_16x16x32_bf16 v[148:151], a[172:175], v[220:223], v[148:151]
    buffer_load_dwordx4 v24, s[16:19], s52 offen offset:2048 sc1 lds
    v_mfma_f32_16x16x32_bf16 v[12:15], v[8:11], v[48:51], 0
    v_mfma_f32_16x16x32_bf16 v[12:15], v[8:11], v[52:55], v[12:15]
    v_mfma_f32_16x16x32_bf16 v[16:19], v[8:11], v[56:59], 0
    v_exp_f32 v240, v128
    v_mfma_f32_16x16x32_bf16 v[16:19], v[8:11], v[60:63], v[16:19]
    v_mfma_f32_16x16x32_bf16 v[152:155], a[176:179], v[192:195], v[224:227]
    v_exp_f32 v241, v129
    v_mfma_f32_16x16x32_bf16 v[152:155], a[180:183], v[200:203], v[152:155]
    v_cvt_pk_bf16_f32 v32, v240, v241
    v_mfma_f32_16x16x32_bf16 v[152:155], a[184:187], v[208:211], v[152:155]
    v_exp_f32 v242, v130
    v_mfma_f32_16x16x32_bf16 v[152:155], a[188:191], v[216:219], v[152:155]
    s_nop 0
    v_max_f32 v1, v12, v16
    v_cmp_lt_f32 vcc, s59, v1
    v_mfma_f32_16x16x32_bf16 v[156:159], a[176:179], v[196:199], v[228:231]
    v_exp_f32 v243, v131
    v_mfma_f32_16x16x32_bf16 v[156:159], a[180:183], v[204:207], v[156:159]
    s_cbranch_vccnz S_rdb
S_rdb_r:
    v_cvt_pk_bf16_f32 v33, v242, v243
    v_mfma_f32_16x16x32_bf16 v[156:159], a[184:187], v[212:215], v[156:159]
    v_exp_f32 v240, v132
    v_mfma_f32_16x16x32_bf16 v[156:159], a[188:191], v[220:223], v[156:159]
    v_add_f32 v250, v250, v12
    v_add_f32 v251, v251, v16
    v_mfma_f32_16x16x32_bf16 a[64:67], a[192:195], v[48:51], a[64:67]
    v_exp_f32 v241, v133
    v_mfma_f32_16x16x32_bf16 a[64:67], a[196:199], v[52:55], a[64:67]
    v_cvt_pk_bf16_f32 v40, v240, v241
    v_mfma_f32_16x16x32_bf16 a[68:71], a[192:195], v[56:59], a[68:71]
    v_exp_f32 v242, v134
    v_mfma_f32_16x16x32_bf16 a[68:71], a[196:199], v[60:63], a[68:71]
    buffer_load_dwordx4 v24, s[16:19], s52 offen offset:3072 sc1 lds
    v_mfma_f32_16x16x32_bf16 a[72:75], a[200:203], v[48:51], a[72:75]
    v_exp_f32 v243, v135
    v_mfma_f32_16x16x32_bf16 a[72:75], a[204:207], v[52:55], a[72:75]
    s_add_u32 m0, s50, 16384
    v_cvt_pk_bf16_f32 v41, v242, v243
    v_mfma_f32_16x16x32_bf16 a[76:79], a[200:203], v[56:59], a[76:79]
    v_exp_f32 v240, v136
    v_mfma_f32_16x16x32_bf16 a[76:79], a[204:207], v[60:63], a[76:79]
    buffer_load_dwordx4 v24, s[16:19], s47 offen offset:0 sc1 lds
    v_mfma_f32_16x16x32_bf16 a[80:83], a[208:211], v[48:51], a[80:83]
    v_exp_f32 v241, v137
    v_mfma_f32_16x16x32_bf16 a[80:83], a[212:215], v[52:55], a[80:83]
    ds_read_b128 a[192:195], v26 offset:0
    v_cvt_pk_bf16_f32 v34, v240, v241
    v_mfma_f32_16x16x32_bf16 a[84:87], a[208:211], v[56:59], a[84:87]
    v_exp_f32 v242, v138
    v_mfma_f32_16x16x32_bf16 a[84:87], a[212:215], v[60:63], a[84:87]
    buffer_load_dwordx4 v24, s[16:19], s47 offen offset:1024 sc1 lds
    v_mfma_f32_16x16x32_bf16 a[88:91], a[216:219], v[48:51], a[88:91]
    v_exp_f32 v243, v139
    v_mfma_f32_16x16x32_bf16 a[88:91], a[220:223], v[52:55], a[88:91]
    ds_read_b128 a[196:199], v26 offset:1024
    v_cvt_pk_bf16_f32 v35, v242, v243
    v_mfma_f32_16x16x32_bf16 a[92:95], a[216:219], v[56:59], a[92:95]
    v_exp_f32 v240, v140
    v_mfma_f32_16x16x32_bf16 a[92:95], a[220:223], v[60:63], a[92:95]
    ds_read_b128 a[200:203], v26 offset:2048
    ds_read_b128 a[204:207], v26 offset:3072
    v_mfma_f32_16x16x32_bf16 a[96:99], a[224:227], v[48:51], a[96:99]
    v_exp_f32 v241, v141
    v_mfma_f32_16x16x32_bf16 a[96:99], a[228:231], v[52:55], a[96:99]
    ds_read_b128 a[208:211], v26 offset:4096
    v_cvt_pk_bf16_f32 v42, v240, v241
    v_mfma_f32_16x16x32_bf16 a[100:103], a[224:227], v[56:59], a[100:103]
    v_exp_f32 v242, v142
    v_mfma_f32_16x16x32_bf16 a[100:103], a[228:231], v[60:63], a[100:103]
    buffer_load_dwordx4 v24, s[16:19], s47 offen offset:2048 sc1 lds
    v_mfma_f32_16x16x32_bf16 a[104:107], a[232:235], v[48:51], a[104:107]
    v_exp_f32 v243, v143
    v_mfma_f32_16x16x32_bf16 a[104:107], a[236:239], v[52:55], a[104:107]
    ds_read_b128 a[212:215], v26 offset:5120
    v_cvt_pk_bf16_f32 v43, v242, v243
    v_mfma_f32_16x16x32_bf16 a[108:111], a[232:235], v[56:59], a[108:111]
    v_exp_f32 v240, v144
    v_mfma_f32_16x16x32_bf16 a[108:111], a[236:239], v[60:63], a[108:111]
    buffer_load_dwordx4 v24, s[16:19], s47 offen offset:3072 sc1 lds
    v_mfma_f32_16x16x32_bf16 a[112:115], a[240:243], v[48:51], a[112:115]
    v_exp_f32 v241, v145
    v_mfma_f32_16x16x32_bf16 a[112:115], a[244:247], v[52:55], a[112:115]
    ds_read_b128 a[216:219], v26 offset:6144
    v_cvt_pk_bf16_f32 v36, v240, v241
    v_mfma_f32_16x16x32_bf16 a[116:119], a[240:243], v[56:59], a[116:119]
    v_exp_f32 v242, v146
    v_mfma_f32_16x16x32_bf16 a[116:119], a[244:247], v[60:63], a[116:119]
    buffer_load_dword v5, v3, s[8:11], s26 offen
    v_mfma_f32_16x16x32_bf16 a[120:123], a[248:251], v[48:51], a[120:123]
    v_exp_f32 v243, v147
    v_mfma_f32_16x16x32_bf16 a[120:123], a[252:255], v[52:55], a[120:123]
    s_add_u32 s26, s26, 1024
    v_cvt_pk_bf16_f32 v37, v242, v243
    v_mfma_f32_16x16x32_bf16 a[124:127], a[248:251], v[56:59], a[124:127]
    v_exp_f32 v240, v148
    v_mfma_f32_16x16x32_bf16 a[124:127], a[252:255], v[60:63], a[124:127]
    s_xor_b32 s50, s50, 0x8000
    s_add_u32 m0, s51, 0x10000
    v_mfma_f32_16x16x32_bf16 v[160:163], a[128:131], v[72:75], v[232:235]
    v_exp_f32 v241, v149
    v_mfma_f32_16x16x32_bf16 v[160:163], a[132:135], v[88:91], v[160:163]
    ds_read_b128 a[220:223], v26 offset:7168
    v_cvt_pk_bf16_f32 v44, v240, v241
    v_mfma_f32_16x16x32_bf16 v[160:163], a[136:139], v[104:107], v[160:163]
    v_exp_f32 v242, v150
    v_mfma_f32_16x16x32_bf16 v[160:163], a[140:143], v[120:123], v[160:163]
    buffer_load_dwordx4 v24, s[20:23], s52 offen offset:0 sc1 lds
    v_mfma_f32_16x16x32_bf16 v[164:167], a[128:131], v[76:79], v[236:239]
    v_exp_f32 v243, v151
    v_mfma_f32_16x16x32_bf16 v[164:167], a[132:135], v[92:95], v[164:167]
    ds_read_b128 a[224:227], v26 offset:8192
    v_cvt_pk_bf16_f32 v45, v242, v243
    v_mfma_f32_16x16x32_bf16 v[164:167], a[136:139], v[108:111], v[164:167]
    v_exp_f32 v240, v152
    v_mfma_f32_16x16x32_bf16 v[164:167], a[140:143], v[124:127], v[164:167]
    buffer_load_dwordx4 v24, s[20:23], s52 offen offset:1024 sc1 lds
    v_mfma_f32_16x16x32_bf16 v[168:171], a[144:147], v[72:75], v[232:235]
    v_exp_f32 v241, v153
    v_mfma_f32_16x16x32_bf16 v[168:171], a[148:151], v[88:91], v[168:171]
    ds_read_b128 a[228:231], v26 offset:9216
    v_cvt_pk_bf16_f32 v38, v240, v241
    v_mfma_f32_16x16x32_bf16 v[168:171], a[152:155], v[104:107], v[168:171]
    v_exp_f32 v242, v154
    v_mfma_f32_16x16x32_bf16 v[168:171], a[156:159], v[120:123], v[168:171]
    ds_read_b128 a[232:235], v26 offset:10240
    ds_read_b128 a[236:239], v26 offset:11264
    v_mfma_f32_16x16x32_bf16 v[172:175], a[144:147], v[76:79], v[236:239]
    v_exp_f32 v243, v155
    v_mfma_f32_16x16x32_bf16 v[172:175], a[148:151], v[92:95], v[172:175]
    ds_read_b128 a[240:243], v26 offset:12288
    v_cvt_pk_bf16_f32 v39, v242, v243
    v_mfma_f32_16x16x32_bf16 v[172:175], a[152:155], v[108:111], v[172:175]
    v_exp_f32 v240, v156
    v_mfma_f32_16x16x32_bf16 v[172:175], a[156:159], v[124:127], v[172:175]
    buffer_load_dwordx4 v24, s[20:23], s52 offen offset:2048 sc1 lds
    v_mfma_f32_16x16x32_bf16 v[176:179], a[160:163], v[72:75], v[232:235]
    v_exp_f32 v241, v157
    v_mfma_f32_16x16x32_bf16 v[176:179], a[164:167], v[88:91], v[176:179]
    ds_read_b128 a[244:247], v26 offset:13312
    v_cvt_pk_bf16_f32 v46, v240, v241
    v_mfma_f32_16x16x32_bf16 v[176:179], a[168:171], v[104:107], v[176:179]
    v_exp_f32 v242, v158
    v_mfma_f32_16x16x32_bf16 v[176:179], a[172:175], v[120:123], v[176:179]
    ds_read_b128 a[248:251], v26 offset:14336
    ds_read_b128 a[252:255], v26 offset:15360
    v_mfma_f32_16x16x32_bf16 v[180:183], a[160:163], v[76:79], v[236:239]
    v_exp_f32 v243, v159
    v_mfma_f32_16x16x32_bf16 v[180:183], a[164:167], v[92:95], v[180:183]
    ds_read_b128 a[128:131], v25 offset:0
    v_cvt_pk_bf16_f32 v47, v242, v243
    v_mfma_f32_16x16x32_bf16 v[180:183], a[168:171], v[108:111], v[180:183]
    buffer_load_dwordx4 v24, s[20:23], s52 offen offset:3072 sc1 lds
    v_mfma_f32_16x16x32_bf16 v[180:183], a[172:175], v[124:127], v[180:183]
    s_add_u32 m0, s51, 0x14000
    ds_read_b128 a[132:135], v25 offset:1024
    v_mfma_f32_16x16x32_bf16 v[12:15], v[8:11], v[32:35], 0
    ds_read_b128 a[136:139], v25 offset:2048
    ds_read_b128 a[140:143], v25 offset:3072
    v_mfma_f32_16x16x32_bf16 v[12:15], v[8:11], v[36:39], v[12:15]
    ds_read_b128 a[144:147], v25 offset:4096
    ds_read_b128 a[148:151], v25 offset:5120
    v_mfma_f32_16x16x32_bf16 v[16:19], v[8:11], v[40:43], 0
    v_exp_f32 v240, v160
    v_mfma_f32_16x16x32_bf16 v[16:19], v[8:11], v[44:47], v[16:19]
    ds_read_b128 a[152:155], v25 offset:6144
    ds_read_b128 a[156:159], v25 offset:7168
    v_mfma_f32_16x16x32_bf16 v[184:187], a[176:179], v[72:75], v[232:235]
    v_exp_f32 v241, v161
    v_mfma_f32_16x16x32_bf16 v[184:187], a[180:183], v[88:91], v[184:187]
    ds_read_b128 a[160:163], v25 offset:8192
    v_cvt_pk_bf16_f32 v48, v240, v241
    v_mfma_f32_16x16x32_bf16 v[184:187], a[184:187], v[104:107], v[184:187]
    v_exp_f32 v242, v162
    v_mfma_f32_16x16x32_bf16 v[184:187], a[188:191], v[120:123], v[184:187]
    v_max_f32 v1, v12, v16
    v_cmp_lt_f32 vcc, s59, v1
    v_mfma_f32_16x16x32_bf16 v[188:191], a[176:179], v[76:79], v[236:239]
    v_exp_f32 v243, v163
    v_mfma_f32_16x16x32_bf16 v[188:191], a[180:183], v[92:95], v[188:191]
    s_cbranch_vccnz S_rda
S_rda_r:
    v_cvt_pk_bf16_f32 v49, v242, v243
    v_mfma_f32_16x16x32_bf16 v[188:191], a[184:187], v[108:111], v[188:191]
    v_exp_f32 v240, v164
    v_mfma_f32_16x16x32_bf16 v[188:191], a[188:191], v[124:127], v[188:191]
    v_add_f32 v248, v248, v12
    v_add_f32 v249, v249, v16
    s_waitcnt lgkmcnt(9)
    v_mfma_f32_16x16x32_bf16 a[0:3], a[192:195], v[32:35], a[0:3]
    v_exp_f32 v241, v165
    v_mfma_f32_16x16x32_bf16 a[0:3], a[196:199], v[36:39], a[0:3]
    ds_read_b128 a[164:167], v25 offset:9216
    v_cvt_pk_bf16_f32 v56, v240, v241
    v_mfma_f32_16x16x32_bf16 a[4:7], a[192:195], v[40:43], a[4:7]
    v_exp_f32 v242, v166
    v_mfma_f32_16x16x32_bf16 a[4:7], a[196:199], v[44:47], a[4:7]
    buffer_load_dwordx4 v24, s[20:23], s47 offen offset:0 sc1 lds
    v_mfma_f32_16x16x32_bf16 a[8:11], a[200:203], v[32:35], a[8:11]
    v_exp_f32 v243, v167
    v_mfma_f32_16x16x32_bf16 a[8:11], a[204:207], v[36:39], a[8:11]
    ds_read_b128 a[168:171], v25 offset:10240
    v_cvt_pk_bf16_f32 v57, v242, v243
    v_mfma_f32_16x16x32_bf16 a[12:15], a[200:203], v[40:43], a[12:15]
    v_exp_f32 v240, v168
    v_mfma_f32_16x16x32_bf16 a[12:15], a[204:207], v[44:47], a[12:15]
    buffer_load_dwordx4 v24, s[20:23], s47 offen offset:1024 sc1 lds
    v_mfma_f32_16x16x32_bf16 a[16:19], a[208:211], v[32:35], a[16:19]
    v_exp_f32 v241, v169
    v_mfma_f32_16x16x32_bf16 a[16:19], a[212:215], v[36:39], a[16:19]
    ds_read_b128 a[172:175], v25 offset:11264
    v_cvt_pk_bf16_f32 v50, v240, v241
    v_mfma_f32_16x16x32_bf16 a[20:23], a[208:211], v[40:43], a[20:23]
    v_exp_f32 v242, v170
    v_mfma_f32_16x16x32_bf16 a[20:23], a[212:215], v[44:47], a[20:23]
    buffer_load_dwordx4 v24, s[20:23], s47 offen offset:2048 sc1 lds
    v_mfma_f32_16x16x32_bf16 a[24:27], a[216:219], v[32:35], a[24:27]
    v_exp_f32 v243, v171
    v_mfma_f32_16x16x32_bf16 a[24:27], a[220:223], v[36:39], a[24:27]
    ds_read_b128 a[176:179], v25 offset:12288
    v_cvt_pk_bf16_f32 v51, v242, v243
    v_mfma_f32_16x16x32_bf16 a[28:31], a[216:219], v[40:43], a[28:31]
    v_exp_f32 v240, v172
    v_mfma_f32_16x16x32_bf16 a[28:31], a[220:223], v[44:47], a[28:31]
    buffer_load_dwordx4 v24, s[20:23], s47 offen offset:3072 sc1 lds
    v_mfma_f32_16x16x32_bf16 a[32:35], a[224:227], v[32:35], a[32:35]
    v_exp_f32 v241, v173
    v_mfma_f32_16x16x32_bf16 a[32:35], a[228:231], v[36:39], a[32:35]
    s_add_u32 s51, s51, 32768
    v_cvt_pk_bf16_f32 v58, v240, v241
    v_mfma_f32_16x16x32_bf16 a[36:39], a[224:227], v[40:43], a[36:39]
    v_exp_f32 v242, v174
    v_mfma_f32_16x16x32_bf16 a[36:39], a[228:231], v[44:47], a[36:39]
    s_sub_u32 s45, s51, 98304
    s_min_u32 s51, s51, s45
    v_mfma_f32_16x16x32_bf16 a[40:43], a[232:235], v[32:35], a[40:43]
    v_exp_f32 v243, v175
    v_mfma_f32_16x16x32_bf16 a[40:43], a[236:239], v[36:39], a[40:43]
    s_add_u32 s52, s52, 32768
    v_cvt_pk_bf16_f32 v59, v242, v243
    v_mfma_f32_16x16x32_bf16 a[44:47], a[232:235], v[40:43], a[44:47]
    v_exp_f32 v240, v176
    v_mfma_f32_16x16x32_bf16 a[44:47], a[236:239], v[44:47], a[44:47]
    ds_read_b128 a[180:183], v25 offset:13312
    ds_read_b128 a[184:187], v25 offset:14336
    v_mfma_f32_16x16x32_bf16 a[48:51], a[240:243], v[32:35], a[48:51]
    v_exp_f32 v241, v177
    v_mfma_f32_16x16x32_bf16 a[48:51], a[244:247], v[36:39], a[48:51]
    ds_read_b128 a[188:191], v25 offset:15360
    v_cvt_pk_bf16_f32 v52, v240, v241
    v_mfma_f32_16x16x32_bf16 a[52:55], a[240:243], v[40:43], a[52:55]
    v_exp_f32 v242, v178
    v_mfma_f32_16x16x32_bf16 a[52:55], a[244:247], v[44:47], a[52:55]
    v_mfma_f32_16x16x32_bf16 a[56:59], a[248:251], v[32:35], a[56:59]
    v_exp_f32 v243, v179
    v_mfma_f32_16x16x32_bf16 a[56:59], a[252:255], v[36:39], a[56:59]
    v_cvt_pk_bf16_f32 v53, v242, v243
    v_mfma_f32_16x16x32_bf16 a[60:63], a[248:251], v[40:43], a[60:63]
    v_exp_f32 v240, v180
    v_mfma_f32_16x16x32_bf16 a[60:63], a[252:255], v[44:47], a[60:63]
    s_sub_u32 s58, s58, 1
    s_cbranch_scc0 K2_S
K2_SF:
    s_waitcnt lgkmcnt(0)
    v_mfma_f32_16x16x32_bf16 v[128:131], a[128:131], v[192:195], v[224:227]
    v_exp_f32 v241, v181
    v_mfma_f32_16x16x32_bf16 v[128:131], a[132:135], v[200:203], v[128:131]
    v_cvt_pk_bf16_f32 v60, v240, v241
    v_mfma_f32_16x16x32_bf16 v[128:131], a[136:139], v[208:211], v[128:131]
    v_exp_f32 v242, v182
    v_mfma_f32_16x16x32_bf16 v[128:131], a[140:143], v[216:219], v[128:131]
    s_waitcnt vmcnt(9)
    s_barrier
    v_mfma_f32_16x16x32_bf16 v[132:135], a[128:131], v[196:199], v[228:231]
    v_exp_f32 v243, v183
    v_mfma_f32_16x16x32_bf16 v[132:135], a[132:135], v[204:207], v[132:135]
    v_add_u32 v26, s54, v4
    v_cvt_pk_bf16_f32 v61, v242, v243
    v_mfma_f32_16x16x32_bf16 v[132:135], a[136:139], v[212:215], v[132:135]
    v_exp_f32 v240, v184
    v_mfma_f32_16x16x32_bf16 v[132:135], a[140:143], v[220:223], v[132:135]
    s_bfe_u32 s38, s2, 0x20001
    s_and_b32 s39, s2, 1
    v_mfma_f32_16x16x32_bf16 v[136:139], a[144:147], v[192:195], v[224:227]
    v_exp_f32 v241, v185
    v_mfma_f32_16x16x32_bf16 v[136:139], a[148:151], v[200:203], v[136:139]
    v_lshlrev_b32 v25, 2, v24
    v_cvt_pk_bf16_f32 v54, v240, v241
    v_mfma_f32_16x16x32_bf16 v[136:139], a[152:155], v[208:211], v[136:139]
    v_exp_f32 v242, v186
    v_mfma_f32_16x16x32_bf16 v[136:139], a[156:159], v[216:219], v[136:139]
    v_mul_u32_u24 v5, 3, v3
    v_sub_u32 v25, v25, v5
    v_mfma_f32_16x16x32_bf16 v[140:143], a[144:147], v[196:199], v[228:231]
    v_exp_f32 v243, v187
    v_mfma_f32_16x16x32_bf16 v[140:143], a[148:151], v[204:207], v[140:143]
    s_lshl_b32 s39, s39, 3
    v_cvt_pk_bf16_f32 v55, v242, v243
    v_mfma_f32_16x16x32_bf16 v[140:143], a[152:155], v[212:215], v[140:143]
    v_exp_f32 v240, v188
    v_mfma_f32_16x16x32_bf16 v[140:143], a[156:159], v[220:223], v[140:143]
    s_bfe_u32 s40, s2, 0x30003
    s_add_u32 s36, s39, s40
    v_mfma_f32_16x16x32_bf16 v[144:147], a[160:163], v[192:195], v[224:227]
    v_exp_f32 v241, v189
    v_mfma_f32_16x16x32_bf16 v[144:147], a[164:167], v[200:203], v[144:147]
    s_lshr_b32 s37, s2, 6
    v_cvt_pk_bf16_f32 v62, v240, v241
    v_mfma_f32_16x16x32_bf16 v[144:147], a[168:171], v[208:211], v[144:147]
    v_exp_f32 v242, v190
    v_mfma_f32_16x16x32_bf16 v[144:147], a[172:175], v[216:219], v[144:147]
    s_lshl_b32 s41, s37, 1
    s_add_u32 s40, s40, s41
    v_mfma_f32_16x16x32_bf16 v[148:151], a[160:163], v[196:199], v[228:231]
    v_exp_f32 v243, v191
    v_mfma_f32_16x16x32_bf16 v[148:151], a[164:167], v[204:207], v[148:151]
    s_and_b32 s40, s40, 7
    v_cvt_pk_bf16_f32 v63, v242, v243
    v_mfma_f32_16x16x32_bf16 v[148:151], a[168:171], v[212:215], v[148:151]
    s_sub_u32 s16, s8, 3072
    s_subb_u32 s17, s9, 0
    s_mov_b32 s18, 4197376
    v_mfma_f32_16x16x32_bf16 v[148:151], a[172:175], v[220:223], v[148:151]
    s_mov_b32 s19, 0x00020000
    s_sub_u32 s20, s12, 3072
    s_subb_u32 s21, s13, 0
    v_mfma_f32_16x16x32_bf16 v[12:15], v[8:11], v[48:51], 0
    s_mov_b32 s22, 1412096
    s_mov_b32 s23, 0x00020000
    v_mfma_f32_16x16x32_bf16 v[12:15], v[8:11], v[52:55], v[12:15]
    s_cmp_le_i32 s56, 0
    s_cbranch_scc1 Sf_mka0
Sf_mka0_r:
    v_mfma_f32_16x16x32_bf16 v[16:19], v[8:11], v[56:59], 0
    v_exp_f32 v240, v128
    v_mfma_f32_16x16x32_bf16 v[16:19], v[8:11], v[60:63], v[16:19]
    v_mfma_f32_16x16x32_bf16 v[152:155], a[176:179], v[192:195], v[224:227]
    v_exp_f32 v241, v129
    v_mfma_f32_16x16x32_bf16 v[152:155], a[180:183], v[200:203], v[152:155]
    v_cvt_pk_bf16_f32 v32, v240, v241
    v_mfma_f32_16x16x32_bf16 v[152:155], a[184:187], v[208:211], v[152:155]
    v_exp_f32 v242, v130
    v_mfma_f32_16x16x32_bf16 v[152:155], a[188:191], v[216:219], v[152:155]
    s_nop 0
    v_max_f32 v1, v12, v16
    v_cmp_lt_f32 vcc, s59, v1
    v_mfma_f32_16x16x32_bf16 v[156:159], a[176:179], v[196:199], v[228:231]
    v_exp_f32 v243, v131
    v_mfma_f32_16x16x32_bf16 v[156:159], a[180:183], v[204:207], v[156:159]
    s_cbranch_vccnz Sf_rdb
Sf_rdb_r:
    v_cvt_pk_bf16_f32 v33, v242, v243
    v_mfma_f32_16x16x32_bf16 v[156:159], a[184:187], v[212:215], v[156:159]
    v_exp_f32 v240, v132
    v_mfma_f32_16x16x32_bf16 v[156:159], a[188:191], v[220:223], v[156:159]
    v_add_f32 v250, v250, v12
    v_add_f32 v251, v251, v16
    v_mfma_f32_16x16x32_bf16 a[64:67], a[192:195], v[48:51], a[64:67]
    v_exp_f32 v241, v133
    v_mfma_f32_16x16x32_bf16 a[64:67], a[196:199], v[52:55], a[64:67]
    v_cvt_pk_bf16_f32 v40, v240, v241
    v_mfma_f32_16x16x32_bf16 a[68:71], a[192:195], v[56:59], a[68:71]
    v_exp_f32 v242, v134
    v_mfma_f32_16x16x32_bf16 a[68:71], a[196:199], v[60:63], a[68:71]
    v_mfma_f32_16x16x32_bf16 a[72:75], a[200:203], v[48:51], a[72:75]
    v_exp_f32 v243, v135
    v_mfma_f32_16x16x32_bf16 a[72:75], a[204:207], v[52:55], a[72:75]
    v_and_b32 v197, 31, v2
    v_cvt_pk_bf16_f32 v41, v242, v243
    v_mfma_f32_16x16x32_bf16 a[76:79], a[200:203], v[56:59], a[76:79]
    v_exp_f32 v240, v136
    v_mfma_f32_16x16x32_bf16 a[76:79], a[204:207], v[60:63], a[76:79]
    ds_read_b128 a[192:195], v26 offset:0
    ds_read_b128 a[196:199], v26 offset:1024
    v_mfma_f32_16x16x32_bf16 a[80:83], a[208:211], v[48:51], a[80:83]
    v_exp_f32 v241, v137
    v_mfma_f32_16x16x32_bf16 a[80:83], a[212:215], v[52:55], a[80:83]
    ds_read_b128 a[200:203], v26 offset:2048
    v_cvt_pk_bf16_f32 v34, v240, v241
    v_mfma_f32_16x16x32_bf16 a[84:87], a[208:211], v[56:59], a[84:87]
    v_exp_f32 v242, v138
    v_mfma_f32_16x16x32_bf16 a[84:87], a[212:215], v[60:63], a[84:87]
    ds_read_b128 a[204:207], v26 offset:3072
    v_lshlrev_b32 v197, 2, v197
    v_mfma_f32_16x16x32_bf16 a[88:91], a[216:219], v[48:51], a[88:91]
    v_exp_f32 v243, v139
    v_mfma_f32_16x16x32_bf16 a[88:91], a[220:223], v[52:55], a[88:91]
    ds_read_b128 a[208:211], v26 offset:4096
    v_cvt_pk_bf16_f32 v35, v242, v243
    v_mfma_f32_16x16x32_bf16 a[92:95], a[216:219], v[56:59], a[92:95]
    v_exp_f32 v240, v140
    v_mfma_f32_16x16x32_bf16 a[92:95], a[220:223], v[60:63], a[92:95]
    ds_read_b128 a[212:215], v26 offset:5120
    s_lshl_b32 s51, s36, 7
    v_mfma_f32_16x16x32_bf16 a[96:99], a[224:227], v[48:51], a[96:99]
    v_exp_f32 v241, v141
    v_mfma_f32_16x16x32_bf16 a[96:99], a[228:231], v[52:55], a[96:99]
    ds_read_b128 a[216:219], v26 offset:6144
    v_cvt_pk_bf16_f32 v42, v240, v241
    v_mfma_f32_16x16x32_bf16 a[100:103], a[224:227], v[56:59], a[100:103]
    v_exp_f32 v242, v142
    v_mfma_f32_16x16x32_bf16 a[100:103], a[228:231], v[60:63], a[100:103]
    ds_read_b128 a[220:223], v26 offset:7168
    s_add_u32 s52, s51, 83890176
    v_mfma_f32_16x16x32_bf16 a[104:107], a[232:235], v[48:51], a[104:107]
    v_exp_f32 v243, v143
    v_mfma_f32_16x16x32_bf16 a[104:107], a[236:239], v[52:55], a[104:107]
    s_cmp_le_i32 s56, 32
    s_cbranch_scc1 Sf_mka1
Sf_mka1_r:
    v_cvt_pk_bf16_f32 v43, v242, v243
    v_mfma_f32_16x16x32_bf16 a[108:111], a[232:235], v[56:59], a[108:111]
    v_exp_f32 v240, v144
    v_mfma_f32_16x16x32_bf16 a[108:111], a[236:239], v[60:63], a[108:111]
    ds_read_b128 a[224:227], v26 offset:8192
    ds_read_b128 a[228:231], v26 offset:9216
    v_mfma_f32_16x16x32_bf16 a[112:115], a[240:243], v[48:51], a[112:115]
    v_exp_f32 v241, v145
    v_mfma_f32_16x16x32_bf16 a[112:115], a[244:247], v[52:55], a[112:115]
    ds_read_b128 a[232:235], v26 offset:10240
    v_cvt_pk_bf16_f32 v36, v240, v241
    v_mfma_f32_16x16x32_bf16 a[116:119], a[240:243], v[56:59], a[116:119]
    v_exp_f32 v242, v146
    v_mfma_f32_16x16x32_bf16 a[116:119], a[244:247], v[60:63], a[116:119]
    ds_read_b128 a[236:239], v26 offset:11264
    v_mfma_f32_16x16x32_bf16 a[120:123], a[248:251], v[48:51], a[120:123]
    v_exp_f32 v243, v147
    v_mfma_f32_16x16x32_bf16 a[120:123], a[252:255], v[52:55], a[120:123]
    ds_read_b128 a[240:243], v26 offset:12288
    v_cvt_pk_bf16_f32 v37, v242, v243
    v_mfma_f32_16x16x32_bf16 a[124:127], a[248:251], v[56:59], a[124:127]
    v_exp_f32 v240, v148
    v_mfma_f32_16x16x32_bf16 a[124:127], a[252:255], v[60:63], a[124:127]
    ds_read_b128 a[244:247], v26 offset:13312
    v_mfma_f32_16x16x32_bf16 v[160:163], a[128:131], v[72:75], v[232:235]
    v_exp_f32 v241, v149
    v_mfma_f32_16x16x32_bf16 v[160:163], a[132:135], v[88:91], v[160:163]
    ds_read_b128 a[248:251], v26 offset:14336
    v_cvt_pk_bf16_f32 v44, v240, v241
    v_mfma_f32_16x16x32_bf16 v[160:163], a[136:139], v[104:107], v[160:163]
    v_exp_f32 v242, v150
    v_mfma_f32_16x16x32_bf16 v[160:163], a[140:143], v[120:123], v[160:163]
    ds_read_b128 a[252:255], v26 offset:15360
    v_mfma_f32_16x16x32_bf16 v[164:167], a[128:131], v[76:79], v[236:239]
    v_exp_f32 v243, v151
    v_mfma_f32_16x16x32_bf16 v[164:167], a[132:135], v[92:95], v[164:167]
    v_cvt_pk_bf16_f32 v45, v242, v243
    v_mfma_f32_16x16x32_bf16 v[164:167], a[136:139], v[108:111], v[164:167]
    v_exp_f32 v240, v152
    v_mfma_f32_16x16x32_bf16 v[164:167], a[140:143], v[124:127], v[164:167]
    buffer_load_dword v198, v197, s[4:7], s52 offen sc1
    v_mfma_f32_16x16x32_bf16 v[168:171], a[144:147], v[72:75], v[232:235]
    v_exp_f32 v241, v153
    v_mfma_f32_16x16x32_bf16 v[168:171], a[148:151], v[88:91], v[168:171]
    s_lshl_b32 s39, s36, 3
    v_cvt_pk_bf16_f32 v38, v240, v241
    v_mfma_f32_16x16x32_bf16 v[168:171], a[152:155], v[104:107], v[168:171]
    v_exp_f32 v242, v154
    v_mfma_f32_16x16x32_bf16 v[168:171], a[156:159], v[120:123], v[168:171]
    s_lshl_b32 s41, s28, 1
    s_add_u32 s39, s39, s41
    v_mfma_f32_16x16x32_bf16 v[172:175], a[144:147], v[76:79], v[236:239]
    v_exp_f32 v243, v155
    v_mfma_f32_16x16x32_bf16 v[172:175], a[148:151], v[92:95], v[172:175]
    s_mul_i32 s39, s39, 176128
    v_cvt_pk_bf16_f32 v39, v242, v243
    v_mfma_f32_16x16x32_bf16 v[172:175], a[152:155], v[108:111], v[172:175]
    v_exp_f32 v240, v156
    v_mfma_f32_16x16x32_bf16 v[172:175], a[156:159], v[124:127], v[172:175]
    s_add_u32 s32, s39, 35651584
    s_mul_i32 s39, s38, 11
    v_mfma_f32_16x16x32_bf16 v[176:179], a[160:163], v[72:75], v[232:235]
    v_exp_f32 v241, v157
    v_mfma_f32_16x16x32_bf16 v[176:179], a[164:167], v[88:91], v[176:179]
    s_lshl_b32 s43, s39, 15
    v_cvt_pk_bf16_f32 v46, v240, v241
    v_mfma_f32_16x16x32_bf16 v[176:179], a[168:171], v[104:107], v[176:179]
    v_exp_f32 v242, v158
    v_mfma_f32_16x16x32_bf16 v[176:179], a[172:175], v[120:123], v[176:179]
    s_lshl_b32 s39, s39, 10
    s_add_u32 s42, s32, s39
    v_mfma_f32_16x16x32_bf16 v[180:183], a[160:163], v[76:79], v[236:239]
    v_exp_f32 v243, v159
    v_mfma_f32_16x16x32_bf16 v[180:183], a[164:167], v[92:95], v[180:183]
    s_add_u32 s42, s42, 131072
    v_cvt_pk_bf16_f32 v47, v242, v243
    v_mfma_f32_16x16x32_bf16 v[180:183], a[168:171], v[108:111], v[180:183]
    s_add_u32 s33, s32, 174080
    v_add_u32 v194, 175104, v3
    v_mfma_f32_16x16x32_bf16 v[180:183], a[172:175], v[124:127], v[180:183]
    s_lshl_b32 s44, s28, 12
    v_bfe_u32 v199, v2, 4, 2
    v_mfma_f32_16x16x32_bf16 v[12:15], v[8:11], v[32:35], 0
    v_lshlrev_b32 v199, 1, v199
    v_and_b32 v200, 7, v2
    v_mfma_f32_16x16x32_bf16 v[12:15], v[8:11], v[36:39], v[12:15]
    s_cmp_le_i32 s57, 0
    s_cbranch_scc1 Sf_mkb0
Sf_mkb0_r:
    v_mfma_f32_16x16x32_bf16 v[16:19], v[8:11], v[40:43], 0
    v_exp_f32 v240, v160
    v_mfma_f32_16x16x32_bf16 v[16:19], v[8:11], v[44:47], v[16:19]
    v_xor_b32 v199, v199, v200
    v_lshlrev_b32 v199, 4, v199
    v_mfma_f32_16x16x32_bf16 v[184:187], a[176:179], v[72:75], v[232:235]
    v_exp_f32 v241, v161
    v_mfma_f32_16x16x32_bf16 v[184:187], a[180:183], v[88:91], v[184:187]
    v_lshrrev_b32 v200, 3, v2
    v_cvt_pk_bf16_f32 v48, v240, v241
    v_mfma_f32_16x16x32_bf16 v[184:187], a[184:187], v[104:107], v[184:187]
    v_exp_f32 v242, v162
    v_mfma_f32_16x16x32_bf16 v[184:187], a[188:191], v[120:123], v[184:187]
    v_max_f32 v1, v12, v16
    v_cmp_lt_f32 vcc, s59, v1
    v_mfma_f32_16x16x32_bf16 v[188:191], a[176:179], v[76:79], v[236:239]
    v_exp_f32 v243, v163
    v_mfma_f32_16x16x32_bf16 v[188:191], a[180:183], v[92:95], v[188:191]
    s_cbranch_vccnz Sf_rda
Sf_rda_r:
    v_cvt_pk_bf16_f32 v49, v242, v243
    v_mfma_f32_16x16x32_bf16 v[188:191], a[184:187], v[108:111], v[188:191]
    v_exp_f32 v240, v164
    v_mfma_f32_16x16x32_bf16 v[188:191], a[188:191], v[124:127], v[188:191]
    v_add_f32 v248, v248, v12
    v_add_f32 v249, v249, v16
    s_waitcnt lgkmcnt(0)
    v_mfma_f32_16x16x32_bf16 a[0:3], a[192:195], v[32:35], a[0:3]
    v_exp_f32 v241, v165
    v_mfma_f32_16x16x32_bf16 a[0:3], a[196:199], v[36:39], a[0:3]
    v_lshl_add_u32 v196, v200, 10, v199
    v_cvt_pk_bf16_f32 v56, v240, v241
    v_mfma_f32_16x16x32_bf16 a[4:7], a[192:195], v[40:43], a[4:7]
    v_exp_f32 v242, v166
    v_mfma_f32_16x16x32_bf16 a[4:7], a[196:199], v[44:47], a[4:7]
    s_lshl_b32 s39, s37, 8
    s_lshl_b32 s41, s28, 13
    v_mfma_f32_16x16x32_bf16 a[8:11], a[200:203], v[32:35], a[8:11]
    v_exp_f32 v243, v167
    v_mfma_f32_16x16x32_bf16 a[8:11], a[204:207], v[36:39], a[8:11]
    ds_write_b128 v25, a[0:3] offset:0
    v_cvt_pk_bf16_f32 v57, v242, v243
    v_mfma_f32_16x16x32_bf16 a[12:15], a[200:203], v[40:43], a[12:15]
    v_exp_f32 v240, v168
    v_mfma_f32_16x16x32_bf16 a[12:15], a[204:207], v[44:47], a[12:15]
    ds_write_b128 v25, a[4:7] offset:1024
    s_add_u32 s39, s39, s41
    v_mfma_f32_16x16x32_bf16 a[16:19], a[208:211], v[32:35], a[16:19]
    v_exp_f32 v241, v169
    v_mfma_f32_16x16x32_bf16 a[16:19], a[212:215], v[36:39], a[16:19]
    ds_write_b128 v25, a[8:11] offset:2048
    v_cvt_pk_bf16_f32 v50, v240, v241
    v_mfma_f32_16x16x32_bf16 a[20:23], a[208:211], v[40:43], a[20:23]
    v_exp_f32 v242, v170
    v_mfma_f32_16x16x32_bf16 a[20:23], a[212:215], v[44:47], a[20:23]
    ds_write_b128 v25, a[12:15] offset:3072
    v_add_u32 v196, s39, v196
    v_mfma_f32_16x16x32_bf16 a[24:27], a[216:219], v[32:35], a[24:27]
    v_exp_f32 v243, v171
    v_mfma_f32_16x16x32_bf16 a[24:27], a[220:223], v[36:39], a[24:27]
    ds_write_b128 v25, a[16:19] offset:4096
    v_cvt_pk_bf16_f32 v51, v242, v243
    v_mfma_f32_16x16x32_bf16 a[28:31], a[216:219], v[40:43], a[28:31]
    v_exp_f32 v240, v172
    v_mfma_f32_16x16x32_bf16 a[28:31], a[220:223], v[44:47], a[28:31]
    ds_write_b128 v25, a[20:23] offset:5120
    v_add_u32 v195, 1024, v196
    v_mfma_f32_16x16x32_bf16 a[32:35], a[224:227], v[32:35], a[32:35]
    v_exp_f32 v241, v173
    v_mfma_f32_16x16x32_bf16 a[32:35], a[228:231], v[36:39], a[32:35]
    ds_write_b128 v25, a[24:27] offset:6144
    v_cvt_pk_bf16_f32 v58, v240, v241
    v_mfma_f32_16x16x32_bf16 a[36:39], a[224:227], v[40:43], a[36:39]
    v_exp_f32 v242, v174
    v_mfma_f32_16x16x32_bf16 a[36:39], a[228:231], v[44:47], a[36:39]
    ds_write_b128 v25, a[28:31] offset:7168
    v_add_u32 v196, 128, v196
    v_mfma_f32_16x16x32_bf16 a[40:43], a[232:235], v[32:35], a[40:43]
    v_exp_f32 v243, v175
    v_mfma_f32_16x16x32_bf16 a[40:43], a[236:239], v[36:39], a[40:43]
    s_cmp_le_i32 s57, 32
    s_cbranch_scc1 Sf_mkb1
Sf_mkb1_r:
    v_cvt_pk_bf16_f32 v59, v242, v243
    v_mfma_f32_16x16x32_bf16 a[44:47], a[232:235], v[40:43], a[44:47]
    v_exp_f32 v240, v176
    v_mfma_f32_16x16x32_bf16 a[44:47], a[236:239], v[44:47], a[44:47]
    ds_write_b128 v25, a[32:35] offset:8192
    ds_write_b128 v25, a[36:39] offset:9216
    v_mfma_f32_16x16x32_bf16 a[48:51], a[240:243], v[32:35], a[48:51]
    v_exp_f32 v241, v177
    v_mfma_f32_16x16x32_bf16 a[48:51], a[244:247], v[36:39], a[48:51]
    ds_write_b128 v25, a[40:43] offset:10240
    v_cvt_pk_bf16_f32 v52, v240, v241
    v_mfma_f32_16x16x32_bf16 a[52:55], a[240:243], v[40:43], a[52:55]
    v_exp_f32 v242, v178
    v_mfma_f32_16x16x32_bf16 a[52:55], a[244:247], v[44:47], a[52:55]
    ds_write_b128 v25, a[44:47] offset:11264
    v_mfma_f32_16x16x32_bf16 a[56:59], a[248:251], v[32:35], a[56:59]
    v_exp_f32 v243, v179
    v_mfma_f32_16x16x32_bf16 a[56:59], a[252:255], v[36:39], a[56:59]
    ds_write_b128 v25, a[48:51] offset:12288
    v_cvt_pk_bf16_f32 v53, v242, v243
    v_mfma_f32_16x16x32_bf16 a[60:63], a[248:251], v[40:43], a[60:63]
    v_exp_f32 v240, v180
    v_mfma_f32_16x16x32_bf16 a[60:63], a[252:255], v[44:47], a[60:63]
    ds_write_b128 v25, a[52:55] offset:13312
    s_waitcnt vmcnt(1)
    s_barrier
    v_xor_b32 v26, 0x4000, v25
    v_add_u32 v24, 0x10000, v24
    v_mov_b32 v224, v252
    v_mov_b32 v225, v253
    v_mov_b32 v226, v248
    v_mov_b32 v227, v249
    ds_write_b128 v24, v[224:227]
    v_exp_f32 v241, v181
    s_waitcnt vmcnt(0)
    ds_write_b128 v25, a[56:59] offset:14336
    v_cmp_ne_u32 vcc, 1, v198
    v_cvt_pk_bf16_f32 v60, v240, v241
    s_cbranch_vccnz K3_ASPIN_E
K3_AOK:
    ds_write_b128 v25, a[60:63] offset:15360
    s_add_u32 m0, s44, 81920
    v_exp_f32 v242, v182
    s_nop 0
    v_exp_f32 v243, v183
    buffer_load_dwordx4 v3, s[4:7], s42 offen sc1 lds
    v_cvt_pk_bf16_f32 v61, v242, v243
    buffer_load_dwordx4 v194, s[4:7], s42 offen offset:1024 sc1 lds
    v_exp_f32 v240, v184
    buffer_load_dwordx4 v195, s[20:23], s43 offen offset:2048 lds
    v_exp_f32 v241, v185
    buffer_load_dwordx4 v196, s[20:23], s43 offen offset:3072 lds
    v_cvt_pk_bf16_f32 v54, v240, v241
    s_add_u32 s42, s42, 1024
    v_exp_f32 v242, v186
    s_add_u32 s43, s43, 32768
    v_exp_f32 v243, v187
    s_add_u32 m0, s44, 98304
    v_cvt_pk_bf16_f32 v55, v242, v243
    buffer_load_dwordx4 v3, s[4:7], s42 offen sc1 lds
    v_exp_f32 v240, v188
    buffer_load_dwordx4 v194, s[4:7], s42 offen offset:1024 sc1 lds
    v_exp_f32 v241, v189
    buffer_load_dwordx4 v195, s[20:23], s43 offen offset:2048 lds
    v_cvt_pk_bf16_f32 v62, v240, v241
    buffer_load_dwordx4 v196, s[20:23], s43 offen offset:3072 lds
    v_exp_f32 v242, v190
    s_add_u32 s42, s42, 1024
    v_exp_f32 v243, v191
    s_add_u32 s43, s43, 32768
    v_cvt_pk_bf16_f32 v63, v242, v243
    s_add_u32 m0, s44, 114688
    v_mfma_f32_16x16x32_bf16 v[12:15], v[8:11], v[48:51], 0
    buffer_load_dwordx4 v3, s[4:7], s42 offen sc1 lds
    v_mfma_f32_16x16x32_bf16 v[12:15], v[8:11], v[52:55], v[12:15]
    buffer_load_dwordx4 v194, s[4:7], s42 offen offset:1024 sc1 lds
    v_mfma_f32_16x16x32_bf16 v[16:19], v[8:11], v[56:59], 0
    buffer_load_dwordx4 v195, s[20:23], s43 offen offset:2048 lds
    v_mfma_f32_16x16x32_bf16 v[16:19], v[8:11], v[60:63], v[16:19]
    buffer_load_dwordx4 v196, s[20:23], s43 offen offset:3072 lds
    s_nop 6
    v_max_f32 v1, v12, v16
    v_cmp_lt_f32 vcc, s59, v1
    s_cbranch_vccnz TL_rdb
TL_rdb_r:
    v_add_f32 v250, v250, v12
    v_add_f32 v251, v251, v16
    v_mfma_f32_16x16x32_bf16 a[64:67], a[192:195], v[48:51], a[64:67]
    s_load_dwordx2 s[56:57], s[0:1], 0
    v_mfma_f32_16x16x32_bf16 a[64:67], a[196:199], v[52:55], a[64:67]
    s_load_dwordx2 s[62:63], s[0:1], 80
    v_mfma_f32_16x16x32_bf16 a[68:71], a[192:195], v[56:59], a[68:71]
    v_lshrrev_b32 v16, 5, v2
    v_mfma_f32_16x16x32_bf16 a[68:71], a[196:199], v[60:63], a[68:71]
    v_lshlrev_b32 v16, 12, v16
    v_mfma_f32_16x16x32_bf16 a[72:75], a[200:203], v[48:51], a[72:75]
    v_bfe_u32 v17, v2, 2, 3
    v_mfma_f32_16x16x32_bf16 a[72:75], a[204:207], v[52:55], a[72:75]
    v_lshl_add_u32 v16, v17, 7, v16
    v_mfma_f32_16x16x32_bf16 a[76:79], a[200:203], v[56:59], a[76:79]
    v_and_b32 v17, 3, v2
    v_mfma_f32_16x16x32_bf16 a[76:79], a[204:207], v[60:63], a[76:79]
    v_lshl_add_u32 v16, v17, 3, v16
    s_waitcnt lgkmcnt(0)
    s_barrier
    v_xor_b32 v24, 0x1000, v24
    ds_read_b128 v[224:227], v24
    v_mfma_f32_16x16x32_bf16 a[80:83], a[208:211], v[48:51], a[80:83]
    ds_read_b128 v[64:67], v26 offset:0
    ds_read_b128 v[68:71], v26 offset:1024
    v_mfma_f32_16x16x32_bf16 a[80:83], a[212:215], v[52:55], a[80:83]
    ds_read_b128 v[72:75], v26 offset:2048
    ds_read_b128 v[76:79], v26 offset:3072
    v_mfma_f32_16x16x32_bf16 a[84:87], a[208:211], v[56:59], a[84:87]
    ds_read_b128 v[80:83], v26 offset:4096
    ds_read_b128 v[84:87], v26 offset:5120
    v_mfma_f32_16x16x32_bf16 a[84:87], a[212:215], v[60:63], a[84:87]
    ds_read_b128 v[88:91], v26 offset:6144
    ds_read_b128 v[92:95], v26 offset:7168
    v_mfma_f32_16x16x32_bf16 a[88:91], a[216:219], v[48:51], a[88:91]
    ds_read_b128 v[96:99], v26 offset:8192
    ds_read_b128 v[100:103], v26 offset:9216
    v_mfma_f32_16x16x32_bf16 a[88:91], a[220:223], v[52:55], a[88:91]
    ds_read_b128 v[104:107], v26 offset:10240
    ds_read_b128 v[108:111], v26 offset:11264
    v_mfma_f32_16x16x32_bf16 a[92:95], a[216:219], v[56:59], a[92:95]
    ds_read_b128 v[112:115], v26 offset:12288
    ds_read_b128 v[116:119], v26 offset:13312
    v_mfma_f32_16x16x32_bf16 a[92:95], a[220:223], v[60:63], a[92:95]
    ds_read_b128 v[120:123], v26 offset:14336
    ds_read_b128 v[124:127], v26 offset:15360
    v_mfma_f32_16x16x32_bf16 a[96:99], a[224:227], v[48:51], a[96:99]
    s_waitcnt lgkmcnt(15)
    v_max_f32 v29, v224, v254
    v_mfma_f32_16x16x32_bf16 a[96:99], a[228:231], v[52:55], a[96:99]
    v_max_f32 v30, v225, v255
    v_sub_f32 v224, v224, v29
    v_mfma_f32_16x16x32_bf16 a[100:103], a[224:227], v[56:59], a[100:103]
    v_sub_f32 v225, v225, v30
    v_sub_f32 v254, v254, v29
    v_mfma_f32_16x16x32_bf16 a[100:103], a[228:231], v[60:63], a[100:103]
    v_sub_f32 v255, v255, v30
    v_exp_f32 v224, v224
    v_mfma_f32_16x16x32_bf16 a[104:107], a[232:235], v[48:51], a[104:107]
    v_exp_f32 v225, v225
    v_exp_f32 v254, v254
    v_mfma_f32_16x16x32_bf16 a[104:107], a[236:239], v[52:55], a[104:107]
    v_exp_f32 v255, v255
    v_mul_f32 v250, v250, v254
    v_mfma_f32_16x16x32_bf16 a[108:111], a[232:235], v[56:59], a[108:111]
    v_mul_f32 v251, v251, v255
    v_fmac_f32 v250, v226, v224
    v_mfma_f32_16x16x32_bf16 a[108:111], a[236:239], v[60:63], a[108:111]
    v_fmac_f32 v251, v227, v225
    v_rcp_f32 v250, v250
    v_mfma_f32_16x16x32_bf16 a[112:115], a[240:243], v[48:51], a[112:115]
    v_rcp_f32 v251, v251
    v_mul_f32 v246, v254, v250
    v_mfma_f32_16x16x32_bf16 a[112:115], a[244:247], v[52:55], a[112:115]
    v_mul_f32 v247, v255, v251
    v_mul_f32 v244, v224, v250
    v_mfma_f32_16x16x32_bf16 a[116:119], a[240:243], v[56:59], a[116:119]
    v_mul_f32 v245, v225, v251
    v_bfe_u32 v17, v2, 3, 2
    v_mfma_f32_16x16x32_bf16 a[116:119], a[244:247], v[60:63], a[116:119]
    v_lshl_add_u32 v16, v17, 5, v16
    s_and_b32 s39, s28, 1
    v_mfma_f32_16x16x32_bf16 a[120:123], a[248:251], v[48:51], a[120:123]
    s_lshl_b32 s39, s39, 10
    s_add_u32 s39, s39, 2048
    v_mfma_f32_16x16x32_bf16 a[120:123], a[252:255], v[52:55], a[120:123]
    v_add_u32 v12, s39, v16
    v_xor_b32 v13, 32, v12
    v_mfma_f32_16x16x32_bf16 a[124:127], a[248:251], v[56:59], a[124:127]
    v_xor_b32 v14, 64, v12
    v_xor_b32 v15, 96, v12
    v_mfma_f32_16x16x32_bf16 a[124:127], a[252:255], v[60:63], a[124:127]
    s_lshl_b32 s39, s38, 2
    s_lshr_b32 s39, 0x54105410, s39
    s_and_b32 s41, s28, 2
    s_lshl_b32 s41, s41, 12
    v_add_u32 v16, s41, v3
    s_bfe_u32 s41, s39, 0x40000
    v_lshl_add_u32 v8, s41, 10, v16
    s_bfe_u32 s41, s39, 0x40004
    v_lshl_add_u32 v9, s41, 10, v16
    s_bfe_u32 s41, s39, 0x40008
    v_lshl_add_u32 v10, s41, 10, v16
    s_bfe_u32 s41, s39, 0x4000c
    v_lshl_add_u32 v11, s41, 10, v16
    v_add_u32 v208, 65536, v8
    v_add_u32 v209, 65536, v9
    v_add_u32 v210, 65536, v10
    v_add_u32 v211, 65536, v11
    v_add_u32 v212, 65536, v12
    v_add_u32 v213, 65536, v13
    v_add_u32 v214, 65536, v14
    v_add_u32 v215, 65536, v15
    v_add_u32 v216, 131072, v8
    v_add_u32 v217, 131072, v9
    v_add_u32 v218, 131072, v10
    v_add_u32 v219, 131072, v11
    v_add_u32 v220, 131072, v12
    v_add_u32 v221, 131072, v13
    v_add_u32 v222, 131072, v14
    v_add_u32 v223, 131072, v15
    s_waitcnt lgkmcnt(0)
    v_accvgpr_read_b32 v136, a64
    v_accvgpr_read_b32 v137, a65
    v_accvgpr_read_b32 v138, a66
    v_accvgpr_read_b32 v139, a67
    v_accvgpr_read_b32 v140, a72
    v_accvgpr_read_b32 v141, a73
    v_accvgpr_read_b32 v142, a74
    v_accvgpr_read_b32 v143, a75
    v_pk_mul_f32 v[136:137], v[136:137], v[246:247] op_sel_hi:[1,0]
    v_pk_fma_f32 v[136:137], v[64:65], v[244:245], v[136:137] op_sel_hi:[1,0,1]
    v_pk_mul_f32 v[138:139], v[138:139], v[246:247] op_sel_hi:[1,0]
    v_pk_fma_f32 v[138:139], v[66:67], v[244:245], v[138:139] op_sel_hi:[1,0,1]
    v_pk_mul_f32 v[140:141], v[140:141], v[246:247] op_sel_hi:[1,0]
    v_pk_fma_f32 v[140:141], v[72:73], v[244:245], v[140:141] op_sel_hi:[1,0,1]
    v_pk_mul_f32 v[142:143], v[142:143], v[246:247] op_sel_hi:[1,0]
    v_pk_fma_f32 v[142:143], v[74:75], v[244:245], v[142:143] op_sel_hi:[1,0,1]
    v_cvt_pk_bf16_f32 v152, v136, v137
    v_cvt_pk_bf16_f32 v153, v138, v139
    v_cvt_pk_bf16_f32 v154, v140, v141
    v_cvt_pk_bf16_f32 v155, v142, v143
    buffer_store_dwordx4 v[152:155], v3, s[4:7], s34 offen offset:0 sc1
    v_accvgpr_read_b32 v144, a68
    v_accvgpr_read_b32 v145, a69
    v_accvgpr_read_b32 v146, a70
    v_accvgpr_read_b32 v147, a71
    v_accvgpr_read_b32 v148, a76
    v_accvgpr_read_b32 v149, a77
    v_accvgpr_read_b32 v150, a78
    v_accvgpr_read_b32 v151, a79
    v_pk_mul_f32 v[144:145], v[144:145], v[246:247] op_sel:[0,1] op_sel_hi:[1,1]
    v_pk_fma_f32 v[144:145], v[68:69], v[244:245], v[144:145] op_sel:[0,1,0] op_sel_hi:[1,1,1]
    v_pk_mul_f32 v[146:147], v[146:147], v[246:247] op_sel:[0,1] op_sel_hi:[1,1]
    v_pk_fma_f32 v[146:147], v[70:71], v[244:245], v[146:147] op_sel:[0,1,0] op_sel_hi:[1,1,1]
    v_pk_mul_f32 v[148:149], v[148:149], v[246:247] op_sel:[0,1] op_sel_hi:[1,1]
    v_pk_fma_f32 v[148:149], v[76:77], v[244:245], v[148:149] op_sel:[0,1,0] op_sel_hi:[1,1,1]
    v_pk_mul_f32 v[150:151], v[150:151], v[246:247] op_sel:[0,1] op_sel_hi:[1,1]
    v_pk_fma_f32 v[150:151], v[78:79], v[244:245], v[150:151] op_sel:[0,1,0] op_sel_hi:[1,1,1]
    v_cvt_pk_bf16_f32 v156, v144, v145
    v_cvt_pk_bf16_f32 v157, v146, v147
    v_cvt_pk_bf16_f32 v158, v148, v149
    v_cvt_pk_bf16_f32 v159, v150, v151
    buffer_store_dwordx4 v[156:159], v3, s[4:7], s35 offen offset:0 sc1
    v_accvgpr_read_b32 v136, a80
    v_accvgpr_read_b32 v137, a81
    v_accvgpr_read_b32 v138, a82
    v_accvgpr_read_b32 v139, a83
    v_accvgpr_read_b32 v140, a88
    v_accvgpr_read_b32 v141, a89
    v_accvgpr_read_b32 v142, a90
    v_accvgpr_read_b32 v143, a91
    v_pk_mul_f32 v[136:137], v[136:137], v[246:247] op_sel_hi:[1,0]
    v_pk_fma_f32 v[136:137], v[80:81], v[244:245], v[136:137] op_sel_hi:[1,0,1]
    v_pk_mul_f32 v[138:139], v[138:139], v[246:247] op_sel_hi:[1,0]
    v_pk_fma_f32 v[138:139], v[82:83], v[244:245], v[138:139] op_sel_hi:[1,0,1]
    v_pk_mul_f32 v[140:141], v[140:141], v[246:247] op_sel_hi:[1,0]
    v_pk_fma_f32 v[140:141], v[88:89], v[244:245], v[140:141] op_sel_hi:[1,0,1]
    v_pk_mul_f32 v[142:143], v[142:143], v[246:247] op_sel_hi:[1,0]
    v_pk_fma_f32 v[142:143], v[90:91], v[244:245], v[142:143] op_sel_hi:[1,0,1]
    v_cvt_pk_bf16_f32 v152, v136, v137
    v_cvt_pk_bf16_f32 v153, v138, v139
    v_cvt_pk_bf16_f32 v154, v140, v141
    v_cvt_pk_bf16_f32 v155, v142, v143
    buffer_store_dwordx4 v[152:155], v3, s[4:7], s34 offen offset:1024 sc1
    v_accvgpr_read_b32 v144, a84
    v_accvgpr_read_b32 v145, a85
    v_accvgpr_read_b32 v146, a86
    v_accvgpr_read_b32 v147, a87
    v_accvgpr_read_b32 v148, a92
    v_accvgpr_read_b32 v149, a93
    v_accvgpr_read_b32 v150, a94
    v_accvgpr_read_b32 v151, a95
    v_pk_mul_f32 v[144:145], v[144:145], v[246:247] op_sel:[0,1] op_sel_hi:[1,1]
    v_pk_fma_f32 v[144:145], v[84:85], v[244:245], v[144:145] op_sel:[0,1,0] op_sel_hi:[1,1,1]
    v_pk_mul_f32 v[146:147], v[146:147], v[246:247] op_sel:[0,1] op_sel_hi:[1,1]
    v_pk_fma_f32 v[146:147], v[86:87], v[244:245], v[146:147] op_sel:[0,1,0] op_sel_hi:[1,1,1]
    v_pk_mul_f32 v[148:149], v[148:149], v[246:247] op_sel:[0,1] op_sel_hi:[1,1]
    v_pk_fma_f32 v[148:149], v[92:93], v[244:245], v[148:149] op_sel:[0,1,0] op_sel_hi:[1,1,1]
    v_pk_mul_f32 v[150:151], v[150:151], v[246:247] op_sel:[0,1] op_sel_hi:[1,1]
    v_pk_fma_f32 v[150:151], v[94:95], v[244:245], v[150:151] op_sel:[0,1,0] op_sel_hi:[1,1,1]
    v_cvt_pk_bf16_f32 v156, v144, v145
    v_cvt_pk_bf16_f32 v157, v146, v147
    v_cvt_pk_bf16_f32 v158, v148, v149
    v_cvt_pk_bf16_f32 v159, v150, v151
    buffer_store_dwordx4 v[156:159], v3, s[4:7], s35 offen offset:1024 sc1
    v_accvgpr_read_b32 v136, a96
    v_accvgpr_read_b32 v137, a97
    v_accvgpr_read_b32 v138, a98
    v_accvgpr_read_b32 v139, a99
    v_accvgpr_read_b32 v140, a104
    v_accvgpr_read_b32 v141, a105
    v_accvgpr_read_b32 v142, a106
    v_accvgpr_read_b32 v143, a107
    v_pk_mul_f32 v[136:137], v[136:137], v[246:247] op_sel_hi:[1,0]
    v_pk_fma_f32 v[136:137], v[96:97], v[244:245], v[136:137] op_sel_hi:[1,0,1]
    v_pk_mul_f32 v[138:139], v[138:139], v[246:247] op_sel_hi:[1,0]
    v_pk_fma_f32 v[138:139], v[98:99], v[244:245], v[138:139] op_sel_hi:[1,0,1]
    v_pk_mul_f32 v[140:141], v[140:141], v[246:247] op_sel_hi:[1,0]
    v_pk_fma_f32 v[140:141], v[104:105], v[244:245], v[140:141] op_sel_hi:[1,0,1]
    v_pk_mul_f32 v[142:143], v[142:143], v[246:247] op_sel_hi:[1,0]
    v_pk_fma_f32 v[142:143], v[106:107], v[244:245], v[142:143] op_sel_hi:[1,0,1]
    v_cvt_pk_bf16_f32 v152, v136, v137
    v_cvt_pk_bf16_f32 v153, v138, v139
    v_cvt_pk_bf16_f32 v154, v140, v141
    v_cvt_pk_bf16_f32 v155, v142, v143
    buffer_store_dwordx4 v[152:155], v3, s[4:7], s34 offen offset:2048 sc1
    v_accvgpr_read_b32 v144, a100
    v_accvgpr_read_b32 v145, a101
    v_accvgpr_read_b32 v146, a102
    v_accvgpr_read_b32 v147, a103
    v_accvgpr_read_b32 v148, a108
    v_accvgpr_read_b32 v149, a109
    v_accvgpr_read_b32 v150, a110
    v_accvgpr_read_b32 v151, a111
    v_pk_mul_f32 v[144:145], v[144:145], v[246:247] op_sel:[0,1] op_sel_hi:[1,1]
    v_pk_fma_f32 v[144:145], v[100:101], v[244:245], v[144:145] op_sel:[0,1,0] op_sel_hi:[1,1,1]
    v_pk_mul_f32 v[146:147], v[146:147], v[246:247] op_sel:[0,1] op_sel_hi:[1,1]
    v_pk_fma_f32 v[146:147], v[102:103], v[244:245], v[146:147] op_sel:[0,1,0] op_sel_hi:[1,1,1]
    v_pk_mul_f32 v[148:149], v[148:149], v[246:247] op_sel:[0,1] op_sel_hi:[1,1]
    v_pk_fma_f32 v[148:149], v[108:109], v[244:245], v[148:149] op_sel:[0,1,0] op_sel_hi:[1,1,1]
    v_pk_mul_f32 v[150:151], v[150:151], v[246:247] op_sel:[0,1] op_sel_hi:[1,1]
    v_pk_fma_f32 v[150:151], v[110:111], v[244:245], v[150:151] op_sel:[0,1,0] op_sel_hi:[1,1,1]
    v_cvt_pk_bf16_f32 v156, v144, v145
    v_cvt_pk_bf16_f32 v157, v146, v147
    v_cvt_pk_bf16_f32 v158, v148, v149
    v_cvt_pk_bf16_f32 v159, v150, v151
    buffer_store_dwordx4 v[156:159], v3, s[4:7], s35 offen offset:2048 sc1
    v_accvgpr_read_b32 v136, a112
    v_accvgpr_read_b32 v137, a113
    v_accvgpr_read_b32 v138, a114
    v_accvgpr_read_b32 v139, a115
    v_accvgpr_read_b32 v140, a120
    v_accvgpr_read_b32 v141, a121
    v_accvgpr_read_b32 v142, a122
    v_accvgpr_read_b32 v143, a123
    v_pk_mul_f32 v[136:137], v[136:137], v[246:247] op_sel_hi:[1,0]
    v_pk_fma_f32 v[136:137], v[112:113], v[244:245], v[136:137] op_sel_hi:[1,0,1]
    v_pk_mul_f32 v[138:139], v[138:139], v[246:247] op_sel_hi:[1,0]
    v_pk_fma_f32 v[138:139], v[114:115], v[244:245], v[138:139] op_sel_hi:[1,0,1]
    v_pk_mul_f32 v[140:141], v[140:141], v[246:247] op_sel_hi:[1,0]
    v_pk_fma_f32 v[140:141], v[120:121], v[244:245], v[140:141] op_sel_hi:[1,0,1]
    v_pk_mul_f32 v[142:143], v[142:143], v[246:247] op_sel_hi:[1,0]
    v_pk_fma_f32 v[142:143], v[122:123], v[244:245], v[142:143] op_sel_hi:[1,0,1]
    v_cvt_pk_bf16_f32 v152, v136, v137
    v_cvt_pk_bf16_f32 v153, v138, v139
    v_cvt_pk_bf16_f32 v154, v140, v141
    v_cvt_pk_bf16_f32 v155, v142, v143
    buffer_store_dwordx4 v[152:155], v3, s[4:7], s34 offen offset:3072 sc1
    v_accvgpr_read_b32 v144, a116
    v_accvgpr_read_b32 v145, a117
    v_accvgpr_read_b32 v146, a118
    v_accvgpr_read_b32 v147, a119
    v_accvgpr_read_b32 v148, a124
    v_accvgpr_read_b32 v149, a125
    v_accvgpr_read_b32 v150, a126
    v_accvgpr_read_b32 v151, a127
    v_pk_mul_f32 v[144:145], v[144:145], v[246:247] op_sel:[0,1] op_sel_hi:[1,1]
    v_pk_fma_f32 v[144:145], v[116:117], v[244:245], v[144:145] op_sel:[0,1,0] op_sel_hi:[1,1,1]
    v_pk_mul_f32 v[146:147], v[146:147], v[246:247] op_sel:[0,1] op_sel_hi:[1,1]
    v_pk_fma_f32 v[146:147], v[118:119], v[244:245], v[146:147] op_sel:[0,1,0] op_sel_hi:[1,1,1]
    v_pk_mul_f32 v[148:149], v[148:149], v[246:247] op_sel:[0,1] op_sel_hi:[1,1]
    v_pk_fma_f32 v[148:149], v[124:125], v[244:245], v[148:149] op_sel:[0,1,0] op_sel_hi:[1,1,1]
    v_pk_mul_f32 v[150:151], v[150:151], v[246:247] op_sel:[0,1] op_sel_hi:[1,1]
    v_pk_fma_f32 v[150:151], v[126:127], v[244:245], v[150:151] op_sel:[0,1,0] op_sel_hi:[1,1,1]
    v_cvt_pk_bf16_f32 v156, v144, v145
    v_cvt_pk_bf16_f32 v157, v146, v147
    v_cvt_pk_bf16_f32 v158, v148, v149
    v_cvt_pk_bf16_f32 v159, v150, v151
    buffer_store_dwordx4 v[156:159], v3, s[4:7], s35 offen offset:3072 sc1
K3_BEGIN:
    s_add_u32 s42, s42, 1024
    s_add_u32 s43, s43, 32768
    s_add_u32 m0, s44, 131072
    s_nop 0
    buffer_load_dwordx4 v3, s[4:7], s42 offen sc1 lds
    buffer_load_dwordx4 v194, s[4:7], s42 offen offset:1024 sc1 lds
    buffer_load_dwordx4 v195, s[20:23], s43 offen offset:2048 lds
    buffer_load_dwordx4 v196, s[20:23], s43 offen offset:3072 lds
    s_add_u32 s42, s42, 1024
    s_add_u32 s43, s43, 32768
    s_add_u32 m0, s44, 147456
    s_nop 0
    buffer_load_dwordx4 v3, s[4:7], s42 offen sc1 lds
    buffer_load_dwordx4 v194, s[4:7], s42 offen offset:1024 sc1 lds
    buffer_load_dwordx4 v195, s[20:23], s43 offen offset:2048 lds
    buffer_load_dwordx4 v196, s[20:23], s43 offen offset:3072 lds
    s_waitcnt vmcnt(16)
    s_barrier
    ds_read_b128 a[128:131], v208 offset:16384
    ds_read_b64_tr_b16 a[144:145], v212 offset:16384
    ds_read_b64_tr_b16 a[146:147], v212 offset:24576
    ds_read_b128 a[132:135], v209 offset:16384
    ds_read_b64_tr_b16 a[148:149], v213 offset:16384
    ds_read_b64_tr_b16 a[150:151], v213 offset:24576
    ds_read_b128 a[136:139], v210 offset:16384
    ds_read_b64_tr_b16 a[152:153], v214 offset:16384
    ds_read_b64_tr_b16 a[154:155], v214 offset:24576
    ds_read_b128 a[140:143], v211 offset:16384
    ds_read_b64_tr_b16 a[156:157], v215 offset:16384
    ds_read_b64_tr_b16 a[158:159], v215 offset:24576
    ds_read_b128 a[160:163], v208 offset:32768
    ds_read_b64_tr_b16 a[176:177], v212 offset:32768
    ds_read_b64_tr_b16 a[178:179], v212 offset:40960
    ds_read_b128 a[164:167], v209 offset:32768
    ds_read_b64_tr_b16 a[180:181], v213 offset:32768
    ds_read_b64_tr_b16 a[182:183], v213 offset:40960
    ds_read_b128 a[168:171], v210 offset:32768
    ds_read_b64_tr_b16 a[184:185], v214 offset:32768
    ds_read_b64_tr_b16 a[186:187], v214 offset:40960
    ds_read_b128 a[172:175], v211 offset:32768
    ds_read_b64_tr_b16 a[188:189], v215 offset:32768
    ds_read_b64_tr_b16 a[190:191], v215 offset:40960
    s_waitcnt lgkmcnt(12)
    v_mfma_f32_16x16x32_bf16 v[96:99], a[144:147], a[128:131], 0
    s_add_u32 s42, s42, 1024
    s_add_u32 s43, s43, 32768
    s_and_b32 s39, s2, 7
    s_lshl_b32 s39, s39, 2
    v_mfma_f32_16x16x32_bf16 v[112:115], a[144:147], a[132:135], 0
    ds_read_b128 a[192:195], v208 offset:49152
    s_add_u32 m0, s44, 0
    s_bfe_u32 s40, s2, 0x20003
    s_add_u32 s39, s39, s40
    v_mfma_f32_16x16x32_bf16 v[128:131], a[144:147], a[136:139], 0
    ds_read_b64_tr_b16 a[208:209], v212 offset:49152
    buffer_load_dwordx4 v3, s[4:7], s42 offen sc1 lds
    s_lshl_b32 s39, s39, 7
    s_lshl_b32 s41, s28, 12
    v_mfma_f32_16x16x32_bf16 v[144:147], a[144:147], a[140:143], 0
    ds_read_b64_tr_b16 a[210:211], v212 offset:57344
    s_add_u32 s39, s39, s41
    s_add_u32 s52, s39, 84148224
    v_mfma_f32_16x16x32_bf16 v[100:103], a[148:151], a[128:131], 0
    ds_read_b128 a[196:199], v209 offset:49152
    s_lshr_b32 s40, s2, 5
    s_lshl_b32 s40, s40, 14
    v_mfma_f32_16x16x32_bf16 v[116:119], a[148:151], a[132:135], 0
    ds_read_b64_tr_b16 a[212:213], v213 offset:49152
    buffer_load_dwordx4 v194, s[4:7], s42 offen offset:1024 sc1 lds
    s_sub_u32 s39, 245760, s40
    v_mov_b32 v19, s40
    v_mfma_f32_16x16x32_bf16 v[132:135], a[148:151], a[136:139], 0
    ds_read_b64_tr_b16 a[214:215], v213 offset:57344
    v_writelane_b32 v19, s39, 1
    v_mov_b32 v29, 1
    v_mfma_f32_16x16x32_bf16 v[148:151], a[148:151], a[140:143], 0
    ds_read_b128 a[200:203], v210 offset:49152
    v_and_b32 v197, 3, v2
    v_lshlrev_b32 v197, 7, v197
    v_mfma_f32_16x16x32_bf16 v[104:107], a[152:155], a[128:131], 0
    ds_read_b64_tr_b16 a[216:217], v214 offset:49152
    buffer_load_dwordx4 v195, s[20:23], s43 offen offset:2048 lds
    s_lshl_b32 s51, s51, 7
    s_add_u32 s51, s51, s41
    v_mfma_f32_16x16x32_bf16 v[120:123], a[152:155], a[132:135], 0
    ds_read_b64_tr_b16 a[218:219], v214 offset:57344
    s_and_b32 s39, s2, 7
    s_lshl_b32 s39, s39, 9
    v_mfma_f32_16x16x32_bf16 v[136:139], a[152:155], a[136:139], 0
    ds_read_b128 a[204:207], v211 offset:49152
    s_add_u32 s51, s51, s39
    s_add_u32 s51, s51, 84148224
    v_mfma_f32_16x16x32_bf16 v[152:155], a[152:155], a[140:143], 0
    ds_read_b64_tr_b16 a[220:221], v215 offset:49152
    buffer_load_dwordx4 v196, s[20:23], s43 offen offset:3072 lds
    s_add_u32 s42, s42, 1024
    v_and_b32 v16, 15, v2
    v_lshrrev_b32 v17, 4, v2
    v_mfma_f32_16x16x32_bf16 v[108:111], a[156:159], a[128:131], 0
    ds_read_b64_tr_b16 a[222:223], v215 offset:57344
    s_add_u32 s43, s43, 32768
    v_lshlrev_b32 v18, 10, v16
    v_lshl_add_u32 v18, v17, 3, v18
    v_mfma_f32_16x16x32_bf16 v[124:127], a[156:159], a[132:135], 0
    s_add_u32 m0, s44, 16384
    s_lshl_b32 s48, s36, 17
    s_lshr_b32 s39, s28, 1
    s_waitcnt vmcnt(12)
    s_mov_b64 exec, 3
    buffer_store_dword v29, v19, s[4:7], s52 offen sc1
    s_mov_b64 exec, -1
    v_mfma_f32_16x16x32_bf16 v[140:143], a[156:159], a[136:139], 0
    buffer_load_dwordx4 v3, s[4:7], s42 offen sc1 lds
    s_lshl_b32 s39, s39, 16
    s_add_u32 s48, s48, s39
    v_mfma_f32_16x16x32_bf16 v[156:159], a[156:159], a[140:143], 0
    s_lshl_b32 s39, s38, 14
    s_add_u32 s48, s48, s39
    s_waitcnt lgkmcnt(12)
    v_mfma_f32_16x16x32_bf16 v[96:99], a[176:179], a[160:163], v[96:99]
    s_lshl_b32 s39, s37, 8
    s_add_u32 s48, s48, s39
    s_waitcnt vmcnt(6)
    s_barrier
    v_mfma_f32_16x16x32_bf16 v[112:115], a[176:179], a[164:167], v[112:115]
    ds_read_b128 a[128:131], v216 offset:0
    buffer_load_dwordx4 v194, s[4:7], s42 offen offset:1024 sc1 lds
    s_and_b32 s39, s28, 1
    s_lshl_b32 s39, s39, 7
    v_mfma_f32_16x16x32_bf16 v[128:131], a[176:179], a[168:171], v[128:131]
    ds_read_b64_tr_b16 a[144:145], v220 offset:0
    s_add_u32 s48, s48, s39
    s_lshl_b32 s49, s2, 15
    v_mfma_f32_16x16x32_bf16 v[144:147], a[176:179], a[172:175], v[144:147]
    ds_read_b64_tr_b16 a[146:147], v220 offset:8192
    s_lshl_b32 s39, s28, 13
    s_add_u32 s49, s49, s39
    v_mfma_f32_16x16x32_bf16 v[100:103], a[180:183], a[160:163], v[100:103]
    ds_read_b128 a[132:135], v217 offset:0
    buffer_load_dwordx4 v195, s[20:23], s43 offen offset:2048 lds
    v_mfma_f32_16x16x32_bf16 v[116:119], a[180:183], a[164:167], v[116:119]
    ds_read_b64_tr_b16 a[148:149], v221 offset:0
    v_mfma_f32_16x16x32_bf16 v[132:135], a[180:183], a[168:171], v[132:135]
    ds_read_b64_tr_b16 a[150:151], v221 offset:8192
    v_mfma_f32_16x16x32_bf16 v[148:151], a[180:183], a[172:175], v[148:151]
    ds_read_b128 a[136:139], v218 offset:0
    buffer_load_dwordx4 v196, s[20:23], s43 offen offset:3072 lds
    s_add_u32 s42, s42, 1024
    v_mfma_f32_16x16x32_bf16 v[104:107], a[184:187], a[160:163], v[104:107]
    ds_read_b64_tr_b16 a[152:153], v222 offset:0
    s_add_u32 s43, s43, 32768
    v_mfma_f32_16x16x32_bf16 v[120:123], a[184:187], a[164:167], v[120:123]
    ds_read_b64_tr_b16 a[154:155], v222 offset:8192
    s_add_u32 m0, s44, 32768
    v_mfma_f32_16x16x32_bf16 v[136:139], a[184:187], a[168:171], v[136:139]
    ds_read_b128 a[140:143], v219 offset:0
    buffer_load_dwordx4 v3, s[4:7], s42 offen sc1 lds
    v_mfma_f32_16x16x32_bf16 v[152:155], a[184:187], a[172:175], v[152:155]
    ds_read_b64_tr_b16 a[156:157], v223 offset:0
    v_mfma_f32_16x16x32_bf16 v[108:111], a[188:191], a[160:163], v[108:111]
    ds_read_b64_tr_b16 a[158:159], v223 offset:8192
    v_mfma_f32_16x16x32_bf16 v[124:127], a[188:191], a[164:167], v[124:127]
    buffer_load_dwordx4 v194, s[4:7], s42 offen offset:1024 sc1 lds
    v_mfma_f32_16x16x32_bf16 v[140:143], a[188:191], a[168:171], v[140:143]
    v_mfma_f32_16x16x32_bf16 v[156:159], a[188:191], a[172:175], v[156:159]
    s_waitcnt lgkmcnt(12)
    v_mfma_f32_16x16x32_bf16 v[96:99], a[208:211], a[192:195], v[96:99]
    buffer_load_dwordx4 v195, s[20:23], s43 offen offset:2048 lds
    v_mfma_f32_16x16x32_bf16 v[112:115], a[208:211], a[196:199], v[112:115]
    ds_read_b128 a[160:163], v216 offset:16384
    v_mfma_f32_16x16x32_bf16 v[128:131], a[208:211], a[200:203], v[128:131]
    ds_read_b64_tr_b16 a[176:177], v220 offset:16384
    v_mfma_f32_16x16x32_bf16 v[144:147], a[208:211], a[204:207], v[144:147]
    ds_read_b64_tr_b16 a[178:179], v220 offset:24576
    buffer_load_dwordx4 v196, s[20:23], s43 offen offset:3072 lds
    s_add_u32 s42, s42, 1024
    v_mfma_f32_16x16x32_bf16 v[100:103], a[212:215], a[192:195], v[100:103]
    ds_read_b128 a[164:167], v217 offset:16384
    s_add_u32 s43, s43, 32768
    v_mfma_f32_16x16x32_bf16 v[116:119], a[212:215], a[196:199], v[116:119]
    ds_read_b64_tr_b16 a[180:181], v221 offset:16384
    s_add_u32 m0, s44, 49152
    v_mfma_f32_16x16x32_bf16 v[132:135], a[212:215], a[200:203], v[132:135]
    ds_read_b64_tr_b16 a[182:183], v221 offset:24576
    buffer_load_dwordx4 v3, s[4:7], s42 offen sc1 lds
    v_mfma_f32_16x16x32_bf16 v[148:151], a[212:215], a[204:207], v[148:151]
    ds_read_b128 a[168:171], v218 offset:16384
    v_mfma_f32_16x16x32_bf16 v[104:107], a[216:219], a[192:195], v[104:107]
    ds_read_b64_tr_b16 a[184:185], v222 offset:16384
    s_add_u32 s49, s49, 67108864
    v_mfma_f32_16x16x32_bf16 v[120:123], a[216:219], a[196:199], v[120:123]
    ds_read_b64_tr_b16 a[186:187], v222 offset:24576
    buffer_load_dwordx4 v194, s[4:7], s42 offen offset:1024 sc1 lds
    s_mov_b32 s8, s56
    v_mfma_f32_16x16x32_bf16 v[136:139], a[216:219], a[200:203], v[136:139]
    ds_read_b128 a[172:175], v219 offset:16384
    s_mov_b32 s9, s57
    v_mfma_f32_16x16x32_bf16 v[152:155], a[216:219], a[204:207], v[152:155]
    ds_read_b64_tr_b16 a[188:189], v223 offset:16384
    s_mov_b32 s10, 2097152
    v_mfma_f32_16x16x32_bf16 v[108:111], a[220:223], a[192:195], v[108:111]
    ds_read_b64_tr_b16 a[190:191], v223 offset:24576
    buffer_load_dwordx4 v195, s[20:23], s43 offen offset:2048 lds
    s_mov_b32 s11, 0x00020000
    v_mfma_f32_16x16x32_bf16 v[124:127], a[220:223], a[196:199], v[124:127]
    s_mov_b32 s12, s62
    v_mfma_f32_16x16x32_bf16 v[140:143], a[220:223], a[200:203], v[140:143]
    s_mov_b32 s13, s63
    v_mfma_f32_16x16x32_bf16 v[156:159], a[220:223], a[204:207], v[156:159]
    buffer_load_dwordx4 v196, s[20:23], s43 offen offset:3072 lds
    s_mov_b32 s14, 2097152
    s_waitcnt lgkmcnt(12)
    v_mfma_f32_16x16x32_bf16 v[96:99], a[144:147], a[128:131], v[96:99]
    s_mov_b32 s15, 0x00020000
    s_waitcnt vmcnt(8)
    s_barrier
    v_mfma_f32_16x16x32_bf16 v[112:115], a[144:147], a[132:135], v[112:115]
    ds_read_b128 a[192:195], v8 offset:0
    s_add_u32 s42, s42, 1024
    s_add_u32 s43, s43, 32768
    v_mfma_f32_16x16x32_bf16 v[128:131], a[144:147], a[136:139], v[128:131]
    ds_read_b64_tr_b16 a[208:209], v12 offset:0
    s_add_u32 m0, s44, 65536
    v_mfma_f32_16x16x32_bf16 v[144:147], a[144:147], a[140:143], v[144:147]
    ds_read_b64_tr_b16 a[210:211], v12 offset:8192
    buffer_load_dwordx4 v3, s[4:7], s42 offen sc1 lds
    v_mfma_f32_16x16x32_bf16 v[100:103], a[148:151], a[128:131], v[100:103]
    ds_read_b128 a[196:199], v9 offset:0
    v_mfma_f32_16x16x32_bf16 v[116:119], a[148:151], a[132:135], v[116:119]
    ds_read_b64_tr_b16 a[212:213], v13 offset:0
    v_mfma_f32_16x16x32_bf16 v[132:135], a[148:151], a[136:139], v[132:135]
    ds_read_b64_tr_b16 a[214:215], v13 offset:8192
    buffer_load_dwordx4 v194, s[4:7], s42 offen offset:1024 sc1 lds
    v_mfma_f32_16x16x32_bf16 v[148:151], a[148:151], a[140:143], v[148:151]
    ds_read_b128 a[200:203], v10 offset:0
    v_mfma_f32_16x16x32_bf16 v[104:107], a[152:155], a[128:131], v[104:107]
    ds_read_b64_tr_b16 a[216:217], v14 offset:0
    v_mfma_f32_16x16x32_bf16 v[120:123], a[152:155], a[132:135], v[120:123]
    ds_read_b64_tr_b16 a[218:219], v14 offset:8192
    buffer_load_dwordx4 v195, s[20:23], s43 offen offset:2048 lds
    v_mfma_f32_16x16x32_bf16 v[136:139], a[152:155], a[136:139], v[136:139]
    ds_read_b128 a[204:207], v11 offset:0
    v_mfma_f32_16x16x32_bf16 v[152:155], a[152:155], a[140:143], v[152:155]
    ds_read_b64_tr_b16 a[220:221], v15 offset:0
    v_mfma_f32_16x16x32_bf16 v[108:111], a[156:159], a[128:131], v[108:111]
    ds_read_b64_tr_b16 a[222:223], v15 offset:8192
    buffer_load_dwordx4 v196, s[20:23], s43 offen offset:3072 lds
    s_add_u32 s42, s42, 1024
    s_add_u32 s43, s43, 32768
    v_mfma_f32_16x16x32_bf16 v[124:127], a[156:159], a[132:135], v[124:127]
    s_min_u32 s42, s42, s33
    v_mfma_f32_16x16x32_bf16 v[140:143], a[156:159], a[136:139], v[140:143]
    s_add_u32 m0, s44, 81920
    v_mfma_f32_16x16x32_bf16 v[156:159], a[156:159], a[140:143], v[156:159]
    buffer_load_dwordx4 v3, s[4:7], s42 offen sc1 lds
    s_waitcnt lgkmcnt(12)
    v_mfma_f32_16x16x32_bf16 v[96:99], a[176:179], a[160:163], v[96:99]
    v_mfma_f32_16x16x32_bf16 v[112:115], a[176:179], a[164:167], v[112:115]
    ds_read_b128 a[128:131], v8 offset:16384
    v_mfma_f32_16x16x32_bf16 v[128:131], a[176:179], a[168:171], v[128:131]
    ds_read_b64_tr_b16 a[144:145], v12 offset:16384
    buffer_load_dwordx4 v194, s[4:7], s42 offen offset:1024 sc1 lds
    v_mfma_f32_16x16x32_bf16 v[144:147], a[176:179], a[172:175], v[144:147]
    ds_read_b64_tr_b16 a[146:147], v12 offset:24576
    v_mfma_f32_16x16x32_bf16 v[100:103], a[180:183], a[160:163], v[100:103]
    ds_read_b128 a[132:135], v9 offset:16384
    v_mfma_f32_16x16x32_bf16 v[116:119], a[180:183], a[164:167], v[116:119]
    ds_read_b64_tr_b16 a[148:149], v13 offset:16384
    buffer_load_dwordx4 v195, s[20:23], s43 offen offset:2048 lds
    v_mfma_f32_16x16x32_bf16 v[132:135], a[180:183], a[168:171], v[132:135]
    ds_read_b64_tr_b16 a[150:151], v13 offset:24576
    v_mfma_f32_16x16x32_bf16 v[148:151], a[180:183], a[172:175], v[148:151]
    ds_read_b128 a[136:139], v10 offset:16384
    v_mfma_f32_16x16x32_bf16 v[104:107], a[184:187], a[160:163], v[104:107]
    ds_read_b64_tr_b16 a[152:153], v14 offset:16384
    buffer_load_dwordx4 v196, s[20:23], s43 offen offset:3072 lds
    v_mfma_f32_16x16x32_bf16 v[120:123], a[184:187], a[164:167], v[120:123]
    ds_read_b64_tr_b16 a[154:155], v14 offset:24576
    v_mfma_f32_16x16x32_bf16 v[136:139], a[184:187], a[168:171], v[136:139]
    ds_read_b128 a[140:143], v11 offset:16384
    v_mfma_f32_16x16x32_bf16 v[152:155], a[184:187], a[172:175], v[152:155]
    ds_read_b64_tr_b16 a[156:157], v15 offset:16384
    v_mfma_f32_16x16x32_bf16 v[108:111], a[188:191], a[160:163], v[108:111]
    ds_read_b64_tr_b16 a[158:159], v15 offset:24576
    v_mfma_f32_16x16x32_bf16 v[124:127], a[188:191], a[164:167], v[124:127]
    v_mfma_f32_16x16x32_bf16 v[140:143], a[188:191], a[168:171], v[140:143]
    v_mfma_f32_16x16x32_bf16 v[156:159], a[188:191], a[172:175], v[156:159]
    s_waitcnt lgkmcnt(12)
    v_mfma_f32_16x16x32_bf16 v[96:99], a[208:211], a[192:195], v[96:99]
    s_waitcnt vmcnt(8)
    s_barrier
    v_mfma_f32_16x16x32_bf16 v[112:115], a[208:211], a[196:199], v[112:115]
    ds_read_b128 a[160:163], v8 offset:32768
    v_mfma_f32_16x16x32_bf16 v[128:131], a[208:211], a[200:203], v[128:131]
    ds_read_b64_tr_b16 a[176:177], v12 offset:32768
    v_mfma_f32_16x16x32_bf16 v[144:147], a[208:211], a[204:207], v[144:147]
    ds_read_b64_tr_b16 a[178:179], v12 offset:40960
    buffer_load_dword v198, v197, s[4:7], s51 offen sc1
    v_mfma_f32_16x16x32_bf16 v[100:103], a[212:215], a[192:195], v[100:103]
    ds_read_b128 a[164:167], v9 offset:32768
    v_mfma_f32_16x16x32_bf16 v[116:119], a[212:215], a[196:199], v[116:119]
    ds_read_b64_tr_b16 a[180:181], v13 offset:32768
    v_mfma_f32_16x16x32_bf16 v[132:135], a[212:215], a[200:203], v[132:135]
    ds_read_b64_tr_b16 a[182:183], v13 offset:40960
    v_mfma_f32_16x16x32_bf16 v[148:151], a[212:215], a[204:207], v[148:151]
    ds_read_b128 a[168:171], v10 offset:32768
    v_mfma_f32_16x16x32_bf16 v[104:107], a[216:219], a[192:195], v[104:107]
    ds_read_b64_tr_b16 a[184:185], v14 offset:32768
    v_mfma_f32_16x16x32_bf16 v[120:123], a[216:219], a[196:199], v[120:123]
    ds_read_b64_tr_b16 a[186:187], v14 offset:40960
    v_mfma_f32_16x16x32_bf16 v[136:139], a[216:219], a[200:203], v[136:139]
    ds_read_b128 a[172:175], v11 offset:32768
    v_mfma_f32_16x16x32_bf16 v[152:155], a[216:219], a[204:207], v[152:155]
    ds_read_b64_tr_b16 a[188:189], v15 offset:32768
    v_mfma_f32_16x16x32_bf16 v[108:111], a[220:223], a[192:195], v[108:111]
    ds_read_b64_tr_b16 a[190:191], v15 offset:40960
    v_mfma_f32_16x16x32_bf16 v[124:127], a[220:223], a[196:199], v[124:127]
    v_mfma_f32_16x16x32_bf16 v[140:143], a[220:223], a[200:203], v[140:143]
    v_mfma_f32_16x16x32_bf16 v[156:159], a[220:223], a[204:207], v[156:159]
    s_waitcnt lgkmcnt(12)
    v_mfma_f32_16x16x32_bf16 v[96:99], a[144:147], a[128:131], v[96:99]
    v_mfma_f32_16x16x32_bf16 v[112:115], a[144:147], a[132:135], v[112:115]
    ds_read_b128 a[192:195], v8 offset:49152
    v_mfma_f32_16x16x32_bf16 v[128:131], a[144:147], a[136:139], v[128:131]
    ds_read_b64_tr_b16 a[208:209], v12 offset:49152
    v_mfma_f32_16x16x32_bf16 v[144:147], a[144:147], a[140:143], v[144:147]
    ds_read_b64_tr_b16 a[210:211], v12 offset:57344
    v_mfma_f32_16x16x32_bf16 v[100:103], a[148:151], a[128:131], v[100:103]
    ds_read_b128 a[196:199], v9 offset:49152
    v_mfma_f32_16x16x32_bf16 v[116:119], a[148:151], a[132:135], v[116:119]
    ds_read_b64_tr_b16 a[212:213], v13 offset:49152
    v_mfma_f32_16x16x32_bf16 v[132:135], a[148:151], a[136:139], v[132:135]
    ds_read_b64_tr_b16 a[214:215], v13 offset:57344
    v_mfma_f32_16x16x32_bf16 v[148:151], a[148:151], a[140:143], v[148:151]
    ds_read_b128 a[200:203], v10 offset:49152
    v_mfma_f32_16x16x32_bf16 v[104:107], a[152:155], a[128:131], v[104:107]
    ds_read_b64_tr_b16 a[216:217], v14 offset:49152
    v_mfma_f32_16x16x32_bf16 v[120:123], a[152:155], a[132:135], v[120:123]
    ds_read_b64_tr_b16 a[218:219], v14 offset:57344
    v_mfma_f32_16x16x32_bf16 v[136:139], a[152:155], a[136:139], v[136:139]
    ds_read_b128 a[204:207], v11 offset:49152
    v_mfma_f32_16x16x32_bf16 v[152:155], a[152:155], a[140:143], v[152:155]
    ds_read_b64_tr_b16 a[220:221], v15 offset:49152
    v_mfma_f32_16x16x32_bf16 v[108:111], a[156:159], a[128:131], v[108:111]
    ds_read_b64_tr_b16 a[222:223], v15 offset:57344
    v_mfma_f32_16x16x32_bf16 v[124:127], a[156:159], a[132:135], v[124:127]
    v_mfma_f32_16x16x32_bf16 v[140:143], a[156:159], a[136:139], v[140:143]
    v_mfma_f32_16x16x32_bf16 v[156:159], a[156:159], a[140:143], v[156:159]
    s_waitcnt lgkmcnt(12)
    v_mfma_f32_16x16x32_bf16 v[96:99], a[176:179], a[160:163], v[96:99]
    s_waitcnt vmcnt(1)
    s_barrier
    s_waitcnt vmcnt(0)
    v_cmp_ne_u32 vcc, 1, v198
    s_cbranch_vccnz K3_CSPIN_E
K3_COK:
    v_mfma_f32_16x16x32_bf16 v[112:115], a[176:179], a[164:167], v[112:115]
    ds_read_b128 a[128:131], v208 offset:0
    s_and_b32 s43, s2, 7
    s_lshl_b32 s42, s43, 14
    s_add_u32 s42, s42, s32
    s_lshl_b32 s43, s43, 19
    v_mfma_f32_16x16x32_bf16 v[128:131], a[176:179], a[168:171], v[128:131]
    ds_read_b64_tr_b16 a[144:145], v212 offset:0
    s_add_u32 m0, s44, 98304
    v_mfma_f32_16x16x32_bf16 v[144:147], a[176:179], a[172:175], v[144:147]
    ds_read_b64_tr_b16 a[146:147], v212 offset:8192
    buffer_load_dwordx4 v3, s[4:7], s42 offen sc1 lds
    v_mfma_f32_16x16x32_bf16 v[100:103], a[180:183], a[160:163], v[100:103]
    ds_read_b128 a[132:135], v209 offset:0
    v_mfma_f32_16x16x32_bf16 v[116:119], a[180:183], a[164:167], v[116:119]
    ds_read_b64_tr_b16 a[148:149], v213 offset:0
    v_mfma_f32_16x16x32_bf16 v[132:135], a[180:183], a[168:171], v[132:135]
    ds_read_b64_tr_b16 a[150:151], v213 offset:8192
    buffer_load_dwordx4 v194, s[4:7], s42 offen offset:1024 sc1 lds
    v_mfma_f32_16x16x32_bf16 v[148:151], a[180:183], a[172:175], v[148:151]
    ds_read_b128 a[136:139], v210 offset:0
    v_mfma_f32_16x16x32_bf16 v[104:107], a[184:187], a[160:163], v[104:107]
    ds_read_b64_tr_b16 a[152:153], v214 offset:0
    v_mfma_f32_16x16x32_bf16 v[120:123], a[184:187], a[164:167], v[120:123]
    ds_read_b64_tr_b16 a[154:155], v214 offset:8192
    buffer_load_dwordx4 v195, s[16:19], s43 offen offset:2048 lds
    v_mfma_f32_16x16x32_bf16 v[136:139], a[184:187], a[168:171], v[136:139]
    ds_read_b128 a[140:143], v211 offset:0
    v_mfma_f32_16x16x32_bf16 v[152:155], a[184:187], a[172:175], v[152:155]
    ds_read_b64_tr_b16 a[156:157], v215 offset:0
    v_mfma_f32_16x16x32_bf16 v[108:111], a[188:191], a[160:163], v[108:111]
    ds_read_b64_tr_b16 a[158:159], v215 offset:8192
    buffer_load_dwordx4 v196, s[16:19], s43 offen offset:3072 lds
    s_add_u32 s42, s42, 1024
    v_mfma_f32_16x16x32_bf16 v[124:127], a[188:191], a[164:167], v[124:127]
    s_add_u32 s43, s43, 32768
    v_mfma_f32_16x16x32_bf16 v[140:143], a[188:191], a[168:171], v[140:143]
    s_add_u32 m0, s44, 114688
    v_mfma_f32_16x16x32_bf16 v[156:159], a[188:191], a[172:175], v[156:159]
    buffer_load_dwordx4 v3, s[4:7], s42 offen sc1 lds
    s_waitcnt lgkmcnt(12)
    v_mfma_f32_16x16x32_bf16 v[96:99], a[208:211], a[192:195], v[96:99]
    v_mfma_f32_16x16x32_bf16 v[112:115], a[208:211], a[196:199], v[112:115]
    ds_read_b128 a[160:163], v208 offset:16384
    v_mfma_f32_16x16x32_bf16 v[128:131], a[208:211], a[200:203], v[128:131]
    ds_read_b64_tr_b16 a[176:177], v212 offset:16384
    buffer_load_dwordx4 v194, s[4:7], s42 offen offset:1024 sc1 lds
    v_mfma_f32_16x16x32_bf16 v[144:147], a[208:211], a[204:207], v[144:147]
    ds_read_b64_tr_b16 a[178:179], v212 offset:24576
    v_mfma_f32_16x16x32_bf16 v[100:103], a[212:215], a[192:195], v[100:103]
    ds_read_b128 a[164:167], v209 offset:16384
    v_mfma_f32_16x16x32_bf16 v[116:119], a[212:215], a[196:199], v[116:119]
    ds_read_b64_tr_b16 a[180:181], v213 offset:16384
    buffer_load_dwordx4 v195, s[16:19], s43 offen offset:2048 lds
    v_mfma_f32_16x16x32_bf16 v[132:135], a[212:215], a[200:203], v[132:135]
    ds_read_b64_tr_b16 a[182:183], v213 offset:24576
    v_mfma_f32_16x16x32_bf16 v[148:151], a[212:215], a[204:207], v[148:151]
    ds_read_b128 a[168:171], v210 offset:16384
    v_mfma_f32_16x16x32_bf16 v[104:107], a[216:219], a[192:195], v[104:107]
    ds_read_b64_tr_b16 a[184:185], v214 offset:16384
    buffer_load_dwordx4 v196, s[16:19], s43 offen offset:3072 lds
    s_add_u32 s42, s42, 1024
    v_mfma_f32_16x16x32_bf16 v[120:123], a[216:219], a[196:199], v[120:123]
    ds_read_b64_tr_b16 a[186:187], v214 offset:24576
    s_add_u32 s43, s43, 32768
    v_mfma_f32_16x16x32_bf16 v[136:139], a[216:219], a[200:203], v[136:139]
    ds_read_b128 a[172:175], v211 offset:16384
    s_add_u32 m0, s44, 131072
    v_mfma_f32_16x16x32_bf16 v[152:155], a[216:219], a[204:207], v[152:155]
    ds_read_b64_tr_b16 a[188:189], v215 offset:16384
    buffer_load_dwordx4 v3, s[4:7], s42 offen sc1 lds
    v_mfma_f32_16x16x32_bf16 v[108:111], a[220:223], a[192:195], v[108:111]
    ds_read_b64_tr_b16 a[190:191], v215 offset:24576
    v_mfma_f32_16x16x32_bf16 v[124:127], a[220:223], a[196:199], v[124:127]
    v_mfma_f32_16x16x32_bf16 v[140:143], a[220:223], a[200:203], v[140:143]
    buffer_load_dwordx4 v194, s[4:7], s42 offen offset:1024 sc1 lds
    v_mfma_f32_16x16x32_bf16 v[156:159], a[220:223], a[204:207], v[156:159]
    s_waitcnt lgkmcnt(12)
    v_mfma_f32_16x16x32_bf16 v[96:99], a[144:147], a[128:131], v[96:99]
    s_waitcnt vmcnt(2)
    s_barrier
    v_mfma_f32_16x16x32_bf16 v[112:115], a[144:147], a[132:135], v[112:115]
    ds_read_b128 a[192:195], v208 offset:32768
    buffer_load_dwordx4 v195, s[16:19], s43 offen offset:2048 lds
    v_mfma_f32_16x16x32_bf16 v[128:131], a[144:147], a[136:139], v[128:131]
    ds_read_b64_tr_b16 a[208:209], v212 offset:32768
    v_mfma_f32_16x16x32_bf16 v[144:147], a[144:147], a[140:143], v[144:147]
    ds_read_b64_tr_b16 a[210:211], v212 offset:40960
    v_mfma_f32_16x16x32_bf16 v[100:103], a[148:151], a[128:131], v[100:103]
    ds_read_b128 a[196:199], v209 offset:32768
    buffer_load_dwordx4 v196, s[16:19], s43 offen offset:3072 lds
    s_add_u32 s42, s42, 1024
    v_mfma_f32_16x16x32_bf16 v[116:119], a[148:151], a[132:135], v[116:119]
    ds_read_b64_tr_b16 a[212:213], v213 offset:32768
    s_add_u32 s43, s43, 32768
    v_mfma_f32_16x16x32_bf16 v[132:135], a[148:151], a[136:139], v[132:135]
    ds_read_b64_tr_b16 a[214:215], v213 offset:40960
    s_add_u32 m0, s44, 147456
    v_mfma_f32_16x16x32_bf16 v[148:151], a[148:151], a[140:143], v[148:151]
    ds_read_b128 a[200:203], v210 offset:32768
    buffer_load_dwordx4 v3, s[4:7], s42 offen sc1 lds
    v_mfma_f32_16x16x32_bf16 v[104:107], a[152:155], a[128:131], v[104:107]
    ds_read_b64_tr_b16 a[216:217], v214 offset:32768
    v_mfma_f32_16x16x32_bf16 v[120:123], a[152:155], a[132:135], v[120:123]
    ds_read_b64_tr_b16 a[218:219], v214 offset:40960
    v_mfma_f32_16x16x32_bf16 v[136:139], a[152:155], a[136:139], v[136:139]
    ds_read_b128 a[204:207], v211 offset:32768
    buffer_load_dwordx4 v194, s[4:7], s42 offen offset:1024 sc1 lds
    v_mfma_f32_16x16x32_bf16 v[152:155], a[152:155], a[140:143], v[152:155]
    ds_read_b64_tr_b16 a[220:221], v215 offset:32768
    v_mfma_f32_16x16x32_bf16 v[108:111], a[156:159], a[128:131], v[108:111]
    ds_read_b64_tr_b16 a[222:223], v215 offset:40960
    v_mfma_f32_16x16x32_bf16 v[124:127], a[156:159], a[132:135], v[124:127]
    buffer_load_dwordx4 v195, s[16:19], s43 offen offset:2048 lds
    v_mfma_f32_16x16x32_bf16 v[140:143], a[156:159], a[136:139], v[140:143]
    v_mfma_f32_16x16x32_bf16 v[156:159], a[156:159], a[140:143], v[156:159]
    s_waitcnt lgkmcnt(12)
    v_mfma_f32_16x16x32_bf16 v[96:99], a[176:179], a[160:163], v[96:99]
    buffer_load_dwordx4 v196, s[16:19], s43 offen offset:3072 lds
    s_add_u32 s42, s42, 1024
    v_mfma_f32_16x16x32_bf16 v[112:115], a[176:179], a[164:167], v[112:115]
    ds_read_b128 a[128:131], v208 offset:49152
    s_add_u32 s43, s43, 32768
    v_mfma_f32_16x16x32_bf16 v[128:131], a[176:179], a[168:171], v[128:131]
    ds_read_b64_tr_b16 a[144:145], v212 offset:49152
    s_add_u32 m0, s44, 0
    v_mfma_f32_16x16x32_bf16 v[144:147], a[176:179], a[172:175], v[144:147]
    ds_read_b64_tr_b16 a[146:147], v212 offset:57344
    buffer_load_dwordx4 v3, s[4:7], s42 offen sc1 lds
    v_mfma_f32_16x16x32_bf16 v[100:103], a[180:183], a[160:163], v[100:103]
    ds_read_b128 a[132:135], v209 offset:49152
    v_mfma_f32_16x16x32_bf16 v[116:119], a[180:183], a[164:167], v[116:119]
    ds_read_b64_tr_b16 a[148:149], v213 offset:49152
    v_mfma_f32_16x16x32_bf16 v[132:135], a[180:183], a[168:171], v[132:135]
    ds_read_b64_tr_b16 a[150:151], v213 offset:57344
    buffer_load_dwordx4 v194, s[4:7], s42 offen offset:1024 sc1 lds
    v_mfma_f32_16x16x32_bf16 v[148:151], a[180:183], a[172:175], v[148:151]
    ds_read_b128 a[136:139], v210 offset:49152
    v_mfma_f32_16x16x32_bf16 v[104:107], a[184:187], a[160:163], v[104:107]
    ds_read_b64_tr_b16 a[152:153], v214 offset:49152
    v_mfma_f32_16x16x32_bf16 v[120:123], a[184:187], a[164:167], v[120:123]
    ds_read_b64_tr_b16 a[154:155], v214 offset:57344
    buffer_load_dwordx4 v195, s[16:19], s43 offen offset:2048 lds
    v_mfma_f32_16x16x32_bf16 v[136:139], a[184:187], a[168:171], v[136:139]
    ds_read_b128 a[140:143], v211 offset:49152
    v_mfma_f32_16x16x32_bf16 v[152:155], a[184:187], a[172:175], v[152:155]
    ds_read_b64_tr_b16 a[156:157], v215 offset:49152
    v_mfma_f32_16x16x32_bf16 v[108:111], a[188:191], a[160:163], v[108:111]
    ds_read_b64_tr_b16 a[158:159], v215 offset:57344
    buffer_load_dwordx4 v196, s[16:19], s43 offen offset:3072 lds
    s_add_u32 s42, s42, 1024
    v_mfma_f32_16x16x32_bf16 v[124:127], a[188:191], a[164:167], v[124:127]
    s_add_u32 s43, s43, 32768
    v_mfma_f32_16x16x32_bf16 v[140:143], a[188:191], a[168:171], v[140:143]
    s_add_u32 m0, s44, 16384
    v_mfma_f32_16x16x32_bf16 v[156:159], a[188:191], a[172:175], v[156:159]
    buffer_load_dwordx4 v3, s[4:7], s42 offen sc1 lds
    s_waitcnt lgkmcnt(12)
    v_mfma_f32_16x16x32_bf16 v[96:99], a[208:211], a[192:195], v[96:99]
    s_waitcnt vmcnt(5)
    s_barrier
    v_mfma_f32_16x16x32_bf16 v[112:115], a[208:211], a[196:199], v[112:115]
    ds_read_b128 a[160:163], v216 offset:0
    v_mfma_f32_16x16x32_bf16 v[128:131], a[208:211], a[200:203], v[128:131]
    ds_read_b64_tr_b16 a[176:177], v220 offset:0
    buffer_load_dwordx4 v194, s[4:7], s42 offen offset:1024 sc1 lds
    v_mfma_f32_16x16x32_bf16 v[144:147], a[208:211], a[204:207], v[144:147]
    ds_read_b64_tr_b16 a[178:179], v220 offset:8192
    v_mfma_f32_16x16x32_bf16 v[100:103], a[212:215], a[192:195], v[100:103]
    ds_read_b128 a[164:167], v217 offset:0
    v_mfma_f32_16x16x32_bf16 v[116:119], a[212:215], a[196:199], v[116:119]
    ds_read_b64_tr_b16 a[180:181], v221 offset:0
    buffer_load_dwordx4 v195, s[16:19], s43 offen offset:2048 lds
    v_mfma_f32_16x16x32_bf16 v[132:135], a[212:215], a[200:203], v[132:135]
    ds_read_b64_tr_b16 a[182:183], v221 offset:8192
    v_mfma_f32_16x16x32_bf16 v[148:151], a[212:215], a[204:207], v[148:151]
    ds_read_b128 a[168:171], v218 offset:0
    v_mfma_f32_16x16x32_bf16 v[104:107], a[216:219], a[192:195], v[104:107]
    ds_read_b64_tr_b16 a[184:185], v222 offset:0
    buffer_load_dwordx4 v196, s[16:19], s43 offen offset:3072 lds
    s_add_u32 s42, s42, 1024
    v_mfma_f32_16x16x32_bf16 v[120:123], a[216:219], a[196:199], v[120:123]
    ds_read_b64_tr_b16 a[186:187], v222 offset:8192
    s_add_u32 s43, s43, 32768
    v_mfma_f32_16x16x32_bf16 v[136:139], a[216:219], a[200:203], v[136:139]
    ds_read_b128 a[172:175], v219 offset:0
    s_add_u32 m0, s44, 32768
    v_mfma_f32_16x16x32_bf16 v[152:155], a[216:219], a[204:207], v[152:155]
    ds_read_b64_tr_b16 a[188:189], v223 offset:0
    buffer_load_dwordx4 v3, s[4:7], s42 offen sc1 lds
    v_mfma_f32_16x16x32_bf16 v[108:111], a[220:223], a[192:195], v[108:111]
    ds_read_b64_tr_b16 a[190:191], v223 offset:8192
    v_mfma_f32_16x16x32_bf16 v[124:127], a[220:223], a[196:199], v[124:127]
    v_mfma_f32_16x16x32_bf16 v[140:143], a[220:223], a[200:203], v[140:143]
    buffer_load_dwordx4 v194, s[4:7], s42 offen offset:1024 sc1 lds
    v_mfma_f32_16x16x32_bf16 v[156:159], a[220:223], a[204:207], v[156:159]
    s_waitcnt lgkmcnt(12)
    v_mfma_f32_16x16x32_bf16 v[96:99], a[144:147], a[128:131], v[96:99]
    v_mfma_f32_16x16x32_bf16 v[112:115], a[144:147], a[132:135], v[112:115]
    ds_read_b128 a[192:195], v216 offset:16384
    buffer_load_dwordx4 v195, s[16:19], s43 offen offset:2048 lds
    v_mfma_f32_16x16x32_bf16 v[128:131], a[144:147], a[136:139], v[128:131]
    ds_read_b64_tr_b16 a[208:209], v220 offset:16384
    v_mfma_f32_16x16x32_bf16 v[144:147], a[144:147], a[140:143], v[144:147]
    ds_read_b64_tr_b16 a[210:211], v220 offset:24576
    v_mfma_f32_16x16x32_bf16 v[100:103], a[148:151], a[128:131], v[100:103]
    ds_read_b128 a[196:199], v217 offset:16384
    buffer_load_dwordx4 v196, s[16:19], s43 offen offset:3072 lds
    s_add_u32 s42, s42, 1024
    v_mfma_f32_16x16x32_bf16 v[116:119], a[148:151], a[132:135], v[116:119]
    ds_read_b64_tr_b16 a[212:213], v221 offset:16384
    s_add_u32 s43, s43, 32768
    v_mfma_f32_16x16x32_bf16 v[132:135], a[148:151], a[136:139], v[132:135]
    ds_read_b64_tr_b16 a[214:215], v221 offset:24576
    s_add_u32 m0, s44, 49152
    v_mfma_f32_16x16x32_bf16 v[148:151], a[148:151], a[140:143], v[148:151]
    ds_read_b128 a[200:203], v218 offset:16384
    buffer_load_dwordx4 v3, s[4:7], s42 offen sc1 lds
    v_mfma_f32_16x16x32_bf16 v[104:107], a[152:155], a[128:131], v[104:107]
    ds_read_b64_tr_b16 a[216:217], v222 offset:16384
    v_mfma_f32_16x16x32_bf16 v[120:123], a[152:155], a[132:135], v[120:123]
    ds_read_b64_tr_b16 a[218:219], v222 offset:24576
    v_mfma_f32_16x16x32_bf16 v[136:139], a[152:155], a[136:139], v[136:139]
    ds_read_b128 a[204:207], v219 offset:16384
    buffer_load_dwordx4 v194, s[4:7], s42 offen offset:1024 sc1 lds
    v_mfma_f32_16x16x32_bf16 v[152:155], a[152:155], a[140:143], v[152:155]
    ds_read_b64_tr_b16 a[220:221], v223 offset:16384
    v_mfma_f32_16x16x32_bf16 v[108:111], a[156:159], a[128:131], v[108:111]
    ds_read_b64_tr_b16 a[222:223], v223 offset:24576
    v_mfma_f32_16x16x32_bf16 v[124:127], a[156:159], a[132:135], v[124:127]
    buffer_load_dwordx4 v195, s[16:19], s43 offen offset:2048 lds
    v_mfma_f32_16x16x32_bf16 v[140:143], a[156:159], a[136:139], v[140:143]
    v_mfma_f32_16x16x32_bf16 v[156:159], a[156:159], a[140:143], v[156:159]
    s_waitcnt lgkmcnt(12)
    v_mfma_f32_16x16x32_bf16 v[96:99], a[176:179], a[160:163], v[96:99]
    buffer_load_dwordx4 v196, s[16:19], s43 offen offset:3072 lds
    s_waitcnt vmcnt(8)
    s_barrier
    v_mfma_f32_16x16x32_bf16 v[112:115], a[176:179], a[164:167], v[112:115]
    ds_read_b128 a[128:131], v8 offset:0
    s_add_u32 s42, s42, 1024
    s_add_u32 s43, s43, 32768
    v_mfma_f32_16x16x32_bf16 v[128:131], a[176:179], a[168:171], v[128:131]
    ds_read_b64_tr_b16 a[144:145], v12 offset:0
    s_add_u32 m0, s44, 65536
    v_mfma_f32_16x16x32_bf16 v[144:147], a[176:179], a[172:175], v[144:147]
    ds_read_b64_tr_b16 a[146:147], v12 offset:8192
    buffer_load_dwordx4 v3, s[4:7], s42 offen sc1 lds
    v_mfma_f32_16x16x32_bf16 v[100:103], a[180:183], a[160:163], v[100:103]
    ds_read_b128 a[132:135], v9 offset:0
    v_mfma_f32_16x16x32_bf16 v[116:119], a[180:183], a[164:167], v[116:119]
    ds_read_b64_tr_b16 a[148:149], v13 offset:0
    v_mfma_f32_16x16x32_bf16 v[132:135], a[180:183], a[168:171], v[132:135]
    ds_read_b64_tr_b16 a[150:151], v13 offset:8192
    buffer_load_dwordx4 v194, s[4:7], s42 offen offset:1024 sc1 lds
    v_mfma_f32_16x16x32_bf16 v[148:151], a[180:183], a[172:175], v[148:151]
    ds_read_b128 a[136:139], v10 offset:0
    v_mfma_f32_16x16x32_bf16 v[104:107], a[184:187], a[160:163], v[104:107]
    ds_read_b64_tr_b16 a[152:153], v14 offset:0
    v_mfma_f32_16x16x32_bf16 v[120:123], a[184:187], a[164:167], v[120:123]
    ds_read_b64_tr_b16 a[154:155], v14 offset:8192
    buffer_load_dwordx4 v195, s[16:19], s43 offen offset:2048 lds
    v_mfma_f32_16x16x32_bf16 v[136:139], a[184:187], a[168:171], v[136:139]
    ds_read_b128 a[140:143], v11 offset:0
    v_mfma_f32_16x16x32_bf16 v[152:155], a[184:187], a[172:175], v[152:155]
    ds_read_b64_tr_b16 a[156:157], v15 offset:0
    v_mfma_f32_16x16x32_bf16 v[108:111], a[188:191], a[160:163], v[108:111]
    ds_read_b64_tr_b16 a[158:159], v15 offset:8192
    buffer_load_dwordx4 v196, s[16:19], s43 offen offset:3072 lds
    s_add_u32 s42, s42, 1024
    v_mfma_f32_16x16x32_bf16 v[124:127], a[188:191], a[164:167], v[124:127]
    s_add_u32 s43, s43, 32768
    v_mfma_f32_16x16x32_bf16 v[140:143], a[188:191], a[168:171], v[140:143]
    s_add_u32 m0, s44, 81920
    v_mfma_f32_16x16x32_bf16 v[156:159], a[188:191], a[172:175], v[156:159]
    buffer_load_dwordx4 v3, s[4:7], s42 offen sc1 lds
    s_waitcnt lgkmcnt(12)
    v_mfma_f32_16x16x32_bf16 v[96:99], a[208:211], a[192:195], v[96:99]
    v_mfma_f32_16x16x32_bf16 v[112:115], a[208:211], a[196:199], v[112:115]
    ds_read_b128 a[160:163], v8 offset:16384
    v_mfma_f32_16x16x32_bf16 v[128:131], a[208:211], a[200:203], v[128:131]
    ds_read_b64_tr_b16 a[176:177], v12 offset:16384
    buffer_load_dwordx4 v194, s[4:7], s42 offen offset:1024 sc1 lds
    v_mfma_f32_16x16x32_bf16 v[144:147], a[208:211], a[204:207], v[144:147]
    ds_read_b64_tr_b16 a[178:179], v12 offset:24576
    v_mfma_f32_16x16x32_bf16 v[100:103], a[212:215], a[192:195], v[100:103]
    ds_read_b128 a[164:167], v9 offset:16384
    v_mfma_f32_16x16x32_bf16 v[116:119], a[212:215], a[196:199], v[116:119]
    ds_read_b64_tr_b16 a[180:181], v13 offset:16384
    buffer_load_dwordx4 v195, s[16:19], s43 offen offset:2048 lds
    v_mfma_f32_16x16x32_bf16 v[132:135], a[212:215], a[200:203], v[132:135]
    ds_read_b64_tr_b16 a[182:183], v13 offset:24576
    v_mfma_f32_16x16x32_bf16 v[148:151], a[212:215], a[204:207], v[148:151]
    ds_read_b128 a[168:171], v10 offset:16384
    v_mfma_f32_16x16x32_bf16 v[104:107], a[216:219], a[192:195], v[104:107]
    ds_read_b64_tr_b16 a[184:185], v14 offset:16384
    buffer_load_dwordx4 v196, s[16:19], s43 offen offset:3072 lds
    v_mfma_f32_16x16x32_bf16 v[120:123], a[216:219], a[196:199], v[120:123]
    ds_read_b64_tr_b16 a[186:187], v14 offset:24576
    v_mfma_f32_16x16x32_bf16 v[136:139], a[216:219], a[200:203], v[136:139]
    ds_read_b128 a[172:175], v11 offset:16384
    v_mfma_f32_16x16x32_bf16 v[152:155], a[216:219], a[204:207], v[152:155]
    ds_read_b64_tr_b16 a[188:189], v15 offset:16384
    buffer_load_dwordx2 v[20:21], v18, s[8:11], s48 offen offset:0
    v_mfma_f32_16x16x32_bf16 v[108:111], a[220:223], a[192:195], v[108:111]
    ds_read_b64_tr_b16 a[190:191], v15 offset:24576
    v_mfma_f32_16x16x32_bf16 v[124:127], a[220:223], a[196:199], v[124:127]
    v_mfma_f32_16x16x32_bf16 v[140:143], a[220:223], a[200:203], v[140:143]
    buffer_load_dwordx2 v[22:23], v18, s[8:11], s48 offen offset:32
    v_mfma_f32_16x16x32_bf16 v[156:159], a[220:223], a[204:207], v[156:159]
    s_waitcnt lgkmcnt(12)
    v_mfma_f32_16x16x32_bf16 v[96:99], a[144:147], a[128:131], v[96:99]
    s_waitcnt vmcnt(10)
    s_barrier
    v_mfma_f32_16x16x32_bf16 v[112:115], a[144:147], a[132:135], v[112:115]
    ds_read_b128 a[192:195], v8 offset:32768
    buffer_load_dwordx2 v[24:25], v18, s[8:11], s48 offen offset:64
    v_mfma_f32_16x16x32_bf16 v[128:131], a[144:147], a[136:139], v[128:131]
    ds_read_b64_tr_b16 a[208:209], v12 offset:32768
    v_mfma_f32_16x16x32_bf16 v[144:147], a[144:147], a[140:143], v[144:147]
    ds_read_b64_tr_b16 a[210:211], v12 offset:40960
    v_mfma_f32_16x16x32_bf16 v[100:103], a[148:151], a[128:131], v[100:103]
    ds_read_b128 a[196:199], v9 offset:32768
    buffer_load_dwordx2 v[26:27], v18, s[8:11], s48 offen offset:96
    s_add_u32 s42, s42, 1024
    v_mfma_f32_16x16x32_bf16 v[116:119], a[148:151], a[132:135], v[116:119]
    ds_read_b64_tr_b16 a[212:213], v13 offset:32768
    s_add_u32 s43, s43, 32768
    v_mfma_f32_16x16x32_bf16 v[132:135], a[148:151], a[136:139], v[132:135]
    ds_read_b64_tr_b16 a[214:215], v13 offset:40960
    s_add_u32 m0, s44, 98304
    v_mfma_f32_16x16x32_bf16 v[148:151], a[148:151], a[140:143], v[148:151]
    ds_read_b128 a[200:203], v10 offset:32768
    buffer_load_dwordx4 v3, s[4:7], s42 offen sc1 lds
    v_mfma_f32_16x16x32_bf16 v[104:107], a[152:155], a[128:131], v[104:107]
    ds_read_b64_tr_b16 a[216:217], v14 offset:32768
    v_mfma_f32_16x16x32_bf16 v[120:123], a[152:155], a[132:135], v[120:123]
    ds_read_b64_tr_b16 a[218:219], v14 offset:40960
    v_mfma_f32_16x16x32_bf16 v[136:139], a[152:155], a[136:139], v[136:139]
    ds_read_b128 a[204:207], v11 offset:32768
    buffer_load_dwordx4 v194, s[4:7], s42 offen offset:1024 sc1 lds
    v_mfma_f32_16x16x32_bf16 v[152:155], a[152:155], a[140:143], v[152:155]
    ds_read_b64_tr_b16 a[220:221], v15 offset:32768
    v_mfma_f32_16x16x32_bf16 v[108:111], a[156:159], a[128:131], v[108:111]
    ds_read_b64_tr_b16 a[222:223], v15 offset:40960
    v_mfma_f32_16x16x32_bf16 v[124:127], a[156:159], a[132:135], v[124:127]
    buffer_load_dwordx4 v195, s[16:19], s43 offen offset:2048 lds
    v_mfma_f32_16x16x32_bf16 v[140:143], a[156:159], a[136:139], v[140:143]
    v_mfma_f32_16x16x32_bf16 v[156:159], a[156:159], a[140:143], v[156:159]
    s_waitcnt lgkmcnt(12)
    v_mfma_f32_16x16x32_bf16 v[96:99], a[176:179], a[160:163], v[96:99]
    buffer_load_dwordx4 v196, s[16:19], s43 offen offset:3072 lds
    s_add_u32 s42, s42, 1024
    v_mfma_f32_16x16x32_bf16 v[112:115], a[176:179], a[164:167], v[112:115]
    ds_read_b128 a[128:131], v8 offset:49152
    s_add_u32 s43, s43, 32768
    v_mfma_f32_16x16x32_bf16 v[128:131], a[176:179], a[168:171], v[128:131]
    ds_read_b64_tr_b16 a[144:145], v12 offset:49152
    s_add_u32 m0, s44, 114688
    v_mfma_f32_16x16x32_bf16 v[144:147], a[176:179], a[172:175], v[144:147]
    ds_read_b64_tr_b16 a[146:147], v12 offset:57344
    buffer_load_dwordx4 v3, s[4:7], s42 offen sc1 lds
    v_mfma_f32_16x16x32_bf16 v[100:103], a[180:183], a[160:163], v[100:103]
    ds_read_b128 a[132:135], v9 offset:49152
    v_mfma_f32_16x16x32_bf16 v[116:119], a[180:183], a[164:167], v[116:119]
    ds_read_b64_tr_b16 a[148:149], v13 offset:49152
    v_mfma_f32_16x16x32_bf16 v[132:135], a[180:183], a[168:171], v[132:135]
    ds_read_b64_tr_b16 a[150:151], v13 offset:57344
    buffer_load_dwordx4 v194, s[4:7], s42 offen offset:1024 sc1 lds
    v_mfma_f32_16x16x32_bf16 v[148:151], a[180:183], a[172:175], v[148:151]
    ds_read_b128 a[136:139], v10 offset:49152
    v_mfma_f32_16x16x32_bf16 v[104:107], a[184:187], a[160:163], v[104:107]
    ds_read_b64_tr_b16 a[152:153], v14 offset:49152
    v_mfma_f32_16x16x32_bf16 v[120:123], a[184:187], a[164:167], v[120:123]
    ds_read_b64_tr_b16 a[154:155], v14 offset:57344
    buffer_load_dwordx4 v195, s[16:19], s43 offen offset:2048 lds
    v_mfma_f32_16x16x32_bf16 v[136:139], a[184:187], a[168:171], v[136:139]
    ds_read_b128 a[140:143], v11 offset:49152
    v_mfma_f32_16x16x32_bf16 v[152:155], a[184:187], a[172:175], v[152:155]
    ds_read_b64_tr_b16 a[156:157], v15 offset:49152
    v_mfma_f32_16x16x32_bf16 v[108:111], a[188:191], a[160:163], v[108:111]
    ds_read_b64_tr_b16 a[158:159], v15 offset:57344
    buffer_load_dwordx4 v196, s[16:19], s43 offen offset:3072 lds
    v_mfma_f32_16x16x32_bf16 v[124:127], a[188:191], a[164:167], v[124:127]
    v_mfma_f32_16x16x32_bf16 v[140:143], a[188:191], a[168:171], v[140:143]
    v_mfma_f32_16x16x32_bf16 v[156:159], a[188:191], a[172:175], v[156:159]
    s_waitcnt lgkmcnt(12)
    v_mfma_f32_16x16x32_bf16 v[96:99], a[208:211], a[192:195], v[96:99]
    s_waitcnt vmcnt(12)
    s_barrier
    v_mfma_f32_16x16x32_bf16 v[112:115], a[208:211], a[196:199], v[112:115]
    ds_read_b128 a[160:163], v208 offset:0
    v_mfma_f32_16x16x32_bf16 v[128:131], a[208:211], a[200:203], v[128:131]
    ds_read_b64_tr_b16 a[176:177], v212 offset:0
    s_xor_b32 s51, s51, 512
    v_mfma_f32_16x16x32_bf16 v[144:147], a[208:211], a[204:207], v[144:147]
    ds_read_b64_tr_b16 a[178:179], v212 offset:8192
    buffer_load_dword v198, v197, s[4:7], s51 offen sc1
    s_add_u32 s42, s42, 1024
    v_mfma_f32_16x16x32_bf16 v[100:103], a[212:215], a[192:195], v[100:103]
    ds_read_b128 a[164:167], v209 offset:0
    s_add_u32 s43, s43, 32768
    v_mfma_f32_16x16x32_bf16 v[116:119], a[212:215], a[196:199], v[116:119]
    ds_read_b64_tr_b16 a[180:181], v213 offset:0
    s_add_u32 m0, s44, 131072
    v_mfma_f32_16x16x32_bf16 v[132:135], a[212:215], a[200:203], v[132:135]
    ds_read_b64_tr_b16 a[182:183], v213 offset:8192
    buffer_load_dwordx4 v3, s[4:7], s42 offen sc1 lds
    v_mfma_f32_16x16x32_bf16 v[148:151], a[212:215], a[204:207], v[148:151]
    ds_read_b128 a[168:171], v210 offset:0
    v_mfma_f32_16x16x32_bf16 v[104:107], a[216:219], a[192:195], v[104:107]
    ds_read_b64_tr_b16 a[184:185], v214 offset:0
    v_mfma_f32_16x16x32_bf16 v[120:123], a[216:219], a[196:199], v[120:123]
    ds_read_b64_tr_b16 a[186:187], v214 offset:8192
    buffer_load_dwordx4 v194, s[4:7], s42 offen offset:1024 sc1 lds
    v_mfma_f32_16x16x32_bf16 v[136:139], a[216:219], a[200:203], v[136:139]
    ds_read_b128 a[172:175], v211 offset:0
    v_mfma_f32_16x16x32_bf16 v[152:155], a[216:219], a[204:207], v[152:155]
    ds_read_b64_tr_b16 a[188:189], v215 offset:0
    v_mfma_f32_16x16x32_bf16 v[108:111], a[220:223], a[192:195], v[108:111]
    ds_read_b64_tr_b16 a[190:191], v215 offset:8192
    buffer_load_dwordx4 v195, s[16:19], s43 offen offset:2048 lds
    v_mfma_f32_16x16x32_bf16 v[124:127], a[220:223], a[196:199], v[124:127]
    v_mfma_f32_16x16x32_bf16 v[140:143], a[220:223], a[200:203], v[140:143]
    v_mfma_f32_16x16x32_bf16 v[156:159], a[220:223], a[204:207], v[156:159]
    buffer_load_dwordx4 v196, s[16:19], s43 offen offset:3072 lds
    s_add_u32 s42, s42, 1024
    s_waitcnt lgkmcnt(12)
    v_mfma_f32_16x16x32_bf16 v[96:99], a[144:147], a[128:131], v[96:99]
    s_add_u32 s43, s43, 32768
    v_mfma_f32_16x16x32_bf16 v[112:115], a[144:147], a[132:135], v[112:115]
    ds_read_b128 a[192:195], v208 offset:16384
    s_add_u32 m0, s44, 147456
    v_mfma_f32_16x16x32_bf16 v[128:131], a[144:147], a[136:139], v[128:131]
    ds_read_b64_tr_b16 a[208:209], v212 offset:16384
    buffer_load_dwordx4 v3, s[4:7], s42 offen sc1 lds
    v_mfma_f32_16x16x32_bf16 v[144:147], a[144:147], a[140:143], v[144:147]
    ds_read_b64_tr_b16 a[210:211], v212 offset:24576
    v_mfma_f32_16x16x32_bf16 v[100:103], a[148:151], a[128:131], v[100:103]
    ds_read_b128 a[196:199], v209 offset:16384
    v_mfma_f32_16x16x32_bf16 v[116:119], a[148:151], a[132:135], v[116:119]
    ds_read_b64_tr_b16 a[212:213], v213 offset:16384
    buffer_load_dwordx4 v194, s[4:7], s42 offen offset:1024 sc1 lds
    v_mfma_f32_16x16x32_bf16 v[132:135], a[148:151], a[136:139], v[132:135]
    ds_read_b64_tr_b16 a[214:215], v213 offset:24576
    v_mfma_f32_16x16x32_bf16 v[148:151], a[148:151], a[140:143], v[148:151]
    ds_read_b128 a[200:203], v210 offset:16384
    v_mfma_f32_16x16x32_bf16 v[104:107], a[152:155], a[128:131], v[104:107]
    ds_read_b64_tr_b16 a[216:217], v214 offset:16384
    buffer_load_dwordx4 v195, s[16:19], s43 offen offset:2048 lds
    v_mfma_f32_16x16x32_bf16 v[120:123], a[152:155], a[132:135], v[120:123]
    ds_read_b64_tr_b16 a[218:219], v214 offset:24576
    v_mfma_f32_16x16x32_bf16 v[136:139], a[152:155], a[136:139], v[136:139]
    ds_read_b128 a[204:207], v211 offset:16384
    v_mfma_f32_16x16x32_bf16 v[152:155], a[152:155], a[140:143], v[152:155]
    ds_read_b64_tr_b16 a[220:221], v215 offset:16384
    buffer_load_dwordx4 v196, s[16:19], s43 offen offset:3072 lds
    v_mfma_f32_16x16x32_bf16 v[108:111], a[156:159], a[128:131], v[108:111]
    ds_read_b64_tr_b16 a[222:223], v215 offset:24576
    v_mfma_f32_16x16x32_bf16 v[124:127], a[156:159], a[132:135], v[124:127]
    v_mfma_f32_16x16x32_bf16 v[140:143], a[156:159], a[136:139], v[140:143]
    v_mfma_f32_16x16x32_bf16 v[156:159], a[156:159], a[140:143], v[156:159]
    s_waitcnt lgkmcnt(12)
    v_mfma_f32_16x16x32_bf16 v[96:99], a[176:179], a[160:163], v[96:99]
    s_waitcnt vmcnt(9)
    s_barrier
    v_mfma_f32_16x16x32_bf16 v[112:115], a[176:179], a[164:167], v[112:115]
    ds_read_b128 a[128:131], v208 offset:32768
    s_add_u32 s42, s42, 1024
    s_add_u32 s43, s43, 32768
    v_mfma_f32_16x16x32_bf16 v[128:131], a[176:179], a[168:171], v[128:131]
    ds_read_b64_tr_b16 a[144:145], v212 offset:32768
    s_add_u32 m0, s44, 0
    v_mfma_f32_16x16x32_bf16 v[144:147], a[176:179], a[172:175], v[144:147]
    ds_read_b64_tr_b16 a[146:147], v212 offset:40960
    buffer_load_dwordx4 v3, s[4:7], s42 offen sc1 lds
    v_mfma_f32_16x16x32_bf16 v[100:103], a[180:183], a[160:163], v[100:103]
    ds_read_b128 a[132:135], v209 offset:32768
    v_mfma_f32_16x16x32_bf16 v[116:119], a[180:183], a[164:167], v[116:119]
    ds_read_b64_tr_b16 a[148:149], v213 offset:32768
    v_mfma_f32_16x16x32_bf16 v[132:135], a[180:183], a[168:171], v[132:135]
    ds_read_b64_tr_b16 a[150:151], v213 offset:40960
    buffer_load_dwordx4 v194, s[4:7], s42 offen offset:1024 sc1 lds
    v_mfma_f32_16x16x32_bf16 v[148:151], a[180:183], a[172:175], v[148:151]
    ds_read_b128 a[136:139], v210 offset:32768
    v_mfma_f32_16x16x32_bf16 v[104:107], a[184:187], a[160:163], v[104:107]
    ds_read_b64_tr_b16 a[152:153], v214 offset:32768
    v_mfma_f32_16x16x32_bf16 v[120:123], a[184:187], a[164:167], v[120:123]
    ds_read_b64_tr_b16 a[154:155], v214 offset:40960
    buffer_load_dwordx4 v195, s[16:19], s43 offen offset:2048 lds
    v_mfma_f32_16x16x32_bf16 v[136:139], a[184:187], a[168:171], v[136:139]
    ds_read_b128 a[140:143], v211 offset:32768
    v_mfma_f32_16x16x32_bf16 v[152:155], a[184:187], a[172:175], v[152:155]
    ds_read_b64_tr_b16 a[156:157], v215 offset:32768
    v_mfma_f32_16x16x32_bf16 v[108:111], a[188:191], a[160:163], v[108:111]
    ds_read_b64_tr_b16 a[158:159], v215 offset:40960
    buffer_load_dwordx4 v196, s[16:19], s43 offen offset:3072 lds
    s_add_u32 s42, s42, 1024
    v_mfma_f32_16x16x32_bf16 v[124:127], a[188:191], a[164:167], v[124:127]
    s_add_u32 s43, s43, 32768
    v_mfma_f32_16x16x32_bf16 v[140:143], a[188:191], a[168:171], v[140:143]
    s_add_u32 m0, s44, 16384
    v_mfma_f32_16x16x32_bf16 v[156:159], a[188:191], a[172:175], v[156:159]
    buffer_load_dwordx4 v3, s[4:7], s42 offen sc1 lds
    s_waitcnt lgkmcnt(12)
    v_mfma_f32_16x16x32_bf16 v[96:99], a[208:211], a[192:195], v[96:99]
    v_mfma_f32_16x16x32_bf16 v[112:115], a[208:211], a[196:199], v[112:115]
    ds_read_b128 a[160:163], v208 offset:49152
    v_mfma_f32_16x16x32_bf16 v[128:131], a[208:211], a[200:203], v[128:131]
    ds_read_b64_tr_b16 a[176:177], v212 offset:49152
    buffer_load_dwordx4 v194, s[4:7], s42 offen offset:1024 sc1 lds
    v_mfma_f32_16x16x32_bf16 v[144:147], a[208:211], a[204:207], v[144:147]
    ds_read_b64_tr_b16 a[178:179], v212 offset:57344
    v_mfma_f32_16x16x32_bf16 v[100:103], a[212:215], a[192:195], v[100:103]
    ds_read_b128 a[164:167], v209 offset:49152
    v_mfma_f32_16x16x32_bf16 v[116:119], a[212:215], a[196:199], v[116:119]
    ds_read_b64_tr_b16 a[180:181], v213 offset:49152
    buffer_load_dwordx4 v195, s[16:19], s43 offen offset:2048 lds
    v_mfma_f32_16x16x32_bf16 v[132:135], a[212:215], a[200:203], v[132:135]
    ds_read_b64_tr_b16 a[182:183], v213 offset:57344
    v_mfma_f32_16x16x32_bf16 v[148:151], a[212:215], a[204:207], v[148:151]
    ds_read_b128 a[168:171], v210 offset:49152
    v_mfma_f32_16x16x32_bf16 v[104:107], a[216:219], a[192:195], v[104:107]
    ds_read_b64_tr_b16 a[184:185], v214 offset:49152
    buffer_load_dwordx4 v196, s[16:19], s43 offen offset:3072 lds
    v_mfma_f32_16x16x32_bf16 v[120:123], a[216:219], a[196:199], v[120:123]
    ds_read_b64_tr_b16 a[186:187], v214 offset:57344
    v_mfma_f32_16x16x32_bf16 v[136:139], a[216:219], a[200:203], v[136:139]
    ds_read_b128 a[172:175], v211 offset:49152
    v_mfma_f32_16x16x32_bf16 v[152:155], a[216:219], a[204:207], v[152:155]
    ds_read_b64_tr_b16 a[188:189], v215 offset:49152
    v_mfma_f32_16x16x32_bf16 v[108:111], a[220:223], a[192:195], v[108:111]
    ds_read_b64_tr_b16 a[190:191], v215 offset:57344
    v_mfma_f32_16x16x32_bf16 v[124:127], a[220:223], a[196:199], v[124:127]
    v_mfma_f32_16x16x32_bf16 v[140:143], a[220:223], a[200:203], v[140:143]
    v_mfma_f32_16x16x32_bf16 v[156:159], a[220:223], a[204:207], v[156:159]
    s_waitcnt lgkmcnt(12)
    v_mfma_f32_16x16x32_bf16 v[96:99], a[144:147], a[128:131], v[96:99]
    s_waitcnt vmcnt(8)
    s_barrier
    s_waitcnt vmcnt(16)
    v_cmp_ne_u32 vcc, 1, v198
    s_cbranch_vccnz K3_DSPIN_E
K3_DOK:
    v_mfma_f32_16x16x32_bf16 v[112:115], a[144:147], a[132:135], v[112:115]
    ds_read_b128 a[192:195], v216 offset:0
    s_and_b32 s43, s2, 7
    s_xor_b32 s43, s43, 1
    s_lshl_b32 s42, s43, 14
    s_add_u32 s42, s42, s32
    s_lshl_b32 s43, s43, 19
    v_mfma_f32_16x16x32_bf16 v[128:131], a[144:147], a[136:139], v[128:131]
    ds_read_b64_tr_b16 a[208:209], v220 offset:0
    s_add_u32 m0, s44, 32768
    v_mfma_f32_16x16x32_bf16 v[144:147], a[144:147], a[140:143], v[144:147]
    ds_read_b64_tr_b16 a[210:211], v220 offset:8192
    buffer_load_dwordx4 v3, s[4:7], s42 offen sc1 lds
    v_mfma_f32_16x16x32_bf16 v[100:103], a[148:151], a[128:131], v[100:103]
    ds_read_b128 a[196:199], v217 offset:0
    v_mfma_f32_16x16x32_bf16 v[116:119], a[148:151], a[132:135], v[116:119]
    ds_read_b64_tr_b16 a[212:213], v221 offset:0
    v_mfma_f32_16x16x32_bf16 v[132:135], a[148:151], a[136:139], v[132:135]
    ds_read_b64_tr_b16 a[214:215], v221 offset:8192
    buffer_load_dwordx4 v194, s[4:7], s42 offen offset:1024 sc1 lds
    v_mfma_f32_16x16x32_bf16 v[148:151], a[148:151], a[140:143], v[148:151]
    ds_read_b128 a[200:203], v218 offset:0
    v_mfma_f32_16x16x32_bf16 v[104:107], a[152:155], a[128:131], v[104:107]
    ds_read_b64_tr_b16 a[216:217], v222 offset:0
    v_mfma_f32_16x16x32_bf16 v[120:123], a[152:155], a[132:135], v[120:123]
    ds_read_b64_tr_b16 a[218:219], v222 offset:8192
    buffer_load_dwordx4 v195, s[16:19], s43 offen offset:2048 lds
    v_mfma_f32_16x16x32_bf16 v[136:139], a[152:155], a[136:139], v[136:139]
    ds_read_b128 a[204:207], v219 offset:0
    v_mfma_f32_16x16x32_bf16 v[152:155], a[152:155], a[140:143], v[152:155]
    ds_read_b64_tr_b16 a[220:221], v223 offset:0
    v_mfma_f32_16x16x32_bf16 v[108:111], a[156:159], a[128:131], v[108:111]
    ds_read_b64_tr_b16 a[222:223], v223 offset:8192
    buffer_load_dwordx4 v196, s[16:19], s43 offen offset:3072 lds
    s_add_u32 s42, s42, 1024
    v_mfma_f32_16x16x32_bf16 v[124:127], a[156:159], a[132:135], v[124:127]
    s_add_u32 s43, s43, 32768
    v_mfma_f32_16x16x32_bf16 v[140:143], a[156:159], a[136:139], v[140:143]
    s_add_u32 m0, s44, 49152
    v_mfma_f32_16x16x32_bf16 v[156:159], a[156:159], a[140:143], v[156:159]
    buffer_load_dwordx4 v3, s[4:7], s42 offen sc1 lds
    s_waitcnt lgkmcnt(12)
    v_mfma_f32_16x16x32_bf16 v[96:99], a[176:179], a[160:163], v[96:99]
    v_mfma_f32_16x16x32_bf16 v[112:115], a[176:179], a[164:167], v[112:115]
    ds_read_b128 a[128:131], v216 offset:16384
    v_mfma_f32_16x16x32_bf16 v[128:131], a[176:179], a[168:171], v[128:131]
    ds_read_b64_tr_b16 a[144:145], v220 offset:16384
    buffer_load_dwordx4 v194, s[4:7], s42 offen offset:1024 sc1 lds
    v_mfma_f32_16x16x32_bf16 v[144:147], a[176:179], a[172:175], v[144:147]
    ds_read_b64_tr_b16 a[146:147], v220 offset:24576
    v_mfma_f32_16x16x32_bf16 v[100:103], a[180:183], a[160:163], v[100:103]
    ds_read_b128 a[132:135], v217 offset:16384
    v_mfma_f32_16x16x32_bf16 v[116:119], a[180:183], a[164:167], v[116:119]
    ds_read_b64_tr_b16 a[148:149], v221 offset:16384
    buffer_load_dwordx4 v195, s[16:19], s43 offen offset:2048 lds
    v_mfma_f32_16x16x32_bf16 v[132:135], a[180:183], a[168:171], v[132:135]
    ds_read_b64_tr_b16 a[150:151], v221 offset:24576
    v_mfma_f32_16x16x32_bf16 v[148:151], a[180:183], a[172:175], v[148:151]
    ds_read_b128 a[136:139], v218 offset:16384
    v_mfma_f32_16x16x32_bf16 v[104:107], a[184:187], a[160:163], v[104:107]
    ds_read_b64_tr_b16 a[152:153], v222 offset:16384
    buffer_load_dwordx4 v196, s[16:19], s43 offen offset:3072 lds
    v_mfma_f32_16x16x32_bf16 v[120:123], a[184:187], a[164:167], v[120:123]
    ds_read_b64_tr_b16 a[154:155], v222 offset:24576
    v_mfma_f32_16x16x32_bf16 v[136:139], a[184:187], a[168:171], v[136:139]
    ds_read_b128 a[140:143], v219 offset:16384
    v_mfma_f32_16x16x32_bf16 v[152:155], a[184:187], a[172:175], v[152:155]
    ds_read_b64_tr_b16 a[156:157], v223 offset:16384
    v_mfma_f32_16x16x32_bf16 v[108:111], a[188:191], a[160:163], v[108:111]
    ds_read_b64_tr_b16 a[158:159], v223 offset:24576
    v_mfma_f32_16x16x32_bf16 v[124:127], a[188:191], a[164:167], v[124:127]
    v_mfma_f32_16x16x32_bf16 v[140:143], a[188:191], a[168:171], v[140:143]
    v_mfma_f32_16x16x32_bf16 v[156:159], a[188:191], a[172:175], v[156:159]
    s_waitcnt lgkmcnt(12)
    v_mfma_f32_16x16x32_bf16 v[96:99], a[208:211], a[192:195], v[96:99]
    s_waitcnt vmcnt(8)
    s_barrier
    v_mfma_f32_16x16x32_bf16 v[112:115], a[208:211], a[196:199], v[112:115]
    ds_read_b128 a[160:163], v8 offset:0
    s_add_u32 s42, s42, 1024
    s_add_u32 s43, s43, 32768
    v_mfma_f32_16x16x32_bf16 v[128:131], a[208:211], a[200:203], v[128:131]
    ds_read_b64_tr_b16 a[176:177], v12 offset:0
    s_add_u32 m0, s44, 65536
    v_mfma_f32_16x16x32_bf16 v[144:147], a[208:211], a[204:207], v[144:147]
    ds_read_b64_tr_b16 a[178:179], v12 offset:8192
    buffer_load_dwordx4 v3, s[4:7], s42 offen sc1 lds
    v_mfma_f32_16x16x32_bf16 v[100:103], a[212:215], a[192:195], v[100:103]
    ds_read_b128 a[164:167], v9 offset:0
    v_mfma_f32_16x16x32_bf16 v[116:119], a[212:215], a[196:199], v[116:119]
    ds_read_b64_tr_b16 a[180:181], v13 offset:0
    v_mfma_f32_16x16x32_bf16 v[132:135], a[212:215], a[200:203], v[132:135]
    ds_read_b64_tr_b16 a[182:183], v13 offset:8192
    buffer_load_dwordx4 v194, s[4:7], s42 offen offset:1024 sc1 lds
    v_mfma_f32_16x16x32_bf16 v[148:151], a[212:215], a[204:207], v[148:151]
    ds_read_b128 a[168:171], v10 offset:0
    v_mfma_f32_16x16x32_bf16 v[104:107], a[216:219], a[192:195], v[104:107]
    ds_read_b64_tr_b16 a[184:185], v14 offset:0
    v_mfma_f32_16x16x32_bf16 v[120:123], a[216:219], a[196:199], v[120:123]
    ds_read_b64_tr_b16 a[186:187], v14 offset:8192
    buffer_load_dwordx4 v195, s[16:19], s43 offen offset:2048 lds
    v_mfma_f32_16x16x32_bf16 v[136:139], a[216:219], a[200:203], v[136:139]
    ds_read_b128 a[172:175], v11 offset:0
    v_mfma_f32_16x16x32_bf16 v[152:155], a[216:219], a[204:207], v[152:155]
    ds_read_b64_tr_b16 a[188:189], v15 offset:0
    v_mfma_f32_16x16x32_bf16 v[108:111], a[220:223], a[192:195], v[108:111]
    ds_read_b64_tr_b16 a[190:191], v15 offset:8192
    buffer_load_dwordx4 v196, s[16:19], s43 offen offset:3072 lds
    s_add_u32 s42, s42, 1024
    v_mfma_f32_16x16x32_bf16 v[124:127], a[220:223], a[196:199], v[124:127]
    s_add_u32 s43, s43, 32768
    v_mfma_f32_16x16x32_bf16 v[140:143], a[220:223], a[200:203], v[140:143]
    s_add_u32 m0, s44, 81920
    v_mfma_f32_16x16x32_bf16 v[156:159], a[220:223], a[204:207], v[156:159]
    buffer_load_dwordx4 v3, s[4:7], s42 offen sc1 lds
    s_waitcnt lgkmcnt(12)
    v_mfma_f32_16x16x32_bf16 v[96:99], a[144:147], a[128:131], v[96:99]
    v_mfma_f32_16x16x32_bf16 v[112:115], a[144:147], a[132:135], v[112:115]
    ds_read_b128 a[192:195], v8 offset:16384
    v_mfma_f32_16x16x32_bf16 v[128:131], a[144:147], a[136:139], v[128:131]
    ds_read_b64_tr_b16 a[208:209], v12 offset:16384
    buffer_load_dwordx4 v194, s[4:7], s42 offen offset:1024 sc1 lds
    v_mfma_f32_16x16x32_bf16 v[144:147], a[144:147], a[140:143], v[144:147]
    ds_read_b64_tr_b16 a[210:211], v12 offset:24576
    v_mfma_f32_16x16x32_bf16 v[100:103], a[148:151], a[128:131], v[100:103]
    ds_read_b128 a[196:199], v9 offset:16384
    v_mfma_f32_16x16x32_bf16 v[116:119], a[148:151], a[132:135], v[116:119]
    ds_read_b64_tr_b16 a[212:213], v13 offset:16384
    buffer_load_dwordx4 v195, s[16:19], s43 offen offset:2048 lds
    v_mfma_f32_16x16x32_bf16 v[132:135], a[148:151], a[136:139], v[132:135]
    ds_read_b64_tr_b16 a[214:215], v13 offset:24576
    v_mfma_f32_16x16x32_bf16 v[148:151], a[148:151], a[140:143], v[148:151]
    ds_read_b128 a[200:203], v10 offset:16384
    v_mfma_f32_16x16x32_bf16 v[104:107], a[152:155], a[128:131], v[104:107]
    ds_read_b64_tr_b16 a[216:217], v14 offset:16384
    buffer_load_dwordx4 v196, s[16:19], s43 offen offset:3072 lds
    v_mfma_f32_16x16x32_bf16 v[120:123], a[152:155], a[132:135], v[120:123]
    ds_read_b64_tr_b16 a[218:219], v14 offset:24576
    v_mfma_f32_16x16x32_bf16 v[136:139], a[152:155], a[136:139], v[136:139]
    ds_read_b128 a[204:207], v11 offset:16384
    v_mfma_f32_16x16x32_bf16 v[152:155], a[152:155], a[140:143], v[152:155]
    ds_read_b64_tr_b16 a[220:221], v15 offset:16384
    v_mfma_f32_16x16x32_bf16 v[108:111], a[156:159], a[128:131], v[108:111]
    ds_read_b64_tr_b16 a[222:223], v15 offset:24576
    v_mfma_f32_16x16x32_bf16 v[124:127], a[156:159], a[132:135], v[124:127]
    v_mfma_f32_16x16x32_bf16 v[140:143], a[156:159], a[136:139], v[140:143]
    v_mfma_f32_16x16x32_bf16 v[156:159], a[156:159], a[140:143], v[156:159]
    s_waitcnt lgkmcnt(12)
    v_mfma_f32_16x16x32_bf16 v[96:99], a[176:179], a[160:163], v[96:99]
    s_waitcnt vmcnt(8)
    s_barrier
    v_mfma_f32_16x16x32_bf16 v[112:115], a[176:179], a[164:167], v[112:115]
    ds_read_b128 a[128:131], v8 offset:32768
    s_add_u32 s42, s42, 1024
    s_add_u32 s43, s43, 32768
    v_mfma_f32_16x16x32_bf16 v[128:131], a[176:179], a[168:171], v[128:131]
    ds_read_b64_tr_b16 a[144:145], v12 offset:32768
    s_add_u32 m0, s44, 98304
    v_mfma_f32_16x16x32_bf16 v[144:147], a[176:179], a[172:175], v[144:147]
    ds_read_b64_tr_b16 a[146:147], v12 offset:40960
    buffer_load_dwordx4 v3, s[4:7], s42 offen sc1 lds
    v_mfma_f32_16x16x32_bf16 v[100:103], a[180:183], a[160:163], v[100:103]
    ds_read_b128 a[132:135], v9 offset:32768
    v_mfma_f32_16x16x32_bf16 v[116:119], a[180:183], a[164:167], v[116:119]
    ds_read_b64_tr_b16 a[148:149], v13 offset:32768
    v_mfma_f32_16x16x32_bf16 v[132:135], a[180:183], a[168:171], v[132:135]
    ds_read_b64_tr_b16 a[150:151], v13 offset:40960
    buffer_load_dwordx4 v194, s[4:7], s42 offen offset:1024 sc1 lds
    v_mfma_f32_16x16x32_bf16 v[148:151], a[180:183], a[172:175], v[148:151]
    ds_read_b128 a[136:139], v10 offset:32768
    v_mfma_f32_16x16x32_bf16 v[104:107], a[184:187], a[160:163], v[104:107]
    ds_read_b64_tr_b16 a[152:153], v14 offset:32768
    v_mfma_f32_16x16x32_bf16 v[120:123], a[184:187], a[164:167], v[120:123]
    ds_read_b64_tr_b16 a[154:155], v14 offset:40960
    buffer_load_dwordx4 v195, s[16:19], s43 offen offset:2048 lds
    v_mfma_f32_16x16x32_bf16 v[136:139], a[184:187], a[168:171], v[136:139]
    ds_read_b128 a[140:143], v11 offset:32768
    v_mfma_f32_16x16x32_bf16 v[152:155], a[184:187], a[172:175], v[152:155]
    ds_read_b64_tr_b16 a[156:157], v15 offset:32768
    v_mfma_f32_16x16x32_bf16 v[108:111], a[188:191], a[160:163], v[108:111]
    ds_read_b64_tr_b16 a[158:159], v15 offset:40960
    buffer_load_dwordx4 v196, s[16:19], s43 offen offset:3072 lds
    s_add_u32 s42, s42, 1024
    v_mfma_f32_16x16x32_bf16 v[124:127], a[188:191], a[164:167], v[124:127]
    s_add_u32 s43, s43, 32768
    v_mfma_f32_16x16x32_bf16 v[140:143], a[188:191], a[168:171], v[140:143]
    s_add_u32 m0, s44, 114688
    v_mfma_f32_16x16x32_bf16 v[156:159], a[188:191], a[172:175], v[156:159]
    buffer_load_dwordx4 v3, s[4:7], s42 offen sc1 lds
    s_waitcnt lgkmcnt(12)
    v_mfma_f32_16x16x32_bf16 v[96:99], a[208:211], a[192:195], v[96:99]
    v_mfma_f32_16x16x32_bf16 v[112:115], a[208:211], a[196:199], v[112:115]
    ds_read_b128 a[160:163], v8 offset:49152
    v_mfma_f32_16x16x32_bf16 v[128:131], a[208:211], a[200:203], v[128:131]
    ds_read_b64_tr_b16 a[176:177], v12 offset:49152
    buffer_load_dwordx4 v194, s[4:7], s42 offen offset:1024 sc1 lds
    v_mfma_f32_16x16x32_bf16 v[144:147], a[208:211], a[204:207], v[144:147]
    ds_read_b64_tr_b16 a[178:179], v12 offset:57344
    v_mfma_f32_16x16x32_bf16 v[100:103], a[212:215], a[192:195], v[100:103]
    ds_read_b128 a[164:167], v9 offset:49152
    v_mfma_f32_16x16x32_bf16 v[116:119], a[212:215], a[196:199], v[116:119]
    ds_read_b64_tr_b16 a[180:181], v13 offset:49152
    buffer_load_dwordx4 v195, s[16:19], s43 offen offset:2048 lds
    v_mfma_f32_16x16x32_bf16 v[132:135], a[212:215], a[200:203], v[132:135]
    ds_read_b64_tr_b16 a[182:183], v13 offset:57344
    v_mfma_f32_16x16x32_bf16 v[148:151], a[212:215], a[204:207], v[148:151]
    ds_read_b128 a[168:171], v10 offset:49152
    v_mfma_f32_16x16x32_bf16 v[104:107], a[216:219], a[192:195], v[104:107]
    ds_read_b64_tr_b16 a[184:185], v14 offset:49152
    buffer_load_dwordx4 v196, s[16:19], s43 offen offset:3072 lds
    v_mfma_f32_16x16x32_bf16 v[120:123], a[216:219], a[196:199], v[120:123]
    ds_read_b64_tr_b16 a[186:187], v14 offset:57344
    v_mfma_f32_16x16x32_bf16 v[136:139], a[216:219], a[200:203], v[136:139]
    ds_read_b128 a[172:175], v11 offset:49152
    v_mfma_f32_16x16x32_bf16 v[152:155], a[216:219], a[204:207], v[152:155]
    ds_read_b64_tr_b16 a[188:189], v15 offset:49152
    v_mfma_f32_16x16x32_bf16 v[108:111], a[220:223], a[192:195], v[108:111]
    ds_read_b64_tr_b16 a[190:191], v15 offset:57344
    v_mfma_f32_16x16x32_bf16 v[124:127], a[220:223], a[196:199], v[124:127]
    v_mfma_f32_16x16x32_bf16 v[140:143], a[220:223], a[200:203], v[140:143]
    v_mfma_f32_16x16x32_bf16 v[156:159], a[220:223], a[204:207], v[156:159]
    s_waitcnt lgkmcnt(12)
    v_mfma_f32_16x16x32_bf16 v[96:99], a[144:147], a[128:131], v[96:99]
    s_waitcnt vmcnt(8)
    s_barrier
    v_mfma_f32_16x16x32_bf16 v[112:115], a[144:147], a[132:135], v[112:115]
    ds_read_b128 a[192:195], v208 offset:0
    s_add_u32 s42, s42, 1024
    s_add_u32 s43, s43, 32768
    v_mfma_f32_16x16x32_bf16 v[128:131], a[144:147], a[136:139], v[128:131]
    ds_read_b64_tr_b16 a[208:209], v212 offset:0
    s_add_u32 m0, s44, 131072
    v_mfma_f32_16x16x32_bf16 v[144:147], a[144:147], a[140:143], v[144:147]
    ds_read_b64_tr_b16 a[210:211], v212 offset:8192
    buffer_load_dwordx4 v3, s[4:7], s42 offen sc1 lds
    v_mfma_f32_16x16x32_bf16 v[100:103], a[148:151], a[128:131], v[100:103]
    ds_read_b128 a[196:199], v209 offset:0
    v_mfma_f32_16x16x32_bf16 v[116:119], a[148:151], a[132:135], v[116:119]
    ds_read_b64_tr_b16 a[212:213], v213 offset:0
    v_mfma_f32_16x16x32_bf16 v[132:135], a[148:151], a[136:139], v[132:135]
    ds_read_b64_tr_b16 a[214:215], v213 offset:8192
    buffer_load_dwordx4 v194, s[4:7], s42 offen offset:1024 sc1 lds
    v_mfma_f32_16x16x32_bf16 v[148:151], a[148:151], a[140:143], v[148:151]
    ds_read_b128 a[200:203], v210 offset:0
    v_mfma_f32_16x16x32_bf16 v[104:107], a[152:155], a[128:131], v[104:107]
    ds_read_b64_tr_b16 a[216:217], v214 offset:0
    v_mfma_f32_16x16x32_bf16 v[120:123], a[152:155], a[132:135], v[120:123]
    ds_read_b64_tr_b16 a[218:219], v214 offset:8192
    buffer_load_dwordx4 v195, s[16:19], s43 offen offset:2048 lds
    v_mfma_f32_16x16x32_bf16 v[136:139], a[152:155], a[136:139], v[136:139]
    ds_read_b128 a[204:207], v211 offset:0
    v_mfma_f32_16x16x32_bf16 v[152:155], a[152:155], a[140:143], v[152:155]
    ds_read_b64_tr_b16 a[220:221], v215 offset:0
    v_mfma_f32_16x16x32_bf16 v[108:111], a[156:159], a[128:131], v[108:111]
    ds_read_b64_tr_b16 a[222:223], v215 offset:8192
    buffer_load_dwordx4 v196, s[16:19], s43 offen offset:3072 lds
    s_add_u32 s42, s42, 1024
    v_mfma_f32_16x16x32_bf16 v[124:127], a[156:159], a[132:135], v[124:127]
    s_add_u32 s43, s43, 32768
    v_mfma_f32_16x16x32_bf16 v[140:143], a[156:159], a[136:139], v[140:143]
    s_add_u32 m0, s44, 147456
    v_mfma_f32_16x16x32_bf16 v[156:159], a[156:159], a[140:143], v[156:159]
    buffer_load_dwordx4 v3, s[4:7], s42 offen sc1 lds
    s_waitcnt lgkmcnt(12)
    v_mfma_f32_16x16x32_bf16 v[96:99], a[176:179], a[160:163], v[96:99]
    v_mfma_f32_16x16x32_bf16 v[112:115], a[176:179], a[164:167], v[112:115]
    ds_read_b128 a[128:131], v208 offset:16384
    v_mfma_f32_16x16x32_bf16 v[128:131], a[176:179], a[168:171], v[128:131]
    ds_read_b64_tr_b16 a[144:145], v212 offset:16384
    buffer_load_dwordx4 v194, s[4:7], s42 offen offset:1024 sc1 lds
    v_mfma_f32_16x16x32_bf16 v[144:147], a[176:179], a[172:175], v[144:147]
    ds_read_b64_tr_b16 a[146:147], v212 offset:24576
    v_mfma_f32_16x16x32_bf16 v[100:103], a[180:183], a[160:163], v[100:103]
    ds_read_b128 a[132:135], v209 offset:16384
    v_mfma_f32_16x16x32_bf16 v[116:119], a[180:183], a[164:167], v[116:119]
    ds_read_b64_tr_b16 a[148:149], v213 offset:16384
    buffer_load_dwordx4 v195, s[16:19], s43 offen offset:2048 lds
    v_mfma_f32_16x16x32_bf16 v[132:135], a[180:183], a[168:171], v[132:135]
    ds_read_b64_tr_b16 a[150:151], v213 offset:24576
    v_mfma_f32_16x16x32_bf16 v[148:151], a[180:183], a[172:175], v[148:151]
    ds_read_b128 a[136:139], v210 offset:16384
    v_mfma_f32_16x16x32_bf16 v[104:107], a[184:187], a[160:163], v[104:107]
    ds_read_b64_tr_b16 a[152:153], v214 offset:16384
    buffer_load_dwordx4 v196, s[16:19], s43 offen offset:3072 lds
    v_mfma_f32_16x16x32_bf16 v[120:123], a[184:187], a[164:167], v[120:123]
    ds_read_b64_tr_b16 a[154:155], v214 offset:24576
    v_mfma_f32_16x16x32_bf16 v[136:139], a[184:187], a[168:171], v[136:139]
    ds_read_b128 a[140:143], v211 offset:16384
    v_mfma_f32_16x16x32_bf16 v[152:155], a[184:187], a[172:175], v[152:155]
    ds_read_b64_tr_b16 a[156:157], v215 offset:16384
    v_mfma_f32_16x16x32_bf16 v[108:111], a[188:191], a[160:163], v[108:111]
    ds_read_b64_tr_b16 a[158:159], v215 offset:24576
    v_mfma_f32_16x16x32_bf16 v[124:127], a[188:191], a[164:167], v[124:127]
    v_mfma_f32_16x16x32_bf16 v[140:143], a[188:191], a[168:171], v[140:143]
    v_mfma_f32_16x16x32_bf16 v[156:159], a[188:191], a[172:175], v[156:159]
    s_waitcnt lgkmcnt(12)
    v_mfma_f32_16x16x32_bf16 v[96:99], a[208:211], a[192:195], v[96:99]
    s_waitcnt vmcnt(8)
    s_barrier
    v_mfma_f32_16x16x32_bf16 v[112:115], a[208:211], a[196:199], v[112:115]
    ds_read_b128 a[160:163], v208 offset:32768
    s_lshr_b32 s39, s2, 5
    s_lshl_b32 s39, s39, 14
    s_lshl_b32 s41, s28, 12
    s_add_u32 s39, s39, s41
    s_and_b32 s41, s2, 1
    s_lshl_b32 s41, s41, 9
    s_add_u32 s39, s39, s41
    s_bfe_u32 s41, s2, 0x20003
    s_lshl_b32 s41, s41, 7
    s_add_u32 s39, s39, s41
    s_add_u32 s51, s39, 84148224
    v_and_b32 v197, 3, v2
    v_mfma_f32_16x16x32_bf16 v[128:131], a[208:211], a[200:203], v[128:131]
    ds_read_b64_tr_b16 a[176:177], v212 offset:32768
    v_lshlrev_b32 v197, 10, v197
    v_mfma_f32_16x16x32_bf16 v[144:147], a[208:211], a[204:207], v[144:147]
    ds_read_b64_tr_b16 a[178:179], v212 offset:40960
    buffer_load_dword v198, v197, s[4:7], s51 offen sc1
    s_add_u32 s42, s42, 1024
    v_mfma_f32_16x16x32_bf16 v[100:103], a[212:215], a[192:195], v[100:103]
    ds_read_b128 a[164:167], v209 offset:32768
    s_add_u32 s43, s43, 32768
    v_mfma_f32_16x16x32_bf16 v[116:119], a[212:215], a[196:199], v[116:119]
    ds_read_b64_tr_b16 a[180:181], v213 offset:32768
    s_add_u32 m0, s44, 0
    v_mfma_f32_16x16x32_bf16 v[132:135], a[212:215], a[200:203], v[132:135]
    ds_read_b64_tr_b16 a[182:183], v213 offset:40960
    buffer_load_dwordx4 v3, s[4:7], s42 offen sc1 lds
    v_mfma_f32_16x16x32_bf16 v[148:151], a[212:215], a[204:207], v[148:151]
    ds_read_b128 a[168:171], v210 offset:32768
    v_mfma_f32_16x16x32_bf16 v[104:107], a[216:219], a[192:195], v[104:107]
    ds_read_b64_tr_b16 a[184:185], v214 offset:32768
    v_mfma_f32_16x16x32_bf16 v[120:123], a[216:219], a[196:199], v[120:123]
    ds_read_b64_tr_b16 a[186:187], v214 offset:40960
    buffer_load_dwordx4 v194, s[4:7], s42 offen offset:1024 sc1 lds
    v_mfma_f32_16x16x32_bf16 v[136:139], a[216:219], a[200:203], v[136:139]
    ds_read_b128 a[172:175], v211 offset:32768
    v_mfma_f32_16x16x32_bf16 v[152:155], a[216:219], a[204:207], v[152:155]
    ds_read_b64_tr_b16 a[188:189], v215 offset:32768
    v_mfma_f32_16x16x32_bf16 v[108:111], a[220:223], a[192:195], v[108:111]
    ds_read_b64_tr_b16 a[190:191], v215 offset:40960
    buffer_load_dwordx4 v195, s[16:19], s43 offen offset:2048 lds
    v_mfma_f32_16x16x32_bf16 v[124:127], a[220:223], a[196:199], v[124:127]
    v_mfma_f32_16x16x32_bf16 v[140:143], a[220:223], a[200:203], v[140:143]
    v_mfma_f32_16x16x32_bf16 v[156:159], a[220:223], a[204:207], v[156:159]
    buffer_load_dwordx4 v196, s[16:19], s43 offen offset:3072 lds
    s_add_u32 s42, s42, 1024
    s_waitcnt lgkmcnt(12)
    v_mfma_f32_16x16x32_bf16 v[96:99], a[144:147], a[128:131], v[96:99]
    s_add_u32 s43, s43, 32768
    v_mfma_f32_16x16x32_bf16 v[112:115], a[144:147], a[132:135], v[112:115]
    ds_read_b128 a[192:195], v208 offset:49152
    s_add_u32 m0, s44, 16384
    v_mfma_f32_16x16x32_bf16 v[128:131], a[144:147], a[136:139], v[128:131]
    ds_read_b64_tr_b16 a[208:209], v212 offset:49152
    buffer_load_dwordx4 v3, s[4:7], s42 offen sc1 lds
    v_mfma_f32_16x16x32_bf16 v[144:147], a[144:147], a[140:143], v[144:147]
    ds_read_b64_tr_b16 a[210:211], v212 offset:57344
    v_mfma_f32_16x16x32_bf16 v[100:103], a[148:151], a[128:131], v[100:103]
    ds_read_b128 a[196:199], v209 offset:49152
    v_mfma_f32_16x16x32_bf16 v[116:119], a[148:151], a[132:135], v[116:119]
    ds_read_b64_tr_b16 a[212:213], v213 offset:49152
    buffer_load_dwordx4 v194, s[4:7], s42 offen offset:1024 sc1 lds
    v_mfma_f32_16x16x32_bf16 v[132:135], a[148:151], a[136:139], v[132:135]
    ds_read_b64_tr_b16 a[214:215], v213 offset:57344
    v_mfma_f32_16x16x32_bf16 v[148:151], a[148:151], a[140:143], v[148:151]
    ds_read_b128 a[200:203], v210 offset:49152
    v_mfma_f32_16x16x32_bf16 v[104:107], a[152:155], a[128:131], v[104:107]
    ds_read_b64_tr_b16 a[216:217], v214 offset:49152
    buffer_load_dwordx4 v195, s[16:19], s43 offen offset:2048 lds
    v_mfma_f32_16x16x32_bf16 v[120:123], a[152:155], a[132:135], v[120:123]
    ds_read_b64_tr_b16 a[218:219], v214 offset:57344
    v_mfma_f32_16x16x32_bf16 v[136:139], a[152:155], a[136:139], v[136:139]
    ds_read_b128 a[204:207], v211 offset:49152
    v_mfma_f32_16x16x32_bf16 v[152:155], a[152:155], a[140:143], v[152:155]
    ds_read_b64_tr_b16 a[220:221], v215 offset:49152
    buffer_load_dwordx4 v196, s[16:19], s43 offen offset:3072 lds
    v_mfma_f32_16x16x32_bf16 v[108:111], a[156:159], a[128:131], v[108:111]
    ds_read_b64_tr_b16 a[222:223], v215 offset:57344
    v_mfma_f32_16x16x32_bf16 v[124:127], a[156:159], a[132:135], v[124:127]
    v_mfma_f32_16x16x32_bf16 v[140:143], a[156:159], a[136:139], v[140:143]
    v_mfma_f32_16x16x32_bf16 v[156:159], a[156:159], a[140:143], v[156:159]
    s_waitcnt lgkmcnt(12)
    v_mfma_f32_16x16x32_bf16 v[96:99], a[176:179], a[160:163], v[96:99]
    s_waitcnt vmcnt(9)
    s_barrier
    v_mfma_f32_16x16x32_bf16 v[112:115], a[176:179], a[164:167], v[112:115]
    ds_read_b128 a[128:131], v216 offset:0
    s_add_u32 s42, s42, 1024
    s_add_u32 s43, s43, 32768
    v_mfma_f32_16x16x32_bf16 v[128:131], a[176:179], a[168:171], v[128:131]
    ds_read_b64_tr_b16 a[144:145], v220 offset:0
    s_add_u32 m0, s44, 32768
    v_mfma_f32_16x16x32_bf16 v[144:147], a[176:179], a[172:175], v[144:147]
    ds_read_b64_tr_b16 a[146:147], v220 offset:8192
    buffer_load_dwordx4 v3, s[4:7], s42 offen sc1 lds
    v_mfma_f32_16x16x32_bf16 v[100:103], a[180:183], a[160:163], v[100:103]
    ds_read_b128 a[132:135], v217 offset:0
    v_mfma_f32_16x16x32_bf16 v[116:119], a[180:183], a[164:167], v[116:119]
    ds_read_b64_tr_b16 a[148:149], v221 offset:0
    v_mfma_f32_16x16x32_bf16 v[132:135], a[180:183], a[168:171], v[132:135]
    ds_read_b64_tr_b16 a[150:151], v221 offset:8192
    buffer_load_dwordx4 v194, s[4:7], s42 offen offset:1024 sc1 lds
    v_mfma_f32_16x16x32_bf16 v[148:151], a[180:183], a[172:175], v[148:151]
    ds_read_b128 a[136:139], v218 offset:0
    v_mfma_f32_16x16x32_bf16 v[104:107], a[184:187], a[160:163], v[104:107]
    ds_read_b64_tr_b16 a[152:153], v222 offset:0
    v_mfma_f32_16x16x32_bf16 v[120:123], a[184:187], a[164:167], v[120:123]
    ds_read_b64_tr_b16 a[154:155], v222 offset:8192
    buffer_load_dwordx4 v195, s[16:19], s43 offen offset:2048 lds
    v_mfma_f32_16x16x32_bf16 v[136:139], a[184:187], a[168:171], v[136:139]
    ds_read_b128 a[140:143], v219 offset:0
    v_mfma_f32_16x16x32_bf16 v[152:155], a[184:187], a[172:175], v[152:155]
    ds_read_b64_tr_b16 a[156:157], v223 offset:0
    v_mfma_f32_16x16x32_bf16 v[108:111], a[188:191], a[160:163], v[108:111]
    ds_read_b64_tr_b16 a[158:159], v223 offset:8192
    buffer_load_dwordx4 v196, s[16:19], s43 offen offset:3072 lds
    s_add_u32 s42, s42, 1024
    v_mfma_f32_16x16x32_bf16 v[124:127], a[188:191], a[164:167], v[124:127]
    s_add_u32 s43, s43, 32768
    v_mfma_f32_16x16x32_bf16 v[140:143], a[188:191], a[168:171], v[140:143]
    s_add_u32 m0, s44, 49152
    v_mfma_f32_16x16x32_bf16 v[156:159], a[188:191], a[172:175], v[156:159]
    buffer_load_dwordx4 v3, s[4:7], s42 offen sc1 lds
    s_waitcnt lgkmcnt(12)
    v_mfma_f32_16x16x32_bf16 v[96:99], a[208:211], a[192:195], v[96:99]
    v_mfma_f32_16x16x32_bf16 v[112:115], a[208:211], a[196:199], v[112:115]
    ds_read_b128 a[160:163], v216 offset:16384
    v_mfma_f32_16x16x32_bf16 v[128:131], a[208:211], a[200:203], v[128:131]
    ds_read_b64_tr_b16 a[176:177], v220 offset:16384
    buffer_load_dwordx4 v194, s[4:7], s42 offen offset:1024 sc1 lds
    v_mfma_f32_16x16x32_bf16 v[144:147], a[208:211], a[204:207], v[144:147]
    ds_read_b64_tr_b16 a[178:179], v220 offset:24576
    v_mfma_f32_16x16x32_bf16 v[100:103], a[212:215], a[192:195], v[100:103]
    ds_read_b128 a[164:167], v217 offset:16384
    v_mfma_f32_16x16x32_bf16 v[116:119], a[212:215], a[196:199], v[116:119]
    ds_read_b64_tr_b16 a[180:181], v221 offset:16384
    buffer_load_dwordx4 v195, s[16:19], s43 offen offset:2048 lds
    v_mfma_f32_16x16x32_bf16 v[132:135], a[212:215], a[200:203], v[132:135]
    ds_read_b64_tr_b16 a[182:183], v221 offset:24576
    v_mfma_f32_16x16x32_bf16 v[148:151], a[212:215], a[204:207], v[148:151]
    ds_read_b128 a[168:171], v218 offset:16384
    v_mfma_f32_16x16x32_bf16 v[104:107], a[216:219], a[192:195], v[104:107]
    ds_read_b64_tr_b16 a[184:185], v222 offset:16384
    buffer_load_dwordx4 v196, s[16:19], s43 offen offset:3072 lds
    v_mfma_f32_16x16x32_bf16 v[120:123], a[216:219], a[196:199], v[120:123]
    ds_read_b64_tr_b16 a[186:187], v222 offset:24576
    v_mfma_f32_16x16x32_bf16 v[136:139], a[216:219], a[200:203], v[136:139]
    ds_read_b128 a[172:175], v219 offset:16384
    v_mfma_f32_16x16x32_bf16 v[152:155], a[216:219], a[204:207], v[152:155]
    ds_read_b64_tr_b16 a[188:189], v223 offset:16384
    v_mfma_f32_16x16x32_bf16 v[108:111], a[220:223], a[192:195], v[108:111]
    ds_read_b64_tr_b16 a[190:191], v223 offset:24576
    v_mfma_f32_16x16x32_bf16 v[124:127], a[220:223], a[196:199], v[124:127]
    v_mfma_f32_16x16x32_bf16 v[140:143], a[220:223], a[200:203], v[140:143]
    v_mfma_f32_16x16x32_bf16 v[156:159], a[220:223], a[204:207], v[156:159]
    s_waitcnt lgkmcnt(12)
    v_mfma_f32_16x16x32_bf16 v[96:99], a[144:147], a[128:131], v[96:99]
    s_waitcnt vmcnt(8)
    s_barrier
    s_waitcnt vmcnt(16)
    v_cmp_ne_u32 vcc, 1, v198
    s_cbranch_vccnz K3_PSPIN_E
K3_POK:
    v_mfma_f32_16x16x32_bf16 v[112:115], a[144:147], a[132:135], v[112:115]
    ds_read_b128 a[192:195], v8 offset:0
    s_add_u32 s42, s42, 1024
    s_add_u32 s43, s43, 32768
    v_mfma_f32_16x16x32_bf16 v[128:131], a[144:147], a[136:139], v[128:131]
    ds_read_b64_tr_b16 a[208:209], v12 offset:0
    s_add_u32 m0, s44, 65536
    v_mfma_f32_16x16x32_bf16 v[144:147], a[144:147], a[140:143], v[144:147]
    ds_read_b64_tr_b16 a[210:211], v12 offset:8192
    buffer_load_dwordx4 v3, s[4:7], s42 offen sc1 lds
    v_mfma_f32_16x16x32_bf16 v[100:103], a[148:151], a[128:131], v[100:103]
    ds_read_b128 a[196:199], v9 offset:0
    v_mfma_f32_16x16x32_bf16 v[116:119], a[148:151], a[132:135], v[116:119]
    ds_read_b64_tr_b16 a[212:213], v13 offset:0
    v_mfma_f32_16x16x32_bf16 v[132:135], a[148:151], a[136:139], v[132:135]
    ds_read_b64_tr_b16 a[214:215], v13 offset:8192
    buffer_load_dwordx4 v194, s[4:7], s42 offen offset:1024 sc1 lds
    v_mfma_f32_16x16x32_bf16 v[148:151], a[148:151], a[140:143], v[148:151]
    ds_read_b128 a[200:203], v10 offset:0
    v_mfma_f32_16x16x32_bf16 v[104:107], a[152:155], a[128:131], v[104:107]
    ds_read_b64_tr_b16 a[216:217], v14 offset:0
    v_mfma_f32_16x16x32_bf16 v[120:123], a[152:155], a[132:135], v[120:123]
    ds_read_b64_tr_b16 a[218:219], v14 offset:8192
    buffer_load_dwordx4 v195, s[16:19], s43 offen offset:2048 lds
    v_mfma_f32_16x16x32_bf16 v[136:139], a[152:155], a[136:139], v[136:139]
    ds_read_b128 a[204:207], v11 offset:0
    v_mfma_f32_16x16x32_bf16 v[152:155], a[152:155], a[140:143], v[152:155]
    ds_read_b64_tr_b16 a[220:221], v15 offset:0
    v_mfma_f32_16x16x32_bf16 v[108:111], a[156:159], a[128:131], v[108:111]
    ds_read_b64_tr_b16 a[222:223], v15 offset:8192
    buffer_load_dwordx4 v196, s[16:19], s43 offen offset:3072 lds
    s_add_u32 s42, s42, 1024
    v_mfma_f32_16x16x32_bf16 v[124:127], a[156:159], a[132:135], v[124:127]
    s_add_u32 s43, s43, 32768
    v_mfma_f32_16x16x32_bf16 v[140:143], a[156:159], a[136:139], v[140:143]
    s_add_u32 m0, s44, 81920
    v_mfma_f32_16x16x32_bf16 v[156:159], a[156:159], a[140:143], v[156:159]
    buffer_load_dwordx4 v3, s[4:7], s42 offen sc1 lds
    s_waitcnt lgkmcnt(12)
    v_mfma_f32_16x16x32_bf16 v[96:99], a[176:179], a[160:163], v[96:99]
    v_mfma_f32_16x16x32_bf16 v[112:115], a[176:179], a[164:167], v[112:115]
    ds_read_b128 a[128:131], v8 offset:16384
    v_mfma_f32_16x16x32_bf16 v[128:131], a[176:179], a[168:171], v[128:131]
    ds_read_b64_tr_b16 a[144:145], v12 offset:16384
    buffer_load_dwordx4 v194, s[4:7], s42 offen offset:1024 sc1 lds
    v_mfma_f32_16x16x32_bf16 v[144:147], a[176:179], a[172:175], v[144:147]
    ds_read_b64_tr_b16 a[146:147], v12 offset:24576
    v_mfma_f32_16x16x32_bf16 v[100:103], a[180:183], a[160:163], v[100:103]
    ds_read_b128 a[132:135], v9 offset:16384
    v_mfma_f32_16x16x32_bf16 v[116:119], a[180:183], a[164:167], v[116:119]
    ds_read_b64_tr_b16 a[148:149], v13 offset:16384
    buffer_load_dwordx4 v195, s[16:19], s43 offen offset:2048 lds
    v_mfma_f32_16x16x32_bf16 v[132:135], a[180:183], a[168:171], v[132:135]
    ds_read_b64_tr_b16 a[150:151], v13 offset:24576
    v_mfma_f32_16x16x32_bf16 v[148:151], a[180:183], a[172:175], v[148:151]
    ds_read_b128 a[136:139], v10 offset:16384
    v_mfma_f32_16x16x32_bf16 v[104:107], a[184:187], a[160:163], v[104:107]
    ds_read_b64_tr_b16 a[152:153], v14 offset:16384
    buffer_load_dwordx4 v196, s[16:19], s43 offen offset:3072 lds
    v_mfma_f32_16x16x32_bf16 v[120:123], a[184:187], a[164:167], v[120:123]
    ds_read_b64_tr_b16 a[154:155], v14 offset:24576
    v_mfma_f32_16x16x32_bf16 v[136:139], a[184:187], a[168:171], v[136:139]
    ds_read_b128 a[140:143], v11 offset:16384
    v_mfma_f32_16x16x32_bf16 v[152:155], a[184:187], a[172:175], v[152:155]
    ds_read_b64_tr_b16 a[156:157], v15 offset:16384
    v_mfma_f32_16x16x32_bf16 v[108:111], a[188:191], a[160:163], v[108:111]
    ds_read_b64_tr_b16 a[158:159], v15 offset:24576
    v_mfma_f32_16x16x32_bf16 v[124:127], a[188:191], a[164:167], v[124:127]
    v_mfma_f32_16x16x32_bf16 v[140:143], a[188:191], a[168:171], v[140:143]
    v_mfma_f32_16x16x32_bf16 v[156:159], a[188:191], a[172:175], v[156:159]
    s_waitcnt lgkmcnt(12)
    v_mfma_f32_16x16x32_bf16 v[96:99], a[208:211], a[192:195], v[96:99]
    s_waitcnt vmcnt(8)
    s_barrier
    v_mfma_f32_16x16x32_bf16 v[112:115], a[208:211], a[196:199], v[112:115]
    ds_read_b128 a[160:163], v8 offset:32768
    s_add_u32 s42, s42, 1024
    s_add_u32 s43, s43, 32768
    v_mfma_f32_16x16x32_bf16 v[128:131], a[208:211], a[200:203], v[128:131]
    ds_read_b64_tr_b16 a[176:177], v12 offset:32768
    s_add_u32 m0, s44, 98304
    v_mfma_f32_16x16x32_bf16 v[144:147], a[208:211], a[204:207], v[144:147]
    ds_read_b64_tr_b16 a[178:179], v12 offset:40960
    buffer_load_dwordx4 v3, s[4:7], s42 offen sc1 lds
    v_mfma_f32_16x16x32_bf16 v[100:103], a[212:215], a[192:195], v[100:103]
    ds_read_b128 a[164:167], v9 offset:32768
    v_mfma_f32_16x16x32_bf16 v[116:119], a[212:215], a[196:199], v[116:119]
    ds_read_b64_tr_b16 a[180:181], v13 offset:32768
    v_mfma_f32_16x16x32_bf16 v[132:135], a[212:215], a[200:203], v[132:135]
    ds_read_b64_tr_b16 a[182:183], v13 offset:40960
    buffer_load_dwordx4 v194, s[4:7], s42 offen offset:1024 sc1 lds
    v_mfma_f32_16x16x32_bf16 v[148:151], a[212:215], a[204:207], v[148:151]
    ds_read_b128 a[168:171], v10 offset:32768
    v_mfma_f32_16x16x32_bf16 v[104:107], a[216:219], a[192:195], v[104:107]
    ds_read_b64_tr_b16 a[184:185], v14 offset:32768
    v_mfma_f32_16x16x32_bf16 v[120:123], a[216:219], a[196:199], v[120:123]
    ds_read_b64_tr_b16 a[186:187], v14 offset:40960
    buffer_load_dwordx4 v195, s[16:19], s43 offen offset:2048 lds
    v_mfma_f32_16x16x32_bf16 v[136:139], a[216:219], a[200:203], v[136:139]
    ds_read_b128 a[172:175], v11 offset:32768
    v_mfma_f32_16x16x32_bf16 v[152:155], a[216:219], a[204:207], v[152:155]
    ds_read_b64_tr_b16 a[188:189], v15 offset:32768
    v_mfma_f32_16x16x32_bf16 v[108:111], a[220:223], a[192:195], v[108:111]
    ds_read_b64_tr_b16 a[190:191], v15 offset:40960
    buffer_load_dwordx4 v196, s[16:19], s43 offen offset:3072 lds
    s_add_u32 s42, s42, 1024
    v_mfma_f32_16x16x32_bf16 v[124:127], a[220:223], a[196:199], v[124:127]
    s_add_u32 s43, s43, 32768
    v_mfma_f32_16x16x32_bf16 v[140:143], a[220:223], a[200:203], v[140:143]
    s_add_u32 m0, s44, 114688
    v_mfma_f32_16x16x32_bf16 v[156:159], a[220:223], a[204:207], v[156:159]
    buffer_load_dwordx4 v3, s[4:7], s42 offen sc1 lds
    s_waitcnt lgkmcnt(12)
    v_mfma_f32_16x16x32_bf16 v[96:99], a[144:147], a[128:131], v[96:99]
    v_mfma_f32_16x16x32_bf16 v[112:115], a[144:147], a[132:135], v[112:115]
    ds_read_b128 a[192:195], v8 offset:49152
    v_mfma_f32_16x16x32_bf16 v[128:131], a[144:147], a[136:139], v[128:131]
    ds_read_b64_tr_b16 a[208:209], v12 offset:49152
    buffer_load_dwordx4 v194, s[4:7], s42 offen offset:1024 sc1 lds
    v_mfma_f32_16x16x32_bf16 v[144:147], a[144:147], a[140:143], v[144:147]
    ds_read_b64_tr_b16 a[210:211], v12 offset:57344
    v_mfma_f32_16x16x32_bf16 v[100:103], a[148:151], a[128:131], v[100:103]
    ds_read_b128 a[196:199], v9 offset:49152
    v_mfma_f32_16x16x32_bf16 v[116:119], a[148:151], a[132:135], v[116:119]
    ds_read_b64_tr_b16 a[212:213], v13 offset:49152
    buffer_load_dwordx4 v195, s[16:19], s43 offen offset:2048 lds
    v_mfma_f32_16x16x32_bf16 v[132:135], a[148:151], a[136:139], v[132:135]
    ds_read_b64_tr_b16 a[214:215], v13 offset:57344
    v_mfma_f32_16x16x32_bf16 v[148:151], a[148:151], a[140:143], v[148:151]
    ds_read_b128 a[200:203], v10 offset:49152
    v_mfma_f32_16x16x32_bf16 v[104:107], a[152:155], a[128:131], v[104:107]
    ds_read_b64_tr_b16 a[216:217], v14 offset:49152
    buffer_load_dwordx4 v196, s[16:19], s43 offen offset:3072 lds
    v_mfma_f32_16x16x32_bf16 v[120:123], a[152:155], a[132:135], v[120:123]
    ds_read_b64_tr_b16 a[218:219], v14 offset:57344
    v_mfma_f32_16x16x32_bf16 v[136:139], a[152:155], a[136:139], v[136:139]
    ds_read_b128 a[204:207], v11 offset:49152
    v_mfma_f32_16x16x32_bf16 v[152:155], a[152:155], a[140:143], v[152:155]
    ds_read_b64_tr_b16 a[220:221], v15 offset:49152
    v_mfma_f32_16x16x32_bf16 v[108:111], a[156:159], a[128:131], v[108:111]
    ds_read_b64_tr_b16 a[222:223], v15 offset:57344
    v_mfma_f32_16x16x32_bf16 v[124:127], a[156:159], a[132:135], v[124:127]
    v_mfma_f32_16x16x32_bf16 v[140:143], a[156:159], a[136:139], v[140:143]
    v_mfma_f32_16x16x32_bf16 v[156:159], a[156:159], a[140:143], v[156:159]
    s_waitcnt lgkmcnt(12)
    v_mfma_f32_16x16x32_bf16 v[96:99], a[176:179], a[160:163], v[96:99]
    s_waitcnt vmcnt(8)
    s_barrier
    v_mfma_f32_16x16x32_bf16 v[112:115], a[176:179], a[164:167], v[112:115]
    ds_read_b128 a[128:131], v208 offset:0
    v_mfma_f32_16x16x32_bf16 v[128:131], a[176:179], a[168:171], v[128:131]
    ds_read_b64_tr_b16 a[144:145], v212 offset:0
    v_mfma_f32_16x16x32_bf16 v[144:147], a[176:179], a[172:175], v[144:147]
    ds_read_b64_tr_b16 a[146:147], v212 offset:8192
    v_mfma_f32_16x16x32_bf16 v[100:103], a[180:183], a[160:163], v[100:103]
    ds_read_b128 a[132:135], v209 offset:0
    v_mfma_f32_16x16x32_bf16 v[116:119], a[180:183], a[164:167], v[116:119]
    ds_read_b64_tr_b16 a[148:149], v213 offset:0
    v_mfma_f32_16x16x32_bf16 v[132:135], a[180:183], a[168:171], v[132:135]
    ds_read_b64_tr_b16 a[150:151], v213 offset:8192
    v_mfma_f32_16x16x32_bf16 v[148:151], a[180:183], a[172:175], v[148:151]
    ds_read_b128 a[136:139], v210 offset:0
    v_mfma_f32_16x16x32_bf16 v[104:107], a[184:187], a[160:163], v[104:107]
    ds_read_b64_tr_b16 a[152:153], v214 offset:0
    v_mfma_f32_16x16x32_bf16 v[120:123], a[184:187], a[164:167], v[120:123]
    ds_read_b64_tr_b16 a[154:155], v214 offset:8192
    v_mfma_f32_16x16x32_bf16 v[136:139], a[184:187], a[168:171], v[136:139]
    ds_read_b128 a[140:143], v211 offset:0
    v_mfma_f32_16x16x32_bf16 v[152:155], a[184:187], a[172:175], v[152:155]
    ds_read_b64_tr_b16 a[156:157], v215 offset:0
    v_mfma_f32_16x16x32_bf16 v[108:111], a[188:191], a[160:163], v[108:111]
    ds_read_b64_tr_b16 a[158:159], v215 offset:8192
    v_mfma_f32_16x16x32_bf16 v[124:127], a[188:191], a[164:167], v[124:127]
    v_mfma_f32_16x16x32_bf16 v[140:143], a[188:191], a[168:171], v[140:143]
    v_mfma_f32_16x16x32_bf16 v[156:159], a[188:191], a[172:175], v[156:159]
    s_waitcnt lgkmcnt(12)
    v_mfma_f32_16x16x32_bf16 v[96:99], a[208:211], a[192:195], v[96:99]
    v_mfma_f32_16x16x32_bf16 v[112:115], a[208:211], a[196:199], v[112:115]
    ds_read_b128 a[160:163], v208 offset:16384
    v_mfma_f32_16x16x32_bf16 v[128:131], a[208:211], a[200:203], v[128:131]
    ds_read_b64_tr_b16 a[176:177], v212 offset:16384
    v_mfma_f32_16x16x32_bf16 v[144:147], a[208:211], a[204:207], v[144:147]
    ds_read_b64_tr_b16 a[178:179], v212 offset:24576
    v_mfma_f32_16x16x32_bf16 v[100:103], a[212:215], a[192:195], v[100:103]
    ds_read_b128 a[164:167], v209 offset:16384
    v_mfma_f32_16x16x32_bf16 v[116:119], a[212:215], a[196:199], v[116:119]
    ds_read_b64_tr_b16 a[180:181], v213 offset:16384
    v_mfma_f32_16x16x32_bf16 v[132:135], a[212:215], a[200:203], v[132:135]
    ds_read_b64_tr_b16 a[182:183], v213 offset:24576
    v_mfma_f32_16x16x32_bf16 v[148:151], a[212:215], a[204:207], v[148:151]
    ds_read_b128 a[168:171], v210 offset:16384
    v_mfma_f32_16x16x32_bf16 v[104:107], a[216:219], a[192:195], v[104:107]
    ds_read_b64_tr_b16 a[184:185], v214 offset:16384
    v_mfma_f32_16x16x32_bf16 v[120:123], a[216:219], a[196:199], v[120:123]
    ds_read_b64_tr_b16 a[186:187], v214 offset:24576
    v_mfma_f32_16x16x32_bf16 v[136:139], a[216:219], a[200:203], v[136:139]
    ds_read_b128 a[172:175], v211 offset:16384
    v_mfma_f32_16x16x32_bf16 v[152:155], a[216:219], a[204:207], v[152:155]
    ds_read_b64_tr_b16 a[188:189], v215 offset:16384
    v_mfma_f32_16x16x32_bf16 v[108:111], a[220:223], a[192:195], v[108:111]
    ds_read_b64_tr_b16 a[190:191], v215 offset:24576
    v_mfma_f32_16x16x32_bf16 v[124:127], a[220:223], a[196:199], v[124:127]
    v_mfma_f32_16x16x32_bf16 v[140:143], a[220:223], a[200:203], v[140:143]
    v_mfma_f32_16x16x32_bf16 v[156:159], a[220:223], a[204:207], v[156:159]
    s_waitcnt lgkmcnt(12)
    v_mfma_f32_16x16x32_bf16 v[96:99], a[144:147], a[128:131], v[96:99]
    s_waitcnt vmcnt(0)
    s_barrier
    v_mfma_f32_16x16x32_bf16 v[112:115], a[144:147], a[132:135], v[112:115]
    ds_read_b128 a[192:195], v208 offset:32768
    v_mfma_f32_16x16x32_bf16 v[128:131], a[144:147], a[136:139], v[128:131]
    ds_read_b64_tr_b16 a[208:209], v212 offset:32768
    v_mfma_f32_16x16x32_bf16 v[144:147], a[144:147], a[140:143], v[144:147]
    ds_read_b64_tr_b16 a[210:211], v212 offset:40960
    v_mfma_f32_16x16x32_bf16 v[100:103], a[148:151], a[128:131], v[100:103]
    ds_read_b128 a[196:199], v209 offset:32768
    v_mfma_f32_16x16x32_bf16 v[116:119], a[148:151], a[132:135], v[116:119]
    ds_read_b64_tr_b16 a[212:213], v213 offset:32768
    v_mfma_f32_16x16x32_bf16 v[132:135], a[148:151], a[136:139], v[132:135]
    ds_read_b64_tr_b16 a[214:215], v213 offset:40960
    v_mfma_f32_16x16x32_bf16 v[148:151], a[148:151], a[140:143], v[148:151]
    ds_read_b128 a[200:203], v210 offset:32768
    v_mfma_f32_16x16x32_bf16 v[104:107], a[152:155], a[128:131], v[104:107]
    ds_read_b64_tr_b16 a[216:217], v214 offset:32768
    v_mfma_f32_16x16x32_bf16 v[120:123], a[152:155], a[132:135], v[120:123]
    ds_read_b64_tr_b16 a[218:219], v214 offset:40960
    v_mfma_f32_16x16x32_bf16 v[136:139], a[152:155], a[136:139], v[136:139]
    ds_read_b128 a[204:207], v211 offset:32768
    v_mfma_f32_16x16x32_bf16 v[152:155], a[152:155], a[140:143], v[152:155]
    ds_read_b64_tr_b16 a[220:221], v215 offset:32768
    v_mfma_f32_16x16x32_bf16 v[108:111], a[156:159], a[128:131], v[108:111]
    ds_read_b64_tr_b16 a[222:223], v215 offset:40960
    v_mfma_f32_16x16x32_bf16 v[124:127], a[156:159], a[132:135], v[124:127]
    v_mfma_f32_16x16x32_bf16 v[140:143], a[156:159], a[136:139], v[140:143]
    v_mfma_f32_16x16x32_bf16 v[156:159], a[156:159], a[140:143], v[156:159]
    s_waitcnt lgkmcnt(12)
    v_mfma_f32_16x16x32_bf16 v[96:99], a[176:179], a[160:163], v[96:99]
    v_mfma_f32_16x16x32_bf16 v[112:115], a[176:179], a[164:167], v[112:115]
    ds_read_b128 a[128:131], v208 offset:49152
    v_mfma_f32_16x16x32_bf16 v[128:131], a[176:179], a[168:171], v[128:131]
    ds_read_b64_tr_b16 a[144:145], v212 offset:49152
    v_mfma_f32_16x16x32_bf16 v[144:147], a[176:179], a[172:175], v[144:147]
    ds_read_b64_tr_b16 a[146:147], v212 offset:57344
    v_mfma_f32_16x16x32_bf16 v[100:103], a[180:183], a[160:163], v[100:103]
    ds_read_b128 a[132:135], v209 offset:49152
    v_mfma_f32_16x16x32_bf16 v[116:119], a[180:183], a[164:167], v[116:119]
    ds_read_b64_tr_b16 a[148:149], v213 offset:49152
    v_mfma_f32_16x16x32_bf16 v[132:135], a[180:183], a[168:171], v[132:135]
    ds_read_b64_tr_b16 a[150:151], v213 offset:57344
    v_mfma_f32_16x16x32_bf16 v[148:151], a[180:183], a[172:175], v[148:151]
    ds_read_b128 a[136:139], v210 offset:49152
    v_mfma_f32_16x16x32_bf16 v[104:107], a[184:187], a[160:163], v[104:107]
    ds_read_b64_tr_b16 a[152:153], v214 offset:49152
    v_mfma_f32_16x16x32_bf16 v[120:123], a[184:187], a[164:167], v[120:123]
    ds_read_b64_tr_b16 a[154:155], v214 offset:57344
    v_mfma_f32_16x16x32_bf16 v[136:139], a[184:187], a[168:171], v[136:139]
    ds_read_b128 a[140:143], v211 offset:49152
    v_mfma_f32_16x16x32_bf16 v[152:155], a[184:187], a[172:175], v[152:155]
    ds_read_b64_tr_b16 a[156:157], v215 offset:49152
    v_mfma_f32_16x16x32_bf16 v[108:111], a[188:191], a[160:163], v[108:111]
    ds_read_b64_tr_b16 a[158:159], v215 offset:57344
    v_mfma_f32_16x16x32_bf16 v[124:127], a[188:191], a[164:167], v[124:127]
    v_mfma_f32_16x16x32_bf16 v[140:143], a[188:191], a[168:171], v[140:143]
    v_mfma_f32_16x16x32_bf16 v[156:159], a[188:191], a[172:175], v[156:159]
    s_waitcnt lgkmcnt(12)
    v_mfma_f32_16x16x32_bf16 v[96:99], a[208:211], a[192:195], v[96:99]
    v_mfma_f32_16x16x32_bf16 v[112:115], a[208:211], a[196:199], v[112:115]
    v_mfma_f32_16x16x32_bf16 v[128:131], a[208:211], a[200:203], v[128:131]
    v_mfma_f32_16x16x32_bf16 v[144:147], a[208:211], a[204:207], v[144:147]
    v_mfma_f32_16x16x32_bf16 v[100:103], a[212:215], a[192:195], v[100:103]
    v_mfma_f32_16x16x32_bf16 v[116:119], a[212:215], a[196:199], v[116:119]
    v_mfma_f32_16x16x32_bf16 v[132:135], a[212:215], a[200:203], v[132:135]
    v_mfma_f32_16x16x32_bf16 v[148:151], a[212:215], a[204:207], v[148:151]
    v_mfma_f32_16x16x32_bf16 v[104:107], a[216:219], a[192:195], v[104:107]
    v_mfma_f32_16x16x32_bf16 v[120:123], a[216:219], a[196:199], v[120:123]
    v_mfma_f32_16x16x32_bf16 v[136:139], a[216:219], a[200:203], v[136:139]
    v_mfma_f32_16x16x32_bf16 v[152:155], a[216:219], a[204:207], v[152:155]
    v_mfma_f32_16x16x32_bf16 v[108:111], a[220:223], a[192:195], v[108:111]
    v_mfma_f32_16x16x32_bf16 v[124:127], a[220:223], a[196:199], v[124:127]
    v_mfma_f32_16x16x32_bf16 v[140:143], a[220:223], a[200:203], v[140:143]
    v_mfma_f32_16x16x32_bf16 v[156:159], a[220:223], a[204:207], v[156:159]
    s_waitcnt lgkmcnt(0)
    v_mfma_f32_16x16x32_bf16 v[96:99], a[144:147], a[128:131], v[96:99]
    v_mfma_f32_16x16x32_bf16 v[112:115], a[144:147], a[132:135], v[112:115]
    v_mfma_f32_16x16x32_bf16 v[128:131], a[144:147], a[136:139], v[128:131]
    v_mfma_f32_16x16x32_bf16 v[144:147], a[144:147], a[140:143], v[144:147]
    v_mfma_f32_16x16x32_bf16 v[100:103], a[148:151], a[128:131], v[100:103]
    v_mfma_f32_16x16x32_bf16 v[116:119], a[148:151], a[132:135], v[116:119]
    v_mfma_f32_16x16x32_bf16 v[132:135], a[148:151], a[136:139], v[132:135]
    v_mfma_f32_16x16x32_bf16 v[148:151], a[148:151], a[140:143], v[148:151]
    v_mfma_f32_16x16x32_bf16 v[104:107], a[152:155], a[128:131], v[104:107]
    v_mfma_f32_16x16x32_bf16 v[120:123], a[152:155], a[132:135], v[120:123]
    v_mfma_f32_16x16x32_bf16 v[136:139], a[152:155], a[136:139], v[136:139]
    v_mfma_f32_16x16x32_bf16 v[152:155], a[152:155], a[140:143], v[152:155]
    v_mfma_f32_16x16x32_bf16 v[108:111], a[156:159], a[128:131], v[108:111]
    v_mfma_f32_16x16x32_bf16 v[124:127], a[156:159], a[132:135], v[124:127]
    v_mfma_f32_16x16x32_bf16 v[140:143], a[156:159], a[136:139], v[140:143]
    v_mfma_f32_16x16x32_bf16 v[156:159], a[156:159], a[140:143], v[156:159]
    s_add_u32 s39, s49, 4096
    v_cvt_pk_bf16_f32 v112, v112, v113
    v_cvt_pk_bf16_f32 v113, v114, v115
    v_cvt_pk_bf16_f32 v114, v116, v117
    v_cvt_pk_bf16_f32 v115, v118, v119
    buffer_store_dwordx4 v[112:115], v3, s[4:7], s49 offen offset:2048 sc1
    v_cvt_pk_bf16_f32 v120, v120, v121
    v_cvt_pk_bf16_f32 v121, v122, v123
    v_cvt_pk_bf16_f32 v122, v124, v125
    v_cvt_pk_bf16_f32 v123, v126, v127
    buffer_store_dwordx4 v[120:123], v3, s[4:7], s49 offen offset:3072 sc1
    v_cvt_pk_bf16_f32 v128, v128, v129
    v_cvt_pk_bf16_f32 v129, v130, v131
    v_cvt_pk_bf16_f32 v130, v132, v133
    v_cvt_pk_bf16_f32 v131, v134, v135
    buffer_store_dwordx4 v[128:131], v3, s[4:7], s39 offen offset:0 sc1
    v_cvt_pk_bf16_f32 v136, v136, v137
    v_cvt_pk_bf16_f32 v137, v138, v139
    v_cvt_pk_bf16_f32 v138, v140, v141
    v_cvt_pk_bf16_f32 v139, v142, v143
    buffer_store_dwordx4 v[136:139], v3, s[4:7], s39 offen offset:1024 sc1
    v_cvt_pk_bf16_f32 v144, v144, v145
    v_cvt_pk_bf16_f32 v145, v146, v147
    v_cvt_pk_bf16_f32 v146, v148, v149
    v_cvt_pk_bf16_f32 v147, v150, v151
    buffer_store_dwordx4 v[144:147], v3, s[4:7], s39 offen offset:2048 sc1
    v_cvt_pk_bf16_f32 v152, v152, v153
    v_cvt_pk_bf16_f32 v153, v154, v155
    v_cvt_pk_bf16_f32 v154, v156, v157
    v_cvt_pk_bf16_f32 v155, v158, v159
    buffer_store_dwordx4 v[152:155], v3, s[4:7], s39 offen offset:3072 sc1
    s_add_u32 s39, s38, 1
    s_and_b32 s39, s39, 3
    s_sub_u32 s39, s39, s38
    s_lshl_b32 s39, s39, 16
    s_add_u32 s53, s49, s39
    s_add_u32 s53, s53, 6144
    s_add_u32 s39, s38, 2
    s_and_b32 s39, s39, 3
    s_sub_u32 s39, s39, s38
    s_lshl_b32 s39, s39, 16
    s_add_u32 s54, s49, s39
    s_add_u32 s54, s54, 4096
    s_add_u32 s39, s38, 3
    s_and_b32 s39, s39, 3
    s_sub_u32 s39, s39, s38
    s_lshl_b32 s39, s39, 16
    s_add_u32 s55, s49, s39
    s_add_u32 s55, s55, 2048
    v_lshlrev_b32 v32, 16, v20
    v_and_b32 v33, 0xffff0000, v20
    v_add_f32 v96, v96, v32
    v_add_f32 v97, v97, v33
    v_lshlrev_b32 v32, 16, v21
    v_and_b32 v33, 0xffff0000, v21
    v_add_f32 v98, v98, v32
    v_add_f32 v99, v99, v33
    v_lshlrev_b32 v32, 16, v22
    v_and_b32 v33, 0xffff0000, v22
    v_add_f32 v100, v100, v32
    v_add_f32 v101, v101, v33
    v_lshlrev_b32 v32, 16, v23
    v_and_b32 v33, 0xffff0000, v23
    v_add_f32 v102, v102, v32
    v_add_f32 v103, v103, v33
    v_lshlrev_b32 v32, 16, v24
    v_and_b32 v33, 0xffff0000, v24
    v_add_f32 v104, v104, v32
    v_add_f32 v105, v105, v33
    v_lshlrev_b32 v32, 16, v25
    v_and_b32 v33, 0xffff0000, v25
    v_add_f32 v106, v106, v32
    v_add_f32 v107, v107, v33
    v_lshlrev_b32 v32, 16, v26
    v_and_b32 v33, 0xffff0000, v26
    v_add_f32 v108, v108, v32
    v_add_f32 v109, v109, v33
    v_lshlrev_b32 v32, 16, v27
    v_and_b32 v33, 0xffff0000, v27
    v_add_f32 v110, v110, v32
    v_add_f32 v111, v111, v33
    s_mov_b32 s42, 0x20000
K3_XSPIN:
    buffer_load_dwordx4 v[160:163], v3, s[4:7], s53 offen offset:0 sc1
    buffer_load_dwordx4 v[164:167], v3, s[4:7], s53 offen offset:1024 sc1
    buffer_load_dwordx4 v[168:171], v3, s[4:7], s54 offen offset:0 sc1
    buffer_load_dwordx4 v[172:175], v3, s[4:7], s54 offen offset:1024 sc1
    buffer_load_dwordx4 v[176:179], v3, s[4:7], s55 offen offset:0 sc1
    buffer_load_dwordx4 v[180:183], v3, s[4:7], s55 offen offset:1024 sc1
    s_waitcnt vmcnt(0)
    v_max3_u32 v198, v160, v161, v162
    v_max3_u32 v198, v198, v163, v164
    v_max3_u32 v198, v198, v165, v166
    v_max3_u32 v198, v198, v167, v168
    v_max3_u32 v198, v198, v169, v170
    v_max3_u32 v198, v198, v171, v172
    v_max3_u32 v198, v198, v173, v174
    v_max3_u32 v198, v198, v175, v176
    v_max3_u32 v198, v198, v177, v178
    v_max3_u32 v198, v198, v179, v180
    v_max3_u32 v198, v198, v181, v182
    v_max_u32 v198, v198, v183
    v_cmp_eq_u32 vcc, -1, v198
    s_cbranch_vccz K3_XOK
    s_sleep 2
    s_sub_u32 s42, s42, 1
    s_cbranch_scc0 K3_XSPIN
K3_XOK:
    v_lshlrev_b32 v32, 16, v160
    v_and_b32 v33, 0xffff0000, v160
    v_add_f32 v96, v96, v32
    v_add_f32 v97, v97, v33
    v_lshlrev_b32 v34, 16, v161
    v_and_b32 v35, 0xffff0000, v161
    v_add_f32 v98, v98, v34
    v_add_f32 v99, v99, v35
    v_lshlrev_b32 v32, 16, v162
    v_and_b32 v33, 0xffff0000, v162
    v_add_f32 v100, v100, v32
    v_add_f32 v101, v101, v33
    v_lshlrev_b32 v34, 16, v163
    v_and_b32 v35, 0xffff0000, v163
    v_add_f32 v102, v102, v34
    v_add_f32 v103, v103, v35
    v_lshlrev_b32 v32, 16, v164
    v_and_b32 v33, 0xffff0000, v164
    v_add_f32 v104, v104, v32
    v_add_f32 v105, v105, v33
    v_lshlrev_b32 v34, 16, v165
    v_and_b32 v35, 0xffff0000, v165
    v_add_f32 v106, v106, v34
    v_add_f32 v107, v107, v35
    v_lshlrev_b32 v32, 16, v166
    v_and_b32 v33, 0xffff0000, v166
    v_add_f32 v108, v108, v32
    v_add_f32 v109, v109, v33
    v_lshlrev_b32 v34, 16, v167
    v_and_b32 v35, 0xffff0000, v167
    v_add_f32 v110, v110, v34
    v_add_f32 v111, v111, v35
    v_lshlrev_b32 v32, 16, v168
    v_and_b32 v33, 0xffff0000, v168
    v_add_f32 v96, v96, v32
    v_add_f32 v97, v97, v33
    v_lshlrev_b32 v34, 16, v169
    v_and_b32 v35, 0xffff0000, v169
    v_add_f32 v98, v98, v34
    v_add_f32 v99, v99, v35
    v_lshlrev_b32 v32, 16, v170
    v_and_b32 v33, 0xffff0000, v170
    v_add_f32 v100, v100, v32
    v_add_f32 v101, v101, v33
    v_lshlrev_b32 v34, 16, v171
    v_and_b32 v35, 0xffff0000, v171
    v_add_f32 v102, v102, v34
    v_add_f32 v103, v103, v35
    v_lshlrev_b32 v32, 16, v172
    v_and_b32 v33, 0xffff0000, v172
    v_add_f32 v104, v104, v32
    v_add_f32 v105, v105, v33
    v_lshlrev_b32 v34, 16, v173
    v_and_b32 v35, 0xffff0000, v173
    v_add_f32 v106, v106, v34
    v_add_f32 v107, v107, v35
    v_lshlrev_b32 v32, 16, v174
    v_and_b32 v33, 0xffff0000, v174
    v_add_f32 v108, v108, v32
    v_add_f32 v109, v109, v33
    v_lshlrev_b32 v34, 16, v175
    v_and_b32 v35, 0xffff0000, v175
    v_add_f32 v110, v110, v34
    v_add_f32 v111, v111, v35
    v_lshlrev_b32 v32, 16, v176
    v_and_b32 v33, 0xffff0000, v176
    v_add_f32 v96, v96, v32
    v_add_f32 v97, v97, v33
    v_lshlrev_b32 v34, 16, v177
    v_and_b32 v35, 0xffff0000, v177
    v_add_f32 v98, v98, v34
    v_add_f32 v99, v99, v35
    v_lshlrev_b32 v32, 16, v178
    v_and_b32 v33, 0xffff0000, v178
    v_add_f32 v100, v100, v32
    v_add_f32 v101, v101, v33
    v_lshlrev_b32 v34, 16, v179
    v_and_b32 v35, 0xffff0000, v179
    v_add_f32 v102, v102, v34
    v_add_f32 v103, v103, v35
    v_lshlrev_b32 v32, 16, v180
    v_and_b32 v33, 0xffff0000, v180
    v_add_f32 v104, v104, v32
    v_add_f32 v105, v105, v33
    v_lshlrev_b32 v34, 16, v181
    v_and_b32 v35, 0xffff0000, v181
    v_add_f32 v106, v106, v34
    v_add_f32 v107, v107, v35
    v_lshlrev_b32 v32, 16, v182
    v_and_b32 v33, 0xffff0000, v182
    v_add_f32 v108, v108, v32
    v_add_f32 v109, v109, v33
    v_lshlrev_b32 v34, 16, v183
    v_and_b32 v35, 0xffff0000, v183
    v_add_f32 v110, v110, v34
    v_add_f32 v111, v111, v35
    v_cvt_pk_bf16_f32 v20, v96, v97
    v_cvt_pk_bf16_f32 v21, v98, v99
    buffer_store_dwordx2 v[20:21], v18, s[12:15], s48 offen offset:0
    v_cvt_pk_bf16_f32 v22, v100, v101
    v_cvt_pk_bf16_f32 v23, v102, v103
    buffer_store_dwordx2 v[22:23], v18, s[12:15], s48 offen offset:32
    v_cvt_pk_bf16_f32 v24, v104, v105
    v_cvt_pk_bf16_f32 v25, v106, v107
    buffer_store_dwordx2 v[24:25], v18, s[12:15], s48 offen offset:64
    v_cvt_pk_bf16_f32 v26, v108, v109
    v_cvt_pk_bf16_f32 v27, v110, v111
    buffer_store_dwordx2 v[26:27], v18, s[12:15], s48 offen offset:96
K3_END:
    s_endpgm
K2_NOMLP:
    s_waitcnt vmcnt(16)
    buffer_load_dwordx4 a[0:3], v4, s[4:7], s32 offen sc1
    buffer_load_dwordx4 a[16:19], v4, s[4:7], s33 offen sc1
    buffer_load_dwordx4 a[32:35], v4, s[4:7], s34 offen sc1
    buffer_load_dwordx4 a[48:51], v4, s[4:7], s35 offen sc1
    v_add_u32 v4, 4096, v4
    buffer_load_dwordx4 a[196:199], v5, s[4:7], s32 offen sc1
    buffer_load_dwordx4 a[212:215], v5, s[4:7], s33 offen sc1
    buffer_load_dwordx4 a[228:231], v5, s[4:7], s34 offen sc1
    buffer_load_dwordx4 a[244:247], v5, s[4:7], s35 offen sc1
    buffer_load_dwordx4 a[200:203], v6, s[4:7], s32 offen sc1
    buffer_load_dwordx4 a[216:219], v6, s[4:7], s33 offen sc1
    buffer_load_dwordx4 a[232:235], v6, s[4:7], s34 offen sc1
    buffer_load_dwordx4 a[248:251], v6, s[4:7], s35 offen sc1
    buffer_load_dwordx4 a[204:207], v7, s[4:7], s32 offen sc1
    buffer_load_dwordx4 a[220:223], v7, s[4:7], s33 offen sc1
    buffer_load_dwordx4 a[236:239], v7, s[4:7], s34 offen sc1
    s_waitcnt vmcnt(15)
    s_barrier
    buffer_load_dwordx4 a[252:255], v7, s[4:7], s35 offen sc1
    v_add_u32 v5, 4096, v5
    v_add_u32 v6, 4096, v6
    v_add_u32 v7, 4096, v7
    s_waitcnt vmcnt(0)
    buffer_load_dwordx4 a[64:67], v4, s[4:7], s32 offen sc1
    buffer_load_dwordx4 a[80:83], v4, s[4:7], s33 offen sc1
    buffer_load_dwordx4 a[96:99], v4, s[4:7], s34 offen sc1
    buffer_load_dwordx4 a[112:115], v4, s[4:7], s35 offen sc1
    v_add_u32 v4, 4096, v4
    buffer_load_dwordx4 a[4:7], v5, s[4:7], s32 offen sc1
    buffer_load_dwordx4 a[20:23], v5, s[4:7], s33 offen sc1
    buffer_load_dwordx4 a[36:39], v5, s[4:7], s34 offen sc1
    buffer_load_dwordx4 a[52:55], v5, s[4:7], s35 offen sc1
    buffer_load_dwordx4 a[8:11], v6, s[4:7], s32 offen sc1
    buffer_load_dwordx4 a[24:27], v6, s[4:7], s33 offen sc1
    buffer_load_dwordx4 a[40:43], v6, s[4:7], s34 offen sc1
    buffer_load_dwordx4 a[56:59], v6, s[4:7], s35 offen sc1
    buffer_load_dwordx4 a[12:15], v7, s[4:7], s32 offen sc1
    buffer_load_dwordx4 a[28:31], v7, s[4:7], s33 offen sc1
    buffer_load_dwordx4 a[44:47], v7, s[4:7], s34 offen sc1
    buffer_load_dwordx4 a[60:63], v7, s[4:7], s35 offen sc1
    v_add_u32 v5, 4096, v5
    v_add_u32 v6, 4096, v6
    v_add_u32 v7, 4096, v7
    s_barrier
    buffer_load_dwordx4 a[68:71], v5, s[4:7], s32 offen sc1
    buffer_load_dwordx4 a[84:87], v5, s[4:7], s33 offen sc1
    s_waitcnt vmcnt(2)
    buffer_load_dwordx4 a[100:103], v5, s[4:7], s34 offen sc1
    buffer_load_dwordx4 a[116:119], v5, s[4:7], s35 offen sc1
    buffer_load_dwordx4 a[72:75], v6, s[4:7], s32 offen sc1
    buffer_load_dwordx4 a[88:91], v6, s[4:7], s33 offen sc1
    buffer_load_dwordx4 a[104:107], v6, s[4:7], s34 offen sc1
    buffer_load_dwordx4 a[120:123], v6, s[4:7], s35 offen sc1
    buffer_load_dwordx4 a[76:79], v7, s[4:7], s32 offen sc1
    buffer_load_dwordx4 a[92:95], v7, s[4:7], s33 offen sc1
    buffer_load_dwordx4 a[108:111], v7, s[4:7], s34 offen sc1
    buffer_load_dwordx4 a[124:127], v7, s[4:7], s35 offen sc1
    s_add_u32 m0, s44, 81920
    s_add_u32 s47, s48, 0
    buffer_load_dwordx4 v8, s[8:11], s47 offen lds
    buffer_load_dwordx4 v9, s[8:11], s47 offen offset:1024 lds
    s_add_u32 m0, s44, 90112
    s_add_u32 s47, s49, 0
    buffer_load_dwordx4 v8, s[8:11], s47 offen lds
    buffer_load_dwordx4 v9, s[8:11], s47 offen offset:1024 lds
    s_add_u32 m0, s44, 98304
    s_add_u32 s47, s48, 1048576
    buffer_load_dwordx4 v8, s[8:11], s47 offen lds
    buffer_load_dwordx4 v9, s[8:11], s47 offen offset:1024 lds
    s_add_u32 m0, s44, 106496
    s_barrier
    s_add_u32 s47, s49, 1048576
    buffer_load_dwordx4 v8, s[8:11], s47 offen lds
    buffer_load_dwordx4 v9, s[8:11], s47 offen offset:1024 lds
    s_add_u32 m0, s44, 0
    s_add_u32 s47, s48, 2097152
    buffer_load_dwordx4 v8, s[8:11], s47 offen lds
    buffer_load_dwordx4 v9, s[8:11], s47 offen offset:1024 lds
    s_add_u32 m0, s44, 8192
    s_add_u32 s47, s49, 2097152
    buffer_load_dwordx4 v8, s[8:11], s47 offen lds
    s_waitcnt vmcnt(11)
    buffer_load_dwordx4 v9, s[8:11], s47 offen offset:1024 lds
    s_add_u32 m0, s44, 16384
    s_add_u32 s47, s48, 3145728
    buffer_load_dwordx4 v8, s[8:11], s47 offen lds
    buffer_load_dwordx4 v9, s[8:11], s47 offen offset:1024 lds
    s_add_u32 m0, s44, 24576
    s_add_u32 s47, s49, 3145728
    buffer_load_dwordx4 v8, s[8:11], s47 offen lds
    buffer_load_dwordx4 v9, s[8:11], s47 offen offset:1024 lds
    s_add_u32 m0, s44, 49152
    s_add_u32 s47, s48, 128
    buffer_load_dwordx4 v8, s[8:11], s47 offen lds
    buffer_load_dwordx4 v9, s[8:11], s47 offen offset:1024 lds
    s_add_u32 m0, s44, 57344
    s_add_u32 s47, s49, 128
    buffer_load_dwordx4 v8, s[8:11], s47 offen lds
    buffer_load_dwordx4 v9, s[8:11], s47 offen offset:1024 lds
    s_add_u32 m0, s44, 114688
    s_add_u32 s47, s48, 1048704
    buffer_load_dwordx4 v8, s[8:11], s47 offen lds
    buffer_load_dwordx4 v9, s[8:11], s47 offen offset:1024 lds
    s_add_u32 m0, s44, 122880
    s_add_u32 s47, s49, 1048704
    buffer_load_dwordx4 v8, s[8:11], s47 offen lds
    buffer_load_dwordx4 v9, s[8:11], s47 offen offset:1024 lds
    s_add_u32 m0, s44, 131072
    s_add_u32 s47, s48, 2097280
    buffer_load_dwordx4 v8, s[8:11], s47 offen lds
    buffer_load_dwordx4 v9, s[8:11], s47 offen offset:1024 lds
    s_add_u32 m0, s44, 139264
    s_add_u32 s47, s49, 2097280
    buffer_load_dwordx4 v8, s[8:11], s47 offen lds
    s_add_u32 s32, s36, s54
    s_add_u32 s33, s38, s54
    s_waitcnt vmcnt(23)
    s_barrier
    ds_read_b64_tr_b16 v[32:33], v16 offset:16384
    buffer_load_dwordx4 v9, s[8:11], s47 offen offset:1024 lds
    s_add_u32 s34, s40, s54
    s_add_u32 s35, s42, s54
    ds_read_b64_tr_b16 v[34:35], v16 offset:16896
    s_add_u32 m0, s44, 147456
    ds_read_b64_tr_b16 v[36:37], v16 offset:20480
    s_add_u32 s47, s48, 3145856
    buffer_load_dwordx4 v8, s[8:11], s47 offen lds
    ds_read_b64_tr_b16 v[38:39], v16 offset:20992
    ds_read_b64_tr_b16 v[40:41], v16 offset:24576
    ds_read_b64_tr_b16 v[42:43], v16 offset:25088
    buffer_load_dwordx4 v9, s[8:11], s47 offen offset:1024 lds
    s_add_u32 m0, s44, 155648
    ds_read_b64_tr_b16 v[44:45], v16 offset:28672
    s_add_u32 s47, s49, 3145856
    ds_read_b64_tr_b16 v[46:47], v16 offset:29184
    buffer_load_dwordx4 v8, s[8:11], s47 offen lds
    buffer_load_dwordx4 v9, s[8:11], s47 offen offset:1024 lds
    s_waitcnt lgkmcnt(4)
    v_mfma_f32_16x16x32_bf16 v[64:67], v[32:35], a[128:131], 0
    v_mfma_f32_16x16x32_bf16 v[64:67], v[36:39], a[132:135], v[64:67]
    ds_read_b64_tr_b16 v[48:49], v17 offset:16384
    s_waitcnt lgkmcnt(1)
    v_mfma_f32_16x16x32_bf16 v[64:67], v[40:43], a[136:139], v[64:67]
    ds_read_b64_tr_b16 v[50:51], v17 offset:16896
    v_mfma_f32_16x16x32_bf16 v[64:67], v[44:47], a[140:143], v[64:67]
    ds_read_b64_tr_b16 v[52:53], v17 offset:20480
    v_mfma_f32_16x16x32_bf16 v[68:71], v[32:35], a[144:147], 0
    v_mfma_f32_16x16x32_bf16 v[68:71], v[36:39], a[148:151], v[68:71]
    ds_read_b64_tr_b16 v[54:55], v17 offset:20992
    v_mfma_f32_16x16x32_bf16 v[68:71], v[40:43], a[152:155], v[68:71]
    ds_read_b64_tr_b16 v[56:57], v17 offset:24576
    v_mfma_f32_16x16x32_bf16 v[68:71], v[44:47], a[156:159], v[68:71]
    ds_read_b64_tr_b16 v[58:59], v17 offset:25088
    v_mfma_f32_16x16x32_bf16 v[72:75], v[32:35], a[160:163], 0
    v_mfma_f32_16x16x32_bf16 v[72:75], v[36:39], a[164:167], v[72:75]
    ds_read_b64_tr_b16 v[60:61], v17 offset:28672
    v_mfma_f32_16x16x32_bf16 v[72:75], v[40:43], a[168:171], v[72:75]
    ds_read_b64_tr_b16 v[62:63], v17 offset:29184
    v_mfma_f32_16x16x32_bf16 v[72:75], v[44:47], a[172:175], v[72:75]
    v_mfma_f32_16x16x32_bf16 v[76:79], v[32:35], a[176:179], 0
    v_mfma_f32_16x16x32_bf16 v[76:79], v[36:39], a[180:183], v[76:79]
    v_mfma_f32_16x16x32_bf16 v[76:79], v[40:43], a[184:187], v[76:79]
    v_mfma_f32_16x16x32_bf16 v[76:79], v[44:47], a[188:191], v[76:79]
    s_waitcnt lgkmcnt(4)
    v_mfma_f32_16x16x32_bf16 v[128:131], v[48:51], a[128:131], 0
    v_mfma_f32_16x16x32_bf16 v[128:131], v[52:55], a[132:135], v[128:131]
    ds_read_b64_tr_b16 v[32:33], v18 offset:16384
    s_waitcnt lgkmcnt(1)
    v_mfma_f32_16x16x32_bf16 v[128:131], v[56:59], a[136:139], v[128:131]
    ds_read_b64_tr_b16 v[34:35], v18 offset:16896
    v_mfma_f32_16x16x32_bf16 v[128:131], v[60:63], a[140:143], v[128:131]
    ds_read_b64_tr_b16 v[36:37], v18 offset:20480
    v_mfma_f32_16x16x32_bf16 v[132:135], v[48:51], a[144:147], 0
    v_mfma_f32_16x16x32_bf16 v[132:135], v[52:55], a[148:151], v[132:135]
    ds_read_b64_tr_b16 v[38:39], v18 offset:20992
    v_mfma_f32_16x16x32_bf16 v[132:135], v[56:59], a[152:155], v[132:135]
    ds_read_b64_tr_b16 v[40:41], v18 offset:24576
    v_mfma_f32_16x16x32_bf16 v[132:135], v[60:63], a[156:159], v[132:135]
    ds_read_b64_tr_b16 v[42:43], v18 offset:25088
    v_mfma_f32_16x16x32_bf16 v[136:139], v[48:51], a[160:163], 0
    v_mfma_f32_16x16x32_bf16 v[136:139], v[52:55], a[164:167], v[136:139]
    ds_read_b64_tr_b16 v[44:45], v18 offset:28672
    v_mfma_f32_16x16x32_bf16 v[136:139], v[56:59], a[168:171], v[136:139]
    ds_read_b64_tr_b16 v[46:47], v18 offset:29184
    v_mfma_f32_16x16x32_bf16 v[136:139], v[60:63], a[172:175], v[136:139]
    v_mfma_f32_16x16x32_bf16 v[140:143], v[48:51], a[176:179], 0
    v_mfma_f32_16x16x32_bf16 v[140:143], v[52:55], a[180:183], v[140:143]
    v_mfma_f32_16x16x32_bf16 v[140:143], v[56:59], a[184:187], v[140:143]
    v_mfma_f32_16x16x32_bf16 v[140:143], v[60:63], a[188:191], v[140:143]
    s_waitcnt lgkmcnt(4)
    v_mfma_f32_16x16x32_bf16 v[80:83], v[32:35], a[128:131], 0
    v_mfma_f32_16x16x32_bf16 v[80:83], v[36:39], a[132:135], v[80:83]
    ds_read_b64_tr_b16 v[48:49], v19 offset:16384
    s_waitcnt lgkmcnt(1)
    v_mfma_f32_16x16x32_bf16 v[80:83], v[40:43], a[136:139], v[80:83]
    ds_read_b64_tr_b16 v[50:51], v19 offset:16896
    v_mfma_f32_16x16x32_bf16 v[80:83], v[44:47], a[140:143], v[80:83]
    ds_read_b64_tr_b16 v[52:53], v19 offset:20480
    v_mfma_f32_16x16x32_bf16 v[84:87], v[32:35], a[144:147], 0
    v_mfma_f32_16x16x32_bf16 v[84:87], v[36:39], a[148:151], v[84:87]
    ds_read_b64_tr_b16 v[54:55], v19 offset:20992
    v_mfma_f32_16x16x32_bf16 v[84:87], v[40:43], a[152:155], v[84:87]
    ds_read_b64_tr_b16 v[56:57], v19 offset:24576
    v_mfma_f32_16x16x32_bf16 v[84:87], v[44:47], a[156:159], v[84:87]
    ds_read_b64_tr_b16 v[58:59], v19 offset:25088
    v_mfma_f32_16x16x32_bf16 v[88:91], v[32:35], a[160:163], 0
    v_mfma_f32_16x16x32_bf16 v[88:91], v[36:39], a[164:167], v[88:91]
    ds_read_b64_tr_b16 v[60:61], v19 offset:28672
    v_mfma_f32_16x16x32_bf16 v[88:91], v[40:43], a[168:171], v[88:91]
    ds_read_b64_tr_b16 v[62:63], v19 offset:29184
    v_mfma_f32_16x16x32_bf16 v[88:91], v[44:47], a[172:175], v[88:91]
    v_mfma_f32_16x16x32_bf16 v[92:95], v[32:35], a[176:179], 0
    v_mfma_f32_16x16x32_bf16 v[92:95], v[36:39], a[180:183], v[92:95]
    v_mfma_f32_16x16x32_bf16 v[92:95], v[40:43], a[184:187], v[92:95]
    v_mfma_f32_16x16x32_bf16 v[92:95], v[44:47], a[188:191], v[92:95]
    s_waitcnt lgkmcnt(4)
    v_mfma_f32_16x16x32_bf16 v[144:147], v[48:51], a[128:131], 0
    s_waitcnt vmcnt(24)
    s_barrier
    v_mfma_f32_16x16x32_bf16 v[144:147], v[52:55], a[132:135], v[144:147]
    ds_read_b64_tr_b16 v[32:33], v16 offset:32768
    s_waitcnt lgkmcnt(1)
    v_mfma_f32_16x16x32_bf16 v[144:147], v[56:59], a[136:139], v[144:147]
    ds_read_b64_tr_b16 v[34:35], v16 offset:33280
    v_mfma_f32_16x16x32_bf16 v[144:147], v[60:63], a[140:143], v[144:147]
    ds_read_b64_tr_b16 v[36:37], v16 offset:36864
    v_mfma_f32_16x16x32_bf16 v[148:151], v[48:51], a[144:147], 0
    v_mfma_f32_16x16x32_bf16 v[148:151], v[52:55], a[148:151], v[148:151]
    ds_read_b64_tr_b16 v[38:39], v16 offset:37376
    v_mfma_f32_16x16x32_bf16 v[148:151], v[56:59], a[152:155], v[148:151]
    ds_read_b64_tr_b16 v[40:41], v16 offset:40960
    v_mfma_f32_16x16x32_bf16 v[148:151], v[60:63], a[156:159], v[148:151]
    ds_read_b64_tr_b16 v[42:43], v16 offset:41472
    v_mfma_f32_16x16x32_bf16 v[152:155], v[48:51], a[160:163], 0
    v_mfma_f32_16x16x32_bf16 v[152:155], v[52:55], a[164:167], v[152:155]
    ds_read_b64_tr_b16 v[44:45], v16 offset:45056
    v_mfma_f32_16x16x32_bf16 v[152:155], v[56:59], a[168:171], v[152:155]
    ds_read_b64_tr_b16 v[46:47], v16 offset:45568
    v_mfma_f32_16x16x32_bf16 v[152:155], v[60:63], a[172:175], v[152:155]
    v_mfma_f32_16x16x32_bf16 v[156:159], v[48:51], a[176:179], 0
    v_mfma_f32_16x16x32_bf16 v[156:159], v[52:55], a[180:183], v[156:159]
    v_mfma_f32_16x16x32_bf16 v[156:159], v[56:59], a[184:187], v[156:159]
    v_mfma_f32_16x16x32_bf16 v[156:159], v[60:63], a[188:191], v[156:159]
    s_waitcnt lgkmcnt(4)
    v_mfma_f32_16x16x32_bf16 v[64:67], v[32:35], a[192:195], v[64:67]
    buffer_store_dwordx4 v[96:99], v3, s[4:7], s60 offen offset:0 sc1
    v_mfma_f32_16x16x32_bf16 v[64:67], v[36:39], a[196:199], v[64:67]
    ds_read_b64_tr_b16 v[48:49], v17 offset:32768
    s_waitcnt lgkmcnt(1)
    v_mfma_f32_16x16x32_bf16 v[64:67], v[40:43], a[200:203], v[64:67]
    ds_read_b64_tr_b16 v[50:51], v17 offset:33280
    v_mfma_f32_16x16x32_bf16 v[64:67], v[44:47], a[204:207], v[64:67]
    ds_read_b64_tr_b16 v[52:53], v17 offset:36864
    v_mfma_f32_16x16x32_bf16 v[68:71], v[32:35], a[208:211], v[68:71]
    v_mfma_f32_16x16x32_bf16 v[68:71], v[36:39], a[212:215], v[68:71]
    ds_read_b64_tr_b16 v[54:55], v17 offset:37376
    v_mfma_f32_16x16x32_bf16 v[68:71], v[40:43], a[216:219], v[68:71]
    ds_read_b64_tr_b16 v[56:57], v17 offset:40960
    v_mfma_f32_16x16x32_bf16 v[68:71], v[44:47], a[220:223], v[68:71]
    ds_read_b64_tr_b16 v[58:59], v17 offset:41472
    buffer_store_dwordx4 v[112:115], v3, s[4:7], s60 offen offset:1024 sc1
    v_mfma_f32_16x16x32_bf16 v[72:75], v[32:35], a[224:227], v[72:75]
    v_mfma_f32_16x16x32_bf16 v[72:75], v[36:39], a[228:231], v[72:75]
    ds_read_b64_tr_b16 v[60:61], v17 offset:45056
    v_mfma_f32_16x16x32_bf16 v[72:75], v[40:43], a[232:235], v[72:75]
    ds_read_b64_tr_b16 v[62:63], v17 offset:45568
    v_mfma_f32_16x16x32_bf16 v[72:75], v[44:47], a[236:239], v[72:75]
    v_mfma_f32_16x16x32_bf16 v[76:79], v[32:35], a[240:243], v[76:79]
    v_mfma_f32_16x16x32_bf16 v[76:79], v[36:39], a[244:247], v[76:79]
    v_mfma_f32_16x16x32_bf16 v[76:79], v[40:43], a[248:251], v[76:79]
    buffer_store_dwordx4 v[160:163], v3, s[4:7], s60 offen offset:2048 sc1
    v_mfma_f32_16x16x32_bf16 v[76:79], v[44:47], a[252:255], v[76:79]
    s_waitcnt lgkmcnt(4)
    v_mfma_f32_16x16x32_bf16 v[128:131], v[48:51], a[192:195], v[128:131]
    v_mfma_f32_16x16x32_bf16 v[128:131], v[52:55], a[196:199], v[128:131]
    ds_read_b64_tr_b16 v[32:33], v18 offset:32768
    s_waitcnt lgkmcnt(1)
    v_mfma_f32_16x16x32_bf16 v[128:131], v[56:59], a[200:203], v[128:131]
    ds_read_b64_tr_b16 v[34:35], v18 offset:33280
    v_mfma_f32_16x16x32_bf16 v[128:131], v[60:63], a[204:207], v[128:131]
    ds_read_b64_tr_b16 v[36:37], v18 offset:36864
    v_mfma_f32_16x16x32_bf16 v[132:135], v[48:51], a[208:211], v[132:135]
    v_mfma_f32_16x16x32_bf16 v[132:135], v[52:55], a[212:215], v[132:135]
    ds_read_b64_tr_b16 v[38:39], v18 offset:37376
    buffer_store_dwordx4 v[176:179], v3, s[4:7], s60 offen offset:3072 sc1
    v_mfma_f32_16x16x32_bf16 v[132:135], v[56:59], a[216:219], v[132:135]
    ds_read_b64_tr_b16 v[40:41], v18 offset:40960
    v_mfma_f32_16x16x32_bf16 v[132:135], v[60:63], a[220:223], v[132:135]
    ds_read_b64_tr_b16 v[42:43], v18 offset:41472
    v_mfma_f32_16x16x32_bf16 v[136:139], v[48:51], a[224:227], v[136:139]
    v_mfma_f32_16x16x32_bf16 v[136:139], v[52:55], a[228:231], v[136:139]
    ds_read_b64_tr_b16 v[44:45], v18 offset:45056
    v_mfma_f32_16x16x32_bf16 v[136:139], v[56:59], a[232:235], v[136:139]
    ds_read_b64_tr_b16 v[46:47], v18 offset:45568
    v_mfma_f32_16x16x32_bf16 v[136:139], v[60:63], a[236:239], v[136:139]
    v_mfma_f32_16x16x32_bf16 v[140:143], v[48:51], a[240:243], v[140:143]
    s_add_u32 s60, s60, 4096
    buffer_store_dwordx4 v[100:103], v3, s[4:7], s60 offen offset:0 sc1
    v_mfma_f32_16x16x32_bf16 v[140:143], v[52:55], a[244:247], v[140:143]
    v_mfma_f32_16x16x32_bf16 v[140:143], v[56:59], a[248:251], v[140:143]
    v_mfma_f32_16x16x32_bf16 v[140:143], v[60:63], a[252:255], v[140:143]
    s_waitcnt lgkmcnt(4)
    v_mfma_f32_16x16x32_bf16 v[80:83], v[32:35], a[192:195], v[80:83]
    v_mfma_f32_16x16x32_bf16 v[80:83], v[36:39], a[196:199], v[80:83]
    ds_read_b64_tr_b16 v[48:49], v19 offset:32768
    s_waitcnt lgkmcnt(1)
    v_mfma_f32_16x16x32_bf16 v[80:83], v[40:43], a[200:203], v[80:83]
    ds_read_b64_tr_b16 v[50:51], v19 offset:33280
    v_mfma_f32_16x16x32_bf16 v[80:83], v[44:47], a[204:207], v[80:83]
    ds_read_b64_tr_b16 v[52:53], v19 offset:36864
    buffer_store_dwordx4 v[116:119], v3, s[4:7], s60 offen offset:1024 sc1
    v_mfma_f32_16x16x32_bf16 v[84:87], v[32:35], a[208:211], v[84:87]
    v_mfma_f32_16x16x32_bf16 v[84:87], v[36:39], a[212:215], v[84:87]
    ds_read_b64_tr_b16 v[54:55], v19 offset:37376
    v_mfma_f32_16x16x32_bf16 v[84:87], v[40:43], a[216:219], v[84:87]
    ds_read_b64_tr_b16 v[56:57], v19 offset:40960
    v_mfma_f32_16x16x32_bf16 v[84:87], v[44:47], a[220:223], v[84:87]
    ds_read_b64_tr_b16 v[58:59], v19 offset:41472
    v_mfma_f32_16x16x32_bf16 v[88:91], v[32:35], a[224:227], v[88:91]
    s_load_dwordx2 s[8:9], s[0:1], 40
    v_mfma_f32_16x16x32_bf16 v[88:91], v[36:39], a[228:231], v[88:91]
    ds_read_b64_tr_b16 v[60:61], v19 offset:45056
    v_mfma_f32_16x16x32_bf16 v[88:91], v[40:43], a[232:235], v[88:91]
    ds_read_b64_tr_b16 v[62:63], v19 offset:45568
    buffer_store_dwordx4 v[164:167], v3, s[4:7], s60 offen offset:2048 sc1
    s_load_dwordx2 s[12:13], s[0:1], 72
    v_mfma_f32_16x16x32_bf16 v[88:91], v[44:47], a[236:239], v[88:91]
    v_mfma_f32_16x16x32_bf16 v[92:95], v[32:35], a[240:243], v[92:95]
    s_bfe_u32 s26, s2, 0x20001
    v_mfma_f32_16x16x32_bf16 v[92:95], v[36:39], a[244:247], v[92:95]
    v_mfma_f32_16x16x32_bf16 v[92:95], v[40:43], a[248:251], v[92:95]
    s_lshr_b32 s27, s2, 3
    v_mfma_f32_16x16x32_bf16 v[92:95], v[44:47], a[252:255], v[92:95]
    s_waitcnt lgkmcnt(4)
    v_mfma_f32_16x16x32_bf16 v[144:147], v[48:51], a[192:195], v[144:147]
    s_lshl_b32 s27, s27, 2
    s_waitcnt vmcnt(27)
    s_barrier
    v_mfma_f32_16x16x32_bf16 v[144:147], v[52:55], a[196:199], v[144:147]
    ds_read_b64_tr_b16 v[32:33], v12 offset:0
    buffer_store_dwordx4 v[180:183], v3, s[4:7], s60 offen offset:3072 sc1
    s_waitcnt lgkmcnt(1)
    v_mfma_f32_16x16x32_bf16 v[144:147], v[56:59], a[200:203], v[144:147]
    ds_read_b64_tr_b16 v[34:35], v12 offset:512
    s_add_u32 s27, s27, s28
    v_mfma_f32_16x16x32_bf16 v[144:147], v[60:63], a[204:207], v[144:147]
    ds_read_b64_tr_b16 v[36:37], v12 offset:4096
    v_mfma_f32_16x16x32_bf16 v[148:151], v[48:51], a[208:211], v[148:151]
    s_mul_i32 s24, s26, 352
    v_mfma_f32_16x16x32_bf16 v[148:151], v[52:55], a[212:215], v[148:151]
    ds_read_b64_tr_b16 v[38:39], v12 offset:4608
    v_mfma_f32_16x16x32_bf16 v[148:151], v[56:59], a[216:219], v[148:151]
    ds_read_b64_tr_b16 v[40:41], v12 offset:8192
    s_mul_i32 s25, s27, 3
    v_mfma_f32_16x16x32_bf16 v[148:151], v[60:63], a[220:223], v[148:151]
    ds_read_b64_tr_b16 v[42:43], v12 offset:8704
    v_mfma_f32_16x16x32_bf16 v[152:155], v[48:51], a[224:227], v[152:155]
    s_add_u32 s60, s60, 4096
    buffer_store_dwordx4 v[104:107], v3, s[4:7], s60 offen offset:0 sc1
    s_add_u32 s24, s24, s25
    v_mfma_f32_16x16x32_bf16 v[152:155], v[52:55], a[228:231], v[152:155]
    ds_read_b64_tr_b16 v[44:45], v12 offset:12288
    v_mfma_f32_16x16x32_bf16 v[152:155], v[56:59], a[232:235], v[152:155]
    ds_read_b64_tr_b16 v[46:47], v12 offset:12800
    s_lshl_b32 s24, s24, 10
    v_mfma_f32_16x16x32_bf16 v[152:155], v[60:63], a[236:239], v[152:155]
    v_mfma_f32_16x16x32_bf16 v[156:159], v[48:51], a[240:243], v[156:159]
    s_lshl_b32 s26, s26, 20
    v_mfma_f32_16x16x32_bf16 v[156:159], v[52:55], a[244:247], v[156:159]
    v_mfma_f32_16x16x32_bf16 v[156:159], v[56:59], a[248:251], v[156:159]
    s_lshl_b32 s27, s27, 13
    v_mfma_f32_16x16x32_bf16 v[156:159], v[60:63], a[252:255], v[156:159]
    buffer_store_dwordx4 v[120:123], v3, s[4:7], s60 offen offset:1024 sc1
    s_waitcnt lgkmcnt(4)
    v_mfma_f32_16x16x32_bf16 v[64:67], v[32:35], a[0:3], v[64:67]
    s_add_u32 s26, s26, s27
    v_mfma_f32_16x16x32_bf16 v[64:67], v[36:39], a[4:7], v[64:67]
    ds_read_b64_tr_b16 v[48:49], v13 offset:0
    s_waitcnt lgkmcnt(1)
    v_mfma_f32_16x16x32_bf16 v[64:67], v[40:43], a[8:11], v[64:67]
    ds_read_b64_tr_b16 v[50:51], v13 offset:512
    s_add_u32 s10, s26, 8192
    v_mfma_f32_16x16x32_bf16 v[64:67], v[44:47], a[12:15], v[64:67]
    ds_read_b64_tr_b16 v[52:53], v13 offset:4096
    v_mfma_f32_16x16x32_bf16 v[68:71], v[32:35], a[16:19], v[68:71]
    s_mov_b32 s11, 0x00020000
    v_mfma_f32_16x16x32_bf16 v[68:71], v[36:39], a[20:23], v[68:71]
    ds_read_b64_tr_b16 v[54:55], v13 offset:4608
    v_mfma_f32_16x16x32_bf16 v[68:71], v[40:43], a[24:27], v[68:71]
    ds_read_b64_tr_b16 v[56:57], v13 offset:8192
    buffer_store_dwordx4 v[168:171], v3, s[4:7], s60 offen offset:2048 sc1
    s_add_u32 s14, s24, 3072
    v_mfma_f32_16x16x32_bf16 v[68:71], v[44:47], a[28:31], v[68:71]
    ds_read_b64_tr_b16 v[58:59], v13 offset:8704
    v_mfma_f32_16x16x32_bf16 v[72:75], v[32:35], a[32:35], v[72:75]
    s_min_u32 s14, s14, 1409024
    v_mfma_f32_16x16x32_bf16 v[72:75], v[36:39], a[36:39], v[72:75]
    ds_read_b64_tr_b16 v[60:61], v13 offset:12288
    v_mfma_f32_16x16x32_bf16 v[72:75], v[40:43], a[40:43], v[72:75]
    ds_read_b64_tr_b16 v[62:63], v13 offset:12800
    s_mov_b32 s15, 0x00020000
    v_mfma_f32_16x16x32_bf16 v[72:75], v[44:47], a[44:47], v[72:75]
    v_mfma_f32_16x16x32_bf16 v[76:79], v[32:35], a[48:51], v[76:79]
    v_mov_b32 v8, 0x3f803f80
    v_mfma_f32_16x16x32_bf16 v[76:79], v[36:39], a[52:55], v[76:79]
    buffer_store_dwordx4 v[184:187], v3, s[4:7], s60 offen offset:3072 sc1
    v_mfma_f32_16x16x32_bf16 v[76:79], v[40:43], a[56:59], v[76:79]
    v_mov_b32 v9, 0x3f803f80
    v_mfma_f32_16x16x32_bf16 v[76:79], v[44:47], a[60:63], v[76:79]
    s_waitcnt lgkmcnt(4)
    v_mfma_f32_16x16x32_bf16 v[128:131], v[48:51], a[0:3], v[128:131]
    v_mov_b32 v10, 0x3f803f80
    v_mfma_f32_16x16x32_bf16 v[128:131], v[52:55], a[4:7], v[128:131]
    ds_read_b64_tr_b16 v[32:33], v14 offset:0
    s_waitcnt lgkmcnt(1)
    v_mfma_f32_16x16x32_bf16 v[128:131], v[56:59], a[8:11], v[128:131]
    ds_read_b64_tr_b16 v[34:35], v14 offset:512
    v_mov_b32 v11, 0x3f803f80
    v_mfma_f32_16x16x32_bf16 v[128:131], v[60:63], a[12:15], v[128:131]
    ds_read_b64_tr_b16 v[36:37], v14 offset:4096
    v_mfma_f32_16x16x32_bf16 v[132:135], v[48:51], a[16:19], v[132:135]
    s_add_u32 s60, s60, 4096
    buffer_store_dwordx4 v[108:111], v3, s[4:7], s60 offen offset:0 sc1
    v_cmp_le_i32 s[62:63], 0, v27
    v_mfma_f32_16x16x32_bf16 v[132:135], v[52:55], a[20:23], v[132:135]
    ds_read_b64_tr_b16 v[38:39], v14 offset:4608
    v_mfma_f32_16x16x32_bf16 v[132:135], v[56:59], a[24:27], v[132:135]
    ds_read_b64_tr_b16 v[40:41], v14 offset:8192
    v_cmp_le_i32 s[64:65], 1, v27
    v_mfma_f32_16x16x32_bf16 v[132:135], v[60:63], a[28:31], v[132:135]
    ds_read_b64_tr_b16 v[42:43], v14 offset:8704
    v_mfma_f32_16x16x32_bf16 v[136:139], v[48:51], a[32:35], v[136:139]
    v_cmp_le_i32 s[66:67], 2, v27
    v_mfma_f32_16x16x32_bf16 v[136:139], v[52:55], a[36:39], v[136:139]
    ds_read_b64_tr_b16 v[44:45], v14 offset:12288
    v_mfma_f32_16x16x32_bf16 v[136:139], v[56:59], a[40:43], v[136:139]
    ds_read_b64_tr_b16 v[46:47], v14 offset:12800
    v_cmp_le_i32 s[68:69], 3, v27
    v_mfma_f32_16x16x32_bf16 v[136:139], v[60:63], a[44:47], v[136:139]
    buffer_store_dwordx4 v[124:127], v3, s[4:7], s60 offen offset:1024 sc1
    v_mfma_f32_16x16x32_bf16 v[140:143], v[48:51], a[48:51], v[140:143]
    s_lshl_b32 s50, s28, 12
    v_mfma_f32_16x16x32_bf16 v[140:143], v[52:55], a[52:55], v[140:143]
    v_mfma_f32_16x16x32_bf16 v[140:143], v[56:59], a[56:59], v[140:143]
    s_add_u32 s50, s50, 49152
    v_mfma_f32_16x16x32_bf16 v[140:143], v[60:63], a[60:63], v[140:143]
    s_waitcnt lgkmcnt(4)
    v_mfma_f32_16x16x32_bf16 v[80:83], v[32:35], a[0:3], v[80:83]
    s_mov_b32 s51, s50
    v_mfma_f32_16x16x32_bf16 v[80:83], v[36:39], a[4:7], v[80:83]
    ds_read_b64_tr_b16 v[48:49], v15 offset:0
    s_waitcnt lgkmcnt(1)
    v_mfma_f32_16x16x32_bf16 v[80:83], v[40:43], a[8:11], v[80:83]
    ds_read_b64_tr_b16 v[50:51], v15 offset:512
    buffer_store_dwordx4 v[172:175], v3, s[4:7], s60 offen offset:2048 sc1
    v_add_u32 v4, 0x10000, v3
    v_mfma_f32_16x16x32_bf16 v[80:83], v[44:47], a[12:15], v[80:83]
    ds_read_b64_tr_b16 v[52:53], v15 offset:4096
    v_mfma_f32_16x16x32_bf16 v[84:87], v[32:35], a[16:19], v[84:87]
    s_mov_b32 s53, 16384
    v_mfma_f32_16x16x32_bf16 v[84:87], v[36:39], a[20:23], v[84:87]
    ds_read_b64_tr_b16 v[54:55], v15 offset:4608
    v_mfma_f32_16x16x32_bf16 v[84:87], v[40:43], a[24:27], v[84:87]
    ds_read_b64_tr_b16 v[56:57], v15 offset:8192
    s_mov_b32 s54, 0
    v_mfma_f32_16x16x32_bf16 v[84:87], v[44:47], a[28:31], v[84:87]
    ds_read_b64_tr_b16 v[58:59], v15 offset:8704
    v_mfma_f32_16x16x32_bf16 v[88:91], v[32:35], a[32:35], v[88:91]
    s_lshl_b32 s27, s31, 13
    v_mfma_f32_16x16x32_bf16 v[88:91], v[36:39], a[36:39], v[88:91]
    ds_read_b64_tr_b16 v[60:61], v15 offset:12288
    buffer_store_dwordx4 v[188:191], v3, s[4:7], s60 offen offset:3072 sc1
    v_mfma_f32_16x16x32_bf16 v[88:91], v[40:43], a[40:43], v[88:91]
    ds_read_b64_tr_b16 v[62:63], v15 offset:12800
    s_lshr_b32 s25, s28, 1
    v_mfma_f32_16x16x32_bf16 v[88:91], v[44:47], a[44:47], v[88:91]
    v_mfma_f32_16x16x32_bf16 v[92:95], v[32:35], a[48:51], v[92:95]
    s_lshl_b32 s25, s25, 16
    v_mfma_f32_16x16x32_bf16 v[92:95], v[36:39], a[52:55], v[92:95]
    v_mfma_f32_16x16x32_bf16 v[92:95], v[40:43], a[56:59], v[92:95]
    s_add_u32 s27, s27, s25
    v_mfma_f32_16x16x32_bf16 v[92:95], v[44:47], a[60:63], v[92:95]
    s_waitcnt lgkmcnt(4)
    v_mfma_f32_16x16x32_bf16 v[144:147], v[48:51], a[0:3], v[144:147]
    s_add_u32 s27, s27, 49152
    s_waitcnt vmcnt(32)
    s_barrier
    v_mfma_f32_16x16x32_bf16 v[144:147], v[52:55], a[4:7], v[144:147]
    ds_read_b64_tr_b16 v[32:33], v12 offset:16384
    s_waitcnt lgkmcnt(1)
    v_mfma_f32_16x16x32_bf16 v[144:147], v[56:59], a[8:11], v[144:147]
    ds_read_b64_tr_b16 v[34:35], v12 offset:16896
    v_add_u32 v5, s27, v3
    v_mfma_f32_16x16x32_bf16 v[144:147], v[60:63], a[12:15], v[144:147]
    ds_read_b64_tr_b16 v[36:37], v12 offset:20480
    v_mfma_f32_16x16x32_bf16 v[148:151], v[48:51], a[16:19], v[148:151]
    v_mfma_f32_16x16x32_bf16 v[148:151], v[52:55], a[20:23], v[148:151]
    ds_read_b64_tr_b16 v[38:39], v12 offset:20992
    v_mfma_f32_16x16x32_bf16 v[148:151], v[56:59], a[24:27], v[148:151]
    ds_read_b64_tr_b16 v[40:41], v12 offset:24576
    v_mfma_f32_16x16x32_bf16 v[148:151], v[60:63], a[28:31], v[148:151]
    ds_read_b64_tr_b16 v[42:43], v12 offset:25088
    v_mfma_f32_16x16x32_bf16 v[152:155], v[48:51], a[32:35], v[152:155]
    v_mfma_f32_16x16x32_bf16 v[152:155], v[52:55], a[36:39], v[152:155]
    ds_read_b64_tr_b16 v[44:45], v12 offset:28672
    v_mfma_f32_16x16x32_bf16 v[152:155], v[56:59], a[40:43], v[152:155]
    ds_read_b64_tr_b16 v[46:47], v12 offset:29184
    v_mfma_f32_16x16x32_bf16 v[152:155], v[60:63], a[44:47], v[152:155]
    v_mfma_f32_16x16x32_bf16 v[156:159], v[48:51], a[48:51], v[156:159]
    v_mfma_f32_16x16x32_bf16 v[156:159], v[52:55], a[52:55], v[156:159]
    v_mfma_f32_16x16x32_bf16 v[156:159], v[56:59], a[56:59], v[156:159]
    v_mfma_f32_16x16x32_bf16 v[156:159], v[60:63], a[60:63], v[156:159]
    s_waitcnt lgkmcnt(4)
    v_mfma_f32_16x16x32_bf16 v[64:67], v[32:35], a[64:67], v[64:67]
    v_mfma_f32_16x16x32_bf16 v[64:67], v[36:39], a[68:71], v[64:67]
    ds_read_b64_tr_b16 v[48:49], v13 offset:16384
    s_waitcnt lgkmcnt(1)
    v_mfma_f32_16x16x32_bf16 v[64:67], v[40:43], a[72:75], v[64:67]
    ds_read_b64_tr_b16 v[50:51], v13 offset:16896
    v_mfma_f32_16x16x32_bf16 v[64:67], v[44:47], a[76:79], v[64:67]
    ds_read_b64_tr_b16 v[52:53], v13 offset:20480
    v_mfma_f32_16x16x32_bf16 v[68:71], v[32:35], a[80:83], v[68:71]
    v_mfma_f32_16x16x32_bf16 v[68:71], v[36:39], a[84:87], v[68:71]
    ds_read_b64_tr_b16 v[54:55], v13 offset:20992
    v_mfma_f32_16x16x32_bf16 v[68:71], v[40:43], a[88:91], v[68:71]
    ds_read_b64_tr_b16 v[56:57], v13 offset:24576
    v_mfma_f32_16x16x32_bf16 v[68:71], v[44:47], a[92:95], v[68:71]
    ds_read_b64_tr_b16 v[58:59], v13 offset:25088
    v_mfma_f32_16x16x32_bf16 v[72:75], v[32:35], a[96:99], v[72:75]
    v_mfma_f32_16x16x32_bf16 v[72:75], v[36:39], a[100:103], v[72:75]
    ds_read_b64_tr_b16 v[60:61], v13 offset:28672
    v_mfma_f32_16x16x32_bf16 v[72:75], v[40:43], a[104:107], v[72:75]
    ds_read_b64_tr_b16 v[62:63], v13 offset:29184
    v_mfma_f32_16x16x32_bf16 v[72:75], v[44:47], a[108:111], v[72:75]
    v_mfma_f32_16x16x32_bf16 v[76:79], v[32:35], a[112:115], v[76:79]
    v_mfma_f32_16x16x32_bf16 v[76:79], v[36:39], a[116:119], v[76:79]
    v_mfma_f32_16x16x32_bf16 v[76:79], v[40:43], a[120:123], v[76:79]
    v_mfma_f32_16x16x32_bf16 v[76:79], v[44:47], a[124:127], v[76:79]
    s_waitcnt lgkmcnt(4)
    v_mfma_f32_16x16x32_bf16 v[128:131], v[48:51], a[64:67], v[128:131]
    v_mfma_f32_16x16x32_bf16 v[128:131], v[52:55], a[68:71], v[128:131]
    ds_read_b64_tr_b16 v[32:33], v14 offset:16384
    s_waitcnt lgkmcnt(1)
    v_mfma_f32_16x16x32_bf16 v[128:131], v[56:59], a[72:75], v[128:131]
    ds_read_b64_tr_b16 v[34:35], v14 offset:16896
    v_mfma_f32_16x16x32_bf16 v[128:131], v[60:63], a[76:79], v[128:131]
    ds_read_b64_tr_b16 v[36:37], v14 offset:20480
    v_mfma_f32_16x16x32_bf16 v[132:135], v[48:51], a[80:83], v[132:135]
    v_mfma_f32_16x16x32_bf16 v[132:135], v[52:55], a[84:87], v[132:135]
    ds_read_b64_tr_b16 v[38:39], v14 offset:20992
    v_mfma_f32_16x16x32_bf16 v[132:135], v[56:59], a[88:91], v[132:135]
    ds_read_b64_tr_b16 v[40:41], v14 offset:24576
    v_mfma_f32_16x16x32_bf16 v[132:135], v[60:63], a[92:95], v[132:135]
    ds_read_b64_tr_b16 v[42:43], v14 offset:25088
    v_mfma_f32_16x16x32_bf16 v[136:139], v[48:51], a[96:99], v[136:139]
    v_mfma_f32_16x16x32_bf16 v[136:139], v[52:55], a[100:103], v[136:139]
    ds_read_b64_tr_b16 v[44:45], v14 offset:28672
    v_mfma_f32_16x16x32_bf16 v[136:139], v[56:59], a[104:107], v[136:139]
    ds_read_b64_tr_b16 v[46:47], v14 offset:29184
    v_mfma_f32_16x16x32_bf16 v[136:139], v[60:63], a[108:111], v[136:139]
    v_mfma_f32_16x16x32_bf16 v[140:143], v[48:51], a[112:115], v[140:143]
    v_mfma_f32_16x16x32_bf16 v[140:143], v[52:55], a[116:119], v[140:143]
    v_mfma_f32_16x16x32_bf16 v[140:143], v[56:59], a[120:123], v[140:143]
    v_mfma_f32_16x16x32_bf16 v[140:143], v[60:63], a[124:127], v[140:143]
    s_waitcnt lgkmcnt(4)
    v_mfma_f32_16x16x32_bf16 v[80:83], v[32:35], a[64:67], v[80:83]
    v_mfma_f32_16x16x32_bf16 v[80:83], v[36:39], a[68:71], v[80:83]
    ds_read_b64_tr_b16 v[48:49], v15 offset:16384
    s_waitcnt lgkmcnt(1)
    v_mfma_f32_16x16x32_bf16 v[80:83], v[40:43], a[72:75], v[80:83]
    ds_read_b64_tr_b16 v[50:51], v15 offset:16896
    v_mfma_f32_16x16x32_bf16 v[80:83], v[44:47], a[76:79], v[80:83]
    ds_read_b64_tr_b16 v[52:53], v15 offset:20480
    v_mfma_f32_16x16x32_bf16 v[84:87], v[32:35], a[80:83], v[84:87]
    v_mfma_f32_16x16x32_bf16 v[84:87], v[36:39], a[84:87], v[84:87]
    ds_read_b64_tr_b16 v[54:55], v15 offset:20992
    s_lshl_b32 s52, s29, 7
    v_mfma_f32_16x16x32_bf16 v[84:87], v[40:43], a[88:91], v[84:87]
    ds_read_b64_tr_b16 v[56:57], v15 offset:24576
    s_add_u32 s52, s52, 83886080
    v_mfma_f32_16x16x32_bf16 v[84:87], v[44:47], a[92:95], v[84:87]
    ds_read_b64_tr_b16 v[58:59], v15 offset:25088
    s_lshl_b32 s55, s30, 2
    v_mfma_f32_16x16x32_bf16 v[88:91], v[32:35], a[96:99], v[88:91]
    s_add_u32 s55, s55, s52
    v_mfma_f32_16x16x32_bf16 v[88:91], v[36:39], a[100:103], v[88:91]
    ds_read_b64_tr_b16 v[60:61], v15 offset:28672
    v_mov_b32 v25, 1
    v_mfma_f32_16x16x32_bf16 v[88:91], v[40:43], a[104:107], v[88:91]
    ds_read_b64_tr_b16 v[62:63], v15 offset:29184
    v_mov_b32 v26, 0
    v_mfma_f32_16x16x32_bf16 v[88:91], v[44:47], a[108:111], v[88:91]
    v_mfma_f32_16x16x32_bf16 v[92:95], v[32:35], a[112:115], v[92:95]
    v_mfma_f32_16x16x32_bf16 v[92:95], v[36:39], a[116:119], v[92:95]
    v_mfma_f32_16x16x32_bf16 v[92:95], v[40:43], a[120:123], v[92:95]
    v_mfma_f32_16x16x32_bf16 v[92:95], v[44:47], a[124:127], v[92:95]
    s_waitcnt lgkmcnt(4)
    v_mfma_f32_16x16x32_bf16 v[144:147], v[48:51], a[64:67], v[144:147]
    s_waitcnt vmcnt(0)
    s_waitcnt vmcnt(16)
    s_barrier
    v_mfma_f32_16x16x32_bf16 v[144:147], v[52:55], a[68:71], v[144:147]
    ds_read_b64_tr_b16 v[32:33], v12 offset:49152
    s_cmp_lg_u32 s28, 0
    s_cbranch_scc1 K2_SIGB
    s_mov_b64 exec, 1
    buffer_store_dword v25, v26, s[4:7], s55 offen sc1
    s_mov_b64 exec, -1
K2_SIGB:
    v_and_b32 v26, 7, v2
    v_lshlrev_b32 v26, 2, v26
    s_waitcnt lgkmcnt(1)
    v_mfma_f32_16x16x32_bf16 v[144:147], v[56:59], a[72:75], v[144:147]
    ds_read_b64_tr_b16 v[34:35], v12 offset:49664
    v_mfma_f32_16x16x32_bf16 v[144:147], v[60:63], a[76:79], v[144:147]
    ds_read_b64_tr_b16 v[36:37], v12 offset:53248
    v_mfma_f32_16x16x32_bf16 v[148:151], v[48:51], a[80:83], v[148:151]
    v_mfma_f32_16x16x32_bf16 v[148:151], v[52:55], a[84:87], v[148:151]
    ds_read_b64_tr_b16 v[38:39], v12 offset:53760
    v_mfma_f32_16x16x32_bf16 v[148:151], v[56:59], a[88:91], v[148:151]
    ds_read_b64_tr_b16 v[40:41], v12 offset:57344
    v_mfma_f32_16x16x32_bf16 v[148:151], v[60:63], a[92:95], v[148:151]
    ds_read_b64_tr_b16 v[42:43], v12 offset:57856
    v_mfma_f32_16x16x32_bf16 v[152:155], v[48:51], a[96:99], v[152:155]
    v_mfma_f32_16x16x32_bf16 v[152:155], v[52:55], a[100:103], v[152:155]
    ds_read_b64_tr_b16 v[44:45], v12 offset:61440
    v_mfma_f32_16x16x32_bf16 v[152:155], v[56:59], a[104:107], v[152:155]
    ds_read_b64_tr_b16 v[46:47], v12 offset:61952
    v_mfma_f32_16x16x32_bf16 v[152:155], v[60:63], a[108:111], v[152:155]
    v_mfma_f32_16x16x32_bf16 v[156:159], v[48:51], a[112:115], v[156:159]
    v_mfma_f32_16x16x32_bf16 v[156:159], v[52:55], a[116:119], v[156:159]
    v_mfma_f32_16x16x32_bf16 v[156:159], v[56:59], a[120:123], v[156:159]
    v_mfma_f32_16x16x32_bf16 v[156:159], v[60:63], a[124:127], v[156:159]
    s_waitcnt lgkmcnt(4)
    v_mfma_f32_16x16x32_bf16 v[96:99], v[32:35], a[128:131], 0
    v_mfma_f32_16x16x32_bf16 v[96:99], v[36:39], a[132:135], v[96:99]
    ds_read_b64_tr_b16 v[48:49], v16 offset:49152
    s_waitcnt lgkmcnt(1)
    v_mfma_f32_16x16x32_bf16 v[96:99], v[40:43], a[136:139], v[96:99]
    ds_read_b64_tr_b16 v[50:51], v16 offset:49664
    v_mfma_f32_16x16x32_bf16 v[96:99], v[44:47], a[140:143], v[96:99]
    ds_read_b64_tr_b16 v[52:53], v16 offset:53248
    v_mfma_f32_16x16x32_bf16 v[100:103], v[32:35], a[144:147], 0
    v_mfma_f32_16x16x32_bf16 v[100:103], v[36:39], a[148:151], v[100:103]
    ds_read_b64_tr_b16 v[54:55], v16 offset:53760
    v_mfma_f32_16x16x32_bf16 v[100:103], v[40:43], a[152:155], v[100:103]
    ds_read_b64_tr_b16 v[56:57], v16 offset:57344
    v_mfma_f32_16x16x32_bf16 v[100:103], v[44:47], a[156:159], v[100:103]
    ds_read_b64_tr_b16 v[58:59], v16 offset:57856
    v_mfma_f32_16x16x32_bf16 v[104:107], v[32:35], a[160:163], 0
    v_cvt_pk_bf16_f32 v64, v64, v65
    v_mfma_f32_16x16x32_bf16 v[104:107], v[36:39], a[164:167], v[104:107]
    ds_read_b64_tr_b16 v[60:61], v16 offset:61440
    v_mfma_f32_16x16x32_bf16 v[104:107], v[40:43], a[168:171], v[104:107]
    ds_read_b64_tr_b16 v[62:63], v16 offset:61952
    v_mfma_f32_16x16x32_bf16 v[104:107], v[44:47], a[172:175], v[104:107]
    v_cvt_pk_bf16_f32 v65, v66, v67
    v_mfma_f32_16x16x32_bf16 v[108:111], v[32:35], a[176:179], 0
    v_mfma_f32_16x16x32_bf16 v[108:111], v[36:39], a[180:183], v[108:111]
    v_mfma_f32_16x16x32_bf16 v[108:111], v[40:43], a[184:187], v[108:111]
    v_mfma_f32_16x16x32_bf16 v[108:111], v[44:47], a[188:191], v[108:111]
    v_cvt_pk_bf16_f32 v66, v128, v129
    s_waitcnt lgkmcnt(4)
    v_mfma_f32_16x16x32_bf16 v[96:99], v[48:51], a[192:195], v[96:99]
    v_mfma_f32_16x16x32_bf16 v[96:99], v[52:55], a[196:199], v[96:99]
    ds_read_b64_tr_b16 v[32:33], v20 offset:0
    s_waitcnt lgkmcnt(1)
    v_mfma_f32_16x16x32_bf16 v[96:99], v[56:59], a[200:203], v[96:99]
    ds_read_b64_tr_b16 v[34:35], v20 offset:512
    v_mfma_f32_16x16x32_bf16 v[96:99], v[60:63], a[204:207], v[96:99]
    ds_read_b64_tr_b16 v[36:37], v20 offset:4096
    v_cvt_pk_bf16_f32 v67, v130, v131
    v_mfma_f32_16x16x32_bf16 v[100:103], v[48:51], a[208:211], v[100:103]
    v_mfma_f32_16x16x32_bf16 v[100:103], v[52:55], a[212:215], v[100:103]
    ds_read_b64_tr_b16 v[38:39], v20 offset:4608
    v_mfma_f32_16x16x32_bf16 v[100:103], v[56:59], a[216:219], v[100:103]
    ds_read_b64_tr_b16 v[40:41], v20 offset:8192
    v_mfma_f32_16x16x32_bf16 v[100:103], v[60:63], a[220:223], v[100:103]
    ds_read_b64_tr_b16 v[42:43], v20 offset:8704
    v_cvt_pk_bf16_f32 v68, v68, v69
    v_mfma_f32_16x16x32_bf16 v[104:107], v[48:51], a[224:227], v[104:107]
    v_mfma_f32_16x16x32_bf16 v[104:107], v[52:55], a[228:231], v[104:107]
    ds_read_b64_tr_b16 v[44:45], v20 offset:12288
    v_mfma_f32_16x16x32_bf16 v[104:107], v[56:59], a[232:235], v[104:107]
    ds_read_b64_tr_b16 v[46:47], v20 offset:12800
    v_cvt_pk_bf16_f32 v69, v70, v71
    v_mfma_f32_16x16x32_bf16 v[104:107], v[60:63], a[236:239], v[104:107]
    v_mfma_f32_16x16x32_bf16 v[108:111], v[48:51], a[240:243], v[108:111]
    v_mfma_f32_16x16x32_bf16 v[108:111], v[52:55], a[244:247], v[108:111]
    v_mfma_f32_16x16x32_bf16 v[108:111], v[56:59], a[248:251], v[108:111]
    v_cvt_pk_bf16_f32 v70, v132, v133
    v_mfma_f32_16x16x32_bf16 v[108:111], v[60:63], a[252:255], v[108:111]
    s_waitcnt lgkmcnt(4)
    v_mfma_f32_16x16x32_bf16 v[96:99], v[32:35], a[0:3], v[96:99]
    v_mfma_f32_16x16x32_bf16 v[96:99], v[36:39], a[4:7], v[96:99]
    ds_read_b64_tr_b16 v[48:49], v20 offset:16384
    s_waitcnt lgkmcnt(1)
    v_mfma_f32_16x16x32_bf16 v[96:99], v[40:43], a[8:11], v[96:99]
    ds_read_b64_tr_b16 v[50:51], v20 offset:16896
    v_cvt_pk_bf16_f32 v71, v134, v135
    v_mfma_f32_16x16x32_bf16 v[96:99], v[44:47], a[12:15], v[96:99]
    ds_read_b64_tr_b16 v[52:53], v20 offset:20480
    v_mfma_f32_16x16x32_bf16 v[100:103], v[32:35], a[16:19], v[100:103]
    v_mfma_f32_16x16x32_bf16 v[100:103], v[36:39], a[20:23], v[100:103]
    ds_read_b64_tr_b16 v[54:55], v20 offset:20992
    v_mfma_f32_16x16x32_bf16 v[100:103], v[40:43], a[24:27], v[100:103]
    ds_read_b64_tr_b16 v[56:57], v20 offset:24576
    v_cvt_pk_bf16_f32 v72, v72, v73
    v_mfma_f32_16x16x32_bf16 v[100:103], v[44:47], a[28:31], v[100:103]
    ds_read_b64_tr_b16 v[58:59], v20 offset:25088
    s_barrier
    v_mfma_f32_16x16x32_bf16 v[104:107], v[32:35], a[32:35], v[104:107]
    v_mfma_f32_16x16x32_bf16 v[104:107], v[36:39], a[36:39], v[104:107]
    ds_read_b64_tr_b16 v[60:61], v20 offset:28672
    v_cvt_pk_bf16_f32 v73, v74, v75
    v_mfma_f32_16x16x32_bf16 v[104:107], v[40:43], a[40:43], v[104:107]
    ds_read_b64_tr_b16 v[62:63], v20 offset:29184
    v_mfma_f32_16x16x32_bf16 v[104:107], v[44:47], a[44:47], v[104:107]
    v_mfma_f32_16x16x32_bf16 v[108:111], v[32:35], a[48:51], v[108:111]
    v_mfma_f32_16x16x32_bf16 v[108:111], v[36:39], a[52:55], v[108:111]
    v_cvt_pk_bf16_f32 v74, v136, v137
    v_mfma_f32_16x16x32_bf16 v[108:111], v[40:43], a[56:59], v[108:111]
    v_mfma_f32_16x16x32_bf16 v[108:111], v[44:47], a[60:63], v[108:111]
    s_waitcnt lgkmcnt(4)
    v_mfma_f32_16x16x32_bf16 v[96:99], v[48:51], a[64:67], v[96:99]
    v_mfma_f32_16x16x32_bf16 v[96:99], v[52:55], a[68:71], v[96:99]
    ds_read_b64_tr_b16 v[32:33], v13 offset:49152
    v_cvt_pk_bf16_f32 v75, v138, v139
    s_waitcnt lgkmcnt(1)
    v_mfma_f32_16x16x32_bf16 v[96:99], v[56:59], a[72:75], v[96:99]
    ds_read_b64_tr_b16 v[34:35], v13 offset:49664
    v_mfma_f32_16x16x32_bf16 v[96:99], v[60:63], a[76:79], v[96:99]
    ds_read_b64_tr_b16 v[36:37], v13 offset:53248
    v_mfma_f32_16x16x32_bf16 v[100:103], v[48:51], a[80:83], v[100:103]
    v_mfma_f32_16x16x32_bf16 v[100:103], v[52:55], a[84:87], v[100:103]
    ds_read_b64_tr_b16 v[38:39], v13 offset:53760
    v_cvt_pk_bf16_f32 v76, v76, v77
    v_mfma_f32_16x16x32_bf16 v[100:103], v[56:59], a[88:91], v[100:103]
    ds_read_b64_tr_b16 v[40:41], v13 offset:57344
    v_mfma_f32_16x16x32_bf16 v[100:103], v[60:63], a[92:95], v[100:103]
    ds_read_b64_tr_b16 v[42:43], v13 offset:57856
    v_mfma_f32_16x16x32_bf16 v[104:107], v[48:51], a[96:99], v[104:107]
    v_cvt_pk_bf16_f32 v77, v78, v79
    v_mfma_f32_16x16x32_bf16 v[104:107], v[52:55], a[100:103], v[104:107]
    ds_read_b64_tr_b16 v[44:45], v13 offset:61440
    v_mfma_f32_16x16x32_bf16 v[104:107], v[56:59], a[104:107], v[104:107]
    ds_read_b64_tr_b16 v[46:47], v13 offset:61952
    v_mfma_f32_16x16x32_bf16 v[104:107], v[60:63], a[108:111], v[104:107]
    v_mfma_f32_16x16x32_bf16 v[108:111], v[48:51], a[112:115], v[108:111]
    v_cvt_pk_bf16_f32 v78, v140, v141
    v_mfma_f32_16x16x32_bf16 v[108:111], v[52:55], a[116:119], v[108:111]
    v_mfma_f32_16x16x32_bf16 v[108:111], v[56:59], a[120:123], v[108:111]
    v_mfma_f32_16x16x32_bf16 v[108:111], v[60:63], a[124:127], v[108:111]
    s_waitcnt lgkmcnt(4)
    v_mfma_f32_16x16x32_bf16 v[160:163], v[32:35], a[128:131], 0
    v_cvt_pk_bf16_f32 v79, v142, v143
    v_mfma_f32_16x16x32_bf16 v[160:163], v[36:39], a[132:135], v[160:163]
    ds_read_b64_tr_b16 v[48:49], v17 offset:49152
    s_waitcnt lgkmcnt(1)
    v_mfma_f32_16x16x32_bf16 v[160:163], v[40:43], a[136:139], v[160:163]
    ds_read_b64_tr_b16 v[50:51], v17 offset:49664
    v_mfma_f32_16x16x32_bf16 v[160:163], v[44:47], a[140:143], v[160:163]
    ds_read_b64_tr_b16 v[52:53], v17 offset:53248
    v_mfma_f32_16x16x32_bf16 v[164:167], v[32:35], a[144:147], 0
    v_cvt_pk_bf16_f32 v80, v80, v81
    v_mfma_f32_16x16x32_bf16 v[164:167], v[36:39], a[148:151], v[164:167]
    ds_read_b64_tr_b16 v[54:55], v17 offset:53760
    v_mfma_f32_16x16x32_bf16 v[164:167], v[40:43], a[152:155], v[164:167]
    ds_read_b64_tr_b16 v[56:57], v17 offset:57344
    v_mfma_f32_16x16x32_bf16 v[164:167], v[44:47], a[156:159], v[164:167]
    ds_read_b64_tr_b16 v[58:59], v17 offset:57856
    v_cvt_pk_bf16_f32 v81, v82, v83
    v_mfma_f32_16x16x32_bf16 v[168:171], v[32:35], a[160:163], 0
    v_mfma_f32_16x16x32_bf16 v[168:171], v[36:39], a[164:167], v[168:171]
    ds_read_b64_tr_b16 v[60:61], v17 offset:61440
    v_mfma_f32_16x16x32_bf16 v[168:171], v[40:43], a[168:171], v[168:171]
    ds_read_b64_tr_b16 v[62:63], v17 offset:61952
    v_mfma_f32_16x16x32_bf16 v[168:171], v[44:47], a[172:175], v[168:171]
    v_cvt_pk_bf16_f32 v82, v144, v145
    v_mfma_f32_16x16x32_bf16 v[172:175], v[32:35], a[176:179], 0
    v_mfma_f32_16x16x32_bf16 v[172:175], v[36:39], a[180:183], v[172:175]
    v_mfma_f32_16x16x32_bf16 v[172:175], v[40:43], a[184:187], v[172:175]
    v_mfma_f32_16x16x32_bf16 v[172:175], v[44:47], a[188:191], v[172:175]
    v_cvt_pk_bf16_f32 v83, v146, v147
    s_waitcnt lgkmcnt(4)
    v_mfma_f32_16x16x32_bf16 v[160:163], v[48:51], a[192:195], v[160:163]
    v_mfma_f32_16x16x32_bf16 v[160:163], v[52:55], a[196:199], v[160:163]
    ds_read_b64_tr_b16 v[32:33], v21 offset:0
    s_waitcnt lgkmcnt(1)
    v_mfma_f32_16x16x32_bf16 v[160:163], v[56:59], a[200:203], v[160:163]
    ds_read_b64_tr_b16 v[34:35], v21 offset:512
    v_mfma_f32_16x16x32_bf16 v[160:163], v[60:63], a[204:207], v[160:163]
    ds_read_b64_tr_b16 v[36:37], v21 offset:4096
    v_cvt_pk_bf16_f32 v84, v84, v85
    v_mfma_f32_16x16x32_bf16 v[164:167], v[48:51], a[208:211], v[164:167]
    v_mfma_f32_16x16x32_bf16 v[164:167], v[52:55], a[212:215], v[164:167]
    ds_read_b64_tr_b16 v[38:39], v21 offset:4608
    v_mfma_f32_16x16x32_bf16 v[164:167], v[56:59], a[216:219], v[164:167]
    ds_read_b64_tr_b16 v[40:41], v21 offset:8192
    v_cvt_pk_bf16_f32 v85, v86, v87
    v_mfma_f32_16x16x32_bf16 v[164:167], v[60:63], a[220:223], v[164:167]
    ds_read_b64_tr_b16 v[42:43], v21 offset:8704
    v_mfma_f32_16x16x32_bf16 v[168:171], v[48:51], a[224:227], v[168:171]
    buffer_load_dword v25, v26, s[4:7], s52 offen sc1
    v_mfma_f32_16x16x32_bf16 v[168:171], v[52:55], a[228:231], v[168:171]
    ds_read_b64_tr_b16 v[44:45], v21 offset:12288
    v_mfma_f32_16x16x32_bf16 v[168:171], v[56:59], a[232:235], v[168:171]
    ds_read_b64_tr_b16 v[46:47], v21 offset:12800
    v_cvt_pk_bf16_f32 v86, v148, v149
    v_mfma_f32_16x16x32_bf16 v[168:171], v[60:63], a[236:239], v[168:171]
    v_mfma_f32_16x16x32_bf16 v[172:175], v[48:51], a[240:243], v[172:175]
    v_mfma_f32_16x16x32_bf16 v[172:175], v[52:55], a[244:247], v[172:175]
    v_mfma_f32_16x16x32_bf16 v[172:175], v[56:59], a[248:251], v[172:175]
    v_cvt_pk_bf16_f32 v87, v150, v151
    v_mfma_f32_16x16x32_bf16 v[172:175], v[60:63], a[252:255], v[172:175]
    s_waitcnt lgkmcnt(4)
    v_mfma_f32_16x16x32_bf16 v[160:163], v[32:35], a[0:3], v[160:163]
    v_mfma_f32_16x16x32_bf16 v[160:163], v[36:39], a[4:7], v[160:163]
    ds_read_b64_tr_b16 v[48:49], v21 offset:16384
    s_waitcnt lgkmcnt(1)
    v_mfma_f32_16x16x32_bf16 v[160:163], v[40:43], a[8:11], v[160:163]
    ds_read_b64_tr_b16 v[50:51], v21 offset:16896
    v_cvt_pk_bf16_f32 v88, v88, v89
    v_mfma_f32_16x16x32_bf16 v[160:163], v[44:47], a[12:15], v[160:163]
    ds_read_b64_tr_b16 v[52:53], v21 offset:20480
    v_mfma_f32_16x16x32_bf16 v[164:167], v[32:35], a[16:19], v[164:167]
    v_mfma_f32_16x16x32_bf16 v[164:167], v[36:39], a[20:23], v[164:167]
    ds_read_b64_tr_b16 v[54:55], v21 offset:20992
    v_cvt_pk_bf16_f32 v89, v90, v91
    v_mfma_f32_16x16x32_bf16 v[164:167], v[40:43], a[24:27], v[164:167]
    ds_read_b64_tr_b16 v[56:57], v21 offset:24576
    v_mfma_f32_16x16x32_bf16 v[164:167], v[44:47], a[28:31], v[164:167]
    ds_read_b64_tr_b16 v[58:59], v21 offset:25088
    v_mfma_f32_16x16x32_bf16 v[168:171], v[32:35], a[32:35], v[168:171]
    v_mfma_f32_16x16x32_bf16 v[168:171], v[36:39], a[36:39], v[168:171]
    ds_read_b64_tr_b16 v[60:61], v21 offset:28672
    v_cvt_pk_bf16_f32 v90, v152, v153
    v_mfma_f32_16x16x32_bf16 v[168:171], v[40:43], a[40:43], v[168:171]
    ds_read_b64_tr_b16 v[62:63], v21 offset:29184
    v_mfma_f32_16x16x32_bf16 v[168:171], v[44:47], a[44:47], v[168:171]
    v_mfma_f32_16x16x32_bf16 v[172:175], v[32:35], a[48:51], v[172:175]
    v_mfma_f32_16x16x32_bf16 v[172:175], v[36:39], a[52:55], v[172:175]
    v_cvt_pk_bf16_f32 v91, v154, v155
    v_mfma_f32_16x16x32_bf16 v[172:175], v[40:43], a[56:59], v[172:175]
    v_mfma_f32_16x16x32_bf16 v[172:175], v[44:47], a[60:63], v[172:175]
    s_waitcnt lgkmcnt(4)
    v_mfma_f32_16x16x32_bf16 v[160:163], v[48:51], a[64:67], v[160:163]
    v_mfma_f32_16x16x32_bf16 v[160:163], v[52:55], a[68:71], v[160:163]
    ds_read_b64_tr_b16 v[32:33], v14 offset:49152
    v_cvt_pk_bf16_f32 v92, v92, v93
    s_waitcnt lgkmcnt(1)
    v_mfma_f32_16x16x32_bf16 v[160:163], v[56:59], a[72:75], v[160:163]
    ds_read_b64_tr_b16 v[34:35], v14 offset:49664
    v_mfma_f32_16x16x32_bf16 v[160:163], v[60:63], a[76:79], v[160:163]
    ds_read_b64_tr_b16 v[36:37], v14 offset:53248
    v_mfma_f32_16x16x32_bf16 v[164:167], v[48:51], a[80:83], v[164:167]
    v_cvt_pk_bf16_f32 v93, v94, v95
    v_mfma_f32_16x16x32_bf16 v[164:167], v[52:55], a[84:87], v[164:167]
    ds_read_b64_tr_b16 v[38:39], v14 offset:53760
    v_mfma_f32_16x16x32_bf16 v[164:167], v[56:59], a[88:91], v[164:167]
    ds_read_b64_tr_b16 v[40:41], v14 offset:57344
    v_mfma_f32_16x16x32_bf16 v[164:167], v[60:63], a[92:95], v[164:167]
    ds_read_b64_tr_b16 v[42:43], v14 offset:57856
    v_mfma_f32_16x16x32_bf16 v[168:171], v[48:51], a[96:99], v[168:171]
    v_cvt_pk_bf16_f32 v94, v156, v157
    v_mfma_f32_16x16x32_bf16 v[168:171], v[52:55], a[100:103], v[168:171]
    ds_read_b64_tr_b16 v[44:45], v14 offset:61440
    v_mfma_f32_16x16x32_bf16 v[168:171], v[56:59], a[104:107], v[168:171]
    ds_read_b64_tr_b16 v[46:47], v14 offset:61952
    v_mfma_f32_16x16x32_bf16 v[168:171], v[60:63], a[108:111], v[168:171]
    v_mfma_f32_16x16x32_bf16 v[172:175], v[48:51], a[112:115], v[172:175]
    v_cvt_pk_bf16_f32 v95, v158, v159
    v_mfma_f32_16x16x32_bf16 v[172:175], v[52:55], a[116:119], v[172:175]
    v_mfma_f32_16x16x32_bf16 v[172:175], v[56:59], a[120:123], v[172:175]
    v_mfma_f32_16x16x32_bf16 v[172:175], v[60:63], a[124:127], v[172:175]
    s_waitcnt lgkmcnt(4)
    s_waitcnt vmcnt(0)
    v_cmp_ne_u32 vcc, 1, v25
    s_cbranch_vccnz K2_KVBSPIN_E
K2_KVBOK:
    v_mfma_f32_16x16x32_bf16 v[112:115], v[32:35], a[128:131], 0
    s_lshl_b32 s47, s28, 12
    s_add_u32 m0, s47, 0
    v_mfma_f32_16x16x32_bf16 v[112:115], v[36:39], a[132:135], v[112:115]
    ds_read_b64_tr_b16 v[48:49], v18 offset:49152
    s_mov_b32 s47, 0
    s_waitcnt lgkmcnt(1)
    v_mfma_f32_16x16x32_bf16 v[112:115], v[40:43], a[136:139], v[112:115]
    ds_read_b64_tr_b16 v[50:51], v18 offset:49664
    buffer_load_dwordx4 v24, s[16:19], s47 offen offset:0 sc1 lds
    v_mfma_f32_16x16x32_bf16 v[112:115], v[44:47], a[140:143], v[112:115]
    ds_read_b64_tr_b16 v[52:53], v18 offset:53248
    v_mfma_f32_16x16x32_bf16 v[116:119], v[32:35], a[144:147], 0
    v_mfma_f32_16x16x32_bf16 v[116:119], v[36:39], a[148:151], v[116:119]
    ds_read_b64_tr_b16 v[54:55], v18 offset:53760
    v_mfma_f32_16x16x32_bf16 v[116:119], v[40:43], a[152:155], v[116:119]
    ds_read_b64_tr_b16 v[56:57], v18 offset:57344
    buffer_load_dwordx4 v24, s[16:19], s47 offen offset:1024 sc1 lds
    v_mfma_f32_16x16x32_bf16 v[116:119], v[44:47], a[156:159], v[116:119]
    ds_read_b64_tr_b16 v[58:59], v18 offset:57856
    v_mfma_f32_16x16x32_bf16 v[120:123], v[32:35], a[160:163], 0
    v_cvt_pk_bf16_f32 v104, v104, v105
    v_mfma_f32_16x16x32_bf16 v[120:123], v[36:39], a[164:167], v[120:123]
    ds_read_b64_tr_b16 v[60:61], v18 offset:61440
    v_mfma_f32_16x16x32_bf16 v[120:123], v[40:43], a[168:171], v[120:123]
    ds_read_b64_tr_b16 v[62:63], v18 offset:61952
    buffer_load_dwordx4 v24, s[16:19], s47 offen offset:2048 sc1 lds
    v_mfma_f32_16x16x32_bf16 v[120:123], v[44:47], a[172:175], v[120:123]
    v_mfma_f32_16x16x32_bf16 v[124:127], v[32:35], a[176:179], 0
    v_cvt_pk_bf16_f32 v105, v106, v107
    v_mfma_f32_16x16x32_bf16 v[124:127], v[36:39], a[180:183], v[124:127]
    v_mfma_f32_16x16x32_bf16 v[124:127], v[40:43], a[184:187], v[124:127]
    buffer_load_dwordx4 v24, s[16:19], s47 offen offset:3072 sc1 lds
    v_mfma_f32_16x16x32_bf16 v[124:127], v[44:47], a[188:191], v[124:127]
    s_lshl_b32 s47, s28, 12
    s_waitcnt lgkmcnt(4)
    v_mfma_f32_16x16x32_bf16 v[112:115], v[48:51], a[192:195], v[112:115]
    s_add_u32 m0, s47, 65536
    v_cvt_pk_bf16_f32 v106, v168, v169
    v_mfma_f32_16x16x32_bf16 v[112:115], v[52:55], a[196:199], v[112:115]
    ds_read_b64_tr_b16 v[32:33], v22 offset:0
    s_mov_b32 s47, 0
    s_waitcnt lgkmcnt(1)
    v_mfma_f32_16x16x32_bf16 v[112:115], v[56:59], a[200:203], v[112:115]
    ds_read_b64_tr_b16 v[34:35], v22 offset:512
    buffer_load_dwordx4 v24, s[20:23], s47 offen offset:0 sc1 lds
    v_mfma_f32_16x16x32_bf16 v[112:115], v[60:63], a[204:207], v[112:115]
    ds_read_b64_tr_b16 v[36:37], v22 offset:4096
    v_mfma_f32_16x16x32_bf16 v[116:119], v[48:51], a[208:211], v[116:119]
    v_cvt_pk_bf16_f32 v107, v170, v171
    v_mfma_f32_16x16x32_bf16 v[116:119], v[52:55], a[212:215], v[116:119]
    ds_read_b64_tr_b16 v[38:39], v22 offset:4608
    v_mfma_f32_16x16x32_bf16 v[116:119], v[56:59], a[216:219], v[116:119]
    ds_read_b64_tr_b16 v[40:41], v22 offset:8192
    buffer_load_dwordx4 v24, s[20:23], s47 offen offset:1024 sc1 lds
    v_mfma_f32_16x16x32_bf16 v[116:119], v[60:63], a[220:223], v[116:119]
    ds_read_b64_tr_b16 v[42:43], v22 offset:8704
    v_mfma_f32_16x16x32_bf16 v[120:123], v[48:51], a[224:227], v[120:123]
    v_mfma_f32_16x16x32_bf16 v[120:123], v[52:55], a[228:231], v[120:123]
    ds_read_b64_tr_b16 v[44:45], v22 offset:12288
    v_cvt_pk_bf16_f32 v108, v108, v109
    v_mfma_f32_16x16x32_bf16 v[120:123], v[56:59], a[232:235], v[120:123]
    ds_read_b64_tr_b16 v[46:47], v22 offset:12800
    buffer_load_dwordx4 v24, s[20:23], s47 offen offset:2048 sc1 lds
    v_mfma_f32_16x16x32_bf16 v[120:123], v[60:63], a[236:239], v[120:123]
    v_mfma_f32_16x16x32_bf16 v[124:127], v[48:51], a[240:243], v[124:127]
    v_mfma_f32_16x16x32_bf16 v[124:127], v[52:55], a[244:247], v[124:127]
    v_cvt_pk_bf16_f32 v109, v110, v111
    v_mfma_f32_16x16x32_bf16 v[124:127], v[56:59], a[248:251], v[124:127]
    buffer_load_dwordx4 v24, s[20:23], s47 offen offset:3072 sc1 lds
    v_mfma_f32_16x16x32_bf16 v[124:127], v[60:63], a[252:255], v[124:127]
    s_lshl_b32 s47, s28, 12
    s_waitcnt lgkmcnt(4)
    v_mfma_f32_16x16x32_bf16 v[112:115], v[32:35], a[0:3], v[112:115]
    s_add_u32 m0, s47, 16384
    v_mfma_f32_16x16x32_bf16 v[112:115], v[36:39], a[4:7], v[112:115]
    ds_read_b64_tr_b16 v[48:49], v22 offset:16384
    s_mov_b32 s47, 16384
    v_cvt_pk_bf16_f32 v110, v172, v173
    s_waitcnt lgkmcnt(1)
    v_mfma_f32_16x16x32_bf16 v[112:115], v[40:43], a[8:11], v[112:115]
    ds_read_b64_tr_b16 v[50:51], v22 offset:16896
    buffer_load_dwordx4 v24, s[16:19], s47 offen offset:0 sc1 lds
    v_mfma_f32_16x16x32_bf16 v[112:115], v[44:47], a[12:15], v[112:115]
    ds_read_b64_tr_b16 v[52:53], v22 offset:20480
    v_mfma_f32_16x16x32_bf16 v[116:119], v[32:35], a[16:19], v[116:119]
    v_mfma_f32_16x16x32_bf16 v[116:119], v[36:39], a[20:23], v[116:119]
    ds_read_b64_tr_b16 v[54:55], v22 offset:20992
    v_cvt_pk_bf16_f32 v111, v174, v175
    v_mfma_f32_16x16x32_bf16 v[116:119], v[40:43], a[24:27], v[116:119]
    ds_read_b64_tr_b16 v[56:57], v22 offset:24576
    buffer_load_dwordx4 v24, s[16:19], s47 offen offset:1024 sc1 lds
    v_mfma_f32_16x16x32_bf16 v[116:119], v[44:47], a[28:31], v[116:119]
    ds_read_b64_tr_b16 v[58:59], v22 offset:25088
    v_mfma_f32_16x16x32_bf16 v[120:123], v[32:35], a[32:35], v[120:123]
    v_mfma_f32_16x16x32_bf16 v[120:123], v[36:39], a[36:39], v[120:123]
    ds_read_b64_tr_b16 v[60:61], v22 offset:28672
    v_mfma_f32_16x16x32_bf16 v[120:123], v[40:43], a[40:43], v[120:123]
    ds_read_b64_tr_b16 v[62:63], v22 offset:29184
    buffer_load_dwordx4 v24, s[16:19], s47 offen offset:2048 sc1 lds
    v_cvt_pk_bf16_f32 v96, v96, v97
    v_mfma_f32_16x16x32_bf16 v[120:123], v[44:47], a[44:47], v[120:123]
    v_mfma_f32_16x16x32_bf16 v[124:127], v[32:35], a[48:51], v[124:127]
    v_mfma_f32_16x16x32_bf16 v[124:127], v[36:39], a[52:55], v[124:127]
    v_mfma_f32_16x16x32_bf16 v[124:127], v[40:43], a[56:59], v[124:127]
    buffer_load_dwordx4 v24, s[16:19], s47 offen offset:3072 sc1 lds
    v_cvt_pk_bf16_f32 v97, v98, v99
    v_mfma_f32_16x16x32_bf16 v[124:127], v[44:47], a[60:63], v[124:127]
    s_lshl_b32 s47, s28, 12
    s_waitcnt lgkmcnt(4)
    v_mfma_f32_16x16x32_bf16 v[112:115], v[48:51], a[64:67], v[112:115]
    s_add_u32 m0, s47, 32768
    v_mfma_f32_16x16x32_bf16 v[112:115], v[52:55], a[68:71], v[112:115]
    ds_read_b64_tr_b16 v[32:33], v15 offset:49152
    s_mov_b32 s47, 32768
    s_waitcnt lgkmcnt(1)
    v_mfma_f32_16x16x32_bf16 v[112:115], v[56:59], a[72:75], v[112:115]
    ds_read_b64_tr_b16 v[34:35], v15 offset:49664
    buffer_load_dwordx4 v24, s[16:19], s47 offen offset:0 sc1 lds
    v_cvt_pk_bf16_f32 v98, v160, v161
    v_mfma_f32_16x16x32_bf16 v[112:115], v[60:63], a[76:79], v[112:115]
    ds_read_b64_tr_b16 v[36:37], v15 offset:53248
    v_mfma_f32_16x16x32_bf16 v[116:119], v[48:51], a[80:83], v[116:119]
    v_mfma_f32_16x16x32_bf16 v[116:119], v[52:55], a[84:87], v[116:119]
    ds_read_b64_tr_b16 v[38:39], v15 offset:53760
    v_mfma_f32_16x16x32_bf16 v[116:119], v[56:59], a[88:91], v[116:119]
    ds_read_b64_tr_b16 v[40:41], v15 offset:57344
    buffer_load_dwordx4 v24, s[16:19], s47 offen offset:1024 sc1 lds
    v_cvt_pk_bf16_f32 v99, v162, v163
    v_mfma_f32_16x16x32_bf16 v[116:119], v[60:63], a[92:95], v[116:119]
    ds_read_b64_tr_b16 v[42:43], v15 offset:57856
    v_mfma_f32_16x16x32_bf16 v[120:123], v[48:51], a[96:99], v[120:123]
    v_mfma_f32_16x16x32_bf16 v[120:123], v[52:55], a[100:103], v[120:123]
    ds_read_b64_tr_b16 v[44:45], v15 offset:61440
    v_mfma_f32_16x16x32_bf16 v[120:123], v[56:59], a[104:107], v[120:123]
    ds_read_b64_tr_b16 v[46:47], v15 offset:61952
    buffer_load_dwordx4 v24, s[16:19], s47 offen offset:2048 sc1 lds
    v_mfma_f32_16x16x32_bf16 v[120:123], v[60:63], a[108:111], v[120:123]
    v_cvt_pk_bf16_f32 v100, v100, v101
    v_mfma_f32_16x16x32_bf16 v[124:127], v[48:51], a[112:115], v[124:127]
    v_mfma_f32_16x16x32_bf16 v[124:127], v[52:55], a[116:119], v[124:127]
    v_mfma_f32_16x16x32_bf16 v[124:127], v[56:59], a[120:123], v[124:127]
    buffer_load_dwordx4 v24, s[16:19], s47 offen offset:3072 sc1 lds
    v_mfma_f32_16x16x32_bf16 v[124:127], v[60:63], a[124:127], v[124:127]
    s_lshl_b32 s47, s28, 12
    v_cvt_pk_bf16_f32 v101, v102, v103
    s_waitcnt lgkmcnt(4)
    v_mfma_f32_16x16x32_bf16 v[176:179], v[32:35], a[128:131], 0
    s_add_u32 m0, s47, 81920
    v_mfma_f32_16x16x32_bf16 v[176:179], v[36:39], a[132:135], v[176:179]
    ds_read_b64_tr_b16 v[48:49], v19 offset:49152
    s_mov_b32 s47, 16384
    s_waitcnt lgkmcnt(1)
    v_mfma_f32_16x16x32_bf16 v[176:179], v[40:43], a[136:139], v[176:179]
    ds_read_b64_tr_b16 v[50:51], v19 offset:49664
    buffer_load_dwordx4 v24, s[20:23], s47 offen offset:0 sc1 lds
    v_mfma_f32_16x16x32_bf16 v[176:179], v[44:47], a[140:143], v[176:179]
    ds_read_b64_tr_b16 v[52:53], v19 offset:53248
    v_cvt_pk_bf16_f32 v102, v164, v165
    v_mfma_f32_16x16x32_bf16 v[180:183], v[32:35], a[144:147], 0
    v_mfma_f32_16x16x32_bf16 v[180:183], v[36:39], a[148:151], v[180:183]
    ds_read_b64_tr_b16 v[54:55], v19 offset:53760
    v_mfma_f32_16x16x32_bf16 v[180:183], v[40:43], a[152:155], v[180:183]
    ds_read_b64_tr_b16 v[56:57], v19 offset:57344
    buffer_load_dwordx4 v24, s[20:23], s47 offen offset:1024 sc1 lds
    v_mfma_f32_16x16x32_bf16 v[180:183], v[44:47], a[156:159], v[180:183]
    ds_read_b64_tr_b16 v[58:59], v19 offset:57856
    v_cvt_pk_bf16_f32 v103, v166, v167
    v_mfma_f32_16x16x32_bf16 v[184:187], v[32:35], a[160:163], 0
    v_mfma_f32_16x16x32_bf16 v[184:187], v[36:39], a[164:167], v[184:187]
    ds_read_b64_tr_b16 v[60:61], v19 offset:61440
    v_mfma_f32_16x16x32_bf16 v[184:187], v[40:43], a[168:171], v[184:187]
    ds_read_b64_tr_b16 v[62:63], v19 offset:61952
    buffer_load_dwordx4 v24, s[20:23], s47 offen offset:2048 sc1 lds
    v_mfma_f32_16x16x32_bf16 v[184:187], v[44:47], a[172:175], v[184:187]
    v_mfma_f32_16x16x32_bf16 v[188:191], v[32:35], a[176:179], 0
    v_mfma_f32_16x16x32_bf16 v[188:191], v[36:39], a[180:183], v[188:191]
    v_mfma_f32_16x16x32_bf16 v[188:191], v[40:43], a[184:187], v[188:191]
    buffer_load_dwordx4 v24, s[20:23], s47 offen offset:3072 sc1 lds
    v_mfma_f32_16x16x32_bf16 v[188:191], v[44:47], a[188:191], v[188:191]
    s_lshl_b32 s47, s28, 12
    s_waitcnt lgkmcnt(4)
    v_mfma_f32_16x16x32_bf16 v[176:179], v[48:51], a[192:195], v[176:179]
    s_add_u32 m0, s47, 98304
    v_mfma_f32_16x16x32_bf16 v[176:179], v[52:55], a[196:199], v[176:179]
    ds_read_b64_tr_b16 v[32:33], v23 offset:0
    s_mov_b32 s47, 32768
    s_waitcnt lgkmcnt(1)
    s_waitcnt vmcnt(16) lgkmcnt(0)
    s_barrier
    v_mfma_f32_16x16x32_bf16 v[176:179], v[56:59], a[200:203], v[176:179]
    ds_read_b64_tr_b16 v[34:35], v23 offset:512
    buffer_load_dwordx4 v24, s[20:23], s47 offen offset:0 sc1 lds
    v_mfma_f32_16x16x32_bf16 v[176:179], v[60:63], a[204:207], v[176:179]
    ds_read_b64_tr_b16 v[36:37], v23 offset:4096
    v_mfma_f32_16x16x32_bf16 v[180:183], v[48:51], a[208:211], v[180:183]
    ds_read_b128 a[128:131], v3 offset:0
    v_mfma_f32_16x16x32_bf16 v[180:183], v[52:55], a[212:215], v[180:183]
    ds_read_b64_tr_b16 v[38:39], v23 offset:4608
    ds_write_b128 v5, v[72:75] offset:0
    v_mfma_f32_16x16x32_bf16 v[180:183], v[56:59], a[216:219], v[180:183]
    ds_read_b64_tr_b16 v[40:41], v23 offset:8192
    buffer_load_dwordx4 v24, s[20:23], s47 offen offset:1024 sc1 lds
    ds_read_b128 a[132:135], v3 offset:1024
    v_mfma_f32_16x16x32_bf16 v[180:183], v[60:63], a[220:223], v[180:183]
    ds_read_b64_tr_b16 v[42:43], v23 offset:8704
    v_mfma_f32_16x16x32_bf16 v[184:187], v[48:51], a[224:227], v[184:187]
    ds_read_b128 a[136:139], v3 offset:2048
    v_mfma_f32_16x16x32_bf16 v[184:187], v[52:55], a[228:231], v[184:187]
    ds_read_b64_tr_b16 v[44:45], v23 offset:12288
    ds_write_b128 v5, v[76:79] offset:1024
    v_mfma_f32_16x16x32_bf16 v[184:187], v[56:59], a[232:235], v[184:187]
    ds_read_b64_tr_b16 v[46:47], v23 offset:12800
    buffer_load_dwordx4 v24, s[20:23], s47 offen offset:2048 sc1 lds
    ds_read_b128 a[140:143], v3 offset:3072
    v_mfma_f32_16x16x32_bf16 v[184:187], v[60:63], a[236:239], v[184:187]
    v_mfma_f32_16x16x32_bf16 v[188:191], v[48:51], a[240:243], v[188:191]
    ds_read_b128 a[144:147], v3 offset:4096
    v_mfma_f32_16x16x32_bf16 v[188:191], v[52:55], a[244:247], v[188:191]
    ds_write_b128 v5, v[88:91] offset:2048
    v_mfma_f32_16x16x32_bf16 v[188:191], v[56:59], a[248:251], v[188:191]
    buffer_load_dwordx4 v24, s[20:23], s47 offen offset:3072 sc1 lds
    ds_read_b128 a[148:151], v3 offset:5120
    v_mfma_f32_16x16x32_bf16 v[188:191], v[60:63], a[252:255], v[188:191]
    s_waitcnt lgkmcnt(12)
    v_mfma_f32_16x16x32_bf16 v[176:179], v[32:35], a[0:3], v[176:179]
    ds_read_b128 a[152:155], v3 offset:6144
    v_mfma_f32_16x16x32_bf16 v[176:179], v[36:39], a[4:7], v[176:179]
    ds_read_b64_tr_b16 v[48:49], v23 offset:16384
    ds_write_b128 v5, v[92:95] offset:3072
    s_waitcnt lgkmcnt(7)
    v_mfma_f32_16x16x32_bf16 v[176:179], v[40:43], a[8:11], v[176:179]
    ds_read_b64_tr_b16 v[50:51], v23 offset:16896
    ds_read_b128 a[156:159], v3 offset:7168
    v_mfma_f32_16x16x32_bf16 v[176:179], v[44:47], a[12:15], v[176:179]
    ds_read_b64_tr_b16 v[52:53], v23 offset:20480
    v_mfma_f32_16x16x32_bf16 v[180:183], v[32:35], a[16:19], v[180:183]
    ds_read_b128 a[160:163], v3 offset:8192
    v_mfma_f32_16x16x32_bf16 v[180:183], v[36:39], a[20:23], v[180:183]
    ds_read_b64_tr_b16 v[54:55], v23 offset:20992
    ds_write_b128 v5, v[104:107] offset:4096
    v_mfma_f32_16x16x32_bf16 v[180:183], v[40:43], a[24:27], v[180:183]
    ds_read_b64_tr_b16 v[56:57], v23 offset:24576
    ds_read_b128 a[164:167], v3 offset:9216
    v_mfma_f32_16x16x32_bf16 v[180:183], v[44:47], a[28:31], v[180:183]
    ds_read_b64_tr_b16 v[58:59], v23 offset:25088
    v_mfma_f32_16x16x32_bf16 v[184:187], v[32:35], a[32:35], v[184:187]
    ds_read_b128 a[168:171], v3 offset:10240
    v_mfma_f32_16x16x32_bf16 v[184:187], v[36:39], a[36:39], v[184:187]
    ds_read_b64_tr_b16 v[60:61], v23 offset:28672
    ds_write_b128 v5, v[108:111] offset:5120
    v_mfma_f32_16x16x32_bf16 v[184:187], v[40:43], a[40:43], v[184:187]
    ds_read_b64_tr_b16 v[62:63], v23 offset:29184
    ds_read_b128 a[172:175], v3 offset:11264
    v_mfma_f32_16x16x32_bf16 v[184:187], v[44:47], a[44:47], v[184:187]
    v_mfma_f32_16x16x32_bf16 v[188:191], v[32:35], a[48:51], v[188:191]
    ds_read_b128 a[176:179], v3 offset:12288
    v_mfma_f32_16x16x32_bf16 v[188:191], v[36:39], a[52:55], v[188:191]
    v_mfma_f32_16x16x32_bf16 v[188:191], v[40:43], a[56:59], v[188:191]
    ds_read_b128 a[180:183], v3 offset:13312
    v_mfma_f32_16x16x32_bf16 v[188:191], v[44:47], a[60:63], v[188:191]
    s_waitcnt lgkmcnt(11)
    v_mfma_f32_16x16x32_bf16 v[176:179], v[48:51], a[64:67], v[176:179]
    ds_read_b128 a[184:187], v3 offset:14336
    v_mfma_f32_16x16x32_bf16 v[176:179], v[52:55], a[68:71], v[176:179]
    s_waitcnt lgkmcnt(4)
    v_mfma_f32_16x16x32_bf16 v[176:179], v[56:59], a[72:75], v[176:179]
    ds_read_b128 a[188:191], v3 offset:15360
    v_mfma_f32_16x16x32_bf16 v[176:179], v[60:63], a[76:79], v[176:179]
    v_mfma_f32_16x16x32_bf16 v[180:183], v[48:51], a[80:83], v[180:183]
    v_mfma_f32_16x16x32_bf16 v[180:183], v[52:55], a[84:87], v[180:183]
    v_mfma_f32_16x16x32_bf16 v[180:183], v[56:59], a[88:91], v[180:183]
    v_mfma_f32_16x16x32_bf16 v[180:183], v[60:63], a[92:95], v[180:183]
    v_mfma_f32_16x16x32_bf16 v[184:187], v[48:51], a[96:99], v[184:187]
    v_mfma_f32_16x16x32_bf16 v[184:187], v[52:55], a[100:103], v[184:187]
    v_mfma_f32_16x16x32_bf16 v[184:187], v[56:59], a[104:107], v[184:187]
    v_mfma_f32_16x16x32_bf16 v[184:187], v[60:63], a[108:111], v[184:187]
    v_mfma_f32_16x16x32_bf16 v[188:191], v[48:51], a[112:115], v[188:191]
    v_mfma_f32_16x16x32_bf16 v[188:191], v[52:55], a[116:119], v[188:191]
    v_mfma_f32_16x16x32_bf16 v[188:191], v[56:59], a[120:123], v[188:191]
    v_mfma_f32_16x16x32_bf16 v[188:191], v[60:63], a[124:127], v[188:191]
    v_cvt_pk_bf16_f32 v120, v120, v121
    v_cvt_pk_bf16_f32 v121, v122, v123
    s_nop 1
    v_cvt_pk_bf16_f32 v122, v184, v185
    v_cvt_pk_bf16_f32 v123, v186, v187
    v_cvt_pk_bf16_f32 v124, v124, v125
    v_cvt_pk_bf16_f32 v125, v126, v127
    v_cvt_pk_bf16_f32 v126, v188, v189
    v_cvt_pk_bf16_f32 v127, v190, v191
    ds_write_b128 v5, v[120:123] offset:6144
    ds_write_b128 v5, v[124:127] offset:7168
    v_cvt_pk_bf16_f32 v112, v112, v113
    v_cvt_pk_bf16_f32 v113, v114, v115
    v_cvt_pk_bf16_f32 v114, v176, v177
    v_cvt_pk_bf16_f32 v115, v178, v179
    v_cvt_pk_bf16_f32 v116, v116, v117
    v_cvt_pk_bf16_f32 v117, v118, v119
    v_cvt_pk_bf16_f32 v118, v180, v181
    v_cvt_pk_bf16_f32 v119, v182, v183
    v_mfma_f32_16x16x32_bf16 v[128:131], a[128:131], v[64:67], 0
    v_mov_b32 v20, 0
    v_mov_b32 v21, 0
    v_mfma_f32_16x16x32_bf16 v[128:131], a[132:135], v[80:83], v[128:131]
    v_mov_b32 v22, 0
    v_mov_b32 v23, 0
    v_mfma_f32_16x16x32_bf16 v[128:131], a[136:139], v[96:99], v[128:131]
    v_mov_b32 v248, 0
    v_mov_b32 v249, 0
    v_mfma_f32_16x16x32_bf16 v[128:131], a[140:143], v[112:115], v[128:131]
    v_mov_b32 v250, 0
    v_mov_b32 v251, 0
    v_mfma_f32_16x16x32_bf16 v[132:135], a[128:131], v[68:71], 0
    s_mov_b32 s52, 49152
    s_lshl_b32 s58, s30, 1
    v_mfma_f32_16x16x32_bf16 v[132:135], a[132:135], v[84:87], v[132:135]
    s_sub_u32 s58, s58, 1
    v_xor_b32 v5, 0x2000, v5
    v_mfma_f32_16x16x32_bf16 v[132:135], a[136:139], v[100:103], v[132:135]
    v_mfma_f32_16x16x32_bf16 v[132:135], a[140:143], v[116:119], v[132:135]
    s_waitcnt lgkmcnt(0)
    s_barrier
    v_mfma_f32_16x16x32_bf16 v[160:163], a[128:131], v[72:75], 0
    ds_read_b128 v[192:195], v5 offset:0
    ds_read_b128 v[196:199], v5 offset:1024
    v_mfma_f32_16x16x32_bf16 v[160:163], a[132:135], v[88:91], v[160:163]
    ds_read_b128 v[200:203], v5 offset:2048
    ds_read_b128 v[204:207], v5 offset:3072
    v_mfma_f32_16x16x32_bf16 v[160:163], a[136:139], v[104:107], v[160:163]
    ds_read_b128 v[208:211], v5 offset:4096
    ds_read_b128 v[212:215], v5 offset:5120
    v_mfma_f32_16x16x32_bf16 v[160:163], a[140:143], v[120:123], v[160:163]
    ds_read_b128 v[216:219], v5 offset:6144
    ds_read_b128 v[220:223], v5 offset:7168
    v_mfma_f32_16x16x32_bf16 v[164:167], a[128:131], v[76:79], 0
    v_add_u32 v29, s56, v27
    v_cmp_le_i32 vcc, 0, v29
    v_mfma_f32_16x16x32_bf16 v[164:167], a[132:135], v[92:95], v[164:167]
    v_cmp_le_i32 s[60:61], 1, v29
    v_cndmask_b32 v128, v28, v128, vcc
    v_mfma_f32_16x16x32_bf16 v[164:167], a[136:139], v[108:111], v[164:167]
    v_cndmask_b32 v129, v28, v129, s[60:61]
    v_cmp_le_i32 vcc, 2, v29
    v_mfma_f32_16x16x32_bf16 v[164:167], a[140:143], v[124:127], v[164:167]
    v_cmp_le_i32 s[60:61], 3, v29
    v_cndmask_b32 v130, v28, v130, vcc
    s_nop 0
    v_cndmask_b32 v131, v28, v131, s[60:61]
    v_cmp_le_i32 vcc, -16, v29
    v_cmp_le_i32 s[60:61], -15, v29
    s_nop 0
    v_cndmask_b32 v132, v28, v132, vcc
    v_cndmask_b32 v133, v28, v133, s[60:61]
    v_cmp_le_i32 vcc, -14, v29
    v_cmp_le_i32 s[60:61], -13, v29
    s_nop 0
    v_cndmask_b32 v134, v28, v134, vcc
    v_cndmask_b32 v135, v28, v135, s[60:61]
    v_max3_f32 v252, v128, v129, v130
    v_max3_f32 v253, v132, v133, v134
    v_max_f32 v252, v252, v131
    v_max_f32 v253, v253, v135
    v_mov_b32 v29, v252
    v_mov_b32 v30, v253
    s_nop 0
    v_permlane16_swap_b32 v29, v252
    v_permlane16_swap_b32 v30, v253
    v_max_f32 v252, v252, v29
    v_max_f32 v253, v253, v30
    v_mov_b32 v29, v252
    v_mov_b32 v30, v253
    s_nop 0
    v_permlane32_swap_b32 v29, v252
    v_permlane32_swap_b32 v30, v253
    v_max_f32 v252, v252, v29
    v_max_f32 v253, v253, v30
    v_max_f32 v252, 0xf149f2ca, v252
    v_max_f32 v253, 0xf149f2ca, v253
    v_sub_f32 v224, 0, v252
    v_sub_f32 v228, 0, v253
    v_sub_f32 v225, 0, v252
    v_sub_f32 v229, 0, v253
    v_sub_f32 v226, 0, v252
    v_sub_f32 v230, 0, v253
    v_sub_f32 v227, 0, v252
    v_sub_f32 v231, 0, v253
    s_waitcnt lgkmcnt(0)
    v_mfma_f32_16x16x32_bf16 v[128:131], a[128:131], v[64:67], v[224:227]
    v_mfma_f32_16x16x32_bf16 v[128:131], a[132:135], v[80:83], v[128:131]
    v_mfma_f32_16x16x32_bf16 v[128:131], a[136:139], v[96:99], v[128:131]
    v_mfma_f32_16x16x32_bf16 v[128:131], a[140:143], v[112:115], v[128:131]
    s_waitcnt vmcnt(12) lgkmcnt(0)
    s_barrier
    v_mfma_f32_16x16x32_bf16 v[132:135], a[128:131], v[68:71], v[228:231]
    v_max3_f32 v254, v160, v161, v162
    v_max3_f32 v255, v164, v165, v166
    v_mfma_f32_16x16x32_bf16 v[132:135], a[132:135], v[84:87], v[132:135]
    v_max_f32 v254, v254, v163
    v_max_f32 v255, v255, v167
    v_add_u32 v26, s54, v4
    v_mfma_f32_16x16x32_bf16 v[132:135], a[136:139], v[100:103], v[132:135]
    v_mov_b32 v29, v254
    v_mov_b32 v30, v255
    v_mfma_f32_16x16x32_bf16 v[132:135], a[140:143], v[116:119], v[132:135]
    v_permlane16_swap_b32 v29, v254
    v_permlane16_swap_b32 v30, v255
    v_add_u32 v25, s53, v3
    v_mfma_f32_16x16x32_bf16 v[136:139], a[144:147], v[64:67], v[224:227]
    v_max_f32 v254, v254, v29
    v_max_f32 v255, v255, v30
    v_mfma_f32_16x16x32_bf16 v[136:139], a[148:151], v[80:83], v[136:139]
    v_mov_b32 v29, v254
    v_mov_b32 v30, v255
    s_mov_b32 m0, s50
    v_mfma_f32_16x16x32_bf16 v[136:139], a[152:155], v[96:99], v[136:139]
    v_permlane32_swap_b32 v29, v254
    v_permlane32_swap_b32 v30, v255
    v_mfma_f32_16x16x32_bf16 v[136:139], a[156:159], v[112:115], v[136:139]
    v_max_f32 v254, v254, v29
    v_max_f32 v255, v255, v30
    buffer_load_dwordx4 v24, s[16:19], s52 offen offset:0 sc1 lds
    v_mfma_f32_16x16x32_bf16 v[140:143], a[144:147], v[68:71], v[228:231]
    v_max_f32 v254, 0xf149f2ca, v254
    v_max_f32 v255, 0xf149f2ca, v255
    v_mfma_f32_16x16x32_bf16 v[140:143], a[148:151], v[84:87], v[140:143]
    v_sub_f32 v232, 0, v254
    v_sub_f32 v236, 0, v255
    s_add_u32 s53, s53, 16384
    v_mfma_f32_16x16x32_bf16 v[140:143], a[152:155], v[100:103], v[140:143]
    v_sub_f32 v233, 0, v254
    v_sub_f32 v237, 0, v255
    v_mfma_f32_16x16x32_bf16 v[140:143], a[156:159], v[116:119], v[140:143]
    v_sub_f32 v234, 0, v254
    v_sub_f32 v238, 0, v255
    s_and_b32 s53, s53, 0xffff
    s_add_u32 s54, s54, 16384
    v_mfma_f32_16x16x32_bf16 v[144:147], a[160:163], v[64:67], v[224:227]
    v_sub_f32 v235, 0, v254
    v_sub_f32 v239, 0, v255
    v_mfma_f32_16x16x32_bf16 v[144:147], a[164:167], v[80:83], v[144:147]
    buffer_load_dword v6, v3, s[12:15], s24 offen offset:0
    buffer_load_dword v6, v3, s[12:15], s24 offen offset:1024
    s_sub_u32 s46, s54, 98304
    v_mfma_f32_16x16x32_bf16 v[144:147], a[168:171], v[96:99], v[144:147]
    buffer_load_dword v6, v3, s[12:15], s24 offen offset:2048
    v_mfma_f32_16x16x32_bf16 v[144:147], a[172:175], v[112:115], v[144:147]
    s_min_u32 s54, s54, s46
    v_mfma_f32_16x16x32_bf16 v[148:151], a[160:163], v[68:71], v[228:231]
    v_mfma_f32_16x16x32_bf16 v[148:151], a[164:167], v[84:87], v[148:151]
    v_mfma_f32_16x16x32_bf16 v[148:151], a[168:171], v[100:103], v[148:151]
    v_mfma_f32_16x16x32_bf16 v[148:151], a[172:175], v[116:119], v[148:151]
    buffer_load_dwordx4 v24, s[16:19], s52 offen offset:1024 sc1 lds
    s_cmp_le_i32 s56, 0
    s_cbranch_scc1 PB_mka0
PB_mka0_r:
    v_exp_f32 v240, v128
    v_mfma_f32_16x16x32_bf16 v[152:155], a[176:179], v[64:67], v[224:227]
    v_exp_f32 v241, v129
    v_mfma_f32_16x16x32_bf16 v[152:155], a[180:183], v[80:83], v[152:155]
    v_cvt_pk_bf16_f32 v32, v240, v241
    v_mfma_f32_16x16x32_bf16 v[152:155], a[184:187], v[96:99], v[152:155]
    v_exp_f32 v242, v130
    v_mfma_f32_16x16x32_bf16 v[152:155], a[188:191], v[112:115], v[152:155]
    v_mfma_f32_16x16x32_bf16 v[156:159], a[176:179], v[68:71], v[228:231]
    v_exp_f32 v243, v131
    v_mfma_f32_16x16x32_bf16 v[156:159], a[180:183], v[84:87], v[156:159]
    v_cvt_pk_bf16_f32 v33, v242, v243
    v_mfma_f32_16x16x32_bf16 v[156:159], a[184:187], v[100:103], v[156:159]
    v_exp_f32 v240, v132
    v_mfma_f32_16x16x32_bf16 v[156:159], a[188:191], v[116:119], v[156:159]
    v_exp_f32 v241, v133
    s_nop 0
    v_cvt_pk_bf16_f32 v40, v240, v241
    v_mfma_f32_32x32x16_bf16 a[0:15], v[20:23], v[20:23], 0
    v_exp_f32 v242, v134
    buffer_load_dwordx4 v24, s[16:19], s52 offen offset:2048 sc1 lds
    v_exp_f32 v243, v135
    s_nop 0
    v_cvt_pk_bf16_f32 v41, v242, v243
    v_mfma_f32_32x32x16_bf16 a[16:31], v[20:23], v[20:23], 0
    v_exp_f32 v240, v136
    ds_read_b128 a[192:195], v26 offset:0
    ds_read_b128 a[196:199], v26 offset:1024
    v_exp_f32 v241, v137
    ds_read_b128 a[200:203], v26 offset:2048
    v_cvt_pk_bf16_f32 v34, v240, v241
    v_mfma_f32_32x32x16_bf16 a[32:47], v[20:23], v[20:23], 0
    v_exp_f32 v242, v138
    ds_read_b128 a[204:207], v26 offset:3072
    v_exp_f32 v243, v139
    ds_read_b128 a[208:211], v26 offset:4096
    v_cvt_pk_bf16_f32 v35, v242, v243
    v_mfma_f32_32x32x16_bf16 a[48:63], v[20:23], v[20:23], 0
    v_exp_f32 v240, v140
    ds_read_b128 a[212:215], v26 offset:5120
    v_exp_f32 v241, v141
    ds_read_b128 a[216:219], v26 offset:6144
    v_cvt_pk_bf16_f32 v42, v240, v241
    v_mfma_f32_32x32x16_bf16 a[64:79], v[20:23], v[20:23], 0
    v_exp_f32 v242, v142
    buffer_load_dwordx4 v24, s[16:19], s52 offen offset:3072 sc1 lds
    v_exp_f32 v243, v143
    s_cmp_le_i32 s56, 32
    s_cbranch_scc1 PB_mka1
PB_mka1_r:
    v_cvt_pk_bf16_f32 v43, v242, v243
    v_mfma_f32_32x32x16_bf16 a[80:95], v[20:23], v[20:23], 0
    v_exp_f32 v240, v144
    buffer_load_dword v5, v3, s[8:11], s26 offen
    v_exp_f32 v241, v145
    s_add_u32 s26, s26, 1024
    v_cvt_pk_bf16_f32 v36, v240, v241
    v_mfma_f32_32x32x16_bf16 a[96:111], v[20:23], v[20:23], 0
    v_exp_f32 v242, v146
    s_add_u32 s50, s50, 16384
    s_and_b32 s50, s50, 0xffff
    v_exp_f32 v243, v147
    s_add_u32 m0, s51, 0x10000
    v_cvt_pk_bf16_f32 v37, v242, v243
    v_mfma_f32_32x32x16_bf16 a[112:127], v[20:23], v[20:23], 0
    v_exp_f32 v240, v148
    buffer_load_dwordx4 v24, s[20:23], s52 offen offset:0 sc1 lds
    s_lshl_b32 s56, s28, 5
    s_cmp_eq_u32 s30, 0
    s_cbranch_scc1 K2_DM_MID
    s_branch K2_D_MID
PR_mka0:
    s_cmp_lg_u32 s56, 0
    s_cbranch_scc1 PR_mka0_all
    v_cndmask_b32 v128, v28, v128, s[62:63]
    v_cndmask_b32 v129, v28, v129, s[64:65]
    v_cndmask_b32 v130, v28, v130, s[66:67]
    v_cndmask_b32 v131, v28, v131, s[68:69]
    v_mov_b32 v136, v28
    v_mov_b32 v137, v28
    v_mov_b32 v138, v28
    v_mov_b32 v139, v28
    v_cndmask_b32 v140, v28, v140, s[62:63]
    v_cndmask_b32 v141, v28, v141, s[64:65]
    v_cndmask_b32 v142, v28, v142, s[66:67]
    v_cndmask_b32 v143, v28, v143, s[68:69]
    s_branch PR_mka0_r
PR_mka0_all:
    v_mov_b32 v128, v28
    v_mov_b32 v129, v28
    v_mov_b32 v130, v28
    v_mov_b32 v131, v28
    v_mov_b32 v132, v28
    v_mov_b32 v133, v28
    v_mov_b32 v134, v28
    v_mov_b32 v135, v28
    v_mov_b32 v136, v28
    v_mov_b32 v137, v28
    v_mov_b32 v138, v28
    v_mov_b32 v139, v28
    v_mov_b32 v140, v28
    v_mov_b32 v141, v28
    v_mov_b32 v142, v28
    v_mov_b32 v143, v28
    s_branch PR_mka0_r
PR_mka1:
    s_cmp_lg_u32 s56, 32
    s_cbranch_scc1 PR_mka1_all
    v_cndmask_b32 v144, v28, v144, s[62:63]
    v_cndmask_b32 v145, v28, v145, s[64:65]
    v_cndmask_b32 v146, v28, v146, s[66:67]
    v_cndmask_b32 v147, v28, v147, s[68:69]
    v_mov_b32 v152, v28
    v_mov_b32 v153, v28
    v_mov_b32 v154, v28
    v_mov_b32 v155, v28
    v_cndmask_b32 v156, v28, v156, s[62:63]
    v_cndmask_b32 v157, v28, v157, s[64:65]
    v_cndmask_b32 v158, v28, v158, s[66:67]
    v_cndmask_b32 v159, v28, v159, s[68:69]
    s_branch PR_mka1_r
PR_mka1_all:
    v_mov_b32 v144, v28
    v_mov_b32 v145, v28
    v_mov_b32 v146, v28
    v_mov_b32 v147, v28
    v_mov_b32 v148, v28
    v_mov_b32 v149, v28
    v_mov_b32 v150, v28
    v_mov_b32 v151, v28
    v_mov_b32 v152, v28
    v_mov_b32 v153, v28
    v_mov_b32 v154, v28
    v_mov_b32 v155, v28
    v_mov_b32 v156, v28
    v_mov_b32 v157, v28
    v_mov_b32 v158, v28
    v_mov_b32 v159, v28
    s_branch PR_mka1_r
PB_mka0:
    s_cmp_lg_u32 s56, 0
    s_cbranch_scc1 PB_mka0_all
    v_cndmask_b32 v128, v28, v128, s[62:63]
    v_cndmask_b32 v129, v28, v129, s[64:65]
    v_cndmask_b32 v130, v28, v130, s[66:67]
    v_cndmask_b32 v131, v28, v131, s[68:69]
    v_mov_b32 v136, v28
    v_mov_b32 v137, v28
    v_mov_b32 v138, v28
    v_mov_b32 v139, v28
    v_cndmask_b32 v140, v28, v140, s[62:63]
    v_cndmask_b32 v141, v28, v141, s[64:65]
    v_cndmask_b32 v142, v28, v142, s[66:67]
    v_cndmask_b32 v143, v28, v143, s[68:69]
    s_branch PB_mka0_r
PB_mka0_all:
    v_mov_b32 v128, v28
    v_mov_b32 v129, v28
    v_mov_b32 v130, v28
    v_mov_b32 v131, v28
    v_mov_b32 v132, v28
    v_mov_b32 v133, v28
    v_mov_b32 v134, v28
    v_mov_b32 v135, v28
    v_mov_b32 v136, v28
    v_mov_b32 v137, v28
    v_mov_b32 v138, v28
    v_mov_b32 v139, v28
    v_mov_b32 v140, v28
    v_mov_b32 v141, v28
    v_mov_b32 v142, v28
    v_mov_b32 v143, v28
    s_branch PB_mka0_r
PB_mka1:
    s_cmp_lg_u32 s56, 32
    s_cbranch_scc1 PB_mka1_all
    v_cndmask_b32 v144, v28, v144, s[62:63]
    v_cndmask_b32 v145, v28, v145, s[64:65]
    v_cndmask_b32 v146, v28, v146, s[66:67]
    v_cndmask_b32 v147, v28, v147, s[68:69]
    v_mov_b32 v152, v28
    v_mov_b32 v153, v28
    v_mov_b32 v154, v28
    v_mov_b32 v155, v28
    v_cndmask_b32 v156, v28, v156, s[62:63]
    v_cndmask_b32 v157, v28, v157, s[64:65]
    v_cndmask_b32 v158, v28, v158, s[66:67]
    v_cndmask_b32 v159, v28, v159, s[68:69]
    s_branch PB_mka1_r
PB_mka1_all:
    v_mov_b32 v144, v28
    v_mov_b32 v145, v28
    v_mov_b32 v146, v28
    v_mov_b32 v147, v28
    v_mov_b32 v148, v28
    v_mov_b32 v149, v28
    v_mov_b32 v150, v28
    v_mov_b32 v151, v28
    v_mov_b32 v152, v28
    v_mov_b32 v153, v28
    v_mov_b32 v154, v28
    v_mov_b32 v155, v28
    v_mov_b32 v156, v28
    v_mov_b32 v157, v28
    v_mov_b32 v158, v28
    v_mov_b32 v159, v28
    s_branch PB_mka1_r
D_rda:
    s_call_b64 s[60:61], K2_REDO_a
    s_branch D_rda_r
D_rdb:
    s_call_b64 s[60:61], K2_REDO_b
    s_branch D_rdb_r
Dm_mka0:
    s_cmp_lg_u32 s56, 0
    s_cbranch_scc1 Dm_mka0_all
    v_cndmask_b32 v128, v28, v128, s[62:63]
    v_cndmask_b32 v129, v28, v129, s[64:65]
    v_cndmask_b32 v130, v28, v130, s[66:67]
    v_cndmask_b32 v131, v28, v131, s[68:69]
    v_mov_b32 v136, v28
    v_mov_b32 v137, v28
    v_mov_b32 v138, v28
    v_mov_b32 v139, v28
    v_cndmask_b32 v140, v28, v140, s[62:63]
    v_cndmask_b32 v141, v28, v141, s[64:65]
    v_cndmask_b32 v142, v28, v142, s[66:67]
    v_cndmask_b32 v143, v28, v143, s[68:69]
    s_branch Dm_mka0_r
Dm_mka0_all:
    v_mov_b32 v128, v28
    v_mov_b32 v129, v28
    v_mov_b32 v130, v28
    v_mov_b32 v131, v28
    v_mov_b32 v132, v28
    v_mov_b32 v133, v28
    v_mov_b32 v134, v28
    v_mov_b32 v135, v28
    v_mov_b32 v136, v28
    v_mov_b32 v137, v28
    v_mov_b32 v138, v28
    v_mov_b32 v139, v28
    v_mov_b32 v140, v28
    v_mov_b32 v141, v28
    v_mov_b32 v142, v28
    v_mov_b32 v143, v28
    s_branch Dm_mka0_r
Dm_mka1:
    s_cmp_lg_u32 s56, 32
    s_cbranch_scc1 Dm_mka1_all
    v_cndmask_b32 v144, v28, v144, s[62:63]
    v_cndmask_b32 v145, v28, v145, s[64:65]
    v_cndmask_b32 v146, v28, v146, s[66:67]
    v_cndmask_b32 v147, v28, v147, s[68:69]
    v_mov_b32 v152, v28
    v_mov_b32 v153, v28
    v_mov_b32 v154, v28
    v_mov_b32 v155, v28
    v_cndmask_b32 v156, v28, v156, s[62:63]
    v_cndmask_b32 v157, v28, v157, s[64:65]
    v_cndmask_b32 v158, v28, v158, s[66:67]
    v_cndmask_b32 v159, v28, v159, s[68:69]
    s_branch Dm_mka1_r
Dm_mka1_all:
    v_mov_b32 v144, v28
    v_mov_b32 v145, v28
    v_mov_b32 v146, v28
    v_mov_b32 v147, v28
    v_mov_b32 v148, v28
    v_mov_b32 v149, v28
    v_mov_b32 v150, v28
    v_mov_b32 v151, v28
    v_mov_b32 v152, v28
    v_mov_b32 v153, v28
    v_mov_b32 v154, v28
    v_mov_b32 v155, v28
    v_mov_b32 v156, v28
    v_mov_b32 v157, v28
    v_mov_b32 v158, v28
    v_mov_b32 v159, v28
    s_branch Dm_mka1_r
Dm_rda:
    s_call_b64 s[60:61], K2_REDO_a
    s_branch Dm_rda_r
Dm_rdb:
    s_call_b64 s[60:61], K2_REDO_b
    s_branch Dm_rdb_r
S1_mka0:
    s_cmp_lg_u32 s56, 0
    s_cbranch_scc1 S1_mka0_all
    v_cndmask_b32 v128, v28, v128, s[62:63]
    v_cndmask_b32 v129, v28, v129, s[64:65]
    v_cndmask_b32 v130, v28, v130, s[66:67]
    v_cndmask_b32 v131, v28, v131, s[68:69]
    v_mov_b32 v136, v28
    v_mov_b32 v137, v28
    v_mov_b32 v138, v28
    v_mov_b32 v139, v28
    v_cndmask_b32 v140, v28, v140, s[62:63]
    v_cndmask_b32 v141, v28, v141, s[64:65]
    v_cndmask_b32 v142, v28, v142, s[66:67]
    v_cndmask_b32 v143, v28, v143, s[68:69]
    s_branch S1_mka0_r
S1_mka0_all:
    v_mov_b32 v128, v28
    v_mov_b32 v129, v28
    v_mov_b32 v130, v28
    v_mov_b32 v131, v28
    v_mov_b32 v132, v28
    v_mov_b32 v133, v28
    v_mov_b32 v134, v28
    v_mov_b32 v135, v28
    v_mov_b32 v136, v28
    v_mov_b32 v137, v28
    v_mov_b32 v138, v28
    v_mov_b32 v139, v28
    v_mov_b32 v140, v28
    v_mov_b32 v141, v28
    v_mov_b32 v142, v28
    v_mov_b32 v143, v28
    s_branch S1_mka0_r
S1_mka1:
    s_cmp_lg_u32 s56, 32
    s_cbranch_scc1 S1_mka1_all
    v_cndmask_b32 v144, v28, v144, s[62:63]
    v_cndmask_b32 v145, v28, v145, s[64:65]
    v_cndmask_b32 v146, v28, v146, s[66:67]
    v_cndmask_b32 v147, v28, v147, s[68:69]
    v_mov_b32 v152, v28
    v_mov_b32 v153, v28
    v_mov_b32 v154, v28
    v_mov_b32 v155, v28
    v_cndmask_b32 v156, v28, v156, s[62:63]
    v_cndmask_b32 v157, v28, v157, s[64:65]
    v_cndmask_b32 v158, v28, v158, s[66:67]
    v_cndmask_b32 v159, v28, v159, s[68:69]
    s_branch S1_mka1_r
S1_mka1_all:
    v_mov_b32 v144, v28
    v_mov_b32 v145, v28
    v_mov_b32 v146, v28
    v_mov_b32 v147, v28
    v_mov_b32 v148, v28
    v_mov_b32 v149, v28
    v_mov_b32 v150, v28
    v_mov_b32 v151, v28
    v_mov_b32 v152, v28
    v_mov_b32 v153, v28
    v_mov_b32 v154, v28
    v_mov_b32 v155, v28
    v_mov_b32 v156, v28
    v_mov_b32 v157, v28
    v_mov_b32 v158, v28
    v_mov_b32 v159, v28
    s_branch S1_mka1_r
S1_rda:
    s_call_b64 s[60:61], K2_REDO_a
    s_branch S1_rda_r
S1_rdb:
    s_call_b64 s[60:61], K2_REDO_b
    s_branch S1_rdb_r
S_rda:
    s_call_b64 s[60:61], K2_REDO_a
    s_branch S_rda_r
S_rdb:
    s_call_b64 s[60:61], K2_REDO_b
    s_branch S_rdb_r
Sf_mka0:
    s_cmp_lg_u32 s56, 0
    s_cbranch_scc1 Sf_mka0_all
    v_cndmask_b32 v128, v28, v128, s[62:63]
    v_cndmask_b32 v129, v28, v129, s[64:65]
    v_cndmask_b32 v130, v28, v130, s[66:67]
    v_cndmask_b32 v131, v28, v131, s[68:69]
    v_mov_b32 v136, v28
    v_mov_b32 v137, v28
    v_mov_b32 v138, v28
    v_mov_b32 v139, v28
    v_cndmask_b32 v140, v28, v140, s[62:63]
    v_cndmask_b32 v141, v28, v141, s[64:65]
    v_cndmask_b32 v142, v28, v142, s[66:67]
    v_cndmask_b32 v143, v28, v143, s[68:69]
    s_branch Sf_mka0_r
Sf_mka0_all:
    v_mov_b32 v128, v28
    v_mov_b32 v129, v28
    v_mov_b32 v130, v28
    v_mov_b32 v131, v28
    v_mov_b32 v132, v28
    v_mov_b32 v133, v28
    v_mov_b32 v134, v28
    v_mov_b32 v135, v28
    v_mov_b32 v136, v28
    v_mov_b32 v137, v28
    v_mov_b32 v138, v28
    v_mov_b32 v139, v28
    v_mov_b32 v140, v28
    v_mov_b32 v141, v28
    v_mov_b32 v142, v28
    v_mov_b32 v143, v28
    s_branch Sf_mka0_r
Sf_mka1:
    s_cmp_lg_u32 s56, 32
    s_cbranch_scc1 Sf_mka1_all
    v_cndmask_b32 v144, v28, v144, s[62:63]
    v_cndmask_b32 v145, v28, v145, s[64:65]
    v_cndmask_b32 v146, v28, v146, s[66:67]
    v_cndmask_b32 v147, v28, v147, s[68:69]
    v_mov_b32 v152, v28
    v_mov_b32 v153, v28
    v_mov_b32 v154, v28
    v_mov_b32 v155, v28
    v_cndmask_b32 v156, v28, v156, s[62:63]
    v_cndmask_b32 v157, v28, v157, s[64:65]
    v_cndmask_b32 v158, v28, v158, s[66:67]
    v_cndmask_b32 v159, v28, v159, s[68:69]
    s_branch Sf_mka1_r
Sf_mka1_all:
    v_mov_b32 v144, v28
    v_mov_b32 v145, v28
    v_mov_b32 v146, v28
    v_mov_b32 v147, v28
    v_mov_b32 v148, v28
    v_mov_b32 v149, v28
    v_mov_b32 v150, v28
    v_mov_b32 v151, v28
    v_mov_b32 v152, v28
    v_mov_b32 v153, v28
    v_mov_b32 v154, v28
    v_mov_b32 v155, v28
    v_mov_b32 v156, v28
    v_mov_b32 v157, v28
    v_mov_b32 v158, v28
    v_mov_b32 v159, v28
    s_branch Sf_mka1_r
Sf_rda:
    s_call_b64 s[60:61], K2_REDO_a
    s_branch Sf_rda_r
Sf_mkb0:
    s_cmp_lg_u32 s57, 0
    s_cbranch_scc1 Sf_mkb0_all
    v_cndmask_b32 v160, v28, v160, s[62:63]
    v_cndmask_b32 v161, v28, v161, s[64:65]
    v_cndmask_b32 v162, v28, v162, s[66:67]
    v_cndmask_b32 v163, v28, v163, s[68:69]
    v_mov_b32 v168, v28
    v_mov_b32 v169, v28
    v_mov_b32 v170, v28
    v_mov_b32 v171, v28
    v_cndmask_b32 v172, v28, v172, s[62:63]
    v_cndmask_b32 v173, v28, v173, s[64:65]
    v_cndmask_b32 v174, v28, v174, s[66:67]
    v_cndmask_b32 v175, v28, v175, s[68:69]
    s_branch Sf_mkb0_r
Sf_mkb0_all:
    v_mov_b32 v160, v28
    v_mov_b32 v161, v28
    v_mov_b32 v162, v28
    v_mov_b32 v163, v28
    v_mov_b32 v164, v28
    v_mov_b32 v165, v28
    v_mov_b32 v166, v28
    v_mov_b32 v167, v28
    v_mov_b32 v168, v28
    v_mov_b32 v169, v28
    v_mov_b32 v170, v28
    v_mov_b32 v171, v28
    v_mov_b32 v172, v28
    v_mov_b32 v173, v28
    v_mov_b32 v174, v28
    v_mov_b32 v175, v28
    s_branch Sf_mkb0_r
Sf_mkb1:
    s_cmp_lg_u32 s57, 32
    s_cbranch_scc1 Sf_mkb1_all
    v_cndmask_b32 v176, v28, v176, s[62:63]
    v_cndmask_b32 v177, v28, v177, s[64:65]
    v_cndmask_b32 v178, v28, v178, s[66:67]
    v_cndmask_b32 v179, v28, v179, s[68:69]
    v_mov_b32 v184, v28
    v_mov_b32 v185, v28
    v_mov_b32 v186, v28
    v_mov_b32 v187, v28
    v_cndmask_b32 v188, v28, v188, s[62:63]
    v_cndmask_b32 v189, v28, v189, s[64:65]
    v_cndmask_b32 v190, v28, v190, s[66:67]
    v_cndmask_b32 v191, v28, v191, s[68:69]
    s_branch Sf_mkb1_r
Sf_mkb1_all:
    v_mov_b32 v176, v28
    v_mov_b32 v177, v28
    v_mov_b32 v178, v28
    v_mov_b32 v179, v28
    v_mov_b32 v180, v28
    v_mov_b32 v181, v28
    v_mov_b32 v182, v28
    v_mov_b32 v183, v28
    v_mov_b32 v184, v28
    v_mov_b32 v185, v28
    v_mov_b32 v186, v28
    v_mov_b32 v187, v28
    v_mov_b32 v188, v28
    v_mov_b32 v189, v28
    v_mov_b32 v190, v28
    v_mov_b32 v191, v28
    s_branch Sf_mkb1_r
Sf_rdb:
    s_call_b64 s[60:61], K2_REDO_b
    s_branch Sf_rdb_r
TL_rdb:
    s_call_b64 s[60:61], K2_REDO_b
    s_branch TL_rdb_r
K2_REDO_a:
    s_nop 7
    v_max3_f32 v29, v128, v129, v130
    v_max3_f32 v29, v29, v131, v136
    v_max3_f32 v29, v29, v137, v138
    v_max3_f32 v29, v29, v139, v144
    v_max3_f32 v29, v29, v145, v146
    v_max3_f32 v29, v29, v147, v152
    v_max3_f32 v29, v29, v153, v154
    v_max_f32 v29, v29, v155
    v_mov_b32 v30, v29
    s_nop 1
    v_permlane16_swap_b32 v30, v29
    v_max_f32 v29, v29, v30
    v_mov_b32 v30, v29
    s_nop 1
    v_permlane32_swap_b32 v30, v29
    v_max_f32 v29, v29, v30
    v_max_f32 v29, 0, v29
    v_add_f32 v252, v252, v29
    v_sub_f32 v30, 0, v29
    v_exp_f32 v30, v30
    v_sub_f32 v224, 0, v252
    v_sub_f32 v225, 0, v252
    v_sub_f32 v226, 0, v252
    v_sub_f32 v227, 0, v252
    v_mul_f32 v248, v248, v30
    v_sub_f32 v128, v128, v29
    v_sub_f32 v129, v129, v29
    v_sub_f32 v130, v130, v29
    v_sub_f32 v131, v131, v29
    v_sub_f32 v136, v136, v29
    v_sub_f32 v137, v137, v29
    v_sub_f32 v138, v138, v29
    v_sub_f32 v139, v139, v29
    v_sub_f32 v144, v144, v29
    v_sub_f32 v145, v145, v29
    v_sub_f32 v146, v146, v29
    v_sub_f32 v147, v147, v29
    v_sub_f32 v152, v152, v29
    v_sub_f32 v153, v153, v29
    v_sub_f32 v154, v154, v29
    v_sub_f32 v155, v155, v29
    v_accvgpr_read_b32 v0, a0
    v_mul_f32 v0, v0, v30
    v_accvgpr_write_b32 a0, v0
    v_accvgpr_read_b32 v0, a1
    v_mul_f32 v0, v0, v30
    v_accvgpr_write_b32 a1, v0
    v_accvgpr_read_b32 v0, a2
    v_mul_f32 v0, v0, v30
    v_accvgpr_write_b32 a2, v0
    v_accvgpr_read_b32 v0, a3
    v_mul_f32 v0, v0, v30
    v_accvgpr_write_b32 a3, v0
    v_accvgpr_read_b32 v0, a8
    v_mul_f32 v0, v0, v30
    v_accvgpr_write_b32 a8, v0
    v_accvgpr_read_b32 v0, a9
    v_mul_f32 v0, v0, v30
    v_accvgpr_write_b32 a9, v0
    v_accvgpr_read_b32 v0, a10
    v_mul_f32 v0, v0, v30
    v_accvgpr_write_b32 a10, v0
    v_accvgpr_read_b32 v0, a11
    v_mul_f32 v0, v0, v30
    v_accvgpr_write_b32 a11, v0
    v_accvgpr_read_b32 v0, a16
    v_mul_f32 v0, v0, v30
    v_accvgpr_write_b32 a16, v0
    v_accvgpr_read_b32 v0, a17
    v_mul_f32 v0, v0, v30
    v_accvgpr_write_b32 a17, v0
    v_accvgpr_read_b32 v0, a18
    v_mul_f32 v0, v0, v30
    v_accvgpr_write_b32 a18, v0
    v_accvgpr_read_b32 v0, a19
    v_mul_f32 v0, v0, v30
    v_accvgpr_write_b32 a19, v0
    v_accvgpr_read_b32 v0, a24
    v_mul_f32 v0, v0, v30
    v_accvgpr_write_b32 a24, v0
    v_accvgpr_read_b32 v0, a25
    v_mul_f32 v0, v0, v30
    v_accvgpr_write_b32 a25, v0
    v_accvgpr_read_b32 v0, a26
    v_mul_f32 v0, v0, v30
    v_accvgpr_write_b32 a26, v0
    v_accvgpr_read_b32 v0, a27
    v_mul_f32 v0, v0, v30
    v_accvgpr_write_b32 a27, v0
    v_accvgpr_read_b32 v0, a32
    v_mul_f32 v0, v0, v30
    v_accvgpr_write_b32 a32, v0
    v_accvgpr_read_b32 v0, a33
    v_mul_f32 v0, v0, v30
    v_accvgpr_write_b32 a33, v0
    v_accvgpr_read_b32 v0, a34
    v_mul_f32 v0, v0, v30
    v_accvgpr_write_b32 a34, v0
    v_accvgpr_read_b32 v0, a35
    v_mul_f32 v0, v0, v30
    v_accvgpr_write_b32 a35, v0
    v_accvgpr_read_b32 v0, a40
    v_mul_f32 v0, v0, v30
    v_accvgpr_write_b32 a40, v0
    v_accvgpr_read_b32 v0, a41
    v_mul_f32 v0, v0, v30
    v_accvgpr_write_b32 a41, v0
    v_accvgpr_read_b32 v0, a42
    v_mul_f32 v0, v0, v30
    v_accvgpr_write_b32 a42, v0
    v_accvgpr_read_b32 v0, a43
    v_mul_f32 v0, v0, v30
    v_accvgpr_write_b32 a43, v0
    v_accvgpr_read_b32 v0, a48
    v_mul_f32 v0, v0, v30
    v_accvgpr_write_b32 a48, v0
    v_accvgpr_read_b32 v0, a49
    v_mul_f32 v0, v0, v30
    v_accvgpr_write_b32 a49, v0
    v_accvgpr_read_b32 v0, a50
    v_mul_f32 v0, v0, v30
    v_accvgpr_write_b32 a50, v0
    v_accvgpr_read_b32 v0, a51
    v_mul_f32 v0, v0, v30
    v_accvgpr_write_b32 a51, v0
    v_accvgpr_read_b32 v0, a56
    v_mul_f32 v0, v0, v30
    v_accvgpr_write_b32 a56, v0
    v_accvgpr_read_b32 v0, a57
    v_mul_f32 v0, v0, v30
    v_accvgpr_write_b32 a57, v0
    v_accvgpr_read_b32 v0, a58
    v_mul_f32 v0, v0, v30
    v_accvgpr_write_b32 a58, v0
    v_accvgpr_read_b32 v0, a59
    v_mul_f32 v0, v0, v30
    v_accvgpr_write_b32 a59, v0
    v_mov_b32 v12, 0
    v_exp_f32 v29, v128
    v_exp_f32 v30, v129
    v_add_f32 v12, v12, v29
    v_add_f32 v12, v12, v30
    v_cvt_pk_bf16_f32 v32, v29, v30
    v_exp_f32 v29, v130
    v_exp_f32 v30, v131
    v_add_f32 v12, v12, v29
    v_add_f32 v12, v12, v30
    v_cvt_pk_bf16_f32 v33, v29, v30
    v_exp_f32 v29, v136
    v_exp_f32 v30, v137
    v_add_f32 v12, v12, v29
    v_add_f32 v12, v12, v30
    v_cvt_pk_bf16_f32 v34, v29, v30
    v_exp_f32 v29, v138
    v_exp_f32 v30, v139
    v_add_f32 v12, v12, v29
    v_add_f32 v12, v12, v30
    v_cvt_pk_bf16_f32 v35, v29, v30
    v_exp_f32 v29, v144
    v_exp_f32 v30, v145
    v_add_f32 v12, v12, v29
    v_add_f32 v12, v12, v30
    v_cvt_pk_bf16_f32 v36, v29, v30
    v_exp_f32 v29, v146
    v_exp_f32 v30, v147
    v_add_f32 v12, v12, v29
    v_add_f32 v12, v12, v30
    v_cvt_pk_bf16_f32 v37, v29, v30
    v_exp_f32 v29, v152
    v_exp_f32 v30, v153
    v_add_f32 v12, v12, v29
    v_add_f32 v12, v12, v30
    v_cvt_pk_bf16_f32 v38, v29, v30
    v_exp_f32 v29, v154
    v_exp_f32 v30, v155
    v_add_f32 v12, v12, v29
    v_add_f32 v12, v12, v30
    v_cvt_pk_bf16_f32 v39, v29, v30
    v_mov_b32 v30, v12
    s_nop 1
    v_permlane16_swap_b32 v30, v12
    v_add_f32 v12, v12, v30
    v_mov_b32 v30, v12
    s_nop 1
    v_permlane32_swap_b32 v30, v12
    v_add_f32 v12, v12, v30
    v_max3_f32 v29, v132, v133, v134
    v_max3_f32 v29, v29, v135, v140
    v_max3_f32 v29, v29, v141, v142
    v_max3_f32 v29, v29, v143, v148
    v_max3_f32 v29, v29, v149, v150
    v_max3_f32 v29, v29, v151, v156
    v_max3_f32 v29, v29, v157, v158
    v_max_f32 v29, v29, v159
    v_mov_b32 v30, v29
    s_nop 1
    v_permlane16_swap_b32 v30, v29
    v_max_f32 v29, v29, v30
    v_mov_b32 v30, v29
    s_nop 1
    v_permlane32_swap_b32 v30, v29
    v_max_f32 v29, v29, v30
    v_max_f32 v29, 0, v29
    v_add_f32 v253, v253, v29
    v_sub_f32 v30, 0, v29
    v_exp_f32 v30, v30
    v_sub_f32 v228, 0, v253
    v_sub_f32 v229, 0, v253
    v_sub_f32 v230, 0, v253
    v_sub_f32 v231, 0, v253
    v_mul_f32 v249, v249, v30
    v_sub_f32 v132, v132, v29
    v_sub_f32 v133, v133, v29
    v_sub_f32 v134, v134, v29
    v_sub_f32 v135, v135, v29
    v_sub_f32 v140, v140, v29
    v_sub_f32 v141, v141, v29
    v_sub_f32 v142, v142, v29
    v_sub_f32 v143, v143, v29
    v_sub_f32 v148, v148, v29
    v_sub_f32 v149, v149, v29
    v_sub_f32 v150, v150, v29
    v_sub_f32 v151, v151, v29
    v_sub_f32 v156, v156, v29
    v_sub_f32 v157, v157, v29
    v_sub_f32 v158, v158, v29
    v_sub_f32 v159, v159, v29
    v_accvgpr_read_b32 v0, a4
    v_mul_f32 v0, v0, v30
    v_accvgpr_write_b32 a4, v0
    v_accvgpr_read_b32 v0, a5
    v_mul_f32 v0, v0, v30
    v_accvgpr_write_b32 a5, v0
    v_accvgpr_read_b32 v0, a6
    v_mul_f32 v0, v0, v30
    v_accvgpr_write_b32 a6, v0
    v_accvgpr_read_b32 v0, a7
    v_mul_f32 v0, v0, v30
    v_accvgpr_write_b32 a7, v0
    v_accvgpr_read_b32 v0, a12
    v_mul_f32 v0, v0, v30
    v_accvgpr_write_b32 a12, v0
    v_accvgpr_read_b32 v0, a13
    v_mul_f32 v0, v0, v30
    v_accvgpr_write_b32 a13, v0
    v_accvgpr_read_b32 v0, a14
    v_mul_f32 v0, v0, v30
    v_accvgpr_write_b32 a14, v0
    v_accvgpr_read_b32 v0, a15
    v_mul_f32 v0, v0, v30
    v_accvgpr_write_b32 a15, v0
    v_accvgpr_read_b32 v0, a20
    v_mul_f32 v0, v0, v30
    v_accvgpr_write_b32 a20, v0
    v_accvgpr_read_b32 v0, a21
    v_mul_f32 v0, v0, v30
    v_accvgpr_write_b32 a21, v0
    v_accvgpr_read_b32 v0, a22
    v_mul_f32 v0, v0, v30
    v_accvgpr_write_b32 a22, v0
    v_accvgpr_read_b32 v0, a23
    v_mul_f32 v0, v0, v30
    v_accvgpr_write_b32 a23, v0
    v_accvgpr_read_b32 v0, a28
    v_mul_f32 v0, v0, v30
    v_accvgpr_write_b32 a28, v0
    v_accvgpr_read_b32 v0, a29
    v_mul_f32 v0, v0, v30
    v_accvgpr_write_b32 a29, v0
    v_accvgpr_read_b32 v0, a30
    v_mul_f32 v0, v0, v30
    v_accvgpr_write_b32 a30, v0
    v_accvgpr_read_b32 v0, a31
    v_mul_f32 v0, v0, v30
    v_accvgpr_write_b32 a31, v0
    v_accvgpr_read_b32 v0, a36
    v_mul_f32 v0, v0, v30
    v_accvgpr_write_b32 a36, v0
    v_accvgpr_read_b32 v0, a37
    v_mul_f32 v0, v0, v30
    v_accvgpr_write_b32 a37, v0
    v_accvgpr_read_b32 v0, a38
    v_mul_f32 v0, v0, v30
    v_accvgpr_write_b32 a38, v0
    v_accvgpr_read_b32 v0, a39
    v_mul_f32 v0, v0, v30
    v_accvgpr_write_b32 a39, v0
    v_accvgpr_read_b32 v0, a44
    v_mul_f32 v0, v0, v30
    v_accvgpr_write_b32 a44, v0
    v_accvgpr_read_b32 v0, a45
    v_mul_f32 v0, v0, v30
    v_accvgpr_write_b32 a45, v0
    v_accvgpr_read_b32 v0, a46
    v_mul_f32 v0, v0, v30
    v_accvgpr_write_b32 a46, v0
    v_accvgpr_read_b32 v0, a47
    v_mul_f32 v0, v0, v30
    v_accvgpr_write_b32 a47, v0
    v_accvgpr_read_b32 v0, a52
    v_mul_f32 v0, v0, v30
    v_accvgpr_write_b32 a52, v0
    v_accvgpr_read_b32 v0, a53
    v_mul_f32 v0, v0, v30
    v_accvgpr_write_b32 a53, v0
    v_accvgpr_read_b32 v0, a54
    v_mul_f32 v0, v0, v30
    v_accvgpr_write_b32 a54, v0
    v_accvgpr_read_b32 v0, a55
    v_mul_f32 v0, v0, v30
    v_accvgpr_write_b32 a55, v0
    v_accvgpr_read_b32 v0, a60
    v_mul_f32 v0, v0, v30
    v_accvgpr_write_b32 a60, v0
    v_accvgpr_read_b32 v0, a61
    v_mul_f32 v0, v0, v30
    v_accvgpr_write_b32 a61, v0
    v_accvgpr_read_b32 v0, a62
    v_mul_f32 v0, v0, v30
    v_accvgpr_write_b32 a62, v0
    v_accvgpr_read_b32 v0, a63
    v_mul_f32 v0, v0, v30
    v_accvgpr_write_b32 a63, v0
    v_mov_b32 v16, 0
    v_exp_f32 v29, v132
    v_exp_f32 v30, v133
    v_add_f32 v16, v16, v29
    v_add_f32 v16, v16, v30
    v_cvt_pk_bf16_f32 v40, v29, v30
    v_exp_f32 v29, v134
    v_exp_f32 v30, v135
    v_add_f32 v16, v16, v29
    v_add_f32 v16, v16, v30
    v_cvt_pk_bf16_f32 v41, v29, v30
    v_exp_f32 v29, v140
    v_exp_f32 v30, v141
    v_add_f32 v16, v16, v29
    v_add_f32 v16, v16, v30
    v_cvt_pk_bf16_f32 v42, v29, v30
    v_exp_f32 v29, v142
    v_exp_f32 v30, v143
    v_add_f32 v16, v16, v29
    v_add_f32 v16, v16, v30
    v_cvt_pk_bf16_f32 v43, v29, v30
    v_exp_f32 v29, v148
    v_exp_f32 v30, v149
    v_add_f32 v16, v16, v29
    v_add_f32 v16, v16, v30
    v_cvt_pk_bf16_f32 v44, v29, v30
    v_exp_f32 v29, v150
    v_exp_f32 v30, v151
    v_add_f32 v16, v16, v29
    v_add_f32 v16, v16, v30
    v_cvt_pk_bf16_f32 v45, v29, v30
    v_exp_f32 v29, v156
    v_exp_f32 v30, v157
    v_add_f32 v16, v16, v29
    v_add_f32 v16, v16, v30
    v_cvt_pk_bf16_f32 v46, v29, v30
    v_exp_f32 v29, v158
    v_exp_f32 v30, v159
    v_add_f32 v16, v16, v29
    v_add_f32 v16, v16, v30
    v_cvt_pk_bf16_f32 v47, v29, v30
    v_mov_b32 v30, v16
    s_nop 1
    v_permlane16_swap_b32 v30, v16
    v_add_f32 v16, v16, v30
    v_mov_b32 v30, v16
    s_nop 1
    v_permlane32_swap_b32 v30, v16
    v_add_f32 v16, v16, v30
    s_nop 1
    s_setpc_b64 s[60:61]
K2_REDO_b:
    s_nop 7
    v_max3_f32 v29, v160, v161, v162
    v_max3_f32 v29, v29, v163, v168
    v_max3_f32 v29, v29, v169, v170
    v_max3_f32 v29, v29, v171, v176
    v_max3_f32 v29, v29, v177, v178
    v_max3_f32 v29, v29, v179, v184
    v_max3_f32 v29, v29, v185, v186
    v_max_f32 v29, v29, v187
    v_mov_b32 v30, v29
    s_nop 1
    v_permlane16_swap_b32 v30, v29
    v_max_f32 v29, v29, v30
    v_mov_b32 v30, v29
    s_nop 1
    v_permlane32_swap_b32 v30, v29
    v_max_f32 v29, v29, v30
    v_max_f32 v29, 0, v29
    v_add_f32 v254, v254, v29
    v_sub_f32 v30, 0, v29
    v_exp_f32 v30, v30
    v_sub_f32 v232, 0, v254
    v_sub_f32 v233, 0, v254
    v_sub_f32 v234, 0, v254
    v_sub_f32 v235, 0, v254
    v_mul_f32 v250, v250, v30
    v_sub_f32 v160, v160, v29
    v_sub_f32 v161, v161, v29
    v_sub_f32 v162, v162, v29
    v_sub_f32 v163, v163, v29
    v_sub_f32 v168, v168, v29
    v_sub_f32 v169, v169, v29
    v_sub_f32 v170, v170, v29
    v_sub_f32 v171, v171, v29
    v_sub_f32 v176, v176, v29
    v_sub_f32 v177, v177, v29
    v_sub_f32 v178, v178, v29
    v_sub_f32 v179, v179, v29
    v_sub_f32 v184, v184, v29
    v_sub_f32 v185, v185, v29
    v_sub_f32 v186, v186, v29
    v_sub_f32 v187, v187, v29
    v_accvgpr_read_b32 v0, a64
    v_mul_f32 v0, v0, v30
    v_accvgpr_write_b32 a64, v0
    v_accvgpr_read_b32 v0, a65
    v_mul_f32 v0, v0, v30
    v_accvgpr_write_b32 a65, v0
    v_accvgpr_read_b32 v0, a66
    v_mul_f32 v0, v0, v30
    v_accvgpr_write_b32 a66, v0
    v_accvgpr_read_b32 v0, a67
    v_mul_f32 v0, v0, v30
    v_accvgpr_write_b32 a67, v0
    v_accvgpr_read_b32 v0, a72
    v_mul_f32 v0, v0, v30
    v_accvgpr_write_b32 a72, v0
    v_accvgpr_read_b32 v0, a73
    v_mul_f32 v0, v0, v30
    v_accvgpr_write_b32 a73, v0
    v_accvgpr_read_b32 v0, a74
    v_mul_f32 v0, v0, v30
    v_accvgpr_write_b32 a74, v0
    v_accvgpr_read_b32 v0, a75
    v_mul_f32 v0, v0, v30
    v_accvgpr_write_b32 a75, v0
    v_accvgpr_read_b32 v0, a80
    v_mul_f32 v0, v0, v30
    v_accvgpr_write_b32 a80, v0
    v_accvgpr_read_b32 v0, a81
    v_mul_f32 v0, v0, v30
    v_accvgpr_write_b32 a81, v0
    v_accvgpr_read_b32 v0, a82
    v_mul_f32 v0, v0, v30
    v_accvgpr_write_b32 a82, v0
    v_accvgpr_read_b32 v0, a83
    v_mul_f32 v0, v0, v30
    v_accvgpr_write_b32 a83, v0
    v_accvgpr_read_b32 v0, a88
    v_mul_f32 v0, v0, v30
    v_accvgpr_write_b32 a88, v0
    v_accvgpr_read_b32 v0, a89
    v_mul_f32 v0, v0, v30
    v_accvgpr_write_b32 a89, v0
    v_accvgpr_read_b32 v0, a90
    v_mul_f32 v0, v0, v30
    v_accvgpr_write_b32 a90, v0
    v_accvgpr_read_b32 v0, a91
    v_mul_f32 v0, v0, v30
    v_accvgpr_write_b32 a91, v0
    v_accvgpr_read_b32 v0, a96
    v_mul_f32 v0, v0, v30
    v_accvgpr_write_b32 a96, v0
    v_accvgpr_read_b32 v0, a97
    v_mul_f32 v0, v0, v30
    v_accvgpr_write_b32 a97, v0
    v_accvgpr_read_b32 v0, a98
    v_mul_f32 v0, v0, v30
    v_accvgpr_write_b32 a98, v0
    v_accvgpr_read_b32 v0, a99
    v_mul_f32 v0, v0, v30
    v_accvgpr_write_b32 a99, v0
    v_accvgpr_read_b32 v0, a104
    v_mul_f32 v0, v0, v30
    v_accvgpr_write_b32 a104, v0
    v_accvgpr_read_b32 v0, a105
    v_mul_f32 v0, v0, v30
    v_accvgpr_write_b32 a105, v0
    v_accvgpr_read_b32 v0, a106
    v_mul_f32 v0, v0, v30
    v_accvgpr_write_b32 a106, v0
    v_accvgpr_read_b32 v0, a107
    v_mul_f32 v0, v0, v30
    v_accvgpr_write_b32 a107, v0
    v_accvgpr_read_b32 v0, a112
    v_mul_f32 v0, v0, v30
    v_accvgpr_write_b32 a112, v0
    v_accvgpr_read_b32 v0, a113
    v_mul_f32 v0, v0, v30
    v_accvgpr_write_b32 a113, v0
    v_accvgpr_read_b32 v0, a114
    v_mul_f32 v0, v0, v30
    v_accvgpr_write_b32 a114, v0
    v_accvgpr_read_b32 v0, a115
    v_mul_f32 v0, v0, v30
    v_accvgpr_write_b32 a115, v0
    v_accvgpr_read_b32 v0, a120
    v_mul_f32 v0, v0, v30
    v_accvgpr_write_b32 a120, v0
    v_accvgpr_read_b32 v0, a121
    v_mul_f32 v0, v0, v30
    v_accvgpr_write_b32 a121, v0
    v_accvgpr_read_b32 v0, a122
    v_mul_f32 v0, v0, v30
    v_accvgpr_write_b32 a122, v0
    v_accvgpr_read_b32 v0, a123
    v_mul_f32 v0, v0, v30
    v_accvgpr_write_b32 a123, v0
    v_mov_b32 v12, 0
    v_exp_f32 v29, v160
    v_exp_f32 v30, v161
    v_add_f32 v12, v12, v29
    v_add_f32 v12, v12, v30
    v_cvt_pk_bf16_f32 v48, v29, v30
    v_exp_f32 v29, v162
    v_exp_f32 v30, v163
    v_add_f32 v12, v12, v29
    v_add_f32 v12, v12, v30
    v_cvt_pk_bf16_f32 v49, v29, v30
    v_exp_f32 v29, v168
    v_exp_f32 v30, v169
    v_add_f32 v12, v12, v29
    v_add_f32 v12, v12, v30
    v_cvt_pk_bf16_f32 v50, v29, v30
    v_exp_f32 v29, v170
    v_exp_f32 v30, v171
    v_add_f32 v12, v12, v29
    v_add_f32 v12, v12, v30
    v_cvt_pk_bf16_f32 v51, v29, v30
    v_exp_f32 v29, v176
    v_exp_f32 v30, v177
    v_add_f32 v12, v12, v29
    v_add_f32 v12, v12, v30
    v_cvt_pk_bf16_f32 v52, v29, v30
    v_exp_f32 v29, v178
    v_exp_f32 v30, v179
    v_add_f32 v12, v12, v29
    v_add_f32 v12, v12, v30
    v_cvt_pk_bf16_f32 v53, v29, v30
    v_exp_f32 v29, v184
    v_exp_f32 v30, v185
    v_add_f32 v12, v12, v29
    v_add_f32 v12, v12, v30
    v_cvt_pk_bf16_f32 v54, v29, v30
    v_exp_f32 v29, v186
    v_exp_f32 v30, v187
    v_add_f32 v12, v12, v29
    v_add_f32 v12, v12, v30
    v_cvt_pk_bf16_f32 v55, v29, v30
    v_mov_b32 v30, v12
    s_nop 1
    v_permlane16_swap_b32 v30, v12
    v_add_f32 v12, v12, v30
    v_mov_b32 v30, v12
    s_nop 1
    v_permlane32_swap_b32 v30, v12
    v_add_f32 v12, v12, v30
    v_max3_f32 v29, v164, v165, v166
    v_max3_f32 v29, v29, v167, v172
    v_max3_f32 v29, v29, v173, v174
    v_max3_f32 v29, v29, v175, v180
    v_max3_f32 v29, v29, v181, v182
    v_max3_f32 v29, v29, v183, v188
    v_max3_f32 v29, v29, v189, v190
    v_max_f32 v29, v29, v191
    v_mov_b32 v30, v29
    s_nop 1
    v_permlane16_swap_b32 v30, v29
    v_max_f32 v29, v29, v30
    v_mov_b32 v30, v29
    s_nop 1
    v_permlane32_swap_b32 v30, v29
    v_max_f32 v29, v29, v30
    v_max_f32 v29, 0, v29
    v_add_f32 v255, v255, v29
    v_sub_f32 v30, 0, v29
    v_exp_f32 v30, v30
    v_sub_f32 v236, 0, v255
    v_sub_f32 v237, 0, v255
    v_sub_f32 v238, 0, v255
    v_sub_f32 v239, 0, v255
    v_mul_f32 v251, v251, v30
    v_sub_f32 v164, v164, v29
    v_sub_f32 v165, v165, v29
    v_sub_f32 v166, v166, v29
    v_sub_f32 v167, v167, v29
    v_sub_f32 v172, v172, v29
    v_sub_f32 v173, v173, v29
    v_sub_f32 v174, v174, v29
    v_sub_f32 v175, v175, v29
    v_sub_f32 v180, v180, v29
    v_sub_f32 v181, v181, v29
    v_sub_f32 v182, v182, v29
    v_sub_f32 v183, v183, v29
    v_sub_f32 v188, v188, v29
    v_sub_f32 v189, v189, v29
    v_sub_f32 v190, v190, v29
    v_sub_f32 v191, v191, v29
    v_accvgpr_read_b32 v0, a68
    v_mul_f32 v0, v0, v30
    v_accvgpr_write_b32 a68, v0
    v_accvgpr_read_b32 v0, a69
    v_mul_f32 v0, v0, v30
    v_accvgpr_write_b32 a69, v0
    v_accvgpr_read_b32 v0, a70
    v_mul_f32 v0, v0, v30
    v_accvgpr_write_b32 a70, v0
    v_accvgpr_read_b32 v0, a71
    v_mul_f32 v0, v0, v30
    v_accvgpr_write_b32 a71, v0
    v_accvgpr_read_b32 v0, a76
    v_mul_f32 v0, v0, v30
    v_accvgpr_write_b32 a76, v0
    v_accvgpr_read_b32 v0, a77
    v_mul_f32 v0, v0, v30
    v_accvgpr_write_b32 a77, v0
    v_accvgpr_read_b32 v0, a78
    v_mul_f32 v0, v0, v30
    v_accvgpr_write_b32 a78, v0
    v_accvgpr_read_b32 v0, a79
    v_mul_f32 v0, v0, v30
    v_accvgpr_write_b32 a79, v0
    v_accvgpr_read_b32 v0, a84
    v_mul_f32 v0, v0, v30
    v_accvgpr_write_b32 a84, v0
    v_accvgpr_read_b32 v0, a85
    v_mul_f32 v0, v0, v30
    v_accvgpr_write_b32 a85, v0
    v_accvgpr_read_b32 v0, a86
    v_mul_f32 v0, v0, v30
    v_accvgpr_write_b32 a86, v0
    v_accvgpr_read_b32 v0, a87
    v_mul_f32 v0, v0, v30
    v_accvgpr_write_b32 a87, v0
    v_accvgpr_read_b32 v0, a92
    v_mul_f32 v0, v0, v30
    v_accvgpr_write_b32 a92, v0
    v_accvgpr_read_b32 v0, a93
    v_mul_f32 v0, v0, v30
    v_accvgpr_write_b32 a93, v0
    v_accvgpr_read_b32 v0, a94
    v_mul_f32 v0, v0, v30
    v_accvgpr_write_b32 a94, v0
    v_accvgpr_read_b32 v0, a95
    v_mul_f32 v0, v0, v30
    v_accvgpr_write_b32 a95, v0
    v_accvgpr_read_b32 v0, a100
    v_mul_f32 v0, v0, v30
    v_accvgpr_write_b32 a100, v0
    v_accvgpr_read_b32 v0, a101
    v_mul_f32 v0, v0, v30
    v_accvgpr_write_b32 a101, v0
    v_accvgpr_read_b32 v0, a102
    v_mul_f32 v0, v0, v30
    v_accvgpr_write_b32 a102, v0
    v_accvgpr_read_b32 v0, a103
    v_mul_f32 v0, v0, v30
    v_accvgpr_write_b32 a103, v0
    v_accvgpr_read_b32 v0, a108
    v_mul_f32 v0, v0, v30
    v_accvgpr_write_b32 a108, v0
    v_accvgpr_read_b32 v0, a109
    v_mul_f32 v0, v0, v30
    v_accvgpr_write_b32 a109, v0
    v_accvgpr_read_b32 v0, a110
    v_mul_f32 v0, v0, v30
    v_accvgpr_write_b32 a110, v0
    v_accvgpr_read_b32 v0, a111
    v_mul_f32 v0, v0, v30
    v_accvgpr_write_b32 a111, v0
    v_accvgpr_read_b32 v0, a116
    v_mul_f32 v0, v0, v30
    v_accvgpr_write_b32 a116, v0
    v_accvgpr_read_b32 v0, a117
    v_mul_f32 v0, v0, v30
    v_accvgpr_write_b32 a117, v0
    v_accvgpr_read_b32 v0, a118
    v_mul_f32 v0, v0, v30
    v_accvgpr_write_b32 a118, v0
    v_accvgpr_read_b32 v0, a119
    v_mul_f32 v0, v0, v30
    v_accvgpr_write_b32 a119, v0
    v_accvgpr_read_b32 v0, a124
    v_mul_f32 v0, v0, v30
    v_accvgpr_write_b32 a124, v0
    v_accvgpr_read_b32 v0, a125
    v_mul_f32 v0, v0, v30
    v_accvgpr_write_b32 a125, v0
    v_accvgpr_read_b32 v0, a126
    v_mul_f32 v0, v0, v30
    v_accvgpr_write_b32 a126, v0
    v_accvgpr_read_b32 v0, a127
    v_mul_f32 v0, v0, v30
    v_accvgpr_write_b32 a127, v0
    v_mov_b32 v16, 0
    v_exp_f32 v29, v164
    v_exp_f32 v30, v165
    v_add_f32 v16, v16, v29
    v_add_f32 v16, v16, v30
    v_cvt_pk_bf16_f32 v56, v29, v30
    v_exp_f32 v29, v166
    v_exp_f32 v30, v167
    v_add_f32 v16, v16, v29
    v_add_f32 v16, v16, v30
    v_cvt_pk_bf16_f32 v57, v29, v30
    v_exp_f32 v29, v172
    v_exp_f32 v30, v173
    v_add_f32 v16, v16, v29
    v_add_f32 v16, v16, v30
    v_cvt_pk_bf16_f32 v58, v29, v30
    v_exp_f32 v29, v174
    v_exp_f32 v30, v175
    v_add_f32 v16, v16, v29
    v_add_f32 v16, v16, v30
    v_cvt_pk_bf16_f32 v59, v29, v30
    v_exp_f32 v29, v180
    v_exp_f32 v30, v181
    v_add_f32 v16, v16, v29
    v_add_f32 v16, v16, v30
    v_cvt_pk_bf16_f32 v60, v29, v30
    v_exp_f32 v29, v182
    v_exp_f32 v30, v183
    v_add_f32 v16, v16, v29
    v_add_f32 v16, v16, v30
    v_cvt_pk_bf16_f32 v61, v29, v30
    v_exp_f32 v29, v188
    v_exp_f32 v30, v189
    v_add_f32 v16, v16, v29
    v_add_f32 v16, v16, v30
    v_cvt_pk_bf16_f32 v62, v29, v30
    v_exp_f32 v29, v190
    v_exp_f32 v30, v191
    v_add_f32 v16, v16, v29
    v_add_f32 v16, v16, v30
    v_cvt_pk_bf16_f32 v63, v29, v30
    v_mov_b32 v30, v16
    s_nop 1
    v_permlane16_swap_b32 v30, v16
    v_add_f32 v16, v16, v30
    v_mov_b32 v30, v16
    s_nop 1
    v_permlane32_swap_b32 v30, v16
    v_add_f32 v16, v16, v30
    s_nop 1
    s_setpc_b64 s[60:61]
K2_KVSPIN_E:
    s_mov_b32 s58, 0x40000
K2_KVSPIN:
    buffer_load_dword v25, v26, s[4:7], s52 offen sc1
    s_waitcnt vmcnt(0)
    v_cmp_ne_u32 vcc, 1, v25
    s_cbranch_vccz K2_KVSPIN_ok
    s_sleep 1
    s_sub_u32 s58, s58, 1
    s_cbranch_scc0 K2_KVSPIN
K2_KVSPIN_ok:
    s_branch K2_KVOK
K2_KVBSPIN_E:
    s_mov_b32 s58, 0x40000
K2_KVBSPIN:
    buffer_load_dword v25, v26, s[4:7], s52 offen sc1
    s_waitcnt vmcnt(0)
    v_cmp_ne_u32 vcc, 1, v25
    s_cbranch_vccz K2_KVBSPIN_ok
    s_sleep 1
    s_sub_u32 s58, s58, 1
    s_cbranch_scc0 K2_KVBSPIN
K2_KVBSPIN_ok:
    s_branch K2_KVBOK
K1_LNSPIN_E:
    s_mov_b32 s59, 0x40000
K1_LNSPIN:
    buffer_load_dword v27, v25, s[68:71], 0 offen sc1
    s_waitcnt vmcnt(0)
    v_cmp_gt_u32 vcc, s60, v27
    s_cbranch_vccz K1_LNSPIN_ok
    s_sleep 1
    s_sub_u32 s59, s59, 1
    s_cbranch_scc0 K1_LNSPIN
K1_LNSPIN_ok:
    s_branch K1_LNOK
K3_ASPIN_E:
    s_mov_b32 s39, 0x40000
K3_ASPIN:
    buffer_load_dword v198, v197, s[4:7], s52 offen sc1
    s_waitcnt vmcnt(0)
    v_cmp_ne_u32 vcc, 1, v198
    s_cbranch_vccz K3_ASPIN_ok
    s_sleep 1
    s_sub_u32 s39, s39, 1
    s_cbranch_scc0 K3_ASPIN
K3_ASPIN_ok:
    s_branch K3_AOK
K3_CSPIN_E:
    s_mov_b32 s39, 0x40000
K3_CSPIN:
    buffer_load_dword v198, v197, s[4:7], s51 offen sc1
    s_waitcnt vmcnt(0)
    v_cmp_ne_u32 vcc, 1, v198
    s_cbranch_vccz K3_CSPIN_ok
    s_sleep 1
    s_sub_u32 s39, s39, 1
    s_cbranch_scc0 K3_CSPIN
K3_CSPIN_ok:
    s_branch K3_COK
K3_DSPIN_E:
    s_mov_b32 s39, 0x40000
K3_DSPIN:
    buffer_load_dword v198, v197, s[4:7], s51 offen sc1
    s_waitcnt vmcnt(0)
    v_cmp_ne_u32 vcc, 1, v198
    s_cbranch_vccz K3_DSPIN_ok
    s_sleep 1
    s_sub_u32 s39, s39, 1
    s_cbranch_scc0 K3_DSPIN
K3_DSPIN_ok:
    s_branch K3_DOK
K3_PSPIN_E:
    s_mov_b32 s39, 0x40000
K3_PSPIN:
    buffer_load_dword v198, v197, s[4:7], s51 offen sc1
    s_waitcnt vmcnt(0)
    v_cmp_ne_u32 vcc, 1, v198
    s_cbranch_vccz K3_PSPIN_ok
    s_sleep 1
    s_sub_u32 s39, s39, 1
    s_cbranch_scc0 K3_PSPIN
K3_PSPIN_ok:
    s_branch K3_POK
.fill 8192, 4, 0xbf800000
.section .rodata,"a"
.p2align 6
.amdhsa_kernel parallel_sum__compressed_kv_cla__dense_activation_mish__prompt_kernel
  .amdhsa_next_free_vgpr 512
  .amdhsa_next_free_sgpr 102
  .amdhsa_accum_offset 256
  .amdhsa_group_segment_fixed_size 0
  .amdhsa_kernarg_size 104
  .amdhsa_user_sgpr_count 2
  .amdhsa_user_sgpr_kernarg_segment_ptr 1
  .amdhsa_system_sgpr_workgroup_id_x 1
.end_amdhsa_kernel
```
